```python
import torch

def _softmax(x, axis=-1):
    return torch.softmax(x, dim=axis)
def _gelu(x):
    return torch.nn.functional.gelu(x, approximate="tanh")
def _silu(x):
    return torch.nn.functional.silu(x)
def _sigmoid(x):
    return torch.sigmoid(x)
def _layernorm(x, axis=-1, eps=1e-5):
    m = x.mean(dim=axis, keepdim=True)
    v = x.var(dim=axis, keepdim=True, unbiased=False)
    return (x - m) / torch.sqrt(v + eps)
def _scatter_add(tgt, idx, src, axis=0):
    return tgt.clone().index_add_(axis, idx, src)
def _segment_sum(src, seg, n):
    out = torch.zeros((n,) + src.shape[1:], dtype=src.dtype)
    return out.index_add_(0, seg, src)
def _pad(x, pw):
    flat = tuple(v for pair in reversed(pw) for v in pair)
    return torch.nn.functional.pad(x, flat)

kernel_name = 'concat_heads__mha_block_cached__gqa_block_cached__near_ridge'

def setup_inputs():

    _w = (lambda a: (lambda t: t.to(torch.bfloat16) if t.is_floating_point() else t)(torch.as_tensor(a)))
    def _A_setup():
        B, Sq, D = 8, 240, 576
        H, Sk, Dh = 32, 1024, 128
        return {
            "x": _w((lambda *s: torch.randn(*s, dtype=torch.bfloat16) * 0.8)(B, Sq, D)),
            "k_cache": _w((lambda *s: torch.randn(*s, dtype=torch.bfloat16) * 0.8)(B, H, Sk, Dh)),
            "v_cache": _w((lambda *s: torch.randn(*s, dtype=torch.bfloat16) * 0.05)(B, H, Sk, Dh)),
            "wq": _w((lambda *s: torch.randn(*s, dtype=torch.bfloat16) * 0.8)(D, H * Dh) * (D ** -0.5)),
            "wo": _w((lambda *s: torch.randn(*s, dtype=torch.bfloat16) * 0.05)(H * Dh, D) * ((H * Dh) ** -0.5)),
        }
    _A_in = _A_setup()

    def _B_setup():
        B, Sq, D = 8, 240, 576
        Hq, Hkv, Sk, Dh = 32, 32, 1024, 128
        assert Hq % Hkv == 0, (Hq, Hkv)
        return {
            "x": _w((lambda *s: torch.randn(*s, dtype=torch.bfloat16) * 0.8)(B, Sq, D)),
            "k_cache": _w((lambda *s: torch.randn(*s, dtype=torch.bfloat16) * 0.8)(B, Hkv, Sk, Dh)),
            "v_cache": _w((lambda *s: torch.randn(*s, dtype=torch.bfloat16) * 0.05)(B, Hkv, Sk, Dh)),
            "wq": _w((lambda *s: torch.randn(*s, dtype=torch.bfloat16) * 0.8)(D, Hq * Dh) * (D ** -0.5)),
            "wo": _w((lambda *s: torch.randn(*s, dtype=torch.bfloat16) * 0.05)(Hq * Dh, D) * ((Hq * Dh) ** -0.5)),
        }
    _B_in = _B_setup()

    return {
        "A_x": _A_in["x"],
        "A_k_cache": _A_in["k_cache"],
        "A_v_cache": _A_in["v_cache"],
        "A_wq": _A_in["wq"],
        "A_wo": _A_in["wo"],
        "B_x": _B_in["x"],
        "B_k_cache": _B_in["k_cache"],
        "B_v_cache": _B_in["v_cache"],
        "B_wq": _B_in["wq"],
        "B_wo": _B_in["wo"],
    }

def reference(A_x, A_k_cache, A_v_cache, A_wq, A_wo, B_x, B_k_cache, B_v_cache, B_wq, B_wo):
    def _A_ref(x, k_cache, v_cache, wq, wo):
        B, Sq, D = x.shape
        H, Dh = 32, 128
        q = (lambda x, *d: x.permute(*d))((x @ wq).reshape(B, Sq, H, Dh), 0, 2, 1, 3)
        scores = torch.einsum("bhqd,bhkd->bhqk", q, k_cache) * (Dh ** -0.5)
        p = _softmax(scores, axis=-1)
        o = torch.einsum("bhqk,bhkd->bhqd", p, v_cache)
        return (lambda x, *d: x.permute(*d))(o, 0, 2, 1, 3).reshape(B, Sq, H * Dh) @ wo

    def _B_ref(x, k_cache, v_cache, wq, wo):
        B, Sq, D = x.shape
        Hq, Dh = 32, 128
        Hkv = k_cache.shape[1]
        rep = Hq // Hkv
        q = (lambda x, *d: x.permute(*d))((x @ wq).reshape(B, Sq, Hq, Dh), 0, 2, 1, 3)
        k = (lambda x, n, axis: torch.repeat_interleave(x, n, dim=axis))(k_cache, rep, axis=1)
        v = (lambda x, n, axis: torch.repeat_interleave(x, n, dim=axis))(v_cache, rep, axis=1)
        scores = torch.einsum("bhqd,bhkd->bhqk", q, k) * (Dh ** -0.5)
        p = _softmax(scores, axis=-1)
        o = torch.einsum("bhqk,bhkd->bhqd", p, v)
        return (lambda x, *d: x.permute(*d))(o, 0, 2, 1, 3).reshape(B, Sq, Hq * Dh) @ wo

    a = _A_ref(A_x, A_k_cache, A_v_cache, A_wq, A_wo)
    b = _B_ref(B_x, B_k_cache, B_v_cache, B_wq, B_wo)
    return torch.concatenate([a, b], axis=-1)
```

```asm
; @launch grid=(256,1,1) block=(256,1,1) lds=163840
.amdgcn_target "amdgcn-amd-amdhsa--gfx950"
.text
.globl concat_heads__mha_block_cached__gqa_block_cached__near_ridge_kernel
.p2align 8
.type concat_heads__mha_block_cached__gqa_block_cached__near_ridge_kernel,@function
concat_heads__mha_block_cached__gqa_block_cached__near_ridge_kernel:
    s_cmp_ge_u32 s2, 256
    s_cbranch_scc1 L_end
    s_and_b32 s3, s2, 7
    s_lshr_b32 s4, s2, 3
    s_lshr_b32 s40, s3, 2
    s_mul_i32 s5, s40, 40
    s_add_u32 s6, s0, s5
    s_addc_u32 s7, s1, 0
    s_load_dwordx8 s[56:63], s[6:7], 0
    s_load_dwordx2 s[94:95], s[6:7], 32
    s_load_dwordx4 s[96:99], s[0:1], 80
    s_load_dwordx2 s[50:51], s[0:1], 96
    s_and_b32 s52, s3, 3
    s_and_b32 s53, s4, 3
    s_lshr_b32 s42, s4, 2
    s_lshl_b32 s3, s52, 2
    s_add_u32 s41, s3, s53
    v_lshrrev_b32 v1, 6, v0
    v_and_b32 v0, 63, v0
    v_readfirstlane_b32 s43, v1
    v_and_b32 v1, 15, v0
    v_lshrrev_b32 v2, 4, v0
    s_lshl_b32 s48, s43, 13
    s_getpc_b64 s[80:81]
L_pc:
    s_sub_u32 s80, s80, L_pc-concat_heads__mha_block_cached__gqa_block_cached__near_ridge_kernel
    s_subb_u32 s81, s81, 0
    s_mov_b32 s82, L_end-concat_heads__mha_block_cached__gqa_block_cached__near_ridge_kernel
    s_mov_b32 s83, 0x20000
    s_lshr_b32 s3, s2, 3
    s_lshl_b32 s3, s3, 2
    s_add_u32 s3, s3, s43
    s_lshl_b32 s3, s3, 8
    s_add_u32 s3, s3, 0
    v_lshlrev_b32 v31, 7, v0
    s_mov_b64 exec, 3
    buffer_load_dword v31, v31, s[80:83], s3 offen
    s_mov_b64 exec, -1
    s_mul_i32 s3, s43, 73728
    v_lshrrev_b32 v3, 3, v0
    v_mul_u32_u24 v3, 1152, v3
    v_add_u32 v3, s3, v3
    v_and_b32 v4, 7, v0
    v_xor_b32 v4, v4, v2
    v_lshl_add_u32 v32, v4, 4, v3
    v_xor_b32 v4, 4, v4
    v_lshl_add_u32 v33, v4, 4, v3
    s_add_u32 s3, s52, 3
    s_and_b32 s3, s3, 3
    s_mul_i32 s3, s3, 18432
    s_add_u32 s4, s3, 8192
    v_add_u32 v39, s4, v33
    s_add_u32 s4, s3, 0
    v_add_u32 v38, s4, v32
    s_add_u32 s3, s52, 2
    s_and_b32 s3, s3, 3
    s_mul_i32 s3, s3, 18432
    s_add_u32 s4, s3, 8192
    v_add_u32 v37, s4, v33
    s_add_u32 s4, s3, 0
    v_add_u32 v36, s4, v32
    s_add_u32 s3, s52, 1
    s_and_b32 s3, s3, 3
    s_mul_i32 s3, s3, 18432
    s_add_u32 s4, s3, 8192
    v_add_u32 v35, s4, v33
    s_add_u32 s4, s3, 0
    v_add_u32 v34, s4, v32
    s_add_u32 s3, s52, 0
    s_and_b32 s3, s3, 3
    s_mul_i32 s3, s3, 18432
    s_add_u32 s4, s3, 8192
    v_add_u32 v33, s4, v33
    s_add_u32 s4, s3, 0
    v_add_u32 v32, s4, v32
    s_lshl_b32 s3, s43, 17
    v_lshrrev_b32 v3, 5, v0
    v_lshl_add_u32 v5, v3, 13, s3
    v_and_b32 v4, 31, v0
    v_or_b32 v6, 0, v3
    v_lshlrev_b32 v6, 1, v6
    v_xor_b32 v6, v6, v4
    v_lshl_add_u32 v6, v6, 4, v5
    v_add_u32 v40, 0, v6
    v_or_b32 v6, 2, v3
    v_lshlrev_b32 v6, 1, v6
    v_xor_b32 v6, v6, v4
    v_lshl_add_u32 v6, v6, 4, v5
    v_add_u32 v41, 15360, v6
    v_or_b32 v6, 0, v3
    v_lshlrev_b32 v6, 1, v6
    v_xor_b32 v6, v6, v4
    v_lshl_add_u32 v6, v6, 4, v5
    v_add_u32 v42, 30720, v6
    v_or_b32 v6, 2, v3
    v_lshlrev_b32 v6, 1, v6
    v_xor_b32 v6, v6, v4
    v_lshl_add_u32 v6, v6, 4, v5
    v_add_u32 v43, 46080, v6
    v_or_b32 v6, 4, v3
    v_lshlrev_b32 v6, 1, v6
    v_xor_b32 v6, v6, v4
    v_lshl_add_u32 v6, v6, 4, v5
    v_add_u32 v44, 65536, v6
    v_or_b32 v6, 6, v3
    v_lshlrev_b32 v6, 1, v6
    v_xor_b32 v6, v6, v4
    v_lshl_add_u32 v6, v6, 4, v5
    v_add_u32 v45, 80896, v6
    v_or_b32 v6, 4, v3
    v_lshlrev_b32 v6, 1, v6
    v_xor_b32 v6, v6, v4
    v_lshl_add_u32 v6, v6, 4, v5
    v_add_u32 v46, 96256, v6
    v_or_b32 v6, 6, v3
    v_lshlrev_b32 v6, 1, v6
    v_xor_b32 v6, v6, v4
    v_lshl_add_u32 v6, v6, 4, v5
    v_add_u32 v47, 111616, v6
    s_mul_i32 s3, s53, 60
    s_mul_i32 s4, s43, 15
    s_add_u32 s3, s3, s4
    s_mul_i32 s3, s3, 1152
    v_mul_u32_u24 v4, 1152, v0
    v_cmp_gt_u32 vcc, 15, v0
    v_add_u32 v4, s3, v4
    v_add_u32 v5, 4294950144, v4
    v_cndmask_b32 v4, v5, v4, vcc
    v_cmp_gt_u32 vcc, 30, v0
    v_bfrev_b32 v6, 1
    s_lshl_b32 s3, s42, 2
    v_cndmask_b32 v28, v6, v4, vcc
    s_add_u32 s3, s3, s43
    s_lshl_b32 s3, s3, 14
    v_and_b32 v5, 3, v0
    v_lshl_add_u32 v5, v5, 7, s3
    v_bfe_u32 v3, v0, 2, 1
    v_lshl_add_u32 v5, v3, 13, v5
    v_cmp_gt_u32 vcc, 16, v0
    v_lshrrev_b32 v3, 3, v0
    v_lshl_add_u32 v5, v3, 19, v5
    v_cndmask_b32 v26, v6, v5, vcc
    s_waitcnt lgkmcnt(0)
    s_mul_i32 s3, s42, 276480
    s_add_u32 s16, s56, s3
    s_addc_u32 s17, s57, 0
    s_mov_b32 s18, 276480
    s_mov_b32 s19, 0x20000
    s_lshl_b32 s3, s41, 9
    s_add_u32 s20, s62, s3
    s_addc_u32 s21, s63, 0
    s_mov_b32 s22, 0
    s_mov_b32 s23, 0x20000
    s_sub_u32 s22, 4718592, s3
    s_mov_b32 s46, 0
    s_mov_b32 s47, 0
    s_mov_b32 s3, 0
    s_mov_b32 s4, 0
    buffer_load_dword v29, v28, s[16:19], s3 offen nt
    buffer_load_dword v29, v26, s[20:23], s4 offen nt
    s_add_u32 m0, s48, 32768
    s_nop 0
    buffer_load_dwordx4 v32, s[16:19], s46 offen offset:0 lds
    buffer_load_dwordx4 v33, s[16:19], s46 offen offset:1024 lds
    s_add_u32 m0, s48, 34816
    s_nop 0
    buffer_load_dwordx4 v34, s[16:19], s46 offen offset:0 lds
    buffer_load_dwordx4 v35, s[16:19], s46 offen offset:1024 lds
    s_add_u32 m0, s48, 36864
    s_nop 0
    buffer_load_dwordx4 v36, s[16:19], s46 offen offset:0 lds
    buffer_load_dwordx4 v37, s[16:19], s46 offen offset:1024 lds
    s_add_u32 m0, s48, 38912
    s_nop 0
    buffer_load_dwordx4 v38, s[16:19], s46 offen offset:0 lds
    buffer_load_dwordx4 v39, s[16:19], s46 offen offset:1024 lds
    s_add_u32 s46, s46, 128
    s_add_u32 m0, s48, 98304
    s_nop 0
    buffer_load_dwordx4 v40, s[20:23], s47 offen offset:0 lds
    buffer_load_dwordx4 v41, s[20:23], s47 offen offset:1024 lds
    buffer_load_dwordx4 v42, s[20:23], s47 offen offset:2048 lds
    buffer_load_dwordx4 v43, s[20:23], s47 offen offset:3072 lds
    s_add_u32 m0, s48, 102400
    s_nop 0
    buffer_load_dwordx4 v44, s[20:23], s47 offen offset:0 lds
    buffer_load_dwordx4 v45, s[20:23], s47 offen offset:1024 lds
    buffer_load_dwordx4 v46, s[20:23], s47 offen offset:2048 lds
    buffer_load_dwordx4 v47, s[20:23], s47 offen offset:3072 lds
    s_add_u32 s47, s47, 524288
    s_lshl_b32 s3, s42, 5
    s_lshl_b32 s4, s41, 1
    s_add_u32 s3, s3, s4
    s_lshl_b32 s3, s3, 18
    s_add_u32 s8, s58, s3
    s_addc_u32 s9, s59, 0
    s_mov_b32 s10, 524288
    s_mov_b32 s11, 0x20000
    s_add_u32 s12, s60, s3
    s_addc_u32 s13, s61, 0
    s_mov_b32 s14, 524288
    s_mov_b32 s15, 0x20000
    s_mul_i32 s3, s52, 1179648
    s_add_u32 s28, s94, s3
    s_addc_u32 s29, s95, 0
    s_mov_b32 s30, 1179648
    s_mov_b32 s31, 0x20000
    s_lshl_b32 s5, s40, 3
    s_add_u32 s5, s5, s42
    s_lshl_b32 s5, s5, 2
    s_add_u32 s6, s5, s52
    s_add_u32 s7, s5, s53
    s_lshl_b32 s3, s6, 19
    s_add_u32 s24, s50, s3
    s_addc_u32 s25, s51, 0
    s_mov_b32 s26, 524288
    s_mov_b32 s27, 0x20000
    s_mul_i32 s3, s7, 245760
    s_add_u32 s3, s3, 33554432
    s_add_u32 s64, s50, s3
    s_addc_u32 s65, s51, 0
    s_mov_b32 s66, 245760
    s_mov_b32 s67, 0x20000
    s_add_u32 s68, s50, 49283072
    s_addc_u32 s69, s51, 0
    s_mov_b32 s70, 16384
    s_mov_b32 s71, 0x20000
    s_mov_b32 s76, s96
    s_mov_b32 s77, s97
    s_mov_b32 s78, 4423680
    s_mov_b32 s79, 0x20000
    s_mov_b32 s72, s98
    s_mov_b32 s73, s99
    s_mov_b32 s74, 256
    s_mov_b32 s75, 0x20000
    s_lshl_b32 s90, s6, 7
    s_lshl_b32 s91, s7, 7
    s_add_u32 s91, s91, 8192
    s_lshl_b32 s3, s43, 4
    s_add_u32 s90, s90, s3
    s_add_u32 s91, s91, s3
    s_sub_u32 s3, 3, s52
    s_cmp_eq_u32 s43, 3
    s_cselect_b32 s88, s3, 7
    s_mul_i32 s92, s43, 9216
    s_mov_b32 s51, 0
    s_mov_b32 s89, 1
L_go:
    s_mov_b32 s44, 0
    s_mov_b32 s45, 0
    v_lshrrev_b32 v3, 1, v0
    v_and_b32 v3, 7, v3
    v_xor_b32 v3, v3, v2
    v_lshl_add_u32 v4, v1, 7, s48
    v_lshl_add_u32 v6, v3, 4, v4
    v_xor_b32 v3, 4, v3
    v_lshl_add_u32 v7, v3, 4, v4
    v_bfe_u32 v3, v0, 2, 2
    v_lshl_add_u32 v4, v2, 3, v3
    v_lshlrev_b32 v4, 9, v4
    v_add_u32 v4, 0x10000, v4
    v_and_b32 v5, 3, v0
    v_lshl_add_u32 v4, v5, 3, v4
    v_and_b32 v5, 1, v2
    v_lshl_or_b32 v3, v5, 2, v3
    v_xor_b32 v5, 0, v3
    v_lshl_add_u32 v48, v5, 5, v4
    v_xor_b32 v5, 1, v3
    v_lshl_add_u32 v49, v5, 5, v4
    v_xor_b32 v5, 2, v3
    v_lshl_add_u32 v50, v5, 5, v4
    v_xor_b32 v5, 3, v3
    v_lshl_add_u32 v51, v5, 5, v4
    v_xor_b32 v5, 4, v3
    v_lshl_add_u32 v52, v5, 5, v4
    v_xor_b32 v5, 5, v3
    v_lshl_add_u32 v53, v5, 5, v4
    v_xor_b32 v5, 6, v3
    v_lshl_add_u32 v54, v5, 5, v4
    v_xor_b32 v5, 7, v3
    v_lshl_add_u32 v55, v5, 5, v4
    v_add_u32 v56, 0x8000, v48
    v_add_u32 v57, 0x8000, v49
    v_add_u32 v58, 0x8000, v50
    v_add_u32 v59, 0x8000, v51
    v_add_u32 v60, 0x8000, v52
    v_add_u32 v61, 0x8000, v53
    v_add_u32 v62, 0x8000, v54
    v_add_u32 v63, 0x8000, v55
    v_lshrrev_b32 v3, 1, v2
    v_and_b32 v4, 1, v2
    v_lshl_or_b32 v3, v4, 1, v3
    v_or_b32 v4, 0, v3
    v_xor_b32 v4, v4, v1
    v_lshlrev_b32 v4, 4, v4
    v_lshl_add_u32 v8, v1, 8, v4
    v_or_b32 v4, 4, v3
    v_xor_b32 v4, v4, v1
    v_lshlrev_b32 v4, 4, v4
    v_lshl_add_u32 v9, v1, 8, v4
    v_or_b32 v4, 8, v3
    v_xor_b32 v4, v4, v1
    v_lshlrev_b32 v4, 4, v4
    v_lshl_add_u32 v10, v1, 8, v4
    v_or_b32 v4, 12, v3
    v_xor_b32 v4, v4, v1
    v_lshlrev_b32 v4, 4, v4
    v_lshl_add_u32 v11, v1, 8, v4
    v_lshrrev_b32 v4, 2, v0
    v_lshlrev_b32 v5, 8, v4
    v_and_b32 v3, 3, v0
    v_lshl_add_u32 v5, v3, 3, v5
    v_add_u32 v5, 0x10000, v5
    v_and_b32 v4, 7, v4
    v_xor_b32 v3, 0, v4
    v_lshl_add_u32 v12, v3, 5, v5
    v_xor_b32 v3, 1, v4
    v_lshl_add_u32 v13, v3, 5, v5
    v_xor_b32 v3, 2, v4
    v_lshl_add_u32 v14, v3, 5, v5
    v_xor_b32 v3, 3, v4
    v_lshl_add_u32 v15, v3, 5, v5
    v_xor_b32 v3, 4, v4
    v_lshl_add_u32 v16, v3, 5, v5
    v_xor_b32 v3, 5, v4
    v_lshl_add_u32 v17, v3, 5, v5
    v_xor_b32 v3, 6, v4
    v_lshl_add_u32 v18, v3, 5, v5
    v_xor_b32 v3, 7, v4
    v_lshl_add_u32 v19, v3, 5, v5
    s_lshl_b32 s3, s43, 12
    v_lshl_add_u32 v64, v0, 7, s3
    v_cmp_gt_u32 vcc, 32, v0
    v_bfrev_b32 v3, 1
    s_nop 0
    v_cndmask_b32 v64, v3, v64, vcc
    s_lshl_b32 s3, s43, 12
    v_lshl_add_u32 v5, v2, 8, s3
    v_or_b32 v3, 0, v2
    v_xor_b32 v3, v3, v1
    v_lshl_add_u32 v20, v3, 4, v5
    v_or_b32 v3, 4, v2
    v_xor_b32 v3, v3, v1
    v_lshl_add_u32 v21, v3, 4, v5
    v_or_b32 v3, 8, v2
    v_xor_b32 v3, v3, v1
    v_lshl_add_u32 v22, v3, 4, v5
    v_or_b32 v3, 12, v2
    v_xor_b32 v3, v3, v1
    v_lshl_add_u32 v23, v3, 4, v5
    v_or_b32 v3, 0, v2
    v_lshlrev_b32 v3, 1, v3
    v_xor_b32 v3, v3, v1
    v_lshl_add_u32 v24, v3, 4, v5
    v_or_b32 v3, 4, v2
    v_lshlrev_b32 v3, 1, v3
    v_xor_b32 v3, v3, v1
    v_lshl_add_u32 v25, v3, 4, v5
    s_add_u32 s32, s3, 0
    s_add_u32 s36, s3, 98304
    s_add_u32 s33, s3, 16384
    s_add_u32 s37, s3, 114688
    s_add_u32 s34, s3, 32768
    s_add_u32 s38, s3, 65536
    s_add_u32 s35, s3, 49152
    s_add_u32 s39, s3, 81920
    s_mov_b32 s3, 256
    s_mov_b32 s4, 1048576
    buffer_load_dword v29, v28, s[16:19], s3 offen nt
    buffer_load_dword v29, v26, s[20:23], s4 offen nt
    s_waitcnt vmcnt(10)
    ds_read_b128 a[128:131], v6 offset:32768
    ds_read_b128 a[132:135], v7 offset:32768
    ds_read_b128 a[136:139], v6 offset:34816
    ds_read_b128 a[140:143], v7 offset:34816
    ds_read_b128 a[144:147], v6 offset:36864
    ds_read_b128 a[148:151], v7 offset:36864
    ds_read_b128 a[152:155], v6 offset:38912
    ds_read_b128 a[156:159], v7 offset:38912
    s_waitcnt vmcnt(2)
    s_barrier
    ds_read_b64_tr_b16 a[192:193], v56 offset:0
    ds_read_b64_tr_b16 a[194:195], v56 offset:2048
    ds_read_b64_tr_b16 a[196:197], v56 offset:16384
    ds_read_b64_tr_b16 a[198:199], v56 offset:18432
    ds_read_b64_tr_b16 a[200:201], v57 offset:0
    ds_read_b64_tr_b16 a[202:203], v57 offset:2048
    ds_read_b64_tr_b16 a[204:205], v57 offset:16384
    ds_read_b64_tr_b16 a[206:207], v57 offset:18432
    s_waitcnt lgkmcnt(8)
    s_waitcnt lgkmcnt(4)
    v_mfma_f32_16x16x32_bf16 v[160:163], a[192:195], a[128:131], 0
    ds_read_b64_tr_b16 a[208:209], v58 offset:0
    ds_read_b64_tr_b16 a[210:211], v58 offset:2048
    v_mfma_f32_16x16x32_bf16 v[160:163], a[196:199], a[132:135], v[160:163]
    ds_read_b64_tr_b16 a[212:213], v58 offset:16384
    ds_read_b64_tr_b16 a[214:215], v58 offset:18432
    s_add_u32 m0, s48, 0
    v_mfma_f32_16x16x32_bf16 v[176:179], a[192:195], a[136:139], 0
    buffer_load_dwordx4 v32, s[16:19], s46 offen offset:0 lds
    v_mfma_f32_16x16x32_bf16 v[176:179], a[196:199], a[140:143], v[176:179]
    v_mfma_f32_16x16x32_bf16 v[192:195], a[192:195], a[144:147], 0
    v_mfma_f32_16x16x32_bf16 v[192:195], a[196:199], a[148:151], v[192:195]
    v_mfma_f32_16x16x32_bf16 v[208:211], a[192:195], a[152:155], 0
    buffer_load_dwordx4 v33, s[16:19], s46 offen offset:1024 lds
    v_mfma_f32_16x16x32_bf16 v[208:211], a[196:199], a[156:159], v[208:211]
    s_waitcnt lgkmcnt(4)
    v_mfma_f32_16x16x32_bf16 v[164:167], a[200:203], a[128:131], 0
    ds_read_b64_tr_b16 a[216:217], v59 offset:0
    ds_read_b64_tr_b16 a[218:219], v59 offset:2048
    v_mfma_f32_16x16x32_bf16 v[164:167], a[204:207], a[132:135], v[164:167]
    ds_read_b64_tr_b16 a[220:221], v59 offset:16384
    ds_read_b64_tr_b16 a[222:223], v59 offset:18432
    s_add_u32 m0, s48, 2048
    v_mfma_f32_16x16x32_bf16 v[180:183], a[200:203], a[136:139], 0
    buffer_load_dwordx4 v34, s[16:19], s46 offen offset:0 lds
    v_mfma_f32_16x16x32_bf16 v[180:183], a[204:207], a[140:143], v[180:183]
    v_mfma_f32_16x16x32_bf16 v[196:199], a[200:203], a[144:147], 0
    v_mfma_f32_16x16x32_bf16 v[196:199], a[204:207], a[148:151], v[196:199]
    v_mfma_f32_16x16x32_bf16 v[212:215], a[200:203], a[152:155], 0
    buffer_load_dwordx4 v35, s[16:19], s46 offen offset:1024 lds
    v_mfma_f32_16x16x32_bf16 v[212:215], a[204:207], a[156:159], v[212:215]
    s_waitcnt lgkmcnt(4)
    v_mfma_f32_16x16x32_bf16 v[96:99], a[208:211], a[128:131], 0
    ds_read_b64_tr_b16 a[192:193], v60 offset:0
    ds_read_b64_tr_b16 a[194:195], v60 offset:2048
    v_mfma_f32_16x16x32_bf16 v[96:99], a[212:215], a[132:135], v[96:99]
    ds_read_b64_tr_b16 a[196:197], v60 offset:16384
    ds_read_b64_tr_b16 a[198:199], v60 offset:18432
    s_add_u32 m0, s48, 4096
    v_mfma_f32_16x16x32_bf16 v[112:115], a[208:211], a[136:139], 0
    buffer_load_dwordx4 v36, s[16:19], s46 offen offset:0 lds
    v_mfma_f32_16x16x32_bf16 v[112:115], a[212:215], a[140:143], v[112:115]
    v_mfma_f32_16x16x32_bf16 v[128:131], a[208:211], a[144:147], 0
    v_mfma_f32_16x16x32_bf16 v[128:131], a[212:215], a[148:151], v[128:131]
    v_mfma_f32_16x16x32_bf16 v[144:147], a[208:211], a[152:155], 0
    buffer_load_dwordx4 v37, s[16:19], s46 offen offset:1024 lds
    v_mfma_f32_16x16x32_bf16 v[144:147], a[212:215], a[156:159], v[144:147]
    s_waitcnt lgkmcnt(4)
    v_mfma_f32_16x16x32_bf16 v[100:103], a[216:219], a[128:131], 0
    ds_read_b64_tr_b16 a[200:201], v61 offset:0
    ds_read_b64_tr_b16 a[202:203], v61 offset:2048
    v_mfma_f32_16x16x32_bf16 v[100:103], a[220:223], a[132:135], v[100:103]
    ds_read_b64_tr_b16 a[204:205], v61 offset:16384
    ds_read_b64_tr_b16 a[206:207], v61 offset:18432
    s_add_u32 m0, s48, 6144
    v_mfma_f32_16x16x32_bf16 v[116:119], a[216:219], a[136:139], 0
    buffer_load_dwordx4 v38, s[16:19], s46 offen offset:0 lds
    v_mfma_f32_16x16x32_bf16 v[116:119], a[220:223], a[140:143], v[116:119]
    v_mfma_f32_16x16x32_bf16 v[132:135], a[216:219], a[144:147], 0
    v_mfma_f32_16x16x32_bf16 v[132:135], a[220:223], a[148:151], v[132:135]
    v_mfma_f32_16x16x32_bf16 v[148:151], a[216:219], a[152:155], 0
    buffer_load_dwordx4 v39, s[16:19], s46 offen offset:1024 lds
    v_mfma_f32_16x16x32_bf16 v[148:151], a[220:223], a[156:159], v[148:151]
    s_add_u32 s46, s46, 128
    s_waitcnt lgkmcnt(4)
    v_mfma_f32_16x16x32_bf16 v[168:171], a[192:195], a[128:131], 0
    ds_read_b64_tr_b16 a[208:209], v62 offset:0
    ds_read_b64_tr_b16 a[210:211], v62 offset:2048
    v_mfma_f32_16x16x32_bf16 v[168:171], a[196:199], a[132:135], v[168:171]
    ds_read_b64_tr_b16 a[212:213], v62 offset:16384
    ds_read_b64_tr_b16 a[214:215], v62 offset:18432
    s_add_u32 m0, s48, 65536
    v_mfma_f32_16x16x32_bf16 v[184:187], a[192:195], a[136:139], 0
    buffer_load_dwordx4 v40, s[20:23], s47 offen offset:0 lds
    v_mfma_f32_16x16x32_bf16 v[184:187], a[196:199], a[140:143], v[184:187]
    v_mfma_f32_16x16x32_bf16 v[200:203], a[192:195], a[144:147], 0
    v_mfma_f32_16x16x32_bf16 v[200:203], a[196:199], a[148:151], v[200:203]
    v_mfma_f32_16x16x32_bf16 v[216:219], a[192:195], a[152:155], 0
    buffer_load_dwordx4 v41, s[20:23], s47 offen offset:1024 lds
    v_mfma_f32_16x16x32_bf16 v[216:219], a[196:199], a[156:159], v[216:219]
    s_waitcnt lgkmcnt(4)
    v_mfma_f32_16x16x32_bf16 v[172:175], a[200:203], a[128:131], 0
    ds_read_b64_tr_b16 a[216:217], v63 offset:0
    ds_read_b64_tr_b16 a[218:219], v63 offset:2048
    v_mfma_f32_16x16x32_bf16 v[172:175], a[204:207], a[132:135], v[172:175]
    ds_read_b64_tr_b16 a[220:221], v63 offset:16384
    ds_read_b64_tr_b16 a[222:223], v63 offset:18432
    v_mfma_f32_16x16x32_bf16 v[188:191], a[200:203], a[136:139], 0
    buffer_load_dwordx4 v42, s[20:23], s47 offen offset:2048 lds
    v_mfma_f32_16x16x32_bf16 v[188:191], a[204:207], a[140:143], v[188:191]
    v_mfma_f32_16x16x32_bf16 v[204:207], a[200:203], a[144:147], 0
    v_mfma_f32_16x16x32_bf16 v[204:207], a[204:207], a[148:151], v[204:207]
    v_mfma_f32_16x16x32_bf16 v[220:223], a[200:203], a[152:155], 0
    buffer_load_dwordx4 v43, s[20:23], s47 offen offset:3072 lds
    v_mfma_f32_16x16x32_bf16 v[220:223], a[204:207], a[156:159], v[220:223]
    s_waitcnt lgkmcnt(4)
    v_mfma_f32_16x16x32_bf16 v[104:107], a[208:211], a[128:131], 0
    ds_read_b64_tr_b16 a[192:193], v56 offset:256
    ds_read_b64_tr_b16 a[194:195], v56 offset:2304
    v_mfma_f32_16x16x32_bf16 v[104:107], a[212:215], a[132:135], v[104:107]
    ds_read_b64_tr_b16 a[196:197], v56 offset:16640
    ds_read_b64_tr_b16 a[198:199], v56 offset:18688
    s_add_u32 m0, s48, 69632
    v_mfma_f32_16x16x32_bf16 v[120:123], a[208:211], a[136:139], 0
    buffer_load_dwordx4 v44, s[20:23], s47 offen offset:0 lds
    v_mfma_f32_16x16x32_bf16 v[120:123], a[212:215], a[140:143], v[120:123]
    v_mfma_f32_16x16x32_bf16 v[136:139], a[208:211], a[144:147], 0
    v_mfma_f32_16x16x32_bf16 v[136:139], a[212:215], a[148:151], v[136:139]
    v_mfma_f32_16x16x32_bf16 v[152:155], a[208:211], a[152:155], 0
    buffer_load_dwordx4 v45, s[20:23], s47 offen offset:1024 lds
    v_mfma_f32_16x16x32_bf16 v[152:155], a[212:215], a[156:159], v[152:155]
    s_waitcnt lgkmcnt(4)
    v_mfma_f32_16x16x32_bf16 v[108:111], a[216:219], a[128:131], 0
    ds_read_b64_tr_b16 a[200:201], v57 offset:256
    ds_read_b64_tr_b16 a[202:203], v57 offset:2304
    v_mfma_f32_16x16x32_bf16 v[108:111], a[220:223], a[132:135], v[108:111]
    ds_read_b64_tr_b16 a[204:205], v57 offset:16640
    ds_read_b64_tr_b16 a[206:207], v57 offset:18688
    v_mfma_f32_16x16x32_bf16 v[124:127], a[216:219], a[136:139], 0
    buffer_load_dwordx4 v46, s[20:23], s47 offen offset:2048 lds
    v_mfma_f32_16x16x32_bf16 v[124:127], a[220:223], a[140:143], v[124:127]
    v_mfma_f32_16x16x32_bf16 v[140:143], a[216:219], a[144:147], 0
    v_mfma_f32_16x16x32_bf16 v[140:143], a[220:223], a[148:151], v[140:143]
    v_mfma_f32_16x16x32_bf16 v[156:159], a[216:219], a[152:155], 0
    buffer_load_dwordx4 v47, s[20:23], s47 offen offset:3072 lds
    v_mfma_f32_16x16x32_bf16 v[156:159], a[220:223], a[156:159], v[156:159]
    s_add_u32 s47, s47, 524288
    s_waitcnt lgkmcnt(4)
    v_mfma_f32_16x16x32_bf16 a[0:3], a[192:195], a[128:131], 0
    ds_read_b64_tr_b16 a[208:209], v58 offset:256
    ds_read_b64_tr_b16 a[210:211], v58 offset:2304
    v_mfma_f32_16x16x32_bf16 a[0:3], a[196:199], a[132:135], a[0:3]
    ds_read_b64_tr_b16 a[212:213], v58 offset:16640
    ds_read_b64_tr_b16 a[214:215], v58 offset:18688
    s_add_u32 m0, s48, 32768
    s_waitcnt vmcnt(8)
    v_mfma_f32_16x16x32_bf16 a[4:7], a[192:195], a[136:139], 0
    ds_read_b128 a[160:163], v6 offset:0
    buffer_load_dwordx4 v32, s[16:19], s46 offen offset:0 lds
    v_mfma_f32_16x16x32_bf16 a[4:7], a[196:199], a[140:143], a[4:7]
    v_mfma_f32_16x16x32_bf16 a[8:11], a[192:195], a[144:147], 0
    v_mfma_f32_16x16x32_bf16 a[8:11], a[196:199], a[148:151], a[8:11]
    v_mfma_f32_16x16x32_bf16 a[12:15], a[192:195], a[152:155], 0
    buffer_load_dwordx4 v33, s[16:19], s46 offen offset:1024 lds
    v_mfma_f32_16x16x32_bf16 a[12:15], a[196:199], a[156:159], a[12:15]
    s_waitcnt lgkmcnt(5)
    v_mfma_f32_16x16x32_bf16 a[16:19], a[200:203], a[128:131], 0
    ds_read_b64_tr_b16 a[216:217], v59 offset:256
    ds_read_b64_tr_b16 a[218:219], v59 offset:2304
    ds_read_b128 a[164:167], v7 offset:0
    v_mfma_f32_16x16x32_bf16 a[16:19], a[204:207], a[132:135], a[16:19]
    ds_read_b64_tr_b16 a[220:221], v59 offset:16640
    ds_read_b64_tr_b16 a[222:223], v59 offset:18688
    s_add_u32 m0, s48, 34816
    v_mfma_f32_16x16x32_bf16 a[20:23], a[200:203], a[136:139], 0
    buffer_load_dwordx4 v34, s[16:19], s46 offen offset:0 lds
    v_mfma_f32_16x16x32_bf16 a[20:23], a[204:207], a[140:143], a[20:23]
    v_mfma_f32_16x16x32_bf16 a[24:27], a[200:203], a[144:147], 0
    v_mfma_f32_16x16x32_bf16 a[24:27], a[204:207], a[148:151], a[24:27]
    v_mfma_f32_16x16x32_bf16 a[28:31], a[200:203], a[152:155], 0
    ds_read_b128 a[168:171], v6 offset:2048
    buffer_load_dwordx4 v35, s[16:19], s46 offen offset:1024 lds
    v_mfma_f32_16x16x32_bf16 a[28:31], a[204:207], a[156:159], a[28:31]
    s_waitcnt lgkmcnt(7)
    v_mfma_f32_16x16x32_bf16 a[32:35], a[208:211], a[128:131], 0
    ds_read_b64_tr_b16 a[192:193], v60 offset:256
    ds_read_b64_tr_b16 a[194:195], v60 offset:2304
    v_mfma_f32_16x16x32_bf16 a[32:35], a[212:215], a[132:135], a[32:35]
    ds_read_b64_tr_b16 a[196:197], v60 offset:16640
    ds_read_b64_tr_b16 a[198:199], v60 offset:18688
    s_add_u32 m0, s48, 36864
    v_mfma_f32_16x16x32_bf16 a[36:39], a[208:211], a[136:139], 0
    buffer_load_dwordx4 v36, s[16:19], s46 offen offset:0 lds
    v_mfma_f32_16x16x32_bf16 a[36:39], a[212:215], a[140:143], a[36:39]
    v_mfma_f32_16x16x32_bf16 a[40:43], a[208:211], a[144:147], 0
    ds_read_b128 a[172:175], v7 offset:2048
    v_mfma_f32_16x16x32_bf16 a[40:43], a[212:215], a[148:151], a[40:43]
    v_mfma_f32_16x16x32_bf16 a[44:47], a[208:211], a[152:155], 0
    buffer_load_dwordx4 v37, s[16:19], s46 offen offset:1024 lds
    v_mfma_f32_16x16x32_bf16 a[44:47], a[212:215], a[156:159], a[44:47]
    s_waitcnt lgkmcnt(6)
    v_mfma_f32_16x16x32_bf16 a[48:51], a[216:219], a[128:131], 0
    ds_read_b64_tr_b16 a[200:201], v61 offset:256
    ds_read_b64_tr_b16 a[202:203], v61 offset:2304
    v_mfma_f32_16x16x32_bf16 a[48:51], a[220:223], a[132:135], a[48:51]
    ds_read_b64_tr_b16 a[204:205], v61 offset:16640
    ds_read_b64_tr_b16 a[206:207], v61 offset:18688
    s_add_u32 m0, s48, 38912
    v_mfma_f32_16x16x32_bf16 a[52:55], a[216:219], a[136:139], 0
    ds_read_b128 a[176:179], v6 offset:4096
    buffer_load_dwordx4 v38, s[16:19], s46 offen offset:0 lds
    v_mfma_f32_16x16x32_bf16 a[52:55], a[220:223], a[140:143], a[52:55]
    v_mfma_f32_16x16x32_bf16 a[56:59], a[216:219], a[144:147], 0
    v_mfma_f32_16x16x32_bf16 a[56:59], a[220:223], a[148:151], a[56:59]
    v_mfma_f32_16x16x32_bf16 a[60:63], a[216:219], a[152:155], 0
    buffer_load_dwordx4 v39, s[16:19], s46 offen offset:1024 lds
    v_mfma_f32_16x16x32_bf16 a[60:63], a[220:223], a[156:159], a[60:63]
    s_add_u32 s46, s46, 128
    s_waitcnt lgkmcnt(6)
    v_mfma_f32_16x16x32_bf16 a[64:67], a[192:195], a[128:131], 0
    ds_read_b64_tr_b16 a[208:209], v62 offset:256
    ds_read_b64_tr_b16 a[210:211], v62 offset:2304
    ds_read_b128 a[180:183], v7 offset:4096
    v_mfma_f32_16x16x32_bf16 a[64:67], a[196:199], a[132:135], a[64:67]
    ds_read_b64_tr_b16 a[212:213], v62 offset:16640
    ds_read_b64_tr_b16 a[214:215], v62 offset:18688
    s_add_u32 m0, s48, 131072
    v_mfma_f32_16x16x32_bf16 a[68:71], a[192:195], a[136:139], 0
    buffer_load_dwordx4 v40, s[20:23], s47 offen offset:0 lds
    v_mfma_f32_16x16x32_bf16 a[68:71], a[196:199], a[140:143], a[68:71]
    v_mfma_f32_16x16x32_bf16 a[72:75], a[192:195], a[144:147], 0
    v_mfma_f32_16x16x32_bf16 a[72:75], a[196:199], a[148:151], a[72:75]
    v_mfma_f32_16x16x32_bf16 a[76:79], a[192:195], a[152:155], 0
    ds_read_b128 a[184:187], v6 offset:6144
    buffer_load_dwordx4 v41, s[20:23], s47 offen offset:1024 lds
    v_mfma_f32_16x16x32_bf16 a[76:79], a[196:199], a[156:159], a[76:79]
    s_waitcnt lgkmcnt(7)
    v_mfma_f32_16x16x32_bf16 a[80:83], a[200:203], a[128:131], 0
    ds_read_b64_tr_b16 a[216:217], v63 offset:256
    ds_read_b64_tr_b16 a[218:219], v63 offset:2304
    v_mfma_f32_16x16x32_bf16 a[80:83], a[204:207], a[132:135], a[80:83]
    ds_read_b64_tr_b16 a[220:221], v63 offset:16640
    ds_read_b64_tr_b16 a[222:223], v63 offset:18688
    v_mfma_f32_16x16x32_bf16 a[84:87], a[200:203], a[136:139], 0
    buffer_load_dwordx4 v42, s[20:23], s47 offen offset:2048 lds
    v_mfma_f32_16x16x32_bf16 a[84:87], a[204:207], a[140:143], a[84:87]
    v_mfma_f32_16x16x32_bf16 a[88:91], a[200:203], a[144:147], 0
    ds_read_b128 a[188:191], v7 offset:6144
    v_mfma_f32_16x16x32_bf16 a[88:91], a[204:207], a[148:151], a[88:91]
    v_mfma_f32_16x16x32_bf16 a[92:95], a[200:203], a[152:155], 0
    buffer_load_dwordx4 v43, s[20:23], s47 offen offset:3072 lds
    v_mfma_f32_16x16x32_bf16 a[92:95], a[204:207], a[156:159], a[92:95]
    s_waitcnt vmcnt(12) lgkmcnt(0)
    s_barrier
    v_mfma_f32_16x16x32_bf16 a[96:99], a[208:211], a[128:131], 0
    ds_read_b64_tr_b16 a[192:193], v48 offset:0
    ds_read_b64_tr_b16 a[194:195], v48 offset:2048
    v_mfma_f32_16x16x32_bf16 a[96:99], a[212:215], a[132:135], a[96:99]
    ds_read_b64_tr_b16 a[196:197], v48 offset:16384
    ds_read_b64_tr_b16 a[198:199], v48 offset:18432
    s_add_u32 m0, s48, 135168
    v_mfma_f32_16x16x32_bf16 a[100:103], a[208:211], a[136:139], 0
    buffer_load_dwordx4 v44, s[20:23], s47 offen offset:0 lds
    v_mfma_f32_16x16x32_bf16 a[100:103], a[212:215], a[140:143], a[100:103]
    v_mfma_f32_16x16x32_bf16 a[104:107], a[208:211], a[144:147], 0
    v_mfma_f32_16x16x32_bf16 a[104:107], a[212:215], a[148:151], a[104:107]
    v_mfma_f32_16x16x32_bf16 a[108:111], a[208:211], a[152:155], 0
    buffer_load_dwordx4 v45, s[20:23], s47 offen offset:1024 lds
    v_mfma_f32_16x16x32_bf16 a[108:111], a[212:215], a[156:159], a[108:111]
    v_mfma_f32_16x16x32_bf16 a[112:115], a[216:219], a[128:131], 0
    ds_read_b64_tr_b16 a[200:201], v49 offset:0
    ds_read_b64_tr_b16 a[202:203], v49 offset:2048
    v_mfma_f32_16x16x32_bf16 a[112:115], a[220:223], a[132:135], a[112:115]
    ds_read_b64_tr_b16 a[204:205], v49 offset:16384
    ds_read_b64_tr_b16 a[206:207], v49 offset:18432
    v_mfma_f32_16x16x32_bf16 a[116:119], a[216:219], a[136:139], 0
    buffer_load_dwordx4 v46, s[20:23], s47 offen offset:2048 lds
    v_mfma_f32_16x16x32_bf16 a[116:119], a[220:223], a[140:143], a[116:119]
    v_mfma_f32_16x16x32_bf16 a[120:123], a[216:219], a[144:147], 0
    v_mfma_f32_16x16x32_bf16 a[120:123], a[220:223], a[148:151], a[120:123]
    v_mfma_f32_16x16x32_bf16 a[124:127], a[216:219], a[152:155], 0
    buffer_load_dwordx4 v47, s[20:23], s47 offen offset:3072 lds
    v_mfma_f32_16x16x32_bf16 a[124:127], a[220:223], a[156:159], a[124:127]
    s_add_u32 s47, s47, 524288
    s_waitcnt lgkmcnt(4)
    v_mfma_f32_16x16x32_bf16 v[160:163], a[192:195], a[160:163], v[160:163]
    ds_read_b64_tr_b16 a[208:209], v50 offset:0
    ds_read_b64_tr_b16 a[210:211], v50 offset:2048
    v_mfma_f32_16x16x32_bf16 v[160:163], a[196:199], a[164:167], v[160:163]
    ds_read_b64_tr_b16 a[212:213], v50 offset:16384
    ds_read_b64_tr_b16 a[214:215], v50 offset:18432
    v_mfma_f32_16x16x32_bf16 v[176:179], a[192:195], a[168:171], v[176:179]
    v_mfma_f32_16x16x32_bf16 v[176:179], a[196:199], a[172:175], v[176:179]
    s_add_u32 m0, s48, 0
    v_mfma_f32_16x16x32_bf16 v[192:195], a[192:195], a[176:179], v[192:195]
    buffer_load_dwordx4 v32, s[16:19], s46 offen offset:0 lds
    v_mfma_f32_16x16x32_bf16 v[192:195], a[196:199], a[180:183], v[192:195]
    v_mfma_f32_16x16x32_bf16 v[208:211], a[192:195], a[184:187], v[208:211]
    v_mfma_f32_16x16x32_bf16 v[208:211], a[196:199], a[188:191], v[208:211]
    s_waitcnt lgkmcnt(4)
    v_mfma_f32_16x16x32_bf16 v[164:167], a[200:203], a[160:163], v[164:167]
    ds_read_b64_tr_b16 a[216:217], v51 offset:0
    ds_read_b64_tr_b16 a[218:219], v51 offset:2048
    v_mfma_f32_16x16x32_bf16 v[164:167], a[204:207], a[164:167], v[164:167]
    ds_read_b64_tr_b16 a[220:221], v51 offset:16384
    ds_read_b64_tr_b16 a[222:223], v51 offset:18432
    v_mfma_f32_16x16x32_bf16 v[180:183], a[200:203], a[168:171], v[180:183]
    buffer_load_dwordx4 v33, s[16:19], s46 offen offset:1024 lds
    v_mfma_f32_16x16x32_bf16 v[180:183], a[204:207], a[172:175], v[180:183]
    v_mfma_f32_16x16x32_bf16 v[196:199], a[200:203], a[176:179], v[196:199]
    v_mfma_f32_16x16x32_bf16 v[196:199], a[204:207], a[180:183], v[196:199]
    v_mfma_f32_16x16x32_bf16 v[212:215], a[200:203], a[184:187], v[212:215]
    v_mfma_f32_16x16x32_bf16 v[212:215], a[204:207], a[188:191], v[212:215]
    s_waitcnt lgkmcnt(4)
    v_mfma_f32_16x16x32_bf16 v[96:99], a[208:211], a[160:163], v[96:99]
    ds_read_b64_tr_b16 a[192:193], v52 offset:0
    ds_read_b64_tr_b16 a[194:195], v52 offset:2048
    v_mfma_f32_16x16x32_bf16 v[96:99], a[212:215], a[164:167], v[96:99]
    ds_read_b64_tr_b16 a[196:197], v52 offset:16384
    ds_read_b64_tr_b16 a[198:199], v52 offset:18432
    s_add_u32 m0, s48, 2048
    v_mfma_f32_16x16x32_bf16 v[112:115], a[208:211], a[168:171], v[112:115]
    buffer_load_dwordx4 v34, s[16:19], s46 offen offset:0 lds
    v_mfma_f32_16x16x32_bf16 v[112:115], a[212:215], a[172:175], v[112:115]
    v_mfma_f32_16x16x32_bf16 v[128:131], a[208:211], a[176:179], v[128:131]
    v_mfma_f32_16x16x32_bf16 v[128:131], a[212:215], a[180:183], v[128:131]
    v_mfma_f32_16x16x32_bf16 v[144:147], a[208:211], a[184:187], v[144:147]
    v_mfma_f32_16x16x32_bf16 v[144:147], a[212:215], a[188:191], v[144:147]
    s_waitcnt lgkmcnt(4)
    v_mfma_f32_16x16x32_bf16 v[100:103], a[216:219], a[160:163], v[100:103]
    ds_read_b64_tr_b16 a[200:201], v53 offset:0
    ds_read_b64_tr_b16 a[202:203], v53 offset:2048
    buffer_load_dwordx4 v35, s[16:19], s46 offen offset:1024 lds
    v_mfma_f32_16x16x32_bf16 v[100:103], a[220:223], a[164:167], v[100:103]
    ds_read_b64_tr_b16 a[204:205], v53 offset:16384
    ds_read_b64_tr_b16 a[206:207], v53 offset:18432
    v_mfma_f32_16x16x32_bf16 v[116:119], a[216:219], a[168:171], v[116:119]
    v_mfma_f32_16x16x32_bf16 v[116:119], a[220:223], a[172:175], v[116:119]
    v_mfma_f32_16x16x32_bf16 v[132:135], a[216:219], a[176:179], v[132:135]
    v_mfma_f32_16x16x32_bf16 v[132:135], a[220:223], a[180:183], v[132:135]
    v_mfma_f32_16x16x32_bf16 v[148:151], a[216:219], a[184:187], v[148:151]
    v_mfma_f32_16x16x32_bf16 v[148:151], a[220:223], a[188:191], v[148:151]
    s_add_u32 m0, s48, 4096
    s_waitcnt lgkmcnt(4)
    v_mfma_f32_16x16x32_bf16 v[168:171], a[192:195], a[160:163], v[168:171]
    ds_read_b64_tr_b16 a[208:209], v54 offset:0
    ds_read_b64_tr_b16 a[210:211], v54 offset:2048
    buffer_load_dwordx4 v36, s[16:19], s46 offen offset:0 lds
    v_mfma_f32_16x16x32_bf16 v[168:171], a[196:199], a[164:167], v[168:171]
    ds_read_b64_tr_b16 a[212:213], v54 offset:16384
    ds_read_b64_tr_b16 a[214:215], v54 offset:18432
    v_mfma_f32_16x16x32_bf16 v[184:187], a[192:195], a[168:171], v[184:187]
    v_mfma_f32_16x16x32_bf16 v[184:187], a[196:199], a[172:175], v[184:187]
    v_mfma_f32_16x16x32_bf16 v[200:203], a[192:195], a[176:179], v[200:203]
    v_mfma_f32_16x16x32_bf16 v[200:203], a[196:199], a[180:183], v[200:203]
    v_mfma_f32_16x16x32_bf16 v[216:219], a[192:195], a[184:187], v[216:219]
    buffer_load_dwordx4 v37, s[16:19], s46 offen offset:1024 lds
    v_mfma_f32_16x16x32_bf16 v[216:219], a[196:199], a[188:191], v[216:219]
    s_waitcnt lgkmcnt(4)
    v_mfma_f32_16x16x32_bf16 v[172:175], a[200:203], a[160:163], v[172:175]
    ds_read_b64_tr_b16 a[216:217], v55 offset:0
    ds_read_b64_tr_b16 a[218:219], v55 offset:2048
    v_mfma_f32_16x16x32_bf16 v[172:175], a[204:207], a[164:167], v[172:175]
    ds_read_b64_tr_b16 a[220:221], v55 offset:16384
    ds_read_b64_tr_b16 a[222:223], v55 offset:18432
    v_mfma_f32_16x16x32_bf16 v[188:191], a[200:203], a[168:171], v[188:191]
    v_mfma_f32_16x16x32_bf16 v[188:191], a[204:207], a[172:175], v[188:191]
    v_mfma_f32_16x16x32_bf16 v[204:207], a[200:203], a[176:179], v[204:207]
    v_mfma_f32_16x16x32_bf16 v[204:207], a[204:207], a[180:183], v[204:207]
    s_add_u32 m0, s48, 6144
    v_mfma_f32_16x16x32_bf16 v[220:223], a[200:203], a[184:187], v[220:223]
    buffer_load_dwordx4 v38, s[16:19], s46 offen offset:0 lds
    v_mfma_f32_16x16x32_bf16 v[220:223], a[204:207], a[188:191], v[220:223]
    s_waitcnt lgkmcnt(4)
    v_mfma_f32_16x16x32_bf16 v[104:107], a[208:211], a[160:163], v[104:107]
    ds_read_b64_tr_b16 a[192:193], v48 offset:256
    ds_read_b64_tr_b16 a[194:195], v48 offset:2304
    v_mfma_f32_16x16x32_bf16 v[104:107], a[212:215], a[164:167], v[104:107]
    ds_read_b64_tr_b16 a[196:197], v48 offset:16640
    ds_read_b64_tr_b16 a[198:199], v48 offset:18688
    s_waitcnt vmcnt(15)
    v_mfma_f32_16x16x32_bf16 v[120:123], a[208:211], a[168:171], v[120:123]
    ds_read_b128 a[128:131], v6 offset:32768
    v_mfma_f32_16x16x32_bf16 v[120:123], a[212:215], a[172:175], v[120:123]
    v_mfma_f32_16x16x32_bf16 v[136:139], a[208:211], a[176:179], v[136:139]
    buffer_load_dwordx4 v39, s[16:19], s46 offen offset:1024 lds
    v_mfma_f32_16x16x32_bf16 v[136:139], a[212:215], a[180:183], v[136:139]
    s_add_u32 s46, s46, 128
    v_mfma_f32_16x16x32_bf16 v[152:155], a[208:211], a[184:187], v[152:155]
    v_mfma_f32_16x16x32_bf16 v[152:155], a[212:215], a[188:191], v[152:155]
    s_waitcnt lgkmcnt(5)
    v_mfma_f32_16x16x32_bf16 v[108:111], a[216:219], a[160:163], v[108:111]
    ds_read_b64_tr_b16 a[200:201], v49 offset:256
    ds_read_b64_tr_b16 a[202:203], v49 offset:2304
    v_mfma_f32_16x16x32_bf16 v[108:111], a[220:223], a[164:167], v[108:111]
    ds_read_b64_tr_b16 a[204:205], v49 offset:16640
    ds_read_b64_tr_b16 a[206:207], v49 offset:18688
    v_mfma_f32_16x16x32_bf16 v[124:127], a[216:219], a[168:171], v[124:127]
    ds_read_b128 a[132:135], v7 offset:32768
    v_mfma_f32_16x16x32_bf16 v[124:127], a[220:223], a[172:175], v[124:127]
    s_add_u32 m0, s48, 98304
    v_mfma_f32_16x16x32_bf16 v[140:143], a[216:219], a[176:179], v[140:143]
    buffer_load_dwordx4 v40, s[20:23], s47 offen offset:0 lds
    v_mfma_f32_16x16x32_bf16 v[140:143], a[220:223], a[180:183], v[140:143]
    v_mfma_f32_16x16x32_bf16 v[156:159], a[216:219], a[184:187], v[156:159]
    v_mfma_f32_16x16x32_bf16 v[156:159], a[220:223], a[188:191], v[156:159]
    s_waitcnt lgkmcnt(6)
    v_mfma_f32_16x16x32_bf16 a[0:3], a[192:195], a[160:163], a[0:3]
    ds_read_b64_tr_b16 a[208:209], v50 offset:256
    ds_read_b64_tr_b16 a[210:211], v50 offset:2304
    v_mfma_f32_16x16x32_bf16 a[0:3], a[196:199], a[164:167], a[0:3]
    ds_read_b64_tr_b16 a[212:213], v50 offset:16640
    ds_read_b64_tr_b16 a[214:215], v50 offset:18688
    v_mfma_f32_16x16x32_bf16 a[4:7], a[192:195], a[168:171], a[4:7]
    ds_read_b128 a[136:139], v6 offset:34816
    buffer_load_dwordx4 v41, s[20:23], s47 offen offset:1024 lds
    v_mfma_f32_16x16x32_bf16 a[4:7], a[196:199], a[172:175], a[4:7]
    v_mfma_f32_16x16x32_bf16 a[8:11], a[192:195], a[176:179], a[8:11]
    v_mfma_f32_16x16x32_bf16 a[8:11], a[196:199], a[180:183], a[8:11]
    v_mfma_f32_16x16x32_bf16 a[12:15], a[192:195], a[184:187], a[12:15]
    v_mfma_f32_16x16x32_bf16 a[12:15], a[196:199], a[188:191], a[12:15]
    s_waitcnt lgkmcnt(6)
    v_mfma_f32_16x16x32_bf16 a[16:19], a[200:203], a[160:163], a[16:19]
    ds_read_b64_tr_b16 a[216:217], v51 offset:256
    ds_read_b64_tr_b16 a[218:219], v51 offset:2304
    v_mfma_f32_16x16x32_bf16 a[16:19], a[204:207], a[164:167], a[16:19]
    ds_read_b64_tr_b16 a[220:221], v51 offset:16640
    ds_read_b64_tr_b16 a[222:223], v51 offset:18688
    v_mfma_f32_16x16x32_bf16 a[20:23], a[200:203], a[168:171], a[20:23]
    ds_read_b128 a[140:143], v7 offset:34816
    buffer_load_dwordx4 v42, s[20:23], s47 offen offset:2048 lds
    v_mfma_f32_16x16x32_bf16 a[20:23], a[204:207], a[172:175], a[20:23]
    v_mfma_f32_16x16x32_bf16 a[24:27], a[200:203], a[176:179], a[24:27]
    v_mfma_f32_16x16x32_bf16 a[24:27], a[204:207], a[180:183], a[24:27]
    v_mfma_f32_16x16x32_bf16 a[28:31], a[200:203], a[184:187], a[28:31]
    v_mfma_f32_16x16x32_bf16 a[28:31], a[204:207], a[188:191], a[28:31]
    s_waitcnt lgkmcnt(6)
    v_mfma_f32_16x16x32_bf16 a[32:35], a[208:211], a[160:163], a[32:35]
    ds_read_b64_tr_b16 a[192:193], v52 offset:256
    ds_read_b64_tr_b16 a[194:195], v52 offset:2304
    buffer_load_dwordx4 v43, s[20:23], s47 offen offset:3072 lds
    v_mfma_f32_16x16x32_bf16 a[32:35], a[212:215], a[164:167], a[32:35]
    ds_read_b64_tr_b16 a[196:197], v52 offset:16640
    ds_read_b64_tr_b16 a[198:199], v52 offset:18688
    v_mfma_f32_16x16x32_bf16 a[36:39], a[208:211], a[168:171], a[36:39]
    ds_read_b128 a[144:147], v6 offset:36864
    v_mfma_f32_16x16x32_bf16 a[36:39], a[212:215], a[172:175], a[36:39]
    v_mfma_f32_16x16x32_bf16 a[40:43], a[208:211], a[176:179], a[40:43]
    v_mfma_f32_16x16x32_bf16 a[40:43], a[212:215], a[180:183], a[40:43]
    v_mfma_f32_16x16x32_bf16 a[44:47], a[208:211], a[184:187], a[44:47]
    v_mfma_f32_16x16x32_bf16 a[44:47], a[212:215], a[188:191], a[44:47]
    s_add_u32 m0, s48, 102400
    s_waitcnt lgkmcnt(6)
    v_mfma_f32_16x16x32_bf16 a[48:51], a[216:219], a[160:163], a[48:51]
    ds_read_b64_tr_b16 a[200:201], v53 offset:256
    ds_read_b64_tr_b16 a[202:203], v53 offset:2304
    buffer_load_dwordx4 v44, s[20:23], s47 offen offset:0 lds
    v_mfma_f32_16x16x32_bf16 a[48:51], a[220:223], a[164:167], a[48:51]
    ds_read_b64_tr_b16 a[204:205], v53 offset:16640
    ds_read_b64_tr_b16 a[206:207], v53 offset:18688
    v_mfma_f32_16x16x32_bf16 a[52:55], a[216:219], a[168:171], a[52:55]
    ds_read_b128 a[148:151], v7 offset:36864
    v_mfma_f32_16x16x32_bf16 a[52:55], a[220:223], a[172:175], a[52:55]
    v_mfma_f32_16x16x32_bf16 a[56:59], a[216:219], a[176:179], a[56:59]
    v_mfma_f32_16x16x32_bf16 a[56:59], a[220:223], a[180:183], a[56:59]
    v_mfma_f32_16x16x32_bf16 a[60:63], a[216:219], a[184:187], a[60:63]
    buffer_load_dwordx4 v45, s[20:23], s47 offen offset:1024 lds
    v_mfma_f32_16x16x32_bf16 a[60:63], a[220:223], a[188:191], a[60:63]
    s_waitcnt lgkmcnt(6)
    v_mfma_f32_16x16x32_bf16 a[64:67], a[192:195], a[160:163], a[64:67]
    ds_read_b64_tr_b16 a[208:209], v54 offset:256
    ds_read_b64_tr_b16 a[210:211], v54 offset:2304
    v_mfma_f32_16x16x32_bf16 a[64:67], a[196:199], a[164:167], a[64:67]
    ds_read_b64_tr_b16 a[212:213], v54 offset:16640
    ds_read_b64_tr_b16 a[214:215], v54 offset:18688
    v_mfma_f32_16x16x32_bf16 a[68:71], a[192:195], a[168:171], a[68:71]
    ds_read_b128 a[152:155], v6 offset:38912
    v_mfma_f32_16x16x32_bf16 a[68:71], a[196:199], a[172:175], a[68:71]
    v_mfma_f32_16x16x32_bf16 a[72:75], a[192:195], a[176:179], a[72:75]
    v_mfma_f32_16x16x32_bf16 a[72:75], a[196:199], a[180:183], a[72:75]
    v_mfma_f32_16x16x32_bf16 a[76:79], a[192:195], a[184:187], a[76:79]
    buffer_load_dwordx4 v46, s[20:23], s47 offen offset:2048 lds
    v_mfma_f32_16x16x32_bf16 a[76:79], a[196:199], a[188:191], a[76:79]
    s_waitcnt lgkmcnt(6)
    v_mfma_f32_16x16x32_bf16 a[80:83], a[200:203], a[160:163], a[80:83]
    ds_read_b64_tr_b16 a[216:217], v55 offset:256
    ds_read_b64_tr_b16 a[218:219], v55 offset:2304
    v_mfma_f32_16x16x32_bf16 a[80:83], a[204:207], a[164:167], a[80:83]
    ds_read_b64_tr_b16 a[220:221], v55 offset:16640
    ds_read_b64_tr_b16 a[222:223], v55 offset:18688
    v_mfma_f32_16x16x32_bf16 a[84:87], a[200:203], a[168:171], a[84:87]
    ds_read_b128 a[156:159], v7 offset:38912
    v_mfma_f32_16x16x32_bf16 a[84:87], a[204:207], a[172:175], a[84:87]
    v_mfma_f32_16x16x32_bf16 a[88:91], a[200:203], a[176:179], a[88:91]
    buffer_load_dwordx4 v47, s[20:23], s47 offen offset:3072 lds
    v_mfma_f32_16x16x32_bf16 a[88:91], a[204:207], a[180:183], a[88:91]
    s_add_u32 s47, s47, 524288
    v_mfma_f32_16x16x32_bf16 a[92:95], a[200:203], a[184:187], a[92:95]
    v_mfma_f32_16x16x32_bf16 a[92:95], a[204:207], a[188:191], a[92:95]
    s_mov_b32 s3, 512
    s_mov_b32 s4, 2097152
    buffer_load_dword v29, v28, s[16:19], s3 offen nt
    buffer_load_dword v29, v26, s[20:23], s4 offen nt
    s_waitcnt vmcnt(18) lgkmcnt(0)
    s_barrier
    v_mfma_f32_16x16x32_bf16 a[96:99], a[208:211], a[160:163], a[96:99]
    ds_read_b64_tr_b16 a[192:193], v56 offset:32768
    ds_read_b64_tr_b16 a[194:195], v56 offset:34816
    v_mfma_f32_16x16x32_bf16 a[96:99], a[212:215], a[164:167], a[96:99]
    ds_read_b64_tr_b16 a[196:197], v56 offset:49152
    ds_read_b64_tr_b16 a[198:199], v56 offset:51200
    v_mfma_f32_16x16x32_bf16 a[100:103], a[208:211], a[168:171], a[100:103]
    v_mfma_f32_16x16x32_bf16 a[100:103], a[212:215], a[172:175], a[100:103]
    v_mfma_f32_16x16x32_bf16 a[104:107], a[208:211], a[176:179], a[104:107]
    v_mfma_f32_16x16x32_bf16 a[104:107], a[212:215], a[180:183], a[104:107]
    v_mfma_f32_16x16x32_bf16 a[108:111], a[208:211], a[184:187], a[108:111]
    v_mfma_f32_16x16x32_bf16 a[108:111], a[212:215], a[188:191], a[108:111]
    s_lshl_b32 s3, s53, 2
    s_add_u32 s3, s3, s90
    s_lshl_b32 s4, s52, 2
    s_add_u32 s4, s4, s91
    s_sub_u32 s4, s4, 64
    s_cmp_eq_u32 s43, 0
    s_cselect_b32 s5, s89, 0
    s_lshl_b32 s5, s5, 3
    v_mov_b32 v3, s4
    v_cmp_gt_u32 vcc, 4, v0
    v_mov_b32 v30, s3
    v_bfrev_b32 v4, 1
    v_cndmask_b32 v30, v3, v30, vcc
    v_cmp_gt_u32 vcc, s5, v0
    v_lshl_add_u32 v30, v0, 4, v30
    v_mov_b32 v3, 0
    v_cndmask_b32 v30, v4, v30, vcc
    buffer_store_dword v3, v30, s[68:71], 0 offen sc1
    v_mfma_f32_16x16x32_bf16 a[112:115], a[216:219], a[160:163], a[112:115]
    ds_read_b64_tr_b16 a[200:201], v57 offset:32768
    ds_read_b64_tr_b16 a[202:203], v57 offset:34816
    v_mfma_f32_16x16x32_bf16 a[112:115], a[220:223], a[164:167], a[112:115]
    ds_read_b64_tr_b16 a[204:205], v57 offset:49152
    ds_read_b64_tr_b16 a[206:207], v57 offset:51200
    v_mfma_f32_16x16x32_bf16 a[116:119], a[216:219], a[168:171], a[116:119]
    v_mfma_f32_16x16x32_bf16 a[116:119], a[220:223], a[172:175], a[116:119]
    v_mfma_f32_16x16x32_bf16 a[120:123], a[216:219], a[176:179], a[120:123]
    v_mfma_f32_16x16x32_bf16 a[120:123], a[220:223], a[180:183], a[120:123]
    v_mfma_f32_16x16x32_bf16 a[124:127], a[216:219], a[184:187], a[124:127]
    v_mfma_f32_16x16x32_bf16 a[124:127], a[220:223], a[188:191], a[124:127]
    s_waitcnt lgkmcnt(4)
    v_mfma_f32_16x16x32_bf16 v[160:163], a[192:195], a[128:131], v[160:163]
    ds_read_b64_tr_b16 a[208:209], v58 offset:32768
    ds_read_b64_tr_b16 a[210:211], v58 offset:34816
    v_mfma_f32_16x16x32_bf16 v[160:163], a[196:199], a[132:135], v[160:163]
    ds_read_b64_tr_b16 a[212:213], v58 offset:49152
    ds_read_b64_tr_b16 a[214:215], v58 offset:51200
    v_mfma_f32_16x16x32_bf16 v[176:179], a[192:195], a[136:139], v[176:179]
    v_mfma_f32_16x16x32_bf16 v[176:179], a[196:199], a[140:143], v[176:179]
    s_add_u32 m0, s48, 32768
    v_mfma_f32_16x16x32_bf16 v[192:195], a[192:195], a[144:147], v[192:195]
    buffer_load_dwordx4 v32, s[16:19], s46 offen offset:0 lds
    v_mfma_f32_16x16x32_bf16 v[192:195], a[196:199], a[148:151], v[192:195]
    v_mfma_f32_16x16x32_bf16 v[208:211], a[192:195], a[152:155], v[208:211]
    v_mfma_f32_16x16x32_bf16 v[208:211], a[196:199], a[156:159], v[208:211]
    s_waitcnt lgkmcnt(4)
    v_mfma_f32_16x16x32_bf16 v[164:167], a[200:203], a[128:131], v[164:167]
    ds_read_b64_tr_b16 a[216:217], v59 offset:32768
    ds_read_b64_tr_b16 a[218:219], v59 offset:34816
    v_mfma_f32_16x16x32_bf16 v[164:167], a[204:207], a[132:135], v[164:167]
    ds_read_b64_tr_b16 a[220:221], v59 offset:49152
    ds_read_b64_tr_b16 a[222:223], v59 offset:51200
    v_mfma_f32_16x16x32_bf16 v[180:183], a[200:203], a[136:139], v[180:183]
    buffer_load_dwordx4 v33, s[16:19], s46 offen offset:1024 lds
    v_mfma_f32_16x16x32_bf16 v[180:183], a[204:207], a[140:143], v[180:183]
    v_mfma_f32_16x16x32_bf16 v[196:199], a[200:203], a[144:147], v[196:199]
    v_mfma_f32_16x16x32_bf16 v[196:199], a[204:207], a[148:151], v[196:199]
    v_mfma_f32_16x16x32_bf16 v[212:215], a[200:203], a[152:155], v[212:215]
    v_mfma_f32_16x16x32_bf16 v[212:215], a[204:207], a[156:159], v[212:215]
    s_waitcnt lgkmcnt(4)
    v_mfma_f32_16x16x32_bf16 v[96:99], a[208:211], a[128:131], v[96:99]
    ds_read_b64_tr_b16 a[192:193], v60 offset:32768
    ds_read_b64_tr_b16 a[194:195], v60 offset:34816
    v_mfma_f32_16x16x32_bf16 v[96:99], a[212:215], a[132:135], v[96:99]
    ds_read_b64_tr_b16 a[196:197], v60 offset:49152
    ds_read_b64_tr_b16 a[198:199], v60 offset:51200
    s_add_u32 m0, s48, 34816
    v_mfma_f32_16x16x32_bf16 v[112:115], a[208:211], a[136:139], v[112:115]
    buffer_load_dwordx4 v34, s[16:19], s46 offen offset:0 lds
    v_mfma_f32_16x16x32_bf16 v[112:115], a[212:215], a[140:143], v[112:115]
    v_mfma_f32_16x16x32_bf16 v[128:131], a[208:211], a[144:147], v[128:131]
    v_mfma_f32_16x16x32_bf16 v[128:131], a[212:215], a[148:151], v[128:131]
    v_mfma_f32_16x16x32_bf16 v[144:147], a[208:211], a[152:155], v[144:147]
    v_mfma_f32_16x16x32_bf16 v[144:147], a[212:215], a[156:159], v[144:147]
    s_waitcnt lgkmcnt(4)
    v_mfma_f32_16x16x32_bf16 v[100:103], a[216:219], a[128:131], v[100:103]
    ds_read_b64_tr_b16 a[200:201], v61 offset:32768
    ds_read_b64_tr_b16 a[202:203], v61 offset:34816
    buffer_load_dwordx4 v35, s[16:19], s46 offen offset:1024 lds
    v_mfma_f32_16x16x32_bf16 v[100:103], a[220:223], a[132:135], v[100:103]
    ds_read_b64_tr_b16 a[204:205], v61 offset:49152
    ds_read_b64_tr_b16 a[206:207], v61 offset:51200
    v_mfma_f32_16x16x32_bf16 v[116:119], a[216:219], a[136:139], v[116:119]
    v_mfma_f32_16x16x32_bf16 v[116:119], a[220:223], a[140:143], v[116:119]
    v_mfma_f32_16x16x32_bf16 v[132:135], a[216:219], a[144:147], v[132:135]
    v_mfma_f32_16x16x32_bf16 v[132:135], a[220:223], a[148:151], v[132:135]
    v_mfma_f32_16x16x32_bf16 v[148:151], a[216:219], a[152:155], v[148:151]
    v_mfma_f32_16x16x32_bf16 v[148:151], a[220:223], a[156:159], v[148:151]
    s_add_u32 m0, s48, 36864
    s_waitcnt lgkmcnt(4)
    v_mfma_f32_16x16x32_bf16 v[168:171], a[192:195], a[128:131], v[168:171]
    ds_read_b64_tr_b16 a[208:209], v62 offset:32768
    ds_read_b64_tr_b16 a[210:211], v62 offset:34816
    buffer_load_dwordx4 v36, s[16:19], s46 offen offset:0 lds
    v_mfma_f32_16x16x32_bf16 v[168:171], a[196:199], a[132:135], v[168:171]
    ds_read_b64_tr_b16 a[212:213], v62 offset:49152
    ds_read_b64_tr_b16 a[214:215], v62 offset:51200
    v_mfma_f32_16x16x32_bf16 v[184:187], a[192:195], a[136:139], v[184:187]
    v_mfma_f32_16x16x32_bf16 v[184:187], a[196:199], a[140:143], v[184:187]
    v_mfma_f32_16x16x32_bf16 v[200:203], a[192:195], a[144:147], v[200:203]
    v_mfma_f32_16x16x32_bf16 v[200:203], a[196:199], a[148:151], v[200:203]
    v_mfma_f32_16x16x32_bf16 v[216:219], a[192:195], a[152:155], v[216:219]
    buffer_load_dwordx4 v37, s[16:19], s46 offen offset:1024 lds
    v_mfma_f32_16x16x32_bf16 v[216:219], a[196:199], a[156:159], v[216:219]
    s_waitcnt lgkmcnt(4)
    v_mfma_f32_16x16x32_bf16 v[172:175], a[200:203], a[128:131], v[172:175]
    ds_read_b64_tr_b16 a[216:217], v63 offset:32768
    ds_read_b64_tr_b16 a[218:219], v63 offset:34816
    v_mfma_f32_16x16x32_bf16 v[172:175], a[204:207], a[132:135], v[172:175]
    ds_read_b64_tr_b16 a[220:221], v63 offset:49152
    ds_read_b64_tr_b16 a[222:223], v63 offset:51200
    v_mfma_f32_16x16x32_bf16 v[188:191], a[200:203], a[136:139], v[188:191]
    v_mfma_f32_16x16x32_bf16 v[188:191], a[204:207], a[140:143], v[188:191]
    v_mfma_f32_16x16x32_bf16 v[204:207], a[200:203], a[144:147], v[204:207]
    v_mfma_f32_16x16x32_bf16 v[204:207], a[204:207], a[148:151], v[204:207]
    s_add_u32 m0, s48, 38912
    v_mfma_f32_16x16x32_bf16 v[220:223], a[200:203], a[152:155], v[220:223]
    buffer_load_dwordx4 v38, s[16:19], s46 offen offset:0 lds
    v_mfma_f32_16x16x32_bf16 v[220:223], a[204:207], a[156:159], v[220:223]
    s_waitcnt lgkmcnt(4)
    v_mfma_f32_16x16x32_bf16 v[104:107], a[208:211], a[128:131], v[104:107]
    ds_read_b64_tr_b16 a[192:193], v56 offset:33024
    ds_read_b64_tr_b16 a[194:195], v56 offset:35072
    v_mfma_f32_16x16x32_bf16 v[104:107], a[212:215], a[132:135], v[104:107]
    ds_read_b64_tr_b16 a[196:197], v56 offset:49408
    ds_read_b64_tr_b16 a[198:199], v56 offset:51456
    s_waitcnt vmcnt(18)
    v_mfma_f32_16x16x32_bf16 v[120:123], a[208:211], a[136:139], v[120:123]
    ds_read_b128 a[160:163], v6 offset:0
    v_mfma_f32_16x16x32_bf16 v[120:123], a[212:215], a[140:143], v[120:123]
    v_mfma_f32_16x16x32_bf16 v[136:139], a[208:211], a[144:147], v[136:139]
    buffer_load_dwordx4 v39, s[16:19], s46 offen offset:1024 lds
    v_mfma_f32_16x16x32_bf16 v[136:139], a[212:215], a[148:151], v[136:139]
    s_add_u32 s46, s46, 128
    v_mfma_f32_16x16x32_bf16 v[152:155], a[208:211], a[152:155], v[152:155]
    v_mfma_f32_16x16x32_bf16 v[152:155], a[212:215], a[156:159], v[152:155]
    s_waitcnt lgkmcnt(5)
    v_mfma_f32_16x16x32_bf16 v[108:111], a[216:219], a[128:131], v[108:111]
    ds_read_b64_tr_b16 a[200:201], v57 offset:33024
    ds_read_b64_tr_b16 a[202:203], v57 offset:35072
    v_mfma_f32_16x16x32_bf16 v[108:111], a[220:223], a[132:135], v[108:111]
    ds_read_b64_tr_b16 a[204:205], v57 offset:49408
    ds_read_b64_tr_b16 a[206:207], v57 offset:51456
    v_mfma_f32_16x16x32_bf16 v[124:127], a[216:219], a[136:139], v[124:127]
    ds_read_b128 a[164:167], v7 offset:0
    v_mfma_f32_16x16x32_bf16 v[124:127], a[220:223], a[140:143], v[124:127]
    s_add_u32 m0, s48, 65536
    v_mfma_f32_16x16x32_bf16 v[140:143], a[216:219], a[144:147], v[140:143]
    buffer_load_dwordx4 v40, s[20:23], s47 offen offset:0 lds
    v_mfma_f32_16x16x32_bf16 v[140:143], a[220:223], a[148:151], v[140:143]
    v_mfma_f32_16x16x32_bf16 v[156:159], a[216:219], a[152:155], v[156:159]
    v_mfma_f32_16x16x32_bf16 v[156:159], a[220:223], a[156:159], v[156:159]
    s_waitcnt lgkmcnt(6)
    v_mfma_f32_16x16x32_bf16 a[0:3], a[192:195], a[128:131], a[0:3]
    ds_read_b64_tr_b16 a[208:209], v58 offset:33024
    ds_read_b64_tr_b16 a[210:211], v58 offset:35072
    v_mfma_f32_16x16x32_bf16 a[0:3], a[196:199], a[132:135], a[0:3]
    ds_read_b64_tr_b16 a[212:213], v58 offset:49408
    ds_read_b64_tr_b16 a[214:215], v58 offset:51456
    v_mfma_f32_16x16x32_bf16 a[4:7], a[192:195], a[136:139], a[4:7]
    ds_read_b128 a[168:171], v6 offset:2048
    buffer_load_dwordx4 v41, s[20:23], s47 offen offset:1024 lds
    v_mfma_f32_16x16x32_bf16 a[4:7], a[196:199], a[140:143], a[4:7]
    v_mfma_f32_16x16x32_bf16 a[8:11], a[192:195], a[144:147], a[8:11]
    v_mfma_f32_16x16x32_bf16 a[8:11], a[196:199], a[148:151], a[8:11]
    v_mfma_f32_16x16x32_bf16 a[12:15], a[192:195], a[152:155], a[12:15]
    v_mfma_f32_16x16x32_bf16 a[12:15], a[196:199], a[156:159], a[12:15]
    s_waitcnt lgkmcnt(6)
    v_mfma_f32_16x16x32_bf16 a[16:19], a[200:203], a[128:131], a[16:19]
    ds_read_b64_tr_b16 a[216:217], v59 offset:33024
    ds_read_b64_tr_b16 a[218:219], v59 offset:35072
    v_mfma_f32_16x16x32_bf16 a[16:19], a[204:207], a[132:135], a[16:19]
    ds_read_b64_tr_b16 a[220:221], v59 offset:49408
    ds_read_b64_tr_b16 a[222:223], v59 offset:51456
    v_mfma_f32_16x16x32_bf16 a[20:23], a[200:203], a[136:139], a[20:23]
    ds_read_b128 a[172:175], v7 offset:2048
    buffer_load_dwordx4 v42, s[20:23], s47 offen offset:2048 lds
    v_mfma_f32_16x16x32_bf16 a[20:23], a[204:207], a[140:143], a[20:23]
    v_mfma_f32_16x16x32_bf16 a[24:27], a[200:203], a[144:147], a[24:27]
    v_mfma_f32_16x16x32_bf16 a[24:27], a[204:207], a[148:151], a[24:27]
    v_mfma_f32_16x16x32_bf16 a[28:31], a[200:203], a[152:155], a[28:31]
    v_mfma_f32_16x16x32_bf16 a[28:31], a[204:207], a[156:159], a[28:31]
    s_waitcnt lgkmcnt(6)
    v_mfma_f32_16x16x32_bf16 a[32:35], a[208:211], a[128:131], a[32:35]
    ds_read_b64_tr_b16 a[192:193], v60 offset:33024
    ds_read_b64_tr_b16 a[194:195], v60 offset:35072
    buffer_load_dwordx4 v43, s[20:23], s47 offen offset:3072 lds
    v_mfma_f32_16x16x32_bf16 a[32:35], a[212:215], a[132:135], a[32:35]
    ds_read_b64_tr_b16 a[196:197], v60 offset:49408
    ds_read_b64_tr_b16 a[198:199], v60 offset:51456
    v_mfma_f32_16x16x32_bf16 a[36:39], a[208:211], a[136:139], a[36:39]
    ds_read_b128 a[176:179], v6 offset:4096
    v_mfma_f32_16x16x32_bf16 a[36:39], a[212:215], a[140:143], a[36:39]
    v_mfma_f32_16x16x32_bf16 a[40:43], a[208:211], a[144:147], a[40:43]
    v_mfma_f32_16x16x32_bf16 a[40:43], a[212:215], a[148:151], a[40:43]
    v_mfma_f32_16x16x32_bf16 a[44:47], a[208:211], a[152:155], a[44:47]
    v_mfma_f32_16x16x32_bf16 a[44:47], a[212:215], a[156:159], a[44:47]
    s_add_u32 m0, s48, 69632
    s_waitcnt lgkmcnt(6)
    v_mfma_f32_16x16x32_bf16 a[48:51], a[216:219], a[128:131], a[48:51]
    ds_read_b64_tr_b16 a[200:201], v61 offset:33024
    ds_read_b64_tr_b16 a[202:203], v61 offset:35072
    buffer_load_dwordx4 v44, s[20:23], s47 offen offset:0 lds
    v_mfma_f32_16x16x32_bf16 a[48:51], a[220:223], a[132:135], a[48:51]
    ds_read_b64_tr_b16 a[204:205], v61 offset:49408
    ds_read_b64_tr_b16 a[206:207], v61 offset:51456
    v_mfma_f32_16x16x32_bf16 a[52:55], a[216:219], a[136:139], a[52:55]
    ds_read_b128 a[180:183], v7 offset:4096
    v_mfma_f32_16x16x32_bf16 a[52:55], a[220:223], a[140:143], a[52:55]
    v_mfma_f32_16x16x32_bf16 a[56:59], a[216:219], a[144:147], a[56:59]
    v_mfma_f32_16x16x32_bf16 a[56:59], a[220:223], a[148:151], a[56:59]
    v_mfma_f32_16x16x32_bf16 a[60:63], a[216:219], a[152:155], a[60:63]
    buffer_load_dwordx4 v45, s[20:23], s47 offen offset:1024 lds
    v_mfma_f32_16x16x32_bf16 a[60:63], a[220:223], a[156:159], a[60:63]
    s_waitcnt lgkmcnt(6)
    v_mfma_f32_16x16x32_bf16 a[64:67], a[192:195], a[128:131], a[64:67]
    ds_read_b64_tr_b16 a[208:209], v62 offset:33024
    ds_read_b64_tr_b16 a[210:211], v62 offset:35072
    v_mfma_f32_16x16x32_bf16 a[64:67], a[196:199], a[132:135], a[64:67]
    ds_read_b64_tr_b16 a[212:213], v62 offset:49408
    ds_read_b64_tr_b16 a[214:215], v62 offset:51456
    v_mfma_f32_16x16x32_bf16 a[68:71], a[192:195], a[136:139], a[68:71]
    ds_read_b128 a[184:187], v6 offset:6144
    v_mfma_f32_16x16x32_bf16 a[68:71], a[196:199], a[140:143], a[68:71]
    v_mfma_f32_16x16x32_bf16 a[72:75], a[192:195], a[144:147], a[72:75]
    v_mfma_f32_16x16x32_bf16 a[72:75], a[196:199], a[148:151], a[72:75]
    v_mfma_f32_16x16x32_bf16 a[76:79], a[192:195], a[152:155], a[76:79]
    buffer_load_dwordx4 v46, s[20:23], s47 offen offset:2048 lds
    v_mfma_f32_16x16x32_bf16 a[76:79], a[196:199], a[156:159], a[76:79]
    s_waitcnt lgkmcnt(6)
    v_mfma_f32_16x16x32_bf16 a[80:83], a[200:203], a[128:131], a[80:83]
    ds_read_b64_tr_b16 a[216:217], v63 offset:33024
    ds_read_b64_tr_b16 a[218:219], v63 offset:35072
    v_mfma_f32_16x16x32_bf16 a[80:83], a[204:207], a[132:135], a[80:83]
    ds_read_b64_tr_b16 a[220:221], v63 offset:49408
    ds_read_b64_tr_b16 a[222:223], v63 offset:51456
    v_mfma_f32_16x16x32_bf16 a[84:87], a[200:203], a[136:139], a[84:87]
    ds_read_b128 a[188:191], v7 offset:6144
    v_mfma_f32_16x16x32_bf16 a[84:87], a[204:207], a[140:143], a[84:87]
    v_mfma_f32_16x16x32_bf16 a[88:91], a[200:203], a[144:147], a[88:91]
    buffer_load_dwordx4 v47, s[20:23], s47 offen offset:3072 lds
    v_mfma_f32_16x16x32_bf16 a[88:91], a[204:207], a[148:151], a[88:91]
    s_add_u32 s47, s47, 524288
    v_mfma_f32_16x16x32_bf16 a[92:95], a[200:203], a[152:155], a[92:95]
    v_mfma_f32_16x16x32_bf16 a[92:95], a[204:207], a[156:159], a[92:95]
    s_mov_b32 s3, 0
    buffer_load_dword v29, v64, s[8:11], s3 offen nt
    s_waitcnt vmcnt(20) lgkmcnt(0)
    s_barrier
    v_mfma_f32_16x16x32_bf16 a[96:99], a[208:211], a[128:131], a[96:99]
    ds_read_b64_tr_b16 a[192:193], v56 offset:0
    ds_read_b64_tr_b16 a[194:195], v56 offset:2048
    v_mfma_f32_16x16x32_bf16 a[96:99], a[212:215], a[132:135], a[96:99]
    ds_read_b64_tr_b16 a[196:197], v56 offset:16384
    ds_read_b64_tr_b16 a[198:199], v56 offset:18432
    v_mfma_f32_16x16x32_bf16 a[100:103], a[208:211], a[136:139], a[100:103]
    v_mfma_f32_16x16x32_bf16 a[100:103], a[212:215], a[140:143], a[100:103]
    v_mfma_f32_16x16x32_bf16 a[104:107], a[208:211], a[144:147], a[104:107]
    v_mfma_f32_16x16x32_bf16 a[104:107], a[212:215], a[148:151], a[104:107]
    v_mfma_f32_16x16x32_bf16 a[108:111], a[208:211], a[152:155], a[108:111]
    v_mfma_f32_16x16x32_bf16 a[108:111], a[212:215], a[156:159], a[108:111]
    v_mfma_f32_16x16x32_bf16 a[112:115], a[216:219], a[128:131], a[112:115]
    ds_read_b64_tr_b16 a[200:201], v57 offset:0
    ds_read_b64_tr_b16 a[202:203], v57 offset:2048
    v_mfma_f32_16x16x32_bf16 a[112:115], a[220:223], a[132:135], a[112:115]
    ds_read_b64_tr_b16 a[204:205], v57 offset:16384
    ds_read_b64_tr_b16 a[206:207], v57 offset:18432
    v_mfma_f32_16x16x32_bf16 a[116:119], a[216:219], a[136:139], a[116:119]
    v_mfma_f32_16x16x32_bf16 a[116:119], a[220:223], a[140:143], a[116:119]
    v_mfma_f32_16x16x32_bf16 a[120:123], a[216:219], a[144:147], a[120:123]
    v_mfma_f32_16x16x32_bf16 a[120:123], a[220:223], a[148:151], a[120:123]
    v_mfma_f32_16x16x32_bf16 a[124:127], a[216:219], a[152:155], a[124:127]
    v_mfma_f32_16x16x32_bf16 a[124:127], a[220:223], a[156:159], a[124:127]
    s_waitcnt lgkmcnt(4)
    v_mfma_f32_16x16x32_bf16 v[160:163], a[192:195], a[160:163], v[160:163]
    ds_read_b64_tr_b16 a[208:209], v58 offset:0
    ds_read_b64_tr_b16 a[210:211], v58 offset:2048
    v_mfma_f32_16x16x32_bf16 v[160:163], a[196:199], a[164:167], v[160:163]
    ds_read_b64_tr_b16 a[212:213], v58 offset:16384
    ds_read_b64_tr_b16 a[214:215], v58 offset:18432
    v_mfma_f32_16x16x32_bf16 v[176:179], a[192:195], a[168:171], v[176:179]
    v_mfma_f32_16x16x32_bf16 v[176:179], a[196:199], a[172:175], v[176:179]
    s_add_u32 m0, s48, 0
    v_mfma_f32_16x16x32_bf16 v[192:195], a[192:195], a[176:179], v[192:195]
    buffer_load_dwordx4 v32, s[16:19], s46 offen offset:0 lds
    v_mfma_f32_16x16x32_bf16 v[192:195], a[196:199], a[180:183], v[192:195]
    v_mfma_f32_16x16x32_bf16 v[208:211], a[192:195], a[184:187], v[208:211]
    v_mfma_f32_16x16x32_bf16 v[208:211], a[196:199], a[188:191], v[208:211]
    s_waitcnt lgkmcnt(4)
    v_mfma_f32_16x16x32_bf16 v[164:167], a[200:203], a[160:163], v[164:167]
    ds_read_b64_tr_b16 a[216:217], v59 offset:0
    ds_read_b64_tr_b16 a[218:219], v59 offset:2048
    v_mfma_f32_16x16x32_bf16 v[164:167], a[204:207], a[164:167], v[164:167]
    ds_read_b64_tr_b16 a[220:221], v59 offset:16384
    ds_read_b64_tr_b16 a[222:223], v59 offset:18432
    v_mfma_f32_16x16x32_bf16 v[180:183], a[200:203], a[168:171], v[180:183]
    buffer_load_dwordx4 v33, s[16:19], s46 offen offset:1024 lds
    v_mfma_f32_16x16x32_bf16 v[180:183], a[204:207], a[172:175], v[180:183]
    v_mfma_f32_16x16x32_bf16 v[196:199], a[200:203], a[176:179], v[196:199]
    v_mfma_f32_16x16x32_bf16 v[196:199], a[204:207], a[180:183], v[196:199]
    v_mfma_f32_16x16x32_bf16 v[212:215], a[200:203], a[184:187], v[212:215]
    v_mfma_f32_16x16x32_bf16 v[212:215], a[204:207], a[188:191], v[212:215]
    s_waitcnt lgkmcnt(4)
    v_mfma_f32_16x16x32_bf16 v[96:99], a[208:211], a[160:163], v[96:99]
    ds_read_b64_tr_b16 a[192:193], v60 offset:0
    ds_read_b64_tr_b16 a[194:195], v60 offset:2048
    v_mfma_f32_16x16x32_bf16 v[96:99], a[212:215], a[164:167], v[96:99]
    ds_read_b64_tr_b16 a[196:197], v60 offset:16384
    ds_read_b64_tr_b16 a[198:199], v60 offset:18432
    s_add_u32 m0, s48, 2048
    v_mfma_f32_16x16x32_bf16 v[112:115], a[208:211], a[168:171], v[112:115]
    buffer_load_dwordx4 v34, s[16:19], s46 offen offset:0 lds
    v_mfma_f32_16x16x32_bf16 v[112:115], a[212:215], a[172:175], v[112:115]
    v_mfma_f32_16x16x32_bf16 v[128:131], a[208:211], a[176:179], v[128:131]
    v_mfma_f32_16x16x32_bf16 v[128:131], a[212:215], a[180:183], v[128:131]
    v_mfma_f32_16x16x32_bf16 v[144:147], a[208:211], a[184:187], v[144:147]
    v_mfma_f32_16x16x32_bf16 v[144:147], a[212:215], a[188:191], v[144:147]
    s_waitcnt lgkmcnt(4)
    v_mfma_f32_16x16x32_bf16 v[100:103], a[216:219], a[160:163], v[100:103]
    ds_read_b64_tr_b16 a[200:201], v61 offset:0
    ds_read_b64_tr_b16 a[202:203], v61 offset:2048
    buffer_load_dwordx4 v35, s[16:19], s46 offen offset:1024 lds
    v_mfma_f32_16x16x32_bf16 v[100:103], a[220:223], a[164:167], v[100:103]
    ds_read_b64_tr_b16 a[204:205], v61 offset:16384
    ds_read_b64_tr_b16 a[206:207], v61 offset:18432
    v_mfma_f32_16x16x32_bf16 v[116:119], a[216:219], a[168:171], v[116:119]
    v_mfma_f32_16x16x32_bf16 v[116:119], a[220:223], a[172:175], v[116:119]
    v_mfma_f32_16x16x32_bf16 v[132:135], a[216:219], a[176:179], v[132:135]
    v_mfma_f32_16x16x32_bf16 v[132:135], a[220:223], a[180:183], v[132:135]
    v_mfma_f32_16x16x32_bf16 v[148:151], a[216:219], a[184:187], v[148:151]
    v_mfma_f32_16x16x32_bf16 v[148:151], a[220:223], a[188:191], v[148:151]
    s_add_u32 m0, s48, 4096
    s_waitcnt lgkmcnt(4)
    v_mfma_f32_16x16x32_bf16 v[168:171], a[192:195], a[160:163], v[168:171]
    ds_read_b64_tr_b16 a[208:209], v62 offset:0
    ds_read_b64_tr_b16 a[210:211], v62 offset:2048
    buffer_load_dwordx4 v36, s[16:19], s46 offen offset:0 lds
    v_mfma_f32_16x16x32_bf16 v[168:171], a[196:199], a[164:167], v[168:171]
    ds_read_b64_tr_b16 a[212:213], v62 offset:16384
    ds_read_b64_tr_b16 a[214:215], v62 offset:18432
    v_mfma_f32_16x16x32_bf16 v[184:187], a[192:195], a[168:171], v[184:187]
    v_mfma_f32_16x16x32_bf16 v[184:187], a[196:199], a[172:175], v[184:187]
    v_mfma_f32_16x16x32_bf16 v[200:203], a[192:195], a[176:179], v[200:203]
    v_mfma_f32_16x16x32_bf16 v[200:203], a[196:199], a[180:183], v[200:203]
    v_mfma_f32_16x16x32_bf16 v[216:219], a[192:195], a[184:187], v[216:219]
    buffer_load_dwordx4 v37, s[16:19], s46 offen offset:1024 lds
    v_mfma_f32_16x16x32_bf16 v[216:219], a[196:199], a[188:191], v[216:219]
    s_waitcnt lgkmcnt(4)
    v_mfma_f32_16x16x32_bf16 v[172:175], a[200:203], a[160:163], v[172:175]
    ds_read_b64_tr_b16 a[216:217], v63 offset:0
    ds_read_b64_tr_b16 a[218:219], v63 offset:2048
    v_mfma_f32_16x16x32_bf16 v[172:175], a[204:207], a[164:167], v[172:175]
    ds_read_b64_tr_b16 a[220:221], v63 offset:16384
    ds_read_b64_tr_b16 a[222:223], v63 offset:18432
    v_mfma_f32_16x16x32_bf16 v[188:191], a[200:203], a[168:171], v[188:191]
    v_mfma_f32_16x16x32_bf16 v[188:191], a[204:207], a[172:175], v[188:191]
    v_mfma_f32_16x16x32_bf16 v[204:207], a[200:203], a[176:179], v[204:207]
    v_mfma_f32_16x16x32_bf16 v[204:207], a[204:207], a[180:183], v[204:207]
    s_add_u32 m0, s48, 6144
    v_mfma_f32_16x16x32_bf16 v[220:223], a[200:203], a[184:187], v[220:223]
    buffer_load_dwordx4 v38, s[16:19], s46 offen offset:0 lds
    v_mfma_f32_16x16x32_bf16 v[220:223], a[204:207], a[188:191], v[220:223]
    s_waitcnt lgkmcnt(4)
    v_mfma_f32_16x16x32_bf16 v[104:107], a[208:211], a[160:163], v[104:107]
    ds_read_b64_tr_b16 a[192:193], v56 offset:256
    ds_read_b64_tr_b16 a[194:195], v56 offset:2304
    v_mfma_f32_16x16x32_bf16 v[104:107], a[212:215], a[164:167], v[104:107]
    ds_read_b64_tr_b16 a[196:197], v56 offset:16640
    ds_read_b64_tr_b16 a[198:199], v56 offset:18688
    s_waitcnt vmcnt(16)
    v_mfma_f32_16x16x32_bf16 v[120:123], a[208:211], a[168:171], v[120:123]
    ds_read_b128 a[128:131], v6 offset:32768
    v_mfma_f32_16x16x32_bf16 v[120:123], a[212:215], a[172:175], v[120:123]
    v_mfma_f32_16x16x32_bf16 v[136:139], a[208:211], a[176:179], v[136:139]
    buffer_load_dwordx4 v39, s[16:19], s46 offen offset:1024 lds
    v_mfma_f32_16x16x32_bf16 v[136:139], a[212:215], a[180:183], v[136:139]
    s_add_u32 s46, s46, 128
    v_mfma_f32_16x16x32_bf16 v[152:155], a[208:211], a[184:187], v[152:155]
    v_mfma_f32_16x16x32_bf16 v[152:155], a[212:215], a[188:191], v[152:155]
    s_waitcnt lgkmcnt(5)
    v_mfma_f32_16x16x32_bf16 v[108:111], a[216:219], a[160:163], v[108:111]
    ds_read_b64_tr_b16 a[200:201], v57 offset:256
    ds_read_b64_tr_b16 a[202:203], v57 offset:2304
    v_mfma_f32_16x16x32_bf16 v[108:111], a[220:223], a[164:167], v[108:111]
    ds_read_b64_tr_b16 a[204:205], v57 offset:16640
    ds_read_b64_tr_b16 a[206:207], v57 offset:18688
    v_mfma_f32_16x16x32_bf16 v[124:127], a[216:219], a[168:171], v[124:127]
    ds_read_b128 a[132:135], v7 offset:32768
    v_mfma_f32_16x16x32_bf16 v[124:127], a[220:223], a[172:175], v[124:127]
    s_add_u32 m0, s48, 131072
    v_mfma_f32_16x16x32_bf16 v[140:143], a[216:219], a[176:179], v[140:143]
    buffer_load_dwordx4 v40, s[20:23], s47 offen offset:0 lds
    v_mfma_f32_16x16x32_bf16 v[140:143], a[220:223], a[180:183], v[140:143]
    v_mfma_f32_16x16x32_bf16 v[156:159], a[216:219], a[184:187], v[156:159]
    v_mfma_f32_16x16x32_bf16 v[156:159], a[220:223], a[188:191], v[156:159]
    s_waitcnt lgkmcnt(6)
    v_mfma_f32_16x16x32_bf16 a[0:3], a[192:195], a[160:163], a[0:3]
    ds_read_b64_tr_b16 a[208:209], v58 offset:256
    ds_read_b64_tr_b16 a[210:211], v58 offset:2304
    v_mfma_f32_16x16x32_bf16 a[0:3], a[196:199], a[164:167], a[0:3]
    ds_read_b64_tr_b16 a[212:213], v58 offset:16640
    ds_read_b64_tr_b16 a[214:215], v58 offset:18688
    v_mfma_f32_16x16x32_bf16 a[4:7], a[192:195], a[168:171], a[4:7]
    ds_read_b128 a[136:139], v6 offset:34816
    buffer_load_dwordx4 v41, s[20:23], s47 offen offset:1024 lds
    v_mfma_f32_16x16x32_bf16 a[4:7], a[196:199], a[172:175], a[4:7]
    v_mfma_f32_16x16x32_bf16 a[8:11], a[192:195], a[176:179], a[8:11]
    v_mfma_f32_16x16x32_bf16 a[8:11], a[196:199], a[180:183], a[8:11]
    v_mfma_f32_16x16x32_bf16 a[12:15], a[192:195], a[184:187], a[12:15]
    v_mfma_f32_16x16x32_bf16 a[12:15], a[196:199], a[188:191], a[12:15]
    s_waitcnt lgkmcnt(6)
    v_mfma_f32_16x16x32_bf16 a[16:19], a[200:203], a[160:163], a[16:19]
    ds_read_b64_tr_b16 a[216:217], v59 offset:256
    ds_read_b64_tr_b16 a[218:219], v59 offset:2304
    v_mfma_f32_16x16x32_bf16 a[16:19], a[204:207], a[164:167], a[16:19]
    ds_read_b64_tr_b16 a[220:221], v59 offset:16640
    ds_read_b64_tr_b16 a[222:223], v59 offset:18688
    v_mfma_f32_16x16x32_bf16 a[20:23], a[200:203], a[168:171], a[20:23]
    ds_read_b128 a[140:143], v7 offset:34816
    buffer_load_dwordx4 v42, s[20:23], s47 offen offset:2048 lds
    v_mfma_f32_16x16x32_bf16 a[20:23], a[204:207], a[172:175], a[20:23]
    v_mfma_f32_16x16x32_bf16 a[24:27], a[200:203], a[176:179], a[24:27]
    v_mfma_f32_16x16x32_bf16 a[24:27], a[204:207], a[180:183], a[24:27]
    v_mfma_f32_16x16x32_bf16 a[28:31], a[200:203], a[184:187], a[28:31]
    v_mfma_f32_16x16x32_bf16 a[28:31], a[204:207], a[188:191], a[28:31]
    s_waitcnt lgkmcnt(6)
    v_mfma_f32_16x16x32_bf16 a[32:35], a[208:211], a[160:163], a[32:35]
    ds_read_b64_tr_b16 a[192:193], v60 offset:256
    ds_read_b64_tr_b16 a[194:195], v60 offset:2304
    buffer_load_dwordx4 v43, s[20:23], s47 offen offset:3072 lds
    v_mfma_f32_16x16x32_bf16 a[32:35], a[212:215], a[164:167], a[32:35]
    ds_read_b64_tr_b16 a[196:197], v60 offset:16640
    ds_read_b64_tr_b16 a[198:199], v60 offset:18688
    v_mfma_f32_16x16x32_bf16 a[36:39], a[208:211], a[168:171], a[36:39]
    ds_read_b128 a[144:147], v6 offset:36864
    v_mfma_f32_16x16x32_bf16 a[36:39], a[212:215], a[172:175], a[36:39]
    v_mfma_f32_16x16x32_bf16 a[40:43], a[208:211], a[176:179], a[40:43]
    v_mfma_f32_16x16x32_bf16 a[40:43], a[212:215], a[180:183], a[40:43]
    v_mfma_f32_16x16x32_bf16 a[44:47], a[208:211], a[184:187], a[44:47]
    v_mfma_f32_16x16x32_bf16 a[44:47], a[212:215], a[188:191], a[44:47]
    s_add_u32 m0, s48, 135168
    s_waitcnt lgkmcnt(6)
    v_mfma_f32_16x16x32_bf16 a[48:51], a[216:219], a[160:163], a[48:51]
    ds_read_b64_tr_b16 a[200:201], v61 offset:256
    ds_read_b64_tr_b16 a[202:203], v61 offset:2304
    buffer_load_dwordx4 v44, s[20:23], s47 offen offset:0 lds
    v_mfma_f32_16x16x32_bf16 a[48:51], a[220:223], a[164:167], a[48:51]
    ds_read_b64_tr_b16 a[204:205], v61 offset:16640
    ds_read_b64_tr_b16 a[206:207], v61 offset:18688
    v_mfma_f32_16x16x32_bf16 a[52:55], a[216:219], a[168:171], a[52:55]
    ds_read_b128 a[148:151], v7 offset:36864
    v_mfma_f32_16x16x32_bf16 a[52:55], a[220:223], a[172:175], a[52:55]
    v_mfma_f32_16x16x32_bf16 a[56:59], a[216:219], a[176:179], a[56:59]
    v_mfma_f32_16x16x32_bf16 a[56:59], a[220:223], a[180:183], a[56:59]
    v_mfma_f32_16x16x32_bf16 a[60:63], a[216:219], a[184:187], a[60:63]
    buffer_load_dwordx4 v45, s[20:23], s47 offen offset:1024 lds
    v_mfma_f32_16x16x32_bf16 a[60:63], a[220:223], a[188:191], a[60:63]
    s_waitcnt lgkmcnt(6)
    v_mfma_f32_16x16x32_bf16 a[64:67], a[192:195], a[160:163], a[64:67]
    ds_read_b64_tr_b16 a[208:209], v62 offset:256
    ds_read_b64_tr_b16 a[210:211], v62 offset:2304
    v_mfma_f32_16x16x32_bf16 a[64:67], a[196:199], a[164:167], a[64:67]
    ds_read_b64_tr_b16 a[212:213], v62 offset:16640
    ds_read_b64_tr_b16 a[214:215], v62 offset:18688
    v_mfma_f32_16x16x32_bf16 a[68:71], a[192:195], a[168:171], a[68:71]
    ds_read_b128 a[152:155], v6 offset:38912
    v_mfma_f32_16x16x32_bf16 a[68:71], a[196:199], a[172:175], a[68:71]
    v_mfma_f32_16x16x32_bf16 a[72:75], a[192:195], a[176:179], a[72:75]
    v_mfma_f32_16x16x32_bf16 a[72:75], a[196:199], a[180:183], a[72:75]
    v_mfma_f32_16x16x32_bf16 a[76:79], a[192:195], a[184:187], a[76:79]
    buffer_load_dwordx4 v46, s[20:23], s47 offen offset:2048 lds
    v_mfma_f32_16x16x32_bf16 a[76:79], a[196:199], a[188:191], a[76:79]
    s_waitcnt lgkmcnt(6)
    v_mfma_f32_16x16x32_bf16 a[80:83], a[200:203], a[160:163], a[80:83]
    ds_read_b64_tr_b16 a[216:217], v63 offset:256
    ds_read_b64_tr_b16 a[218:219], v63 offset:2304
    v_mfma_f32_16x16x32_bf16 a[80:83], a[204:207], a[164:167], a[80:83]
    ds_read_b64_tr_b16 a[220:221], v63 offset:16640
    ds_read_b64_tr_b16 a[222:223], v63 offset:18688
    v_mfma_f32_16x16x32_bf16 a[84:87], a[200:203], a[168:171], a[84:87]
    ds_read_b128 a[156:159], v7 offset:38912
    v_mfma_f32_16x16x32_bf16 a[84:87], a[204:207], a[172:175], a[84:87]
    v_mfma_f32_16x16x32_bf16 a[88:91], a[200:203], a[176:179], a[88:91]
    buffer_load_dwordx4 v47, s[20:23], s47 offen offset:3072 lds
    v_mfma_f32_16x16x32_bf16 a[88:91], a[204:207], a[180:183], a[88:91]
    s_add_u32 s47, s47, 524288
    v_mfma_f32_16x16x32_bf16 a[92:95], a[200:203], a[184:187], a[92:95]
    v_mfma_f32_16x16x32_bf16 a[92:95], a[204:207], a[188:191], a[92:95]
    s_mov_b32 s3, 768
    s_mov_b32 s4, 3145728
    buffer_load_dword v29, v28, s[16:19], s3 offen nt
    buffer_load_dword v29, v26, s[20:23], s4 offen nt
    s_waitcnt vmcnt(19) lgkmcnt(0)
    s_barrier
    v_mfma_f32_16x16x32_bf16 a[96:99], a[208:211], a[160:163], a[96:99]
    ds_read_b64_tr_b16 a[192:193], v48 offset:0
    ds_read_b64_tr_b16 a[194:195], v48 offset:2048
    v_mfma_f32_16x16x32_bf16 a[96:99], a[212:215], a[164:167], a[96:99]
    ds_read_b64_tr_b16 a[196:197], v48 offset:16384
    ds_read_b64_tr_b16 a[198:199], v48 offset:18432
    v_mfma_f32_16x16x32_bf16 a[100:103], a[208:211], a[168:171], a[100:103]
    v_mfma_f32_16x16x32_bf16 a[100:103], a[212:215], a[172:175], a[100:103]
    v_mfma_f32_16x16x32_bf16 a[104:107], a[208:211], a[176:179], a[104:107]
    v_mfma_f32_16x16x32_bf16 a[104:107], a[212:215], a[180:183], a[104:107]
    v_mfma_f32_16x16x32_bf16 a[108:111], a[208:211], a[184:187], a[108:111]
    v_mfma_f32_16x16x32_bf16 a[108:111], a[212:215], a[188:191], a[108:111]
    v_mfma_f32_16x16x32_bf16 a[112:115], a[216:219], a[160:163], a[112:115]
    ds_read_b64_tr_b16 a[200:201], v49 offset:0
    ds_read_b64_tr_b16 a[202:203], v49 offset:2048
    v_mfma_f32_16x16x32_bf16 a[112:115], a[220:223], a[164:167], a[112:115]
    ds_read_b64_tr_b16 a[204:205], v49 offset:16384
    ds_read_b64_tr_b16 a[206:207], v49 offset:18432
    v_mfma_f32_16x16x32_bf16 a[116:119], a[216:219], a[168:171], a[116:119]
    v_mfma_f32_16x16x32_bf16 a[116:119], a[220:223], a[172:175], a[116:119]
    v_mfma_f32_16x16x32_bf16 a[120:123], a[216:219], a[176:179], a[120:123]
    v_mfma_f32_16x16x32_bf16 a[120:123], a[220:223], a[180:183], a[120:123]
    v_mfma_f32_16x16x32_bf16 a[124:127], a[216:219], a[184:187], a[124:127]
    v_mfma_f32_16x16x32_bf16 a[124:127], a[220:223], a[188:191], a[124:127]
    s_waitcnt lgkmcnt(4)
    v_mfma_f32_16x16x32_bf16 v[160:163], a[192:195], a[128:131], v[160:163]
    ds_read_b64_tr_b16 a[208:209], v50 offset:0
    ds_read_b64_tr_b16 a[210:211], v50 offset:2048
    v_mfma_f32_16x16x32_bf16 v[160:163], a[196:199], a[132:135], v[160:163]
    ds_read_b64_tr_b16 a[212:213], v50 offset:16384
    ds_read_b64_tr_b16 a[214:215], v50 offset:18432
    v_mfma_f32_16x16x32_bf16 v[176:179], a[192:195], a[136:139], v[176:179]
    v_mfma_f32_16x16x32_bf16 v[176:179], a[196:199], a[140:143], v[176:179]
    s_add_u32 m0, s48, 32768
    v_mfma_f32_16x16x32_bf16 v[192:195], a[192:195], a[144:147], v[192:195]
    buffer_load_dwordx4 v32, s[16:19], s46 offen offset:0 lds
    v_mfma_f32_16x16x32_bf16 v[192:195], a[196:199], a[148:151], v[192:195]
    v_mfma_f32_16x16x32_bf16 v[208:211], a[192:195], a[152:155], v[208:211]
    v_mfma_f32_16x16x32_bf16 v[208:211], a[196:199], a[156:159], v[208:211]
    s_waitcnt lgkmcnt(4)
    v_mfma_f32_16x16x32_bf16 v[164:167], a[200:203], a[128:131], v[164:167]
    ds_read_b64_tr_b16 a[216:217], v51 offset:0
    ds_read_b64_tr_b16 a[218:219], v51 offset:2048
    v_mfma_f32_16x16x32_bf16 v[164:167], a[204:207], a[132:135], v[164:167]
    ds_read_b64_tr_b16 a[220:221], v51 offset:16384
    ds_read_b64_tr_b16 a[222:223], v51 offset:18432
    v_mfma_f32_16x16x32_bf16 v[180:183], a[200:203], a[136:139], v[180:183]
    buffer_load_dwordx4 v33, s[16:19], s46 offen offset:1024 lds
    v_mfma_f32_16x16x32_bf16 v[180:183], a[204:207], a[140:143], v[180:183]
    v_mfma_f32_16x16x32_bf16 v[196:199], a[200:203], a[144:147], v[196:199]
    v_mfma_f32_16x16x32_bf16 v[196:199], a[204:207], a[148:151], v[196:199]
    v_mfma_f32_16x16x32_bf16 v[212:215], a[200:203], a[152:155], v[212:215]
    v_mfma_f32_16x16x32_bf16 v[212:215], a[204:207], a[156:159], v[212:215]
    s_waitcnt lgkmcnt(4)
    v_mfma_f32_16x16x32_bf16 v[96:99], a[208:211], a[128:131], v[96:99]
    ds_read_b64_tr_b16 a[192:193], v52 offset:0
    ds_read_b64_tr_b16 a[194:195], v52 offset:2048
    v_mfma_f32_16x16x32_bf16 v[96:99], a[212:215], a[132:135], v[96:99]
    ds_read_b64_tr_b16 a[196:197], v52 offset:16384
    ds_read_b64_tr_b16 a[198:199], v52 offset:18432
    s_add_u32 m0, s48, 34816
    v_mfma_f32_16x16x32_bf16 v[112:115], a[208:211], a[136:139], v[112:115]
    buffer_load_dwordx4 v34, s[16:19], s46 offen offset:0 lds
    v_mfma_f32_16x16x32_bf16 v[112:115], a[212:215], a[140:143], v[112:115]
    v_mfma_f32_16x16x32_bf16 v[128:131], a[208:211], a[144:147], v[128:131]
    v_mfma_f32_16x16x32_bf16 v[128:131], a[212:215], a[148:151], v[128:131]
    v_mfma_f32_16x16x32_bf16 v[144:147], a[208:211], a[152:155], v[144:147]
    v_mfma_f32_16x16x32_bf16 v[144:147], a[212:215], a[156:159], v[144:147]
    s_waitcnt lgkmcnt(4)
    v_mfma_f32_16x16x32_bf16 v[100:103], a[216:219], a[128:131], v[100:103]
    ds_read_b64_tr_b16 a[200:201], v53 offset:0
    ds_read_b64_tr_b16 a[202:203], v53 offset:2048
    buffer_load_dwordx4 v35, s[16:19], s46 offen offset:1024 lds
    v_mfma_f32_16x16x32_bf16 v[100:103], a[220:223], a[132:135], v[100:103]
    ds_read_b64_tr_b16 a[204:205], v53 offset:16384
    ds_read_b64_tr_b16 a[206:207], v53 offset:18432
    v_mfma_f32_16x16x32_bf16 v[116:119], a[216:219], a[136:139], v[116:119]
    v_mfma_f32_16x16x32_bf16 v[116:119], a[220:223], a[140:143], v[116:119]
    v_mfma_f32_16x16x32_bf16 v[132:135], a[216:219], a[144:147], v[132:135]
    v_mfma_f32_16x16x32_bf16 v[132:135], a[220:223], a[148:151], v[132:135]
    v_mfma_f32_16x16x32_bf16 v[148:151], a[216:219], a[152:155], v[148:151]
    v_mfma_f32_16x16x32_bf16 v[148:151], a[220:223], a[156:159], v[148:151]
    s_add_u32 m0, s48, 36864
    s_waitcnt lgkmcnt(4)
    v_mfma_f32_16x16x32_bf16 v[168:171], a[192:195], a[128:131], v[168:171]
    ds_read_b64_tr_b16 a[208:209], v54 offset:0
    ds_read_b64_tr_b16 a[210:211], v54 offset:2048
    buffer_load_dwordx4 v36, s[16:19], s46 offen offset:0 lds
    v_mfma_f32_16x16x32_bf16 v[168:171], a[196:199], a[132:135], v[168:171]
    ds_read_b64_tr_b16 a[212:213], v54 offset:16384
    ds_read_b64_tr_b16 a[214:215], v54 offset:18432
    v_mfma_f32_16x16x32_bf16 v[184:187], a[192:195], a[136:139], v[184:187]
    v_mfma_f32_16x16x32_bf16 v[184:187], a[196:199], a[140:143], v[184:187]
    v_mfma_f32_16x16x32_bf16 v[200:203], a[192:195], a[144:147], v[200:203]
    v_mfma_f32_16x16x32_bf16 v[200:203], a[196:199], a[148:151], v[200:203]
    v_mfma_f32_16x16x32_bf16 v[216:219], a[192:195], a[152:155], v[216:219]
    buffer_load_dwordx4 v37, s[16:19], s46 offen offset:1024 lds
    v_mfma_f32_16x16x32_bf16 v[216:219], a[196:199], a[156:159], v[216:219]
    s_waitcnt lgkmcnt(4)
    v_mfma_f32_16x16x32_bf16 v[172:175], a[200:203], a[128:131], v[172:175]
    ds_read_b64_tr_b16 a[216:217], v55 offset:0
    ds_read_b64_tr_b16 a[218:219], v55 offset:2048
    v_mfma_f32_16x16x32_bf16 v[172:175], a[204:207], a[132:135], v[172:175]
    ds_read_b64_tr_b16 a[220:221], v55 offset:16384
    ds_read_b64_tr_b16 a[222:223], v55 offset:18432
    v_mfma_f32_16x16x32_bf16 v[188:191], a[200:203], a[136:139], v[188:191]
    v_mfma_f32_16x16x32_bf16 v[188:191], a[204:207], a[140:143], v[188:191]
    v_mfma_f32_16x16x32_bf16 v[204:207], a[200:203], a[144:147], v[204:207]
    v_mfma_f32_16x16x32_bf16 v[204:207], a[204:207], a[148:151], v[204:207]
    s_add_u32 m0, s48, 38912
    v_mfma_f32_16x16x32_bf16 v[220:223], a[200:203], a[152:155], v[220:223]
    buffer_load_dwordx4 v38, s[16:19], s46 offen offset:0 lds
    v_mfma_f32_16x16x32_bf16 v[220:223], a[204:207], a[156:159], v[220:223]
    s_waitcnt lgkmcnt(4)
    v_mfma_f32_16x16x32_bf16 v[104:107], a[208:211], a[128:131], v[104:107]
    ds_read_b64_tr_b16 a[192:193], v48 offset:256
    ds_read_b64_tr_b16 a[194:195], v48 offset:2304
    v_mfma_f32_16x16x32_bf16 v[104:107], a[212:215], a[132:135], v[104:107]
    ds_read_b64_tr_b16 a[196:197], v48 offset:16640
    ds_read_b64_tr_b16 a[198:199], v48 offset:18688
    s_waitcnt vmcnt(17)
    v_mfma_f32_16x16x32_bf16 v[120:123], a[208:211], a[136:139], v[120:123]
    ds_read_b128 a[160:163], v6 offset:0
    v_mfma_f32_16x16x32_bf16 v[120:123], a[212:215], a[140:143], v[120:123]
    v_mfma_f32_16x16x32_bf16 v[136:139], a[208:211], a[144:147], v[136:139]
    buffer_load_dwordx4 v39, s[16:19], s46 offen offset:1024 lds
    v_mfma_f32_16x16x32_bf16 v[136:139], a[212:215], a[148:151], v[136:139]
    s_add_u32 s46, s46, 128
    v_mfma_f32_16x16x32_bf16 v[152:155], a[208:211], a[152:155], v[152:155]
    v_mfma_f32_16x16x32_bf16 v[152:155], a[212:215], a[156:159], v[152:155]
    s_waitcnt lgkmcnt(5)
    v_mfma_f32_16x16x32_bf16 v[108:111], a[216:219], a[128:131], v[108:111]
    ds_read_b64_tr_b16 a[200:201], v49 offset:256
    ds_read_b64_tr_b16 a[202:203], v49 offset:2304
    v_mfma_f32_16x16x32_bf16 v[108:111], a[220:223], a[132:135], v[108:111]
    ds_read_b64_tr_b16 a[204:205], v49 offset:16640
    ds_read_b64_tr_b16 a[206:207], v49 offset:18688
    v_mfma_f32_16x16x32_bf16 v[124:127], a[216:219], a[136:139], v[124:127]
    ds_read_b128 a[164:167], v7 offset:0
    v_mfma_f32_16x16x32_bf16 v[124:127], a[220:223], a[140:143], v[124:127]
    s_add_u32 m0, s48, 98304
    v_mfma_f32_16x16x32_bf16 v[140:143], a[216:219], a[144:147], v[140:143]
    buffer_load_dwordx4 v40, s[20:23], s47 offen offset:0 lds
    v_mfma_f32_16x16x32_bf16 v[140:143], a[220:223], a[148:151], v[140:143]
    v_mfma_f32_16x16x32_bf16 v[156:159], a[216:219], a[152:155], v[156:159]
    v_mfma_f32_16x16x32_bf16 v[156:159], a[220:223], a[156:159], v[156:159]
    s_waitcnt lgkmcnt(6)
    v_mfma_f32_16x16x32_bf16 a[0:3], a[192:195], a[128:131], a[0:3]
    ds_read_b64_tr_b16 a[208:209], v50 offset:256
    ds_read_b64_tr_b16 a[210:211], v50 offset:2304
    v_mfma_f32_16x16x32_bf16 a[0:3], a[196:199], a[132:135], a[0:3]
    ds_read_b64_tr_b16 a[212:213], v50 offset:16640
    ds_read_b64_tr_b16 a[214:215], v50 offset:18688
    v_mfma_f32_16x16x32_bf16 a[4:7], a[192:195], a[136:139], a[4:7]
    ds_read_b128 a[168:171], v6 offset:2048
    buffer_load_dwordx4 v41, s[20:23], s47 offen offset:1024 lds
    v_mfma_f32_16x16x32_bf16 a[4:7], a[196:199], a[140:143], a[4:7]
    v_mfma_f32_16x16x32_bf16 a[8:11], a[192:195], a[144:147], a[8:11]
    v_mfma_f32_16x16x32_bf16 a[8:11], a[196:199], a[148:151], a[8:11]
    v_mfma_f32_16x16x32_bf16 a[12:15], a[192:195], a[152:155], a[12:15]
    v_mfma_f32_16x16x32_bf16 a[12:15], a[196:199], a[156:159], a[12:15]
    s_waitcnt lgkmcnt(6)
    v_mfma_f32_16x16x32_bf16 a[16:19], a[200:203], a[128:131], a[16:19]
    ds_read_b64_tr_b16 a[216:217], v51 offset:256
    ds_read_b64_tr_b16 a[218:219], v51 offset:2304
    v_mfma_f32_16x16x32_bf16 a[16:19], a[204:207], a[132:135], a[16:19]
    ds_read_b64_tr_b16 a[220:221], v51 offset:16640
    ds_read_b64_tr_b16 a[222:223], v51 offset:18688
    v_mfma_f32_16x16x32_bf16 a[20:23], a[200:203], a[136:139], a[20:23]
    ds_read_b128 a[172:175], v7 offset:2048
    buffer_load_dwordx4 v42, s[20:23], s47 offen offset:2048 lds
    v_mfma_f32_16x16x32_bf16 a[20:23], a[204:207], a[140:143], a[20:23]
    v_mfma_f32_16x16x32_bf16 a[24:27], a[200:203], a[144:147], a[24:27]
    v_mfma_f32_16x16x32_bf16 a[24:27], a[204:207], a[148:151], a[24:27]
    v_mfma_f32_16x16x32_bf16 a[28:31], a[200:203], a[152:155], a[28:31]
    v_mfma_f32_16x16x32_bf16 a[28:31], a[204:207], a[156:159], a[28:31]
    s_waitcnt lgkmcnt(6)
    v_mfma_f32_16x16x32_bf16 a[32:35], a[208:211], a[128:131], a[32:35]
    ds_read_b64_tr_b16 a[192:193], v52 offset:256
    ds_read_b64_tr_b16 a[194:195], v52 offset:2304
    buffer_load_dwordx4 v43, s[20:23], s47 offen offset:3072 lds
    v_mfma_f32_16x16x32_bf16 a[32:35], a[212:215], a[132:135], a[32:35]
    ds_read_b64_tr_b16 a[196:197], v52 offset:16640
    ds_read_b64_tr_b16 a[198:199], v52 offset:18688
    v_mfma_f32_16x16x32_bf16 a[36:39], a[208:211], a[136:139], a[36:39]
    ds_read_b128 a[176:179], v6 offset:4096
    v_mfma_f32_16x16x32_bf16 a[36:39], a[212:215], a[140:143], a[36:39]
    v_mfma_f32_16x16x32_bf16 a[40:43], a[208:211], a[144:147], a[40:43]
    v_mfma_f32_16x16x32_bf16 a[40:43], a[212:215], a[148:151], a[40:43]
    v_mfma_f32_16x16x32_bf16 a[44:47], a[208:211], a[152:155], a[44:47]
    v_mfma_f32_16x16x32_bf16 a[44:47], a[212:215], a[156:159], a[44:47]
    s_add_u32 m0, s48, 102400
    s_waitcnt lgkmcnt(6)
    v_mfma_f32_16x16x32_bf16 a[48:51], a[216:219], a[128:131], a[48:51]
    ds_read_b64_tr_b16 a[200:201], v53 offset:256
    ds_read_b64_tr_b16 a[202:203], v53 offset:2304
    buffer_load_dwordx4 v44, s[20:23], s47 offen offset:0 lds
    v_mfma_f32_16x16x32_bf16 a[48:51], a[220:223], a[132:135], a[48:51]
    ds_read_b64_tr_b16 a[204:205], v53 offset:16640
    ds_read_b64_tr_b16 a[206:207], v53 offset:18688
    v_mfma_f32_16x16x32_bf16 a[52:55], a[216:219], a[136:139], a[52:55]
    ds_read_b128 a[180:183], v7 offset:4096
    v_mfma_f32_16x16x32_bf16 a[52:55], a[220:223], a[140:143], a[52:55]
    v_mfma_f32_16x16x32_bf16 a[56:59], a[216:219], a[144:147], a[56:59]
    v_mfma_f32_16x16x32_bf16 a[56:59], a[220:223], a[148:151], a[56:59]
    v_mfma_f32_16x16x32_bf16 a[60:63], a[216:219], a[152:155], a[60:63]
    buffer_load_dwordx4 v45, s[20:23], s47 offen offset:1024 lds
    v_mfma_f32_16x16x32_bf16 a[60:63], a[220:223], a[156:159], a[60:63]
    s_waitcnt lgkmcnt(6)
    v_mfma_f32_16x16x32_bf16 a[64:67], a[192:195], a[128:131], a[64:67]
    ds_read_b64_tr_b16 a[208:209], v54 offset:256
    ds_read_b64_tr_b16 a[210:211], v54 offset:2304
    v_mfma_f32_16x16x32_bf16 a[64:67], a[196:199], a[132:135], a[64:67]
    ds_read_b64_tr_b16 a[212:213], v54 offset:16640
    ds_read_b64_tr_b16 a[214:215], v54 offset:18688
    v_mfma_f32_16x16x32_bf16 a[68:71], a[192:195], a[136:139], a[68:71]
    ds_read_b128 a[184:187], v6 offset:6144
    v_mfma_f32_16x16x32_bf16 a[68:71], a[196:199], a[140:143], a[68:71]
    v_mfma_f32_16x16x32_bf16 a[72:75], a[192:195], a[144:147], a[72:75]
    v_mfma_f32_16x16x32_bf16 a[72:75], a[196:199], a[148:151], a[72:75]
    v_mfma_f32_16x16x32_bf16 a[76:79], a[192:195], a[152:155], a[76:79]
    buffer_load_dwordx4 v46, s[20:23], s47 offen offset:2048 lds
    v_mfma_f32_16x16x32_bf16 a[76:79], a[196:199], a[156:159], a[76:79]
    s_waitcnt lgkmcnt(6)
    v_mfma_f32_16x16x32_bf16 a[80:83], a[200:203], a[128:131], a[80:83]
    ds_read_b64_tr_b16 a[216:217], v55 offset:256
    ds_read_b64_tr_b16 a[218:219], v55 offset:2304
    v_mfma_f32_16x16x32_bf16 a[80:83], a[204:207], a[132:135], a[80:83]
    ds_read_b64_tr_b16 a[220:221], v55 offset:16640
    ds_read_b64_tr_b16 a[222:223], v55 offset:18688
    v_mfma_f32_16x16x32_bf16 a[84:87], a[200:203], a[136:139], a[84:87]
    ds_read_b128 a[188:191], v7 offset:6144
    v_mfma_f32_16x16x32_bf16 a[84:87], a[204:207], a[140:143], a[84:87]
    v_mfma_f32_16x16x32_bf16 a[88:91], a[200:203], a[144:147], a[88:91]
    buffer_load_dwordx4 v47, s[20:23], s47 offen offset:3072 lds
    v_mfma_f32_16x16x32_bf16 a[88:91], a[204:207], a[148:151], a[88:91]
    s_add_u32 s47, s47, 524288
    v_mfma_f32_16x16x32_bf16 a[92:95], a[200:203], a[152:155], a[92:95]
    v_mfma_f32_16x16x32_bf16 a[92:95], a[204:207], a[156:159], a[92:95]
    s_mov_b32 s3, 16384
    buffer_load_dword v29, v64, s[8:11], s3 offen nt
    s_waitcnt vmcnt(19) lgkmcnt(0)
    s_barrier
    v_mfma_f32_16x16x32_bf16 a[96:99], a[208:211], a[128:131], a[96:99]
    ds_read_b64_tr_b16 a[192:193], v56 offset:32768
    ds_read_b64_tr_b16 a[194:195], v56 offset:34816
    v_mfma_f32_16x16x32_bf16 a[96:99], a[212:215], a[132:135], a[96:99]
    ds_read_b64_tr_b16 a[196:197], v56 offset:49152
    ds_read_b64_tr_b16 a[198:199], v56 offset:51200
    v_mfma_f32_16x16x32_bf16 a[100:103], a[208:211], a[136:139], a[100:103]
    v_mfma_f32_16x16x32_bf16 a[100:103], a[212:215], a[140:143], a[100:103]
    v_mfma_f32_16x16x32_bf16 a[104:107], a[208:211], a[144:147], a[104:107]
    v_mfma_f32_16x16x32_bf16 a[104:107], a[212:215], a[148:151], a[104:107]
    v_mfma_f32_16x16x32_bf16 a[108:111], a[208:211], a[152:155], a[108:111]
    v_mfma_f32_16x16x32_bf16 a[108:111], a[212:215], a[156:159], a[108:111]
    v_mfma_f32_16x16x32_bf16 a[112:115], a[216:219], a[128:131], a[112:115]
    ds_read_b64_tr_b16 a[200:201], v57 offset:32768
    ds_read_b64_tr_b16 a[202:203], v57 offset:34816
    v_mfma_f32_16x16x32_bf16 a[112:115], a[220:223], a[132:135], a[112:115]
    ds_read_b64_tr_b16 a[204:205], v57 offset:49152
    ds_read_b64_tr_b16 a[206:207], v57 offset:51200
    v_mfma_f32_16x16x32_bf16 a[116:119], a[216:219], a[136:139], a[116:119]
    v_mfma_f32_16x16x32_bf16 a[116:119], a[220:223], a[140:143], a[116:119]
    v_mfma_f32_16x16x32_bf16 a[120:123], a[216:219], a[144:147], a[120:123]
    v_mfma_f32_16x16x32_bf16 a[120:123], a[220:223], a[148:151], a[120:123]
    v_mfma_f32_16x16x32_bf16 a[124:127], a[216:219], a[152:155], a[124:127]
    v_mfma_f32_16x16x32_bf16 a[124:127], a[220:223], a[156:159], a[124:127]
    s_waitcnt lgkmcnt(4)
    v_mfma_f32_16x16x32_bf16 v[160:163], a[192:195], a[160:163], v[160:163]
    ds_read_b64_tr_b16 a[208:209], v58 offset:32768
    ds_read_b64_tr_b16 a[210:211], v58 offset:34816
    v_mfma_f32_16x16x32_bf16 v[160:163], a[196:199], a[164:167], v[160:163]
    ds_read_b64_tr_b16 a[212:213], v58 offset:49152
    ds_read_b64_tr_b16 a[214:215], v58 offset:51200
    v_mfma_f32_16x16x32_bf16 v[176:179], a[192:195], a[168:171], v[176:179]
    v_mfma_f32_16x16x32_bf16 v[176:179], a[196:199], a[172:175], v[176:179]
    s_add_u32 m0, s48, 0
    v_mfma_f32_16x16x32_bf16 v[192:195], a[192:195], a[176:179], v[192:195]
    buffer_load_dwordx4 v32, s[16:19], s46 offen offset:0 lds
    v_mfma_f32_16x16x32_bf16 v[192:195], a[196:199], a[180:183], v[192:195]
    v_mfma_f32_16x16x32_bf16 v[208:211], a[192:195], a[184:187], v[208:211]
    v_mfma_f32_16x16x32_bf16 v[208:211], a[196:199], a[188:191], v[208:211]
    s_waitcnt lgkmcnt(4)
    v_mfma_f32_16x16x32_bf16 v[164:167], a[200:203], a[160:163], v[164:167]
    ds_read_b64_tr_b16 a[216:217], v59 offset:32768
    ds_read_b64_tr_b16 a[218:219], v59 offset:34816
    v_mfma_f32_16x16x32_bf16 v[164:167], a[204:207], a[164:167], v[164:167]
    ds_read_b64_tr_b16 a[220:221], v59 offset:49152
    ds_read_b64_tr_b16 a[222:223], v59 offset:51200
    v_mfma_f32_16x16x32_bf16 v[180:183], a[200:203], a[168:171], v[180:183]
    buffer_load_dwordx4 v33, s[16:19], s46 offen offset:1024 lds
    v_mfma_f32_16x16x32_bf16 v[180:183], a[204:207], a[172:175], v[180:183]
    v_mfma_f32_16x16x32_bf16 v[196:199], a[200:203], a[176:179], v[196:199]
    v_mfma_f32_16x16x32_bf16 v[196:199], a[204:207], a[180:183], v[196:199]
    v_mfma_f32_16x16x32_bf16 v[212:215], a[200:203], a[184:187], v[212:215]
    v_mfma_f32_16x16x32_bf16 v[212:215], a[204:207], a[188:191], v[212:215]
    s_waitcnt lgkmcnt(4)
    v_mfma_f32_16x16x32_bf16 v[96:99], a[208:211], a[160:163], v[96:99]
    ds_read_b64_tr_b16 a[192:193], v60 offset:32768
    ds_read_b64_tr_b16 a[194:195], v60 offset:34816
    v_mfma_f32_16x16x32_bf16 v[96:99], a[212:215], a[164:167], v[96:99]
    ds_read_b64_tr_b16 a[196:197], v60 offset:49152
    ds_read_b64_tr_b16 a[198:199], v60 offset:51200
    s_add_u32 m0, s48, 2048
    v_mfma_f32_16x16x32_bf16 v[112:115], a[208:211], a[168:171], v[112:115]
    buffer_load_dwordx4 v34, s[16:19], s46 offen offset:0 lds
    v_mfma_f32_16x16x32_bf16 v[112:115], a[212:215], a[172:175], v[112:115]
    v_mfma_f32_16x16x32_bf16 v[128:131], a[208:211], a[176:179], v[128:131]
    v_mfma_f32_16x16x32_bf16 v[128:131], a[212:215], a[180:183], v[128:131]
    v_mfma_f32_16x16x32_bf16 v[144:147], a[208:211], a[184:187], v[144:147]
    v_mfma_f32_16x16x32_bf16 v[144:147], a[212:215], a[188:191], v[144:147]
    s_waitcnt lgkmcnt(4)
    v_mfma_f32_16x16x32_bf16 v[100:103], a[216:219], a[160:163], v[100:103]
    ds_read_b64_tr_b16 a[200:201], v61 offset:32768
    ds_read_b64_tr_b16 a[202:203], v61 offset:34816
    buffer_load_dwordx4 v35, s[16:19], s46 offen offset:1024 lds
    v_mfma_f32_16x16x32_bf16 v[100:103], a[220:223], a[164:167], v[100:103]
    ds_read_b64_tr_b16 a[204:205], v61 offset:49152
    ds_read_b64_tr_b16 a[206:207], v61 offset:51200
    v_mfma_f32_16x16x32_bf16 v[116:119], a[216:219], a[168:171], v[116:119]
    v_mfma_f32_16x16x32_bf16 v[116:119], a[220:223], a[172:175], v[116:119]
    v_mfma_f32_16x16x32_bf16 v[132:135], a[216:219], a[176:179], v[132:135]
    v_mfma_f32_16x16x32_bf16 v[132:135], a[220:223], a[180:183], v[132:135]
    v_mfma_f32_16x16x32_bf16 v[148:151], a[216:219], a[184:187], v[148:151]
    v_mfma_f32_16x16x32_bf16 v[148:151], a[220:223], a[188:191], v[148:151]
    s_add_u32 m0, s48, 4096
    s_waitcnt lgkmcnt(4)
    v_mfma_f32_16x16x32_bf16 v[168:171], a[192:195], a[160:163], v[168:171]
    ds_read_b64_tr_b16 a[208:209], v62 offset:32768
    ds_read_b64_tr_b16 a[210:211], v62 offset:34816
    buffer_load_dwordx4 v36, s[16:19], s46 offen offset:0 lds
    v_mfma_f32_16x16x32_bf16 v[168:171], a[196:199], a[164:167], v[168:171]
    ds_read_b64_tr_b16 a[212:213], v62 offset:49152
    ds_read_b64_tr_b16 a[214:215], v62 offset:51200
    v_mfma_f32_16x16x32_bf16 v[184:187], a[192:195], a[168:171], v[184:187]
    v_mfma_f32_16x16x32_bf16 v[184:187], a[196:199], a[172:175], v[184:187]
    v_mfma_f32_16x16x32_bf16 v[200:203], a[192:195], a[176:179], v[200:203]
    v_mfma_f32_16x16x32_bf16 v[200:203], a[196:199], a[180:183], v[200:203]
    v_mfma_f32_16x16x32_bf16 v[216:219], a[192:195], a[184:187], v[216:219]
    buffer_load_dwordx4 v37, s[16:19], s46 offen offset:1024 lds
    v_mfma_f32_16x16x32_bf16 v[216:219], a[196:199], a[188:191], v[216:219]
    s_waitcnt lgkmcnt(4)
    v_mfma_f32_16x16x32_bf16 v[172:175], a[200:203], a[160:163], v[172:175]
    ds_read_b64_tr_b16 a[216:217], v63 offset:32768
    ds_read_b64_tr_b16 a[218:219], v63 offset:34816
    v_mfma_f32_16x16x32_bf16 v[172:175], a[204:207], a[164:167], v[172:175]
    ds_read_b64_tr_b16 a[220:221], v63 offset:49152
    ds_read_b64_tr_b16 a[222:223], v63 offset:51200
    v_mfma_f32_16x16x32_bf16 v[188:191], a[200:203], a[168:171], v[188:191]
    v_mfma_f32_16x16x32_bf16 v[188:191], a[204:207], a[172:175], v[188:191]
    v_mfma_f32_16x16x32_bf16 v[204:207], a[200:203], a[176:179], v[204:207]
    v_mfma_f32_16x16x32_bf16 v[204:207], a[204:207], a[180:183], v[204:207]
    s_add_u32 m0, s48, 6144
    v_mfma_f32_16x16x32_bf16 v[220:223], a[200:203], a[184:187], v[220:223]
    buffer_load_dwordx4 v38, s[16:19], s46 offen offset:0 lds
    v_mfma_f32_16x16x32_bf16 v[220:223], a[204:207], a[188:191], v[220:223]
    s_waitcnt lgkmcnt(4)
    v_mfma_f32_16x16x32_bf16 v[104:107], a[208:211], a[160:163], v[104:107]
    ds_read_b64_tr_b16 a[192:193], v56 offset:33024
    ds_read_b64_tr_b16 a[194:195], v56 offset:35072
    v_mfma_f32_16x16x32_bf16 v[104:107], a[212:215], a[164:167], v[104:107]
    ds_read_b64_tr_b16 a[196:197], v56 offset:49408
    ds_read_b64_tr_b16 a[198:199], v56 offset:51456
    s_waitcnt vmcnt(16)
    v_mfma_f32_16x16x32_bf16 v[120:123], a[208:211], a[168:171], v[120:123]
    ds_read_b128 a[128:131], v6 offset:32768
    v_mfma_f32_16x16x32_bf16 v[120:123], a[212:215], a[172:175], v[120:123]
    v_mfma_f32_16x16x32_bf16 v[136:139], a[208:211], a[176:179], v[136:139]
    buffer_load_dwordx4 v39, s[16:19], s46 offen offset:1024 lds
    v_mfma_f32_16x16x32_bf16 v[136:139], a[212:215], a[180:183], v[136:139]
    s_add_u32 s46, s46, 128
    v_mfma_f32_16x16x32_bf16 v[152:155], a[208:211], a[184:187], v[152:155]
    v_mfma_f32_16x16x32_bf16 v[152:155], a[212:215], a[188:191], v[152:155]
    s_waitcnt lgkmcnt(5)
    v_mfma_f32_16x16x32_bf16 v[108:111], a[216:219], a[160:163], v[108:111]
    ds_read_b64_tr_b16 a[200:201], v57 offset:33024
    ds_read_b64_tr_b16 a[202:203], v57 offset:35072
    v_mfma_f32_16x16x32_bf16 v[108:111], a[220:223], a[164:167], v[108:111]
    ds_read_b64_tr_b16 a[204:205], v57 offset:49408
    ds_read_b64_tr_b16 a[206:207], v57 offset:51456
    v_mfma_f32_16x16x32_bf16 v[124:127], a[216:219], a[168:171], v[124:127]
    ds_read_b128 a[132:135], v7 offset:32768
    v_mfma_f32_16x16x32_bf16 v[124:127], a[220:223], a[172:175], v[124:127]
    s_add_u32 m0, s48, 65536
    v_mfma_f32_16x16x32_bf16 v[140:143], a[216:219], a[176:179], v[140:143]
    buffer_load_dwordx4 v40, s[20:23], s47 offen offset:0 lds
    v_mfma_f32_16x16x32_bf16 v[140:143], a[220:223], a[180:183], v[140:143]
    v_mfma_f32_16x16x32_bf16 v[156:159], a[216:219], a[184:187], v[156:159]
    v_mfma_f32_16x16x32_bf16 v[156:159], a[220:223], a[188:191], v[156:159]
    s_waitcnt lgkmcnt(6)
    v_mfma_f32_16x16x32_bf16 a[0:3], a[192:195], a[160:163], a[0:3]
    ds_read_b64_tr_b16 a[208:209], v58 offset:33024
    ds_read_b64_tr_b16 a[210:211], v58 offset:35072
    v_mfma_f32_16x16x32_bf16 a[0:3], a[196:199], a[164:167], a[0:3]
    ds_read_b64_tr_b16 a[212:213], v58 offset:49408
    ds_read_b64_tr_b16 a[214:215], v58 offset:51456
    v_mfma_f32_16x16x32_bf16 a[4:7], a[192:195], a[168:171], a[4:7]
    ds_read_b128 a[136:139], v6 offset:34816
    buffer_load_dwordx4 v41, s[20:23], s47 offen offset:1024 lds
    v_mfma_f32_16x16x32_bf16 a[4:7], a[196:199], a[172:175], a[4:7]
    v_mfma_f32_16x16x32_bf16 a[8:11], a[192:195], a[176:179], a[8:11]
    v_mfma_f32_16x16x32_bf16 a[8:11], a[196:199], a[180:183], a[8:11]
    v_mfma_f32_16x16x32_bf16 a[12:15], a[192:195], a[184:187], a[12:15]
    v_mfma_f32_16x16x32_bf16 a[12:15], a[196:199], a[188:191], a[12:15]
    s_waitcnt lgkmcnt(6)
    v_mfma_f32_16x16x32_bf16 a[16:19], a[200:203], a[160:163], a[16:19]
    ds_read_b64_tr_b16 a[216:217], v59 offset:33024
    ds_read_b64_tr_b16 a[218:219], v59 offset:35072
    v_mfma_f32_16x16x32_bf16 a[16:19], a[204:207], a[164:167], a[16:19]
    ds_read_b64_tr_b16 a[220:221], v59 offset:49408
    ds_read_b64_tr_b16 a[222:223], v59 offset:51456
    v_mfma_f32_16x16x32_bf16 a[20:23], a[200:203], a[168:171], a[20:23]
    ds_read_b128 a[140:143], v7 offset:34816
    buffer_load_dwordx4 v42, s[20:23], s47 offen offset:2048 lds
    v_mfma_f32_16x16x32_bf16 a[20:23], a[204:207], a[172:175], a[20:23]
    v_mfma_f32_16x16x32_bf16 a[24:27], a[200:203], a[176:179], a[24:27]
    v_mfma_f32_16x16x32_bf16 a[24:27], a[204:207], a[180:183], a[24:27]
    v_mfma_f32_16x16x32_bf16 a[28:31], a[200:203], a[184:187], a[28:31]
    v_mfma_f32_16x16x32_bf16 a[28:31], a[204:207], a[188:191], a[28:31]
    s_waitcnt lgkmcnt(6)
    v_mfma_f32_16x16x32_bf16 a[32:35], a[208:211], a[160:163], a[32:35]
    ds_read_b64_tr_b16 a[192:193], v60 offset:33024
    ds_read_b64_tr_b16 a[194:195], v60 offset:35072
    buffer_load_dwordx4 v43, s[20:23], s47 offen offset:3072 lds
    v_mfma_f32_16x16x32_bf16 a[32:35], a[212:215], a[164:167], a[32:35]
    ds_read_b64_tr_b16 a[196:197], v60 offset:49408
    ds_read_b64_tr_b16 a[198:199], v60 offset:51456
    v_mfma_f32_16x16x32_bf16 a[36:39], a[208:211], a[168:171], a[36:39]
    ds_read_b128 a[144:147], v6 offset:36864
    v_mfma_f32_16x16x32_bf16 a[36:39], a[212:215], a[172:175], a[36:39]
    v_mfma_f32_16x16x32_bf16 a[40:43], a[208:211], a[176:179], a[40:43]
    v_mfma_f32_16x16x32_bf16 a[40:43], a[212:215], a[180:183], a[40:43]
    v_mfma_f32_16x16x32_bf16 a[44:47], a[208:211], a[184:187], a[44:47]
    v_mfma_f32_16x16x32_bf16 a[44:47], a[212:215], a[188:191], a[44:47]
    s_add_u32 m0, s48, 69632
    s_waitcnt lgkmcnt(6)
    v_mfma_f32_16x16x32_bf16 a[48:51], a[216:219], a[160:163], a[48:51]
    ds_read_b64_tr_b16 a[200:201], v61 offset:33024
    ds_read_b64_tr_b16 a[202:203], v61 offset:35072
    buffer_load_dwordx4 v44, s[20:23], s47 offen offset:0 lds
    v_mfma_f32_16x16x32_bf16 a[48:51], a[220:223], a[164:167], a[48:51]
    ds_read_b64_tr_b16 a[204:205], v61 offset:49408
    ds_read_b64_tr_b16 a[206:207], v61 offset:51456
    v_mfma_f32_16x16x32_bf16 a[52:55], a[216:219], a[168:171], a[52:55]
    ds_read_b128 a[148:151], v7 offset:36864
    v_mfma_f32_16x16x32_bf16 a[52:55], a[220:223], a[172:175], a[52:55]
    v_mfma_f32_16x16x32_bf16 a[56:59], a[216:219], a[176:179], a[56:59]
    v_mfma_f32_16x16x32_bf16 a[56:59], a[220:223], a[180:183], a[56:59]
    v_mfma_f32_16x16x32_bf16 a[60:63], a[216:219], a[184:187], a[60:63]
    buffer_load_dwordx4 v45, s[20:23], s47 offen offset:1024 lds
    v_mfma_f32_16x16x32_bf16 a[60:63], a[220:223], a[188:191], a[60:63]
    s_waitcnt lgkmcnt(6)
    v_mfma_f32_16x16x32_bf16 a[64:67], a[192:195], a[160:163], a[64:67]
    ds_read_b64_tr_b16 a[208:209], v62 offset:33024
    ds_read_b64_tr_b16 a[210:211], v62 offset:35072
    v_mfma_f32_16x16x32_bf16 a[64:67], a[196:199], a[164:167], a[64:67]
    ds_read_b64_tr_b16 a[212:213], v62 offset:49408
    ds_read_b64_tr_b16 a[214:215], v62 offset:51456
    v_mfma_f32_16x16x32_bf16 a[68:71], a[192:195], a[168:171], a[68:71]
    ds_read_b128 a[152:155], v6 offset:38912
    v_mfma_f32_16x16x32_bf16 a[68:71], a[196:199], a[172:175], a[68:71]
    v_mfma_f32_16x16x32_bf16 a[72:75], a[192:195], a[176:179], a[72:75]
    v_mfma_f32_16x16x32_bf16 a[72:75], a[196:199], a[180:183], a[72:75]
    v_mfma_f32_16x16x32_bf16 a[76:79], a[192:195], a[184:187], a[76:79]
    buffer_load_dwordx4 v46, s[20:23], s47 offen offset:2048 lds
    v_mfma_f32_16x16x32_bf16 a[76:79], a[196:199], a[188:191], a[76:79]
    s_waitcnt lgkmcnt(6)
    v_mfma_f32_16x16x32_bf16 a[80:83], a[200:203], a[160:163], a[80:83]
    ds_read_b64_tr_b16 a[216:217], v63 offset:33024
    ds_read_b64_tr_b16 a[218:219], v63 offset:35072
    v_mfma_f32_16x16x32_bf16 a[80:83], a[204:207], a[164:167], a[80:83]
    ds_read_b64_tr_b16 a[220:221], v63 offset:49408
    ds_read_b64_tr_b16 a[222:223], v63 offset:51456
    v_mfma_f32_16x16x32_bf16 a[84:87], a[200:203], a[168:171], a[84:87]
    ds_read_b128 a[156:159], v7 offset:38912
    v_mfma_f32_16x16x32_bf16 a[84:87], a[204:207], a[172:175], a[84:87]
    v_mfma_f32_16x16x32_bf16 a[88:91], a[200:203], a[176:179], a[88:91]
    buffer_load_dwordx4 v47, s[20:23], s47 offen offset:3072 lds
    v_mfma_f32_16x16x32_bf16 a[88:91], a[204:207], a[180:183], a[88:91]
    s_add_u32 s47, s47, 524288
    v_mfma_f32_16x16x32_bf16 a[92:95], a[200:203], a[184:187], a[92:95]
    v_mfma_f32_16x16x32_bf16 a[92:95], a[204:207], a[188:191], a[92:95]
    s_mov_b32 s3, 1024
    s_mov_b32 s4, 4194304
    s_mov_b64 exec, 0x7fff
    buffer_load_dword v29, v28, s[16:19], s3 offen nt
    s_mov_b64 exec, -1
    buffer_load_dword v29, v26, s[20:23], s4 offen nt
    s_waitcnt vmcnt(19) lgkmcnt(0)
    s_barrier
    v_mfma_f32_16x16x32_bf16 a[96:99], a[208:211], a[160:163], a[96:99]
    ds_read_b64_tr_b16 a[192:193], v56 offset:0
    ds_read_b64_tr_b16 a[194:195], v56 offset:2048
    v_mfma_f32_16x16x32_bf16 a[96:99], a[212:215], a[164:167], a[96:99]
    ds_read_b64_tr_b16 a[196:197], v56 offset:16384
    ds_read_b64_tr_b16 a[198:199], v56 offset:18432
    v_mfma_f32_16x16x32_bf16 a[100:103], a[208:211], a[168:171], a[100:103]
    v_mfma_f32_16x16x32_bf16 a[100:103], a[212:215], a[172:175], a[100:103]
    v_mfma_f32_16x16x32_bf16 a[104:107], a[208:211], a[176:179], a[104:107]
    v_mfma_f32_16x16x32_bf16 a[104:107], a[212:215], a[180:183], a[104:107]
    s_lshr_b32 s3, s2, 3
    s_lshl_b32 s3, s3, 2
    s_add_u32 s3, s3, s43
    s_lshl_b32 s3, s3, 8
    s_add_u32 s3, s3, L_att-concat_heads__mha_block_cached__gqa_block_cached__near_ridge_kernel
    v_lshlrev_b32 v31, 7, v0
    s_mov_b64 exec, 3
    buffer_load_dword v31, v31, s[80:83], s3 offen
    s_mov_b64 exec, -1
    v_mfma_f32_16x16x32_bf16 a[108:111], a[208:211], a[184:187], a[108:111]
    v_mfma_f32_16x16x32_bf16 a[108:111], a[212:215], a[188:191], a[108:111]
    v_mfma_f32_16x16x32_bf16 a[112:115], a[216:219], a[160:163], a[112:115]
    ds_read_b64_tr_b16 a[200:201], v57 offset:0
    ds_read_b64_tr_b16 a[202:203], v57 offset:2048
    v_mfma_f32_16x16x32_bf16 a[112:115], a[220:223], a[164:167], a[112:115]
    ds_read_b64_tr_b16 a[204:205], v57 offset:16384
    ds_read_b64_tr_b16 a[206:207], v57 offset:18432
    v_mfma_f32_16x16x32_bf16 a[116:119], a[216:219], a[168:171], a[116:119]
    v_mfma_f32_16x16x32_bf16 a[116:119], a[220:223], a[172:175], a[116:119]
    v_mfma_f32_16x16x32_bf16 a[120:123], a[216:219], a[176:179], a[120:123]
    v_mfma_f32_16x16x32_bf16 a[120:123], a[220:223], a[180:183], a[120:123]
    v_mfma_f32_16x16x32_bf16 a[124:127], a[216:219], a[184:187], a[124:127]
    v_mfma_f32_16x16x32_bf16 a[124:127], a[220:223], a[188:191], a[124:127]
    s_waitcnt lgkmcnt(4)
    v_mfma_f32_16x16x32_bf16 v[160:163], a[192:195], a[128:131], v[160:163]
    ds_read_b64_tr_b16 a[208:209], v58 offset:0
    ds_read_b64_tr_b16 a[210:211], v58 offset:2048
    v_mfma_f32_16x16x32_bf16 v[160:163], a[196:199], a[132:135], v[160:163]
    ds_read_b64_tr_b16 a[212:213], v58 offset:16384
    ds_read_b64_tr_b16 a[214:215], v58 offset:18432
    v_mfma_f32_16x16x32_bf16 v[176:179], a[192:195], a[136:139], v[176:179]
    v_mfma_f32_16x16x32_bf16 v[176:179], a[196:199], a[140:143], v[176:179]
    s_add_u32 m0, s48, 32768
    v_mfma_f32_16x16x32_bf16 v[192:195], a[192:195], a[144:147], v[192:195]
    buffer_load_dwordx4 v32, s[16:19], s46 offen offset:0 lds
    v_mfma_f32_16x16x32_bf16 v[192:195], a[196:199], a[148:151], v[192:195]
    v_mfma_f32_16x16x32_bf16 v[208:211], a[192:195], a[152:155], v[208:211]
    v_mfma_f32_16x16x32_bf16 v[208:211], a[196:199], a[156:159], v[208:211]
    s_waitcnt lgkmcnt(4)
    v_mfma_f32_16x16x32_bf16 v[164:167], a[200:203], a[128:131], v[164:167]
    ds_read_b64_tr_b16 a[216:217], v59 offset:0
    ds_read_b64_tr_b16 a[218:219], v59 offset:2048
    buffer_load_dwordx4 v33, s[16:19], s46 offen offset:1024 lds
    v_mfma_f32_16x16x32_bf16 v[164:167], a[204:207], a[132:135], v[164:167]
    ds_read_b64_tr_b16 a[220:221], v59 offset:16384
    ds_read_b64_tr_b16 a[222:223], v59 offset:18432
    v_mfma_f32_16x16x32_bf16 v[180:183], a[200:203], a[136:139], v[180:183]
    v_mfma_f32_16x16x32_bf16 v[180:183], a[204:207], a[140:143], v[180:183]
    v_mfma_f32_16x16x32_bf16 v[196:199], a[200:203], a[144:147], v[196:199]
    v_mfma_f32_16x16x32_bf16 v[196:199], a[204:207], a[148:151], v[196:199]
    s_add_u32 m0, s48, 34816
    v_mfma_f32_16x16x32_bf16 v[212:215], a[200:203], a[152:155], v[212:215]
    buffer_load_dwordx4 v34, s[16:19], s46 offen offset:0 lds
    v_mfma_f32_16x16x32_bf16 v[212:215], a[204:207], a[156:159], v[212:215]
    s_waitcnt lgkmcnt(4)
    v_mfma_f32_16x16x32_bf16 v[96:99], a[208:211], a[128:131], v[96:99]
    ds_read_b64_tr_b16 a[192:193], v60 offset:0
    ds_read_b64_tr_b16 a[194:195], v60 offset:2048
    v_mfma_f32_16x16x32_bf16 v[96:99], a[212:215], a[132:135], v[96:99]
    ds_read_b64_tr_b16 a[196:197], v60 offset:16384
    ds_read_b64_tr_b16 a[198:199], v60 offset:18432
    v_mfma_f32_16x16x32_bf16 v[112:115], a[208:211], a[136:139], v[112:115]
    buffer_load_dwordx4 v35, s[16:19], s46 offen offset:1024 lds
    v_mfma_f32_16x16x32_bf16 v[112:115], a[212:215], a[140:143], v[112:115]
    v_mfma_f32_16x16x32_bf16 v[128:131], a[208:211], a[144:147], v[128:131]
    v_mfma_f32_16x16x32_bf16 v[128:131], a[212:215], a[148:151], v[128:131]
    v_mfma_f32_16x16x32_bf16 v[144:147], a[208:211], a[152:155], v[144:147]
    v_mfma_f32_16x16x32_bf16 v[144:147], a[212:215], a[156:159], v[144:147]
    s_add_u32 m0, s48, 36864
    s_waitcnt lgkmcnt(4)
    v_mfma_f32_16x16x32_bf16 v[100:103], a[216:219], a[128:131], v[100:103]
    ds_read_b64_tr_b16 a[200:201], v61 offset:0
    ds_read_b64_tr_b16 a[202:203], v61 offset:2048
    buffer_load_dwordx4 v36, s[16:19], s46 offen offset:0 lds
    v_mfma_f32_16x16x32_bf16 v[100:103], a[220:223], a[132:135], v[100:103]
    ds_read_b64_tr_b16 a[204:205], v61 offset:16384
    ds_read_b64_tr_b16 a[206:207], v61 offset:18432
    v_mfma_f32_16x16x32_bf16 v[116:119], a[216:219], a[136:139], v[116:119]
    v_mfma_f32_16x16x32_bf16 v[116:119], a[220:223], a[140:143], v[116:119]
    v_mfma_f32_16x16x32_bf16 v[132:135], a[216:219], a[144:147], v[132:135]
    buffer_load_dwordx4 v37, s[16:19], s46 offen offset:1024 lds
    v_mfma_f32_16x16x32_bf16 v[132:135], a[220:223], a[148:151], v[132:135]
    v_mfma_f32_16x16x32_bf16 v[148:151], a[216:219], a[152:155], v[148:151]
    v_mfma_f32_16x16x32_bf16 v[148:151], a[220:223], a[156:159], v[148:151]
    s_waitcnt lgkmcnt(4)
    v_mfma_f32_16x16x32_bf16 v[168:171], a[192:195], a[128:131], v[168:171]
    ds_read_b64_tr_b16 a[208:209], v62 offset:0
    ds_read_b64_tr_b16 a[210:211], v62 offset:2048
    v_mfma_f32_16x16x32_bf16 v[168:171], a[196:199], a[132:135], v[168:171]
    ds_read_b64_tr_b16 a[212:213], v62 offset:16384
    ds_read_b64_tr_b16 a[214:215], v62 offset:18432
    s_add_u32 m0, s48, 38912
    v_mfma_f32_16x16x32_bf16 v[184:187], a[192:195], a[136:139], v[184:187]
    buffer_load_dwordx4 v38, s[16:19], s46 offen offset:0 lds
    v_mfma_f32_16x16x32_bf16 v[184:187], a[196:199], a[140:143], v[184:187]
    v_mfma_f32_16x16x32_bf16 v[200:203], a[192:195], a[144:147], v[200:203]
    v_mfma_f32_16x16x32_bf16 v[200:203], a[196:199], a[148:151], v[200:203]
    v_mfma_f32_16x16x32_bf16 v[216:219], a[192:195], a[152:155], v[216:219]
    buffer_load_dwordx4 v39, s[16:19], s46 offen offset:1024 lds
    v_mfma_f32_16x16x32_bf16 v[216:219], a[196:199], a[156:159], v[216:219]
    s_add_u32 s46, s46, 128
    s_waitcnt lgkmcnt(4)
    v_mfma_f32_16x16x32_bf16 v[172:175], a[200:203], a[128:131], v[172:175]
    ds_read_b64_tr_b16 a[216:217], v63 offset:0
    ds_read_b64_tr_b16 a[218:219], v63 offset:2048
    v_mfma_f32_16x16x32_bf16 v[172:175], a[204:207], a[132:135], v[172:175]
    ds_read_b64_tr_b16 a[220:221], v63 offset:16384
    ds_read_b64_tr_b16 a[222:223], v63 offset:18432
    v_mfma_f32_16x16x32_bf16 v[188:191], a[200:203], a[136:139], v[188:191]
    v_mfma_f32_16x16x32_bf16 v[188:191], a[204:207], a[140:143], v[188:191]
    s_add_u32 m0, s48, 131072
    v_mfma_f32_16x16x32_bf16 v[204:207], a[200:203], a[144:147], v[204:207]
    buffer_load_dwordx4 v40, s[20:23], s47 offen offset:0 lds
    v_mfma_f32_16x16x32_bf16 v[204:207], a[204:207], a[148:151], v[204:207]
    v_mfma_f32_16x16x32_bf16 v[220:223], a[200:203], a[152:155], v[220:223]
    v_mfma_f32_16x16x32_bf16 v[220:223], a[204:207], a[156:159], v[220:223]
    s_waitcnt lgkmcnt(4)
    v_mfma_f32_16x16x32_bf16 v[104:107], a[208:211], a[128:131], v[104:107]
    ds_read_b64_tr_b16 a[192:193], v56 offset:256
    ds_read_b64_tr_b16 a[194:195], v56 offset:2304
    buffer_load_dwordx4 v41, s[20:23], s47 offen offset:1024 lds
    v_mfma_f32_16x16x32_bf16 v[104:107], a[212:215], a[132:135], v[104:107]
    ds_read_b64_tr_b16 a[196:197], v56 offset:16640
    ds_read_b64_tr_b16 a[198:199], v56 offset:18688
    s_waitcnt vmcnt(21)
    v_mfma_f32_16x16x32_bf16 v[120:123], a[208:211], a[136:139], v[120:123]
    ds_read_b128 a[160:163], v6 offset:0
    v_mfma_f32_16x16x32_bf16 v[120:123], a[212:215], a[140:143], v[120:123]
    v_mfma_f32_16x16x32_bf16 v[136:139], a[208:211], a[144:147], v[136:139]
    v_mfma_f32_16x16x32_bf16 v[136:139], a[212:215], a[148:151], v[136:139]
    v_mfma_f32_16x16x32_bf16 v[152:155], a[208:211], a[152:155], v[152:155]
    buffer_load_dwordx4 v42, s[20:23], s47 offen offset:2048 lds
    v_mfma_f32_16x16x32_bf16 v[152:155], a[212:215], a[156:159], v[152:155]
    s_waitcnt lgkmcnt(5)
    v_mfma_f32_16x16x32_bf16 v[108:111], a[216:219], a[128:131], v[108:111]
    ds_read_b64_tr_b16 a[200:201], v57 offset:256
    ds_read_b64_tr_b16 a[202:203], v57 offset:2304
    v_mfma_f32_16x16x32_bf16 v[108:111], a[220:223], a[132:135], v[108:111]
    ds_read_b64_tr_b16 a[204:205], v57 offset:16640
    ds_read_b64_tr_b16 a[206:207], v57 offset:18688
    v_mfma_f32_16x16x32_bf16 v[124:127], a[216:219], a[136:139], v[124:127]
    ds_read_b128 a[164:167], v7 offset:0
    buffer_load_dwordx4 v43, s[20:23], s47 offen offset:3072 lds
    v_mfma_f32_16x16x32_bf16 v[124:127], a[220:223], a[140:143], v[124:127]
    v_mfma_f32_16x16x32_bf16 v[140:143], a[216:219], a[144:147], v[140:143]
    v_mfma_f32_16x16x32_bf16 v[140:143], a[220:223], a[148:151], v[140:143]
    v_mfma_f32_16x16x32_bf16 v[156:159], a[216:219], a[152:155], v[156:159]
    v_mfma_f32_16x16x32_bf16 v[156:159], a[220:223], a[156:159], v[156:159]
    s_add_u32 m0, s48, 135168
    s_waitcnt lgkmcnt(6)
    v_mfma_f32_16x16x32_bf16 a[0:3], a[192:195], a[128:131], a[0:3]
    ds_read_b64_tr_b16 a[208:209], v58 offset:256
    ds_read_b64_tr_b16 a[210:211], v58 offset:2304
    buffer_load_dwordx4 v44, s[20:23], s47 offen offset:0 lds
    v_mfma_f32_16x16x32_bf16 a[0:3], a[196:199], a[132:135], a[0:3]
    ds_read_b64_tr_b16 a[212:213], v58 offset:16640
    ds_read_b64_tr_b16 a[214:215], v58 offset:18688
    v_mfma_f32_16x16x32_bf16 a[4:7], a[192:195], a[136:139], a[4:7]
    ds_read_b128 a[168:171], v6 offset:2048
    v_mfma_f32_16x16x32_bf16 a[4:7], a[196:199], a[140:143], a[4:7]
    v_mfma_f32_16x16x32_bf16 a[8:11], a[192:195], a[144:147], a[8:11]
    buffer_load_dwordx4 v45, s[20:23], s47 offen offset:1024 lds
    v_mfma_f32_16x16x32_bf16 a[8:11], a[196:199], a[148:151], a[8:11]
    v_mfma_f32_16x16x32_bf16 a[12:15], a[192:195], a[152:155], a[12:15]
    v_mfma_f32_16x16x32_bf16 a[12:15], a[196:199], a[156:159], a[12:15]
    s_waitcnt lgkmcnt(6)
    v_mfma_f32_16x16x32_bf16 a[16:19], a[200:203], a[128:131], a[16:19]
    ds_read_b64_tr_b16 a[216:217], v59 offset:256
    ds_read_b64_tr_b16 a[218:219], v59 offset:2304
    v_mfma_f32_16x16x32_bf16 a[16:19], a[204:207], a[132:135], a[16:19]
    ds_read_b64_tr_b16 a[220:221], v59 offset:16640
    ds_read_b64_tr_b16 a[222:223], v59 offset:18688
    v_mfma_f32_16x16x32_bf16 a[20:23], a[200:203], a[136:139], a[20:23]
    ds_read_b128 a[172:175], v7 offset:2048
    buffer_load_dwordx4 v46, s[20:23], s47 offen offset:2048 lds
    v_mfma_f32_16x16x32_bf16 a[20:23], a[204:207], a[140:143], a[20:23]
    v_mfma_f32_16x16x32_bf16 a[24:27], a[200:203], a[144:147], a[24:27]
    v_mfma_f32_16x16x32_bf16 a[24:27], a[204:207], a[148:151], a[24:27]
    v_mfma_f32_16x16x32_bf16 a[28:31], a[200:203], a[152:155], a[28:31]
    buffer_load_dwordx4 v47, s[20:23], s47 offen offset:3072 lds
    v_mfma_f32_16x16x32_bf16 a[28:31], a[204:207], a[156:159], a[28:31]
    s_add_u32 s47, s47, 524288
    s_waitcnt lgkmcnt(6)
    v_mfma_f32_16x16x32_bf16 a[32:35], a[208:211], a[128:131], a[32:35]
    ds_read_b64_tr_b16 a[192:193], v60 offset:256
    ds_read_b64_tr_b16 a[194:195], v60 offset:2304
    v_mfma_f32_16x16x32_bf16 a[32:35], a[212:215], a[132:135], a[32:35]
    ds_read_b64_tr_b16 a[196:197], v60 offset:16640
    ds_read_b64_tr_b16 a[198:199], v60 offset:18688
    v_mfma_f32_16x16x32_bf16 a[36:39], a[208:211], a[136:139], a[36:39]
    ds_read_b128 a[176:179], v6 offset:4096
    v_mfma_f32_16x16x32_bf16 a[36:39], a[212:215], a[140:143], a[36:39]
    v_mfma_f32_16x16x32_bf16 a[40:43], a[208:211], a[144:147], a[40:43]
    v_mfma_f32_16x16x32_bf16 a[40:43], a[212:215], a[148:151], a[40:43]
    v_mfma_f32_16x16x32_bf16 a[44:47], a[208:211], a[152:155], a[44:47]
    v_mfma_f32_16x16x32_bf16 a[44:47], a[212:215], a[156:159], a[44:47]
    s_waitcnt lgkmcnt(6)
    v_mfma_f32_16x16x32_bf16 a[48:51], a[216:219], a[128:131], a[48:51]
    ds_read_b64_tr_b16 a[200:201], v61 offset:256
    ds_read_b64_tr_b16 a[202:203], v61 offset:2304
    v_mfma_f32_16x16x32_bf16 a[48:51], a[220:223], a[132:135], a[48:51]
    ds_read_b64_tr_b16 a[204:205], v61 offset:16640
    ds_read_b64_tr_b16 a[206:207], v61 offset:18688
    v_mfma_f32_16x16x32_bf16 a[52:55], a[216:219], a[136:139], a[52:55]
    ds_read_b128 a[180:183], v7 offset:4096
    v_mfma_f32_16x16x32_bf16 a[52:55], a[220:223], a[140:143], a[52:55]
    v_mfma_f32_16x16x32_bf16 a[56:59], a[216:219], a[144:147], a[56:59]
    v_mfma_f32_16x16x32_bf16 a[56:59], a[220:223], a[148:151], a[56:59]
    v_mfma_f32_16x16x32_bf16 a[60:63], a[216:219], a[152:155], a[60:63]
    v_mfma_f32_16x16x32_bf16 a[60:63], a[220:223], a[156:159], a[60:63]
    s_waitcnt lgkmcnt(6)
    v_mfma_f32_16x16x32_bf16 a[64:67], a[192:195], a[128:131], a[64:67]
    ds_read_b64_tr_b16 a[208:209], v62 offset:256
    ds_read_b64_tr_b16 a[210:211], v62 offset:2304
    v_mfma_f32_16x16x32_bf16 a[64:67], a[196:199], a[132:135], a[64:67]
    ds_read_b64_tr_b16 a[212:213], v62 offset:16640
    ds_read_b64_tr_b16 a[214:215], v62 offset:18688
    v_mfma_f32_16x16x32_bf16 a[68:71], a[192:195], a[136:139], a[68:71]
    ds_read_b128 a[184:187], v6 offset:6144
    v_mfma_f32_16x16x32_bf16 a[68:71], a[196:199], a[140:143], a[68:71]
    v_mfma_f32_16x16x32_bf16 a[72:75], a[192:195], a[144:147], a[72:75]
    v_mfma_f32_16x16x32_bf16 a[72:75], a[196:199], a[148:151], a[72:75]
    v_mfma_f32_16x16x32_bf16 a[76:79], a[192:195], a[152:155], a[76:79]
    v_mfma_f32_16x16x32_bf16 a[76:79], a[196:199], a[156:159], a[76:79]
    s_waitcnt lgkmcnt(6)
    v_mfma_f32_16x16x32_bf16 a[80:83], a[200:203], a[128:131], a[80:83]
    ds_read_b64_tr_b16 a[216:217], v63 offset:256
    ds_read_b64_tr_b16 a[218:219], v63 offset:2304
    v_mfma_f32_16x16x32_bf16 a[80:83], a[204:207], a[132:135], a[80:83]
    ds_read_b64_tr_b16 a[220:221], v63 offset:16640
    ds_read_b64_tr_b16 a[222:223], v63 offset:18688
    v_mfma_f32_16x16x32_bf16 a[84:87], a[200:203], a[136:139], a[84:87]
    ds_read_b128 a[188:191], v7 offset:6144
    v_mfma_f32_16x16x32_bf16 a[84:87], a[204:207], a[140:143], a[84:87]
    v_mfma_f32_16x16x32_bf16 a[88:91], a[200:203], a[144:147], a[88:91]
    v_mfma_f32_16x16x32_bf16 a[88:91], a[204:207], a[148:151], a[88:91]
    v_mfma_f32_16x16x32_bf16 a[92:95], a[200:203], a[152:155], a[92:95]
    v_mfma_f32_16x16x32_bf16 a[92:95], a[204:207], a[156:159], a[92:95]
    s_waitcnt vmcnt(19) lgkmcnt(0)
    s_barrier
    v_mfma_f32_16x16x32_bf16 a[96:99], a[208:211], a[128:131], a[96:99]
    ds_read_b64_tr_b16 a[192:193], v48 offset:0
    ds_read_b64_tr_b16 a[194:195], v48 offset:2048
    v_mfma_f32_16x16x32_bf16 a[96:99], a[212:215], a[132:135], a[96:99]
    ds_read_b64_tr_b16 a[196:197], v48 offset:16384
    ds_read_b64_tr_b16 a[198:199], v48 offset:18432
    v_mfma_f32_16x16x32_bf16 a[100:103], a[208:211], a[136:139], a[100:103]
    v_mfma_f32_16x16x32_bf16 a[100:103], a[212:215], a[140:143], a[100:103]
    v_mfma_f32_16x16x32_bf16 a[104:107], a[208:211], a[144:147], a[104:107]
    v_mfma_f32_16x16x32_bf16 a[104:107], a[212:215], a[148:151], a[104:107]
    v_mfma_f32_16x16x32_bf16 a[108:111], a[208:211], a[152:155], a[108:111]
    v_mfma_f32_16x16x32_bf16 a[108:111], a[212:215], a[156:159], a[108:111]
    v_mfma_f32_16x16x32_bf16 a[112:115], a[216:219], a[128:131], a[112:115]
    ds_read_b64_tr_b16 a[200:201], v49 offset:0
    ds_read_b64_tr_b16 a[202:203], v49 offset:2048
    v_mfma_f32_16x16x32_bf16 a[112:115], a[220:223], a[132:135], a[112:115]
    ds_read_b64_tr_b16 a[204:205], v49 offset:16384
    ds_read_b64_tr_b16 a[206:207], v49 offset:18432
    v_mfma_f32_16x16x32_bf16 a[116:119], a[216:219], a[136:139], a[116:119]
    v_mfma_f32_16x16x32_bf16 a[116:119], a[220:223], a[140:143], a[116:119]
    v_mfma_f32_16x16x32_bf16 a[120:123], a[216:219], a[144:147], a[120:123]
    v_mfma_f32_16x16x32_bf16 a[120:123], a[220:223], a[148:151], a[120:123]
    v_mfma_f32_16x16x32_bf16 a[124:127], a[216:219], a[152:155], a[124:127]
    v_mfma_f32_16x16x32_bf16 a[124:127], a[220:223], a[156:159], a[124:127]
    s_mov_b32 s58, 0x3e0293ee
    s_mov_b32 s59, 0x3e0293ee
    s_waitcnt lgkmcnt(4)
    v_mfma_f32_16x16x32_bf16 v[160:163], a[192:195], a[160:163], v[160:163]
    ds_read_b64_tr_b16 a[208:209], v50 offset:0
    ds_read_b64_tr_b16 a[210:211], v50 offset:2048
    v_mfma_f32_16x16x32_bf16 v[160:163], a[196:199], a[164:167], v[160:163]
    ds_read_b64_tr_b16 a[212:213], v50 offset:16384
    ds_read_b64_tr_b16 a[214:215], v50 offset:18432
    v_mfma_f32_16x16x32_bf16 v[176:179], a[192:195], a[168:171], v[176:179]
    v_mfma_f32_16x16x32_bf16 v[176:179], a[196:199], a[172:175], v[176:179]
    s_mov_b32 m0, s32
    v_mfma_f32_16x16x32_bf16 v[192:195], a[192:195], a[176:179], v[192:195]
    buffer_load_dwordx4 v20, s[8:11], s44 offen offset:0 nt lds
    v_mfma_f32_16x16x32_bf16 v[192:195], a[196:199], a[180:183], v[192:195]
    v_mfma_f32_16x16x32_bf16 v[208:211], a[192:195], a[184:187], v[208:211]
    v_mfma_f32_16x16x32_bf16 v[208:211], a[196:199], a[188:191], v[208:211]
    s_waitcnt lgkmcnt(4)
    v_mfma_f32_16x16x32_bf16 v[164:167], a[200:203], a[160:163], v[164:167]
    ds_read_b64_tr_b16 a[216:217], v51 offset:0
    ds_read_b64_tr_b16 a[218:219], v51 offset:2048
    v_mfma_f32_16x16x32_bf16 v[164:167], a[204:207], a[164:167], v[164:167]
    ds_read_b64_tr_b16 a[220:221], v51 offset:16384
    ds_read_b64_tr_b16 a[222:223], v51 offset:18432
    v_mfma_f32_16x16x32_bf16 v[180:183], a[200:203], a[168:171], v[180:183]
    buffer_load_dwordx4 v21, s[8:11], s44 offen offset:1024 nt lds
    s_waitcnt vmcnt(10)
    v_mfma_f32_16x16x32_bf16 v[180:183], a[204:207], a[172:175], v[180:183]
    ds_read_b128 a[128:131], v6 offset:32768
    v_mfma_f32_16x16x32_bf16 v[196:199], a[200:203], a[176:179], v[196:199]
    v_mfma_f32_16x16x32_bf16 v[196:199], a[204:207], a[180:183], v[196:199]
    v_mfma_f32_16x16x32_bf16 v[212:215], a[200:203], a[184:187], v[212:215]
    v_mfma_f32_16x16x32_bf16 v[212:215], a[204:207], a[188:191], v[212:215]
    ds_read_b128 a[132:135], v7 offset:32768
    s_waitcnt lgkmcnt(6)
    v_mfma_f32_16x16x32_bf16 v[96:99], a[208:211], a[160:163], v[96:99]
    ds_read_b64_tr_b16 a[192:193], v52 offset:0
    ds_read_b64_tr_b16 a[194:195], v52 offset:2048
    buffer_load_dwordx4 v22, s[8:11], s44 offen offset:2048 nt lds
    v_mfma_f32_16x16x32_bf16 v[96:99], a[212:215], a[164:167], v[96:99]
    ds_read_b64_tr_b16 a[196:197], v52 offset:16384
    ds_read_b64_tr_b16 a[198:199], v52 offset:18432
    v_mfma_f32_16x16x32_bf16 v[112:115], a[208:211], a[168:171], v[112:115]
    v_mfma_f32_16x16x32_bf16 v[112:115], a[212:215], a[172:175], v[112:115]
    ds_read_b128 a[136:139], v6 offset:34816
    v_mfma_f32_16x16x32_bf16 v[128:131], a[208:211], a[176:179], v[128:131]
    v_mfma_f32_16x16x32_bf16 v[128:131], a[212:215], a[180:183], v[128:131]
    v_mfma_f32_16x16x32_bf16 v[144:147], a[208:211], a[184:187], v[144:147]
    buffer_load_dwordx4 v23, s[8:11], s44 offen offset:3072 nt lds
    v_mfma_f32_16x16x32_bf16 v[144:147], a[212:215], a[188:191], v[144:147]
    ds_read_b128 a[140:143], v7 offset:34816
    s_add_u32 s44, s44, 16384
    s_waitcnt lgkmcnt(8)
    v_mfma_f32_16x16x32_bf16 v[100:103], a[216:219], a[160:163], v[100:103]
    ds_read_b64_tr_b16 a[200:201], v53 offset:0
    ds_read_b64_tr_b16 a[202:203], v53 offset:2048
    v_mfma_f32_16x16x32_bf16 v[100:103], a[220:223], a[164:167], v[100:103]
    ds_read_b64_tr_b16 a[204:205], v53 offset:16384
    ds_read_b64_tr_b16 a[206:207], v53 offset:18432
    v_mfma_f32_16x16x32_bf16 v[116:119], a[216:219], a[168:171], v[116:119]
    v_mfma_f32_16x16x32_bf16 v[116:119], a[220:223], a[172:175], v[116:119]
    ds_read_b128 a[144:147], v6 offset:36864
    s_mov_b32 m0, s33
    v_mfma_f32_16x16x32_bf16 v[132:135], a[216:219], a[176:179], v[132:135]
    buffer_load_dwordx4 v20, s[8:11], s44 offen offset:0 nt lds
    v_mfma_f32_16x16x32_bf16 v[132:135], a[220:223], a[180:183], v[132:135]
    v_mfma_f32_16x16x32_bf16 v[148:151], a[216:219], a[184:187], v[148:151]
    v_mfma_f32_16x16x32_bf16 v[148:151], a[220:223], a[188:191], v[148:151]
    ds_read_b128 a[148:151], v7 offset:36864
    s_waitcnt lgkmcnt(8)
    v_mfma_f32_16x16x32_bf16 v[168:171], a[192:195], a[160:163], v[168:171]
    ds_read_b64_tr_b16 a[208:209], v54 offset:0
    ds_read_b64_tr_b16 a[210:211], v54 offset:2048
    v_mfma_f32_16x16x32_bf16 v[168:171], a[196:199], a[164:167], v[168:171]
    ds_read_b64_tr_b16 a[212:213], v54 offset:16384
    ds_read_b64_tr_b16 a[214:215], v54 offset:18432
    v_mfma_f32_16x16x32_bf16 v[184:187], a[192:195], a[168:171], v[184:187]
    buffer_load_dwordx4 v21, s[8:11], s44 offen offset:1024 nt lds
    v_mfma_f32_16x16x32_bf16 v[184:187], a[196:199], a[172:175], v[184:187]
    ds_read_b128 a[152:155], v6 offset:38912
    v_mfma_f32_16x16x32_bf16 v[200:203], a[192:195], a[176:179], v[200:203]
    v_mfma_f32_16x16x32_bf16 v[200:203], a[196:199], a[180:183], v[200:203]
    v_mfma_f32_16x16x32_bf16 v[216:219], a[192:195], a[184:187], v[216:219]
    v_mfma_f32_16x16x32_bf16 v[216:219], a[196:199], a[188:191], v[216:219]
    ds_read_b128 a[156:159], v7 offset:38912
    s_waitcnt lgkmcnt(8)
    v_mfma_f32_16x16x32_bf16 v[172:175], a[200:203], a[160:163], v[172:175]
    ds_read_b64_tr_b16 a[216:217], v55 offset:0
    ds_read_b64_tr_b16 a[218:219], v55 offset:2048
    buffer_load_dwordx4 v22, s[8:11], s44 offen offset:2048 nt lds
    v_mfma_f32_16x16x32_bf16 v[172:175], a[204:207], a[164:167], v[172:175]
    ds_read_b64_tr_b16 a[220:221], v55 offset:16384
    ds_read_b64_tr_b16 a[222:223], v55 offset:18432
    v_mfma_f32_16x16x32_bf16 v[188:191], a[200:203], a[168:171], v[188:191]
    v_mfma_f32_16x16x32_bf16 v[188:191], a[204:207], a[172:175], v[188:191]
    v_mfma_f32_16x16x32_bf16 v[204:207], a[200:203], a[176:179], v[204:207]
    v_mfma_f32_16x16x32_bf16 v[204:207], a[204:207], a[180:183], v[204:207]
    v_mfma_f32_16x16x32_bf16 v[220:223], a[200:203], a[184:187], v[220:223]
    buffer_load_dwordx4 v23, s[8:11], s44 offen offset:3072 nt lds
    v_mfma_f32_16x16x32_bf16 v[220:223], a[204:207], a[188:191], v[220:223]
    s_add_u32 s44, s44, 16384
    s_waitcnt vmcnt(8) lgkmcnt(0)
    s_barrier
    v_mfma_f32_16x16x32_bf16 v[104:107], a[208:211], a[160:163], v[104:107]
    ds_read_b64_tr_b16 a[192:193], v56 offset:32768
    ds_read_b64_tr_b16 a[194:195], v56 offset:34816
    v_mfma_f32_16x16x32_bf16 v[104:107], a[212:215], a[164:167], v[104:107]
    ds_read_b64_tr_b16 a[196:197], v56 offset:49152
    ds_read_b64_tr_b16 a[198:199], v56 offset:51200
    v_mfma_f32_16x16x32_bf16 v[120:123], a[208:211], a[168:171], v[120:123]
    v_mfma_f32_16x16x32_bf16 v[120:123], a[212:215], a[172:175], v[120:123]
    s_mov_b32 m0, s36
    v_mfma_f32_16x16x32_bf16 v[136:139], a[208:211], a[176:179], v[136:139]
    buffer_load_dwordx4 v24, s[12:15], s45 offen offset:0 nt lds
    v_mfma_f32_16x16x32_bf16 v[136:139], a[212:215], a[180:183], v[136:139]
    v_mfma_f32_16x16x32_bf16 v[152:155], a[208:211], a[184:187], v[152:155]
    v_mfma_f32_16x16x32_bf16 v[152:155], a[212:215], a[188:191], v[152:155]
    v_mfma_f32_16x16x32_bf16 v[108:111], a[216:219], a[160:163], v[108:111]
    ds_read_b64_tr_b16 a[200:201], v57 offset:32768
    ds_read_b64_tr_b16 a[202:203], v57 offset:34816
    v_mfma_f32_16x16x32_bf16 v[108:111], a[220:223], a[164:167], v[108:111]
    ds_read_b64_tr_b16 a[204:205], v57 offset:49152
    ds_read_b64_tr_b16 a[206:207], v57 offset:51200
    v_mfma_f32_16x16x32_bf16 v[124:127], a[216:219], a[168:171], v[124:127]
    buffer_load_dwordx4 v25, s[12:15], s45 offen offset:1024 nt lds
    v_mfma_f32_16x16x32_bf16 v[124:127], a[220:223], a[172:175], v[124:127]
    v_mfma_f32_16x16x32_bf16 v[140:143], a[216:219], a[176:179], v[140:143]
    v_mfma_f32_16x16x32_bf16 v[140:143], a[220:223], a[180:183], v[140:143]
    v_mfma_f32_16x16x32_bf16 v[156:159], a[216:219], a[184:187], v[156:159]
    v_mfma_f32_16x16x32_bf16 v[156:159], a[220:223], a[188:191], v[156:159]
    s_waitcnt lgkmcnt(4)
    v_mfma_f32_16x16x32_bf16 v[160:163], a[192:195], a[128:131], v[160:163]
    ds_read_b64_tr_b16 a[208:209], v58 offset:32768
    ds_read_b64_tr_b16 a[210:211], v58 offset:34816
    buffer_load_dwordx4 v24, s[12:15], s45 offen offset:2048 nt lds
    v_mfma_f32_16x16x32_bf16 v[160:163], a[196:199], a[132:135], v[160:163]
    ds_read_b64_tr_b16 a[212:213], v58 offset:49152
    ds_read_b64_tr_b16 a[214:215], v58 offset:51200
    v_mfma_f32_16x16x32_bf16 v[176:179], a[192:195], a[136:139], v[176:179]
    v_mfma_f32_16x16x32_bf16 v[176:179], a[196:199], a[140:143], v[176:179]
    v_mfma_f32_16x16x32_bf16 v[192:195], a[192:195], a[144:147], v[192:195]
    v_mfma_f32_16x16x32_bf16 v[192:195], a[196:199], a[148:151], v[192:195]
    v_mfma_f32_16x16x32_bf16 v[208:211], a[192:195], a[152:155], v[208:211]
    buffer_load_dwordx4 v25, s[12:15], s45 offen offset:3072 nt lds
    v_mfma_f32_16x16x32_bf16 v[208:211], a[196:199], a[156:159], v[208:211]
    s_add_u32 s45, s45, 16384
    s_waitcnt lgkmcnt(4)
    v_mfma_f32_16x16x32_bf16 v[164:167], a[200:203], a[128:131], v[164:167]
    ds_read_b64_tr_b16 a[216:217], v59 offset:32768
    ds_read_b64_tr_b16 a[218:219], v59 offset:34816
    v_mfma_f32_16x16x32_bf16 v[164:167], a[204:207], a[132:135], v[164:167]
    ds_read_b64_tr_b16 a[220:221], v59 offset:49152
    ds_read_b64_tr_b16 a[222:223], v59 offset:51200
    v_mfma_f32_16x16x32_bf16 v[180:183], a[200:203], a[136:139], v[180:183]
    v_mfma_f32_16x16x32_bf16 v[180:183], a[204:207], a[140:143], v[180:183]
    s_mov_b32 m0, s34
    v_mfma_f32_16x16x32_bf16 v[196:199], a[200:203], a[144:147], v[196:199]
    buffer_load_dwordx4 v20, s[8:11], s44 offen offset:0 nt lds
    v_mfma_f32_16x16x32_bf16 v[196:199], a[204:207], a[148:151], v[196:199]
    v_mfma_f32_16x16x32_bf16 v[212:215], a[200:203], a[152:155], v[212:215]
    v_mfma_f32_16x16x32_bf16 v[212:215], a[204:207], a[156:159], v[212:215]
    s_waitcnt lgkmcnt(4)
    v_mfma_f32_16x16x32_bf16 v[96:99], a[208:211], a[128:131], v[96:99]
    ds_read_b64_tr_b16 a[192:193], v60 offset:32768
    ds_read_b64_tr_b16 a[194:195], v60 offset:34816
    v_mfma_f32_16x16x32_bf16 v[96:99], a[212:215], a[132:135], v[96:99]
    ds_read_b64_tr_b16 a[196:197], v60 offset:49152
    ds_read_b64_tr_b16 a[198:199], v60 offset:51200
    v_mfma_f32_16x16x32_bf16 v[112:115], a[208:211], a[136:139], v[112:115]
    buffer_load_dwordx4 v21, s[8:11], s44 offen offset:1024 nt lds
    v_mfma_f32_16x16x32_bf16 v[112:115], a[212:215], a[140:143], v[112:115]
    v_mfma_f32_16x16x32_bf16 v[128:131], a[208:211], a[144:147], v[128:131]
    v_mfma_f32_16x16x32_bf16 v[128:131], a[212:215], a[148:151], v[128:131]
    v_mfma_f32_16x16x32_bf16 v[144:147], a[208:211], a[152:155], v[144:147]
    v_mfma_f32_16x16x32_bf16 v[144:147], a[212:215], a[156:159], v[144:147]
    s_waitcnt lgkmcnt(4)
    v_mfma_f32_16x16x32_bf16 v[100:103], a[216:219], a[128:131], v[100:103]
    ds_read_b64_tr_b16 a[200:201], v61 offset:32768
    ds_read_b64_tr_b16 a[202:203], v61 offset:34816
    buffer_load_dwordx4 v22, s[8:11], s44 offen offset:2048 nt lds
    v_mfma_f32_16x16x32_bf16 v[100:103], a[220:223], a[132:135], v[100:103]
    ds_read_b64_tr_b16 a[204:205], v61 offset:49152
    ds_read_b64_tr_b16 a[206:207], v61 offset:51200
    v_mfma_f32_16x16x32_bf16 v[116:119], a[216:219], a[136:139], v[116:119]
    v_mfma_f32_16x16x32_bf16 v[116:119], a[220:223], a[140:143], v[116:119]
    v_mfma_f32_16x16x32_bf16 v[132:135], a[216:219], a[144:147], v[132:135]
    v_mfma_f32_16x16x32_bf16 v[132:135], a[220:223], a[148:151], v[132:135]
    v_mfma_f32_16x16x32_bf16 v[148:151], a[216:219], a[152:155], v[148:151]
    buffer_load_dwordx4 v23, s[8:11], s44 offen offset:3072 nt lds
    v_mfma_f32_16x16x32_bf16 v[148:151], a[220:223], a[156:159], v[148:151]
    s_add_u32 s44, s44, 16384
    s_waitcnt lgkmcnt(4)
    v_mfma_f32_16x16x32_bf16 v[168:171], a[192:195], a[128:131], v[168:171]
    ds_read_b64_tr_b16 a[208:209], v62 offset:32768
    ds_read_b64_tr_b16 a[210:211], v62 offset:34816
    v_mfma_f32_16x16x32_bf16 v[168:171], a[196:199], a[132:135], v[168:171]
    ds_read_b64_tr_b16 a[212:213], v62 offset:49152
    ds_read_b64_tr_b16 a[214:215], v62 offset:51200
    v_mfma_f32_16x16x32_bf16 v[184:187], a[192:195], a[136:139], v[184:187]
    v_mfma_f32_16x16x32_bf16 v[184:187], a[196:199], a[140:143], v[184:187]
    s_mov_b32 m0, s37
    v_mfma_f32_16x16x32_bf16 v[200:203], a[192:195], a[144:147], v[200:203]
    buffer_load_dwordx4 v24, s[12:15], s45 offen offset:0 nt lds
    v_mfma_f32_16x16x32_bf16 v[200:203], a[196:199], a[148:151], v[200:203]
    v_mfma_f32_16x16x32_bf16 v[216:219], a[192:195], a[152:155], v[216:219]
    v_mfma_f32_16x16x32_bf16 v[216:219], a[196:199], a[156:159], v[216:219]
    s_waitcnt lgkmcnt(4)
    v_mfma_f32_16x16x32_bf16 v[172:175], a[200:203], a[128:131], v[172:175]
    ds_read_b64_tr_b16 a[216:217], v63 offset:32768
    ds_read_b64_tr_b16 a[218:219], v63 offset:34816
    v_mfma_f32_16x16x32_bf16 v[172:175], a[204:207], a[132:135], v[172:175]
    ds_read_b64_tr_b16 a[220:221], v63 offset:49152
    ds_read_b64_tr_b16 a[222:223], v63 offset:51200
    v_mfma_f32_16x16x32_bf16 v[188:191], a[200:203], a[136:139], v[188:191]
    buffer_load_dwordx4 v25, s[12:15], s45 offen offset:1024 nt lds
    v_mfma_f32_16x16x32_bf16 v[188:191], a[204:207], a[140:143], v[188:191]
    v_mfma_f32_16x16x32_bf16 v[204:207], a[200:203], a[144:147], v[204:207]
    v_mfma_f32_16x16x32_bf16 v[204:207], a[204:207], a[148:151], v[204:207]
    v_mfma_f32_16x16x32_bf16 v[220:223], a[200:203], a[152:155], v[220:223]
    v_mfma_f32_16x16x32_bf16 v[220:223], a[204:207], a[156:159], v[220:223]
    s_waitcnt lgkmcnt(4)
    v_mfma_f32_16x16x32_bf16 v[104:107], a[208:211], a[128:131], v[104:107]
    ds_read_b64_tr_b16 a[192:193], v48 offset:256
    ds_read_b64_tr_b16 a[194:195], v48 offset:2304
    buffer_load_dwordx4 v24, s[12:15], s45 offen offset:2048 nt lds
    v_mfma_f32_16x16x32_bf16 v[104:107], a[212:215], a[132:135], v[104:107]
    ds_read_b64_tr_b16 a[196:197], v48 offset:16640
    ds_read_b64_tr_b16 a[198:199], v48 offset:18688
    v_mfma_f32_16x16x32_bf16 v[120:123], a[208:211], a[136:139], v[120:123]
    v_mfma_f32_16x16x32_bf16 v[120:123], a[212:215], a[140:143], v[120:123]
    v_mfma_f32_16x16x32_bf16 v[136:139], a[208:211], a[144:147], v[136:139]
    v_mfma_f32_16x16x32_bf16 v[136:139], a[212:215], a[148:151], v[136:139]
    v_mfma_f32_16x16x32_bf16 v[152:155], a[208:211], a[152:155], v[152:155]
    buffer_load_dwordx4 v25, s[12:15], s45 offen offset:3072 nt lds
    v_mfma_f32_16x16x32_bf16 v[152:155], a[212:215], a[156:159], v[152:155]
    s_add_u32 s45, s45, 16384
    s_waitcnt lgkmcnt(4)
    v_mfma_f32_16x16x32_bf16 v[108:111], a[216:219], a[128:131], v[108:111]
    ds_read_b64_tr_b16 a[200:201], v49 offset:256
    ds_read_b64_tr_b16 a[202:203], v49 offset:2304
    v_mfma_f32_16x16x32_bf16 v[108:111], a[220:223], a[132:135], v[108:111]
    ds_read_b64_tr_b16 a[204:205], v49 offset:16640
    ds_read_b64_tr_b16 a[206:207], v49 offset:18688
    v_mfma_f32_16x16x32_bf16 v[124:127], a[216:219], a[136:139], v[124:127]
    v_mfma_f32_16x16x32_bf16 v[124:127], a[220:223], a[140:143], v[124:127]
    v_mfma_f32_16x16x32_bf16 v[140:143], a[216:219], a[144:147], v[140:143]
    v_mfma_f32_16x16x32_bf16 v[140:143], a[220:223], a[148:151], v[140:143]
    v_mfma_f32_16x16x32_bf16 v[156:159], a[216:219], a[152:155], v[156:159]
    v_mfma_f32_16x16x32_bf16 v[156:159], a[220:223], a[156:159], v[156:159]
    s_waitcnt lgkmcnt(4)
    v_mfma_f32_16x16x32_bf16 a[0:3], a[192:195], a[160:163], a[0:3]
    ds_read_b64_tr_b16 a[208:209], v50 offset:256
    ds_read_b64_tr_b16 a[210:211], v50 offset:2304
    v_mfma_f32_16x16x32_bf16 a[0:3], a[196:199], a[164:167], a[0:3]
    ds_read_b64_tr_b16 a[212:213], v50 offset:16640
    ds_read_b64_tr_b16 a[214:215], v50 offset:18688
    v_mfma_f32_16x16x32_bf16 a[4:7], a[192:195], a[168:171], a[4:7]
    v_mul_f32 v160, s58, v160
    v_mul_f32 v161, s58, v161
    v_mfma_f32_16x16x32_bf16 a[4:7], a[196:199], a[172:175], a[4:7]
    v_mul_f32 v162, s58, v162
    v_mul_f32 v163, s58, v163
    v_mfma_f32_16x16x32_bf16 a[8:11], a[192:195], a[176:179], a[8:11]
    v_mul_f32 v164, s58, v164
    v_mul_f32 v165, s58, v165
    v_mul_f32 v166, s58, v166
    v_mfma_f32_16x16x32_bf16 a[8:11], a[196:199], a[180:183], a[8:11]
    v_mul_f32 v167, s58, v167
    v_cvt_pk_bf16_f32 v160, v160, v161
    v_mfma_f32_16x16x32_bf16 a[12:15], a[192:195], a[184:187], a[12:15]
    v_cvt_pk_bf16_f32 v161, v162, v163
    v_cvt_pk_bf16_f32 v162, v164, v165
    v_mfma_f32_16x16x32_bf16 a[12:15], a[196:199], a[188:191], a[12:15]
    v_cvt_pk_bf16_f32 v163, v166, v167
    v_mul_f32 v96, s58, v96
    s_waitcnt lgkmcnt(4)
    v_mfma_f32_16x16x32_bf16 a[16:19], a[200:203], a[160:163], a[16:19]
    ds_read_b64_tr_b16 a[216:217], v51 offset:256
    ds_read_b64_tr_b16 a[218:219], v51 offset:2304
    v_mfma_f32_16x16x32_bf16 a[16:19], a[204:207], a[164:167], a[16:19]
    ds_read_b64_tr_b16 a[220:221], v51 offset:16640
    ds_read_b64_tr_b16 a[222:223], v51 offset:18688
    v_mfma_f32_16x16x32_bf16 a[20:23], a[200:203], a[168:171], a[20:23]
    v_mul_f32 v97, s58, v97
    v_mul_f32 v98, s58, v98
    v_mfma_f32_16x16x32_bf16 a[20:23], a[204:207], a[172:175], a[20:23]
    v_mul_f32 v99, s58, v99
    v_mul_f32 v100, s58, v100
    v_mfma_f32_16x16x32_bf16 a[24:27], a[200:203], a[176:179], a[24:27]
    v_mul_f32 v101, s58, v101
    v_mul_f32 v102, s58, v102
    v_mul_f32 v103, s58, v103
    v_mfma_f32_16x16x32_bf16 a[24:27], a[204:207], a[180:183], a[24:27]
    v_permlane16_swap_b32 v160, v162
    v_permlane16_swap_b32 v161, v163
    v_mfma_f32_16x16x32_bf16 a[28:31], a[200:203], a[184:187], a[28:31]
    v_cvt_pk_bf16_f32 v164, v96, v97
    v_cvt_pk_bf16_f32 v165, v98, v99
    v_mfma_f32_16x16x32_bf16 a[28:31], a[204:207], a[188:191], a[28:31]
    v_cvt_pk_bf16_f32 v166, v100, v101
    v_cvt_pk_bf16_f32 v167, v102, v103
    s_waitcnt lgkmcnt(4)
    v_mfma_f32_16x16x32_bf16 a[32:35], a[208:211], a[160:163], a[32:35]
    ds_read_b64_tr_b16 a[192:193], v52 offset:256
    ds_read_b64_tr_b16 a[194:195], v52 offset:2304
    v_mfma_f32_16x16x32_bf16 a[32:35], a[212:215], a[164:167], a[32:35]
    ds_read_b64_tr_b16 a[196:197], v52 offset:16640
    ds_read_b64_tr_b16 a[198:199], v52 offset:18688
    v_mfma_f32_16x16x32_bf16 a[36:39], a[208:211], a[168:171], a[36:39]
    v_mul_f32 v168, s58, v168
    v_mul_f32 v169, s58, v169
    v_mfma_f32_16x16x32_bf16 a[36:39], a[212:215], a[172:175], a[36:39]
    v_mul_f32 v170, s58, v170
    v_mul_f32 v171, s58, v171
    v_mfma_f32_16x16x32_bf16 a[40:43], a[208:211], a[176:179], a[40:43]
    v_mul_f32 v172, s58, v172
    v_mul_f32 v173, s58, v173
    v_mul_f32 v174, s58, v174
    v_mfma_f32_16x16x32_bf16 a[40:43], a[212:215], a[180:183], a[40:43]
    v_mul_f32 v175, s58, v175
    v_permlane16_swap_b32 v164, v166
    v_mfma_f32_16x16x32_bf16 a[44:47], a[208:211], a[184:187], a[44:47]
    v_permlane16_swap_b32 v165, v167
    v_cvt_pk_bf16_f32 v168, v168, v169
    v_mfma_f32_16x16x32_bf16 a[44:47], a[212:215], a[188:191], a[44:47]
    v_cvt_pk_bf16_f32 v169, v170, v171
    v_cvt_pk_bf16_f32 v170, v172, v173
    s_waitcnt lgkmcnt(4)
    v_mfma_f32_16x16x32_bf16 a[48:51], a[216:219], a[160:163], a[48:51]
    ds_read_b64_tr_b16 a[200:201], v53 offset:256
    ds_read_b64_tr_b16 a[202:203], v53 offset:2304
    v_mfma_f32_16x16x32_bf16 a[48:51], a[220:223], a[164:167], a[48:51]
    ds_read_b64_tr_b16 a[204:205], v53 offset:16640
    ds_read_b64_tr_b16 a[206:207], v53 offset:18688
    v_mfma_f32_16x16x32_bf16 a[52:55], a[216:219], a[168:171], a[52:55]
    v_cvt_pk_bf16_f32 v171, v174, v175
    v_mul_f32 v104, s58, v104
    v_mfma_f32_16x16x32_bf16 a[52:55], a[220:223], a[172:175], a[52:55]
    v_mul_f32 v105, s58, v105
    v_mul_f32 v106, s58, v106
    v_mfma_f32_16x16x32_bf16 a[56:59], a[216:219], a[176:179], a[56:59]
    v_mul_f32 v107, s58, v107
    v_mul_f32 v108, s58, v108
    v_mul_f32 v109, s58, v109
    v_mfma_f32_16x16x32_bf16 a[56:59], a[220:223], a[180:183], a[56:59]
    v_mul_f32 v110, s58, v110
    v_mul_f32 v111, s58, v111
    v_mfma_f32_16x16x32_bf16 a[60:63], a[216:219], a[184:187], a[60:63]
    v_permlane16_swap_b32 v168, v170
    v_permlane16_swap_b32 v169, v171
    v_mfma_f32_16x16x32_bf16 a[60:63], a[220:223], a[188:191], a[60:63]
    v_cvt_pk_bf16_f32 v172, v104, v105
    v_cvt_pk_bf16_f32 v173, v106, v107
    s_waitcnt lgkmcnt(4)
    v_mfma_f32_16x16x32_bf16 a[64:67], a[192:195], a[160:163], a[64:67]
    ds_read_b64_tr_b16 a[208:209], v54 offset:256
    ds_read_b64_tr_b16 a[210:211], v54 offset:2304
    v_mfma_f32_16x16x32_bf16 a[64:67], a[196:199], a[164:167], a[64:67]
    ds_read_b64_tr_b16 a[212:213], v54 offset:16640
    ds_read_b64_tr_b16 a[214:215], v54 offset:18688
    v_mfma_f32_16x16x32_bf16 a[68:71], a[192:195], a[168:171], a[68:71]
    v_cvt_pk_bf16_f32 v174, v108, v109
    v_cvt_pk_bf16_f32 v175, v110, v111
    v_mfma_f32_16x16x32_bf16 a[68:71], a[196:199], a[172:175], a[68:71]
    v_mul_f32 v176, s58, v176
    v_mul_f32 v177, s58, v177
    v_mfma_f32_16x16x32_bf16 a[72:75], a[192:195], a[176:179], a[72:75]
    v_mul_f32 v178, s58, v178
    v_mul_f32 v179, s58, v179
    v_mul_f32 v180, s58, v180
    v_mfma_f32_16x16x32_bf16 a[72:75], a[196:199], a[180:183], a[72:75]
    v_mul_f32 v181, s58, v181
    v_mul_f32 v182, s58, v182
    v_mfma_f32_16x16x32_bf16 a[76:79], a[192:195], a[184:187], a[76:79]
    v_mul_f32 v183, s58, v183
    v_permlane16_swap_b32 v172, v174
    v_mfma_f32_16x16x32_bf16 a[76:79], a[196:199], a[188:191], a[76:79]
    v_permlane16_swap_b32 v173, v175
    v_cvt_pk_bf16_f32 v176, v176, v177
    s_waitcnt lgkmcnt(4)
    v_mfma_f32_16x16x32_bf16 a[80:83], a[200:203], a[160:163], a[80:83]
    ds_read_b64_tr_b16 a[216:217], v55 offset:256
    ds_read_b64_tr_b16 a[218:219], v55 offset:2304
    v_mfma_f32_16x16x32_bf16 a[80:83], a[204:207], a[164:167], a[80:83]
    ds_read_b64_tr_b16 a[220:221], v55 offset:16640
    ds_read_b64_tr_b16 a[222:223], v55 offset:18688
    v_mfma_f32_16x16x32_bf16 a[84:87], a[200:203], a[168:171], a[84:87]
    v_cvt_pk_bf16_f32 v177, v178, v179
    v_cvt_pk_bf16_f32 v178, v180, v181
    v_mfma_f32_16x16x32_bf16 a[84:87], a[204:207], a[172:175], a[84:87]
    v_cvt_pk_bf16_f32 v179, v182, v183
    v_mul_f32 v112, s58, v112
    v_mfma_f32_16x16x32_bf16 a[88:91], a[200:203], a[176:179], a[88:91]
    v_mul_f32 v113, s58, v113
    v_mul_f32 v114, s58, v114
    v_mul_f32 v115, s58, v115
    v_mfma_f32_16x16x32_bf16 a[88:91], a[204:207], a[180:183], a[88:91]
    v_mul_f32 v116, s58, v116
    v_mul_f32 v117, s58, v117
    v_mfma_f32_16x16x32_bf16 a[92:95], a[200:203], a[184:187], a[92:95]
    v_mul_f32 v118, s58, v118
    v_mul_f32 v119, s58, v119
    v_mfma_f32_16x16x32_bf16 a[92:95], a[204:207], a[188:191], a[92:95]
    v_permlane16_swap_b32 v176, v178
    v_permlane16_swap_b32 v177, v179
    s_waitcnt lgkmcnt(4)
    v_mfma_f32_16x16x32_bf16 a[96:99], a[208:211], a[160:163], a[96:99]
    ds_read_b64_tr_b16 a[192:193], v56 offset:33024
    ds_read_b64_tr_b16 a[194:195], v56 offset:35072
    v_mfma_f32_16x16x32_bf16 a[96:99], a[212:215], a[164:167], a[96:99]
    ds_read_b64_tr_b16 a[196:197], v56 offset:49408
    ds_read_b64_tr_b16 a[198:199], v56 offset:51456
    v_mfma_f32_16x16x32_bf16 a[100:103], a[208:211], a[168:171], a[100:103]
    v_cvt_pk_bf16_f32 v180, v112, v113
    v_cvt_pk_bf16_f32 v181, v114, v115
    v_mfma_f32_16x16x32_bf16 a[100:103], a[212:215], a[172:175], a[100:103]
    v_cvt_pk_bf16_f32 v182, v116, v117
    v_cvt_pk_bf16_f32 v183, v118, v119
    v_mfma_f32_16x16x32_bf16 a[104:107], a[208:211], a[176:179], a[104:107]
    v_mul_f32 v184, s58, v184
    v_mul_f32 v185, s58, v185
    v_mul_f32 v186, s58, v186
    v_mfma_f32_16x16x32_bf16 a[104:107], a[212:215], a[180:183], a[104:107]
    v_mul_f32 v187, s58, v187
    v_mul_f32 v188, s58, v188
    v_mfma_f32_16x16x32_bf16 a[108:111], a[208:211], a[184:187], a[108:111]
    v_mul_f32 v189, s58, v189
    v_mul_f32 v190, s58, v190
    v_mfma_f32_16x16x32_bf16 a[108:111], a[212:215], a[188:191], a[108:111]
    v_mul_f32 v191, s58, v191
    v_permlane16_swap_b32 v180, v182
    s_waitcnt lgkmcnt(4)
    s_barrier
    v_mfma_f32_16x16x32_bf16 a[112:115], a[216:219], a[160:163], a[112:115]
    ds_read_b64_tr_b16 a[200:201], v57 offset:33024
    ds_read_b64_tr_b16 a[202:203], v57 offset:35072
    v_mfma_f32_16x16x32_bf16 a[112:115], a[220:223], a[164:167], a[112:115]
    ds_read_b64_tr_b16 a[204:205], v57 offset:49408
    ds_read_b64_tr_b16 a[206:207], v57 offset:51456
    v_mfma_f32_16x16x32_bf16 a[116:119], a[216:219], a[168:171], a[116:119]
    v_permlane16_swap_b32 v181, v183
    v_cvt_pk_bf16_f32 v184, v184, v185
    v_mfma_f32_16x16x32_bf16 a[116:119], a[220:223], a[172:175], a[116:119]
    v_cvt_pk_bf16_f32 v185, v186, v187
    v_cvt_pk_bf16_f32 v186, v188, v189
    v_mfma_f32_16x16x32_bf16 a[120:123], a[216:219], a[176:179], a[120:123]
    v_cvt_pk_bf16_f32 v187, v190, v191
    v_mul_f32 v120, s58, v120
    v_mul_f32 v121, s58, v121
    v_mfma_f32_16x16x32_bf16 a[120:123], a[220:223], a[180:183], a[120:123]
    v_mul_f32 v122, s58, v122
    v_mul_f32 v123, s58, v123
    v_mfma_f32_16x16x32_bf16 a[124:127], a[216:219], a[184:187], a[124:127]
    v_mul_f32 v124, s58, v124
    v_mul_f32 v125, s58, v125
    v_mfma_f32_16x16x32_bf16 a[124:127], a[220:223], a[188:191], a[124:127]
    v_mul_f32 v126, s58, v126
    v_mul_f32 v127, s58, v127
    s_waitcnt lgkmcnt(4)
    v_mfma_f32_16x16x32_bf16 a[0:3], a[192:195], a[128:131], a[0:3]
    ds_read_b64_tr_b16 a[208:209], v58 offset:33024
    ds_read_b64_tr_b16 a[210:211], v58 offset:35072
    v_mfma_f32_16x16x32_bf16 a[0:3], a[196:199], a[132:135], a[0:3]
    ds_read_b64_tr_b16 a[212:213], v58 offset:49408
    ds_read_b64_tr_b16 a[214:215], v58 offset:51456
    v_mfma_f32_16x16x32_bf16 a[4:7], a[192:195], a[136:139], a[4:7]
    v_permlane16_swap_b32 v184, v186
    v_permlane16_swap_b32 v185, v187
    v_mfma_f32_16x16x32_bf16 a[4:7], a[196:199], a[140:143], a[4:7]
    v_cvt_pk_bf16_f32 v188, v120, v121
    v_cvt_pk_bf16_f32 v189, v122, v123
    v_mfma_f32_16x16x32_bf16 a[8:11], a[192:195], a[144:147], a[8:11]
    v_cvt_pk_bf16_f32 v190, v124, v125
    v_cvt_pk_bf16_f32 v191, v126, v127
    v_mul_f32 v192, s58, v192
    v_mfma_f32_16x16x32_bf16 a[8:11], a[196:199], a[148:151], a[8:11]
    v_mul_f32 v193, s58, v193
    v_mul_f32 v194, s58, v194
    v_mfma_f32_16x16x32_bf16 a[12:15], a[192:195], a[152:155], a[12:15]
    v_mul_f32 v195, s58, v195
    v_mul_f32 v196, s58, v196
    v_mfma_f32_16x16x32_bf16 a[12:15], a[196:199], a[156:159], a[12:15]
    v_mul_f32 v197, s58, v197
    v_mul_f32 v198, s58, v198
    s_waitcnt lgkmcnt(4)
    v_mfma_f32_16x16x32_bf16 a[16:19], a[200:203], a[128:131], a[16:19]
    ds_read_b64_tr_b16 a[216:217], v59 offset:33024
    ds_read_b64_tr_b16 a[218:219], v59 offset:35072
    v_mfma_f32_16x16x32_bf16 a[16:19], a[204:207], a[132:135], a[16:19]
    ds_read_b64_tr_b16 a[220:221], v59 offset:49408
    ds_read_b64_tr_b16 a[222:223], v59 offset:51456
    v_mfma_f32_16x16x32_bf16 a[20:23], a[200:203], a[136:139], a[20:23]
    v_mul_f32 v199, s58, v199
    v_permlane16_swap_b32 v188, v190
    v_mfma_f32_16x16x32_bf16 a[20:23], a[204:207], a[140:143], a[20:23]
    v_permlane16_swap_b32 v189, v191
    v_cvt_pk_bf16_f32 v192, v192, v193
    v_mfma_f32_16x16x32_bf16 a[24:27], a[200:203], a[144:147], a[24:27]
    v_cvt_pk_bf16_f32 v193, v194, v195
    v_cvt_pk_bf16_f32 v194, v196, v197
    v_cvt_pk_bf16_f32 v195, v198, v199
    v_mfma_f32_16x16x32_bf16 a[24:27], a[204:207], a[148:151], a[24:27]
    v_mul_f32 v128, s58, v128
    v_mul_f32 v129, s58, v129
    v_mfma_f32_16x16x32_bf16 a[28:31], a[200:203], a[152:155], a[28:31]
    v_mul_f32 v130, s58, v130
    v_mul_f32 v131, s58, v131
    v_mfma_f32_16x16x32_bf16 a[28:31], a[204:207], a[156:159], a[28:31]
    v_mul_f32 v132, s58, v132
    v_mul_f32 v133, s58, v133
    s_waitcnt lgkmcnt(4)
    v_mfma_f32_16x16x32_bf16 a[32:35], a[208:211], a[128:131], a[32:35]
    ds_read_b64_tr_b16 a[192:193], v60 offset:33024
    ds_read_b64_tr_b16 a[194:195], v60 offset:35072
    v_mfma_f32_16x16x32_bf16 a[32:35], a[212:215], a[132:135], a[32:35]
    ds_read_b64_tr_b16 a[196:197], v60 offset:49408
    ds_read_b64_tr_b16 a[198:199], v60 offset:51456
    v_mfma_f32_16x16x32_bf16 a[36:39], a[208:211], a[136:139], a[36:39]
    v_mul_f32 v134, s58, v134
    v_mul_f32 v135, s58, v135
    v_mfma_f32_16x16x32_bf16 a[36:39], a[212:215], a[140:143], a[36:39]
    v_permlane16_swap_b32 v192, v194
    v_permlane16_swap_b32 v193, v195
    v_mfma_f32_16x16x32_bf16 a[40:43], a[208:211], a[144:147], a[40:43]
    v_cvt_pk_bf16_f32 v196, v128, v129
    v_cvt_pk_bf16_f32 v197, v130, v131
    v_cvt_pk_bf16_f32 v198, v132, v133
    v_mfma_f32_16x16x32_bf16 a[40:43], a[212:215], a[148:151], a[40:43]
    v_cvt_pk_bf16_f32 v199, v134, v135
    v_mul_f32 v200, s58, v200
    v_mfma_f32_16x16x32_bf16 a[44:47], a[208:211], a[152:155], a[44:47]
    v_mul_f32 v201, s58, v201
    v_mul_f32 v202, s58, v202
    v_mfma_f32_16x16x32_bf16 a[44:47], a[212:215], a[156:159], a[44:47]
    v_mul_f32 v203, s58, v203
    v_mul_f32 v204, s58, v204
    s_waitcnt lgkmcnt(4)
    v_mfma_f32_16x16x32_bf16 a[48:51], a[216:219], a[128:131], a[48:51]
    ds_read_b64_tr_b16 a[200:201], v61 offset:33024
    ds_read_b64_tr_b16 a[202:203], v61 offset:35072
    v_mfma_f32_16x16x32_bf16 a[48:51], a[220:223], a[132:135], a[48:51]
    ds_read_b64_tr_b16 a[204:205], v61 offset:49408
    ds_read_b64_tr_b16 a[206:207], v61 offset:51456
    v_mfma_f32_16x16x32_bf16 a[52:55], a[216:219], a[136:139], a[52:55]
    v_mul_f32 v205, s58, v205
    v_mul_f32 v206, s58, v206
    v_mfma_f32_16x16x32_bf16 a[52:55], a[220:223], a[140:143], a[52:55]
    v_mul_f32 v207, s58, v207
    v_permlane16_swap_b32 v196, v198
    v_mfma_f32_16x16x32_bf16 a[56:59], a[216:219], a[144:147], a[56:59]
    v_permlane16_swap_b32 v197, v199
    v_cvt_pk_bf16_f32 v200, v200, v201
    v_cvt_pk_bf16_f32 v201, v202, v203
    v_mfma_f32_16x16x32_bf16 a[56:59], a[220:223], a[148:151], a[56:59]
    v_cvt_pk_bf16_f32 v202, v204, v205
    v_cvt_pk_bf16_f32 v203, v206, v207
    v_mfma_f32_16x16x32_bf16 a[60:63], a[216:219], a[152:155], a[60:63]
    v_mul_f32 v136, s58, v136
    v_mul_f32 v137, s58, v137
    v_mfma_f32_16x16x32_bf16 a[60:63], a[220:223], a[156:159], a[60:63]
    v_mul_f32 v138, s58, v138
    v_mul_f32 v139, s58, v139
    s_waitcnt lgkmcnt(4)
    v_mfma_f32_16x16x32_bf16 a[64:67], a[192:195], a[128:131], a[64:67]
    ds_read_b64_tr_b16 a[208:209], v62 offset:33024
    ds_read_b64_tr_b16 a[210:211], v62 offset:35072
    v_mfma_f32_16x16x32_bf16 a[64:67], a[196:199], a[132:135], a[64:67]
    ds_read_b64_tr_b16 a[212:213], v62 offset:49408
    ds_read_b64_tr_b16 a[214:215], v62 offset:51456
    v_mfma_f32_16x16x32_bf16 a[68:71], a[192:195], a[136:139], a[68:71]
    v_mul_f32 v140, s58, v140
    v_mul_f32 v141, s58, v141
    v_mfma_f32_16x16x32_bf16 a[68:71], a[196:199], a[140:143], a[68:71]
    v_mul_f32 v142, s58, v142
    v_mul_f32 v143, s58, v143
    v_mfma_f32_16x16x32_bf16 a[72:75], a[192:195], a[144:147], a[72:75]
    v_permlane16_swap_b32 v200, v202
    v_permlane16_swap_b32 v201, v203
    v_cvt_pk_bf16_f32 v204, v136, v137
    v_mfma_f32_16x16x32_bf16 a[72:75], a[196:199], a[148:151], a[72:75]
    s_mov_b32 m0, s35
    v_cvt_pk_bf16_f32 v205, v138, v139
    v_cvt_pk_bf16_f32 v206, v140, v141
    v_mfma_f32_16x16x32_bf16 a[76:79], a[192:195], a[152:155], a[76:79]
    buffer_load_dwordx4 v20, s[8:11], s44 offen offset:0 nt lds
    v_cvt_pk_bf16_f32 v207, v142, v143
    v_mul_f32 v208, s58, v208
    v_mfma_f32_16x16x32_bf16 a[76:79], a[196:199], a[156:159], a[76:79]
    v_mul_f32 v209, s58, v209
    v_mul_f32 v210, s58, v210
    s_waitcnt lgkmcnt(4)
    v_mfma_f32_16x16x32_bf16 a[80:83], a[200:203], a[128:131], a[80:83]
    ds_read_b64_tr_b16 a[216:217], v63 offset:33024
    ds_read_b64_tr_b16 a[218:219], v63 offset:35072
    v_mfma_f32_16x16x32_bf16 a[80:83], a[204:207], a[132:135], a[80:83]
    ds_read_b64_tr_b16 a[220:221], v63 offset:49408
    ds_read_b64_tr_b16 a[222:223], v63 offset:51456
    v_mfma_f32_16x16x32_bf16 a[84:87], a[200:203], a[136:139], a[84:87]
    v_mul_f32 v211, s58, v211
    v_mul_f32 v212, s58, v212
    v_mfma_f32_16x16x32_bf16 a[84:87], a[204:207], a[140:143], a[84:87]
    v_mul_f32 v213, s58, v213
    v_mul_f32 v214, s58, v214
    v_mfma_f32_16x16x32_bf16 a[88:91], a[200:203], a[144:147], a[88:91]
    buffer_load_dwordx4 v21, s[8:11], s44 offen offset:1024 nt lds
    v_mul_f32 v215, s58, v215
    v_permlane16_swap_b32 v204, v206
    v_permlane16_swap_b32 v205, v207
    v_mfma_f32_16x16x32_bf16 a[88:91], a[204:207], a[148:151], a[88:91]
    v_cvt_pk_bf16_f32 v208, v208, v209
    v_cvt_pk_bf16_f32 v209, v210, v211
    v_mfma_f32_16x16x32_bf16 a[92:95], a[200:203], a[152:155], a[92:95]
    v_cvt_pk_bf16_f32 v210, v212, v213
    v_cvt_pk_bf16_f32 v211, v214, v215
    v_mfma_f32_16x16x32_bf16 a[92:95], a[204:207], a[156:159], a[92:95]
    v_mul_f32 v144, s58, v144
    v_mul_f32 v145, s58, v145
    s_waitcnt lgkmcnt(4)
    v_mfma_f32_16x16x32_bf16 a[96:99], a[208:211], a[128:131], a[96:99]
    v_mul_f32 v146, s58, v146
    v_mul_f32 v147, s58, v147
    v_mul_f32 v148, s58, v148
    v_mfma_f32_16x16x32_bf16 a[96:99], a[212:215], a[132:135], a[96:99]
    v_mul_f32 v149, s58, v149
    v_mul_f32 v150, s58, v150
    v_mfma_f32_16x16x32_bf16 a[100:103], a[208:211], a[136:139], a[100:103]
    buffer_load_dwordx4 v22, s[8:11], s44 offen offset:2048 nt lds
    v_mul_f32 v151, s58, v151
    v_permlane16_swap_b32 v208, v210
    v_mfma_f32_16x16x32_bf16 a[100:103], a[212:215], a[140:143], a[100:103]
    v_permlane16_swap_b32 v209, v211
    v_cvt_pk_bf16_f32 v212, v144, v145
    v_mfma_f32_16x16x32_bf16 a[104:107], a[208:211], a[144:147], a[104:107]
    v_cvt_pk_bf16_f32 v213, v146, v147
    v_cvt_pk_bf16_f32 v214, v148, v149
    v_cvt_pk_bf16_f32 v215, v150, v151
    v_mfma_f32_16x16x32_bf16 a[104:107], a[212:215], a[148:151], a[104:107]
    v_mul_f32 v216, s58, v216
    v_mul_f32 v217, s58, v217
    v_mfma_f32_16x16x32_bf16 a[108:111], a[208:211], a[152:155], a[108:111]
    v_mul_f32 v218, s58, v218
    v_mul_f32 v219, s58, v219
    v_mfma_f32_16x16x32_bf16 a[108:111], a[212:215], a[156:159], a[108:111]
    v_mul_f32 v220, s58, v220
    v_mul_f32 v221, s58, v221
    s_waitcnt lgkmcnt(0)
    v_mfma_f32_16x16x32_bf16 a[112:115], a[216:219], a[128:131], a[112:115]
    buffer_load_dwordx4 v23, s[8:11], s44 offen offset:3072 nt lds
    v_mul_f32 v222, s58, v222
    v_mul_f32 v223, s58, v223
    v_permlane16_swap_b32 v212, v214
    v_mfma_f32_16x16x32_bf16 a[112:115], a[220:223], a[132:135], a[112:115]
    s_add_u32 s44, s44, 16384
    v_permlane16_swap_b32 v213, v215
    v_cvt_pk_bf16_f32 v216, v216, v217
    v_mfma_f32_16x16x32_bf16 a[116:119], a[216:219], a[136:139], a[116:119]
    v_cvt_pk_bf16_f32 v217, v218, v219
    v_cvt_pk_bf16_f32 v218, v220, v221
    v_mfma_f32_16x16x32_bf16 a[116:119], a[220:223], a[140:143], a[116:119]
    v_cvt_pk_bf16_f32 v219, v222, v223
    v_mul_f32 v152, s58, v152
    v_mfma_f32_16x16x32_bf16 a[120:123], a[216:219], a[144:147], a[120:123]
    v_mul_f32 v153, s58, v153
    v_mul_f32 v154, s58, v154
    v_mul_f32 v155, s58, v155
    v_mfma_f32_16x16x32_bf16 a[120:123], a[220:223], a[148:151], a[120:123]
    v_mul_f32 v156, s58, v156
    v_mul_f32 v157, s58, v157
    v_mfma_f32_16x16x32_bf16 a[124:127], a[216:219], a[152:155], a[124:127]
    v_mul_f32 v158, s58, v158
    v_mul_f32 v159, s58, v159
    v_mfma_f32_16x16x32_bf16 a[124:127], a[220:223], a[156:159], a[124:127]
    v_permlane16_swap_b32 v216, v218
    v_permlane16_swap_b32 v217, v219
    v_cvt_pk_bf16_f32 v220, v152, v153
    v_cvt_pk_bf16_f32 v221, v154, v155
    v_cvt_pk_bf16_f32 v222, v156, v157
    v_cvt_pk_bf16_f32 v223, v158, v159
    s_cmp_eq_u32 s43, 0
    s_cselect_b32 s3, 0, 2147483648
    v_bfrev_b32 v30, 1
    v_writelane_b32 v30, s3, 0
    v_mov_b32 v3, s89
    buffer_atomic_add v3, v30, s[72:75], 0 offen sc1
    v_permlane16_swap_b32 v220, v222
    v_permlane16_swap_b32 v221, v223
    v_accvgpr_read_b32 v64, a0
    v_accvgpr_read_b32 v65, a1
    v_accvgpr_read_b32 v66, a2
    v_accvgpr_read_b32 v67, a3
    v_accvgpr_read_b32 v68, a16
    v_accvgpr_read_b32 v69, a17
    v_accvgpr_read_b32 v70, a18
    v_accvgpr_read_b32 v71, a19
    v_pk_mul_f32 v[64:65], v[64:65], s[58:59]
    v_pk_mul_f32 v[66:67], v[66:67], s[58:59]
    v_pk_mul_f32 v[68:69], v[68:69], s[58:59]
    v_pk_mul_f32 v[70:71], v[70:71], s[58:59]
    v_accvgpr_read_b32 v72, a4
    v_accvgpr_read_b32 v73, a5
    v_cvt_pk_bf16_f32 v240, v64, v65
    v_cvt_pk_bf16_f32 v242, v68, v69
    v_cvt_pk_bf16_f32 v241, v66, v67
    v_cvt_pk_bf16_f32 v243, v70, v71
    v_accvgpr_read_b32 v74, a6
    v_accvgpr_read_b32 v75, a7
    v_accvgpr_read_b32 v76, a20
    v_accvgpr_read_b32 v77, a21
    v_permlane16_swap_b32 v240, v242
    v_permlane16_swap_b32 v241, v243
    v_accvgpr_read_b32 v78, a22
    v_accvgpr_read_b32 v79, a23
    v_pk_mul_f32 v[72:73], v[72:73], s[58:59]
    v_pk_mul_f32 v[74:75], v[74:75], s[58:59]
    v_pk_mul_f32 v[76:77], v[76:77], s[58:59]
    v_pk_mul_f32 v[78:79], v[78:79], s[58:59]
    v_accvgpr_read_b32 v64, a8
    v_accvgpr_read_b32 v65, a9
    v_cvt_pk_bf16_f32 v28, v72, v73
    v_cvt_pk_bf16_f32 v30, v76, v77
    v_cvt_pk_bf16_f32 v29, v74, v75
    v_cvt_pk_bf16_f32 v31, v78, v79
    v_accvgpr_read_b32 v66, a10
    v_accvgpr_read_b32 v67, a11
    v_accvgpr_read_b32 v68, a24
    v_accvgpr_read_b32 v69, a25
    v_permlane16_swap_b32 v28, v30
    v_permlane16_swap_b32 v29, v31
    v_accvgpr_read_b32 v70, a26
    v_accvgpr_read_b32 v71, a27
    v_pk_mul_f32 v[64:65], v[64:65], s[58:59]
    v_pk_mul_f32 v[66:67], v[66:67], s[58:59]
    v_pk_mul_f32 v[68:69], v[68:69], s[58:59]
    v_pk_mul_f32 v[70:71], v[70:71], s[58:59]
    v_accvgpr_read_b32 v72, a12
    v_accvgpr_read_b32 v73, a13
    v_cvt_pk_bf16_f32 v80, v64, v65
    v_cvt_pk_bf16_f32 v82, v68, v69
    v_cvt_pk_bf16_f32 v81, v66, v67
    v_cvt_pk_bf16_f32 v83, v70, v71
    v_accvgpr_read_b32 v74, a14
    v_accvgpr_read_b32 v75, a15
    v_accvgpr_read_b32 v76, a28
    v_accvgpr_read_b32 v77, a29
    v_permlane16_swap_b32 v80, v82
    v_permlane16_swap_b32 v81, v83
    v_accvgpr_read_b32 v78, a30
    v_accvgpr_read_b32 v79, a31
    v_pk_mul_f32 v[72:73], v[72:73], s[58:59]
    v_pk_mul_f32 v[74:75], v[74:75], s[58:59]
    v_pk_mul_f32 v[76:77], v[76:77], s[58:59]
    v_pk_mul_f32 v[78:79], v[78:79], s[58:59]
    v_accvgpr_write_b32 a224, v80
    v_accvgpr_write_b32 a225, v81
    v_accvgpr_write_b32 a226, v82
    v_accvgpr_write_b32 a227, v83
    v_accvgpr_read_b32 v64, a32
    v_accvgpr_read_b32 v65, a33
    v_cvt_pk_bf16_f32 v84, v72, v73
    v_cvt_pk_bf16_f32 v86, v76, v77
    v_cvt_pk_bf16_f32 v85, v74, v75
    v_cvt_pk_bf16_f32 v87, v78, v79
    v_accvgpr_read_b32 v66, a34
    v_accvgpr_read_b32 v67, a35
    v_accvgpr_read_b32 v68, a48
    v_accvgpr_read_b32 v69, a49
    v_permlane16_swap_b32 v84, v86
    v_permlane16_swap_b32 v85, v87
    v_accvgpr_read_b32 v70, a50
    v_accvgpr_read_b32 v71, a51
    v_pk_mul_f32 v[64:65], v[64:65], s[58:59]
    v_pk_mul_f32 v[66:67], v[66:67], s[58:59]
    v_pk_mul_f32 v[68:69], v[68:69], s[58:59]
    v_pk_mul_f32 v[70:71], v[70:71], s[58:59]
    v_accvgpr_write_b32 a240, v84
    v_accvgpr_write_b32 a241, v85
    v_accvgpr_write_b32 a242, v86
    v_accvgpr_write_b32 a243, v87
    v_accvgpr_read_b32 v72, a36
    v_accvgpr_read_b32 v73, a37
    v_cvt_pk_bf16_f32 v244, v64, v65
    v_cvt_pk_bf16_f32 v246, v68, v69
    v_cvt_pk_bf16_f32 v245, v66, v67
    v_cvt_pk_bf16_f32 v247, v70, v71
    v_accvgpr_read_b32 v74, a38
    v_accvgpr_read_b32 v75, a39
    v_accvgpr_read_b32 v76, a52
    v_accvgpr_read_b32 v77, a53
    v_permlane16_swap_b32 v244, v246
    v_permlane16_swap_b32 v245, v247
    v_accvgpr_read_b32 v78, a54
    v_accvgpr_read_b32 v79, a55
    v_pk_mul_f32 v[72:73], v[72:73], s[58:59]
    v_pk_mul_f32 v[74:75], v[74:75], s[58:59]
    v_pk_mul_f32 v[76:77], v[76:77], s[58:59]
    v_pk_mul_f32 v[78:79], v[78:79], s[58:59]
    v_accvgpr_read_b32 v64, a40
    v_accvgpr_read_b32 v65, a41
    v_cvt_pk_bf16_f32 v84, v72, v73
    v_cvt_pk_bf16_f32 v86, v76, v77
    v_cvt_pk_bf16_f32 v85, v74, v75
    v_cvt_pk_bf16_f32 v87, v78, v79
    v_accvgpr_read_b32 v66, a42
    v_accvgpr_read_b32 v67, a43
    v_accvgpr_read_b32 v68, a56
    v_accvgpr_read_b32 v69, a57
    v_permlane16_swap_b32 v84, v86
    v_permlane16_swap_b32 v85, v87
    v_accvgpr_read_b32 v70, a58
    v_accvgpr_read_b32 v71, a59
    v_pk_mul_f32 v[64:65], v[64:65], s[58:59]
    v_pk_mul_f32 v[66:67], v[66:67], s[58:59]
    v_pk_mul_f32 v[68:69], v[68:69], s[58:59]
    v_pk_mul_f32 v[70:71], v[70:71], s[58:59]
    v_accvgpr_write_b32 a212, v84
    v_accvgpr_write_b32 a213, v85
    v_accvgpr_write_b32 a214, v86
    v_accvgpr_write_b32 a215, v87
    v_accvgpr_read_b32 v72, a44
    v_accvgpr_read_b32 v73, a45
    v_cvt_pk_bf16_f32 v80, v64, v65
    v_cvt_pk_bf16_f32 v82, v68, v69
    v_cvt_pk_bf16_f32 v81, v66, v67
    v_cvt_pk_bf16_f32 v83, v70, v71
    v_accvgpr_read_b32 v74, a46
    v_accvgpr_read_b32 v75, a47
    v_accvgpr_read_b32 v76, a60
    v_accvgpr_read_b32 v77, a61
    v_permlane16_swap_b32 v80, v82
    v_permlane16_swap_b32 v81, v83
    v_accvgpr_read_b32 v78, a62
    v_accvgpr_read_b32 v79, a63
    v_pk_mul_f32 v[72:73], v[72:73], s[58:59]
    v_pk_mul_f32 v[74:75], v[74:75], s[58:59]
    v_pk_mul_f32 v[76:77], v[76:77], s[58:59]
    v_pk_mul_f32 v[78:79], v[78:79], s[58:59]
    v_accvgpr_write_b32 a228, v80
    v_accvgpr_write_b32 a229, v81
    v_accvgpr_write_b32 a230, v82
    v_accvgpr_write_b32 a231, v83
    v_accvgpr_read_b32 v64, a64
    v_accvgpr_read_b32 v65, a65
    v_cvt_pk_bf16_f32 v84, v72, v73
    v_cvt_pk_bf16_f32 v86, v76, v77
    v_cvt_pk_bf16_f32 v85, v74, v75
    v_cvt_pk_bf16_f32 v87, v78, v79
    v_accvgpr_read_b32 v66, a66
    v_accvgpr_read_b32 v67, a67
    v_accvgpr_read_b32 v68, a80
    v_accvgpr_read_b32 v69, a81
    v_permlane16_swap_b32 v84, v86
    v_permlane16_swap_b32 v85, v87
    v_accvgpr_read_b32 v70, a82
    v_accvgpr_read_b32 v71, a83
    v_pk_mul_f32 v[64:65], v[64:65], s[58:59]
    v_pk_mul_f32 v[66:67], v[66:67], s[58:59]
    v_pk_mul_f32 v[68:69], v[68:69], s[58:59]
    v_pk_mul_f32 v[70:71], v[70:71], s[58:59]
    v_accvgpr_write_b32 a244, v84
    v_accvgpr_write_b32 a245, v85
    v_accvgpr_write_b32 a246, v86
    v_accvgpr_write_b32 a247, v87
    v_accvgpr_read_b32 v72, a68
    v_accvgpr_read_b32 v73, a69
    v_cvt_pk_bf16_f32 v248, v64, v65
    v_cvt_pk_bf16_f32 v250, v68, v69
    v_cvt_pk_bf16_f32 v249, v66, v67
    v_cvt_pk_bf16_f32 v251, v70, v71
    v_accvgpr_read_b32 v74, a70
    v_accvgpr_read_b32 v75, a71
    v_accvgpr_read_b32 v76, a84
    v_accvgpr_read_b32 v77, a85
    v_permlane16_swap_b32 v248, v250
    v_permlane16_swap_b32 v249, v251
    v_accvgpr_read_b32 v78, a86
    v_accvgpr_read_b32 v79, a87
    s_mov_b32 m0, s38
    s_nop 0
    buffer_load_dwordx4 v24, s[12:15], s45 offen offset:0 nt lds
    v_pk_mul_f32 v[72:73], v[72:73], s[58:59]
    v_pk_mul_f32 v[74:75], v[74:75], s[58:59]
    v_pk_mul_f32 v[76:77], v[76:77], s[58:59]
    v_pk_mul_f32 v[78:79], v[78:79], s[58:59]
    v_accvgpr_read_b32 v64, a72
    v_accvgpr_read_b32 v65, a73
    v_cvt_pk_bf16_f32 v84, v72, v73
    v_cvt_pk_bf16_f32 v86, v76, v77
    v_cvt_pk_bf16_f32 v85, v74, v75
    v_cvt_pk_bf16_f32 v87, v78, v79
    v_accvgpr_read_b32 v66, a74
    v_accvgpr_read_b32 v67, a75
    v_accvgpr_read_b32 v68, a88
    v_accvgpr_read_b32 v69, a89
    v_permlane16_swap_b32 v84, v86
    v_permlane16_swap_b32 v85, v87
    v_accvgpr_read_b32 v70, a90
    v_accvgpr_read_b32 v71, a91
    v_pk_mul_f32 v[64:65], v[64:65], s[58:59]
    v_pk_mul_f32 v[66:67], v[66:67], s[58:59]
    v_pk_mul_f32 v[68:69], v[68:69], s[58:59]
    v_pk_mul_f32 v[70:71], v[70:71], s[58:59]
    v_accvgpr_write_b32 a216, v84
    v_accvgpr_write_b32 a217, v85
    v_accvgpr_write_b32 a218, v86
    v_accvgpr_write_b32 a219, v87
    v_accvgpr_read_b32 v72, a76
    v_accvgpr_read_b32 v73, a77
    v_cvt_pk_bf16_f32 v80, v64, v65
    v_cvt_pk_bf16_f32 v82, v68, v69
    v_cvt_pk_bf16_f32 v81, v66, v67
    v_cvt_pk_bf16_f32 v83, v70, v71
    v_accvgpr_read_b32 v74, a78
    v_accvgpr_read_b32 v75, a79
    v_accvgpr_read_b32 v76, a92
    v_accvgpr_read_b32 v77, a93
    v_permlane16_swap_b32 v80, v82
    v_permlane16_swap_b32 v81, v83
    v_accvgpr_read_b32 v78, a94
    v_accvgpr_read_b32 v79, a95
    buffer_load_dwordx4 v25, s[12:15], s45 offen offset:1024 nt lds
    v_pk_mul_f32 v[72:73], v[72:73], s[58:59]
    v_pk_mul_f32 v[74:75], v[74:75], s[58:59]
    v_pk_mul_f32 v[76:77], v[76:77], s[58:59]
    v_pk_mul_f32 v[78:79], v[78:79], s[58:59]
    v_accvgpr_write_b32 a232, v80
    v_accvgpr_write_b32 a233, v81
    v_accvgpr_write_b32 a234, v82
    v_accvgpr_write_b32 a235, v83
    v_accvgpr_read_b32 v64, a96
    v_accvgpr_read_b32 v65, a97
    v_cvt_pk_bf16_f32 v84, v72, v73
    v_cvt_pk_bf16_f32 v86, v76, v77
    v_cvt_pk_bf16_f32 v85, v74, v75
    v_cvt_pk_bf16_f32 v87, v78, v79
    v_accvgpr_read_b32 v66, a98
    v_accvgpr_read_b32 v67, a99
    v_accvgpr_read_b32 v68, a112
    v_accvgpr_read_b32 v69, a113
    v_permlane16_swap_b32 v84, v86
    v_permlane16_swap_b32 v85, v87
    v_accvgpr_read_b32 v70, a114
    v_accvgpr_read_b32 v71, a115
    v_pk_mul_f32 v[64:65], v[64:65], s[58:59]
    v_pk_mul_f32 v[66:67], v[66:67], s[58:59]
    v_pk_mul_f32 v[68:69], v[68:69], s[58:59]
    v_pk_mul_f32 v[70:71], v[70:71], s[58:59]
    v_accvgpr_write_b32 a248, v84
    v_accvgpr_write_b32 a249, v85
    v_accvgpr_write_b32 a250, v86
    v_accvgpr_write_b32 a251, v87
    v_accvgpr_read_b32 v72, a100
    v_accvgpr_read_b32 v73, a101
    v_cvt_pk_bf16_f32 v252, v64, v65
    v_cvt_pk_bf16_f32 v254, v68, v69
    v_cvt_pk_bf16_f32 v253, v66, v67
    v_cvt_pk_bf16_f32 v255, v70, v71
    v_accvgpr_read_b32 v74, a102
    v_accvgpr_read_b32 v75, a103
    v_accvgpr_read_b32 v76, a116
    v_accvgpr_read_b32 v77, a117
    v_permlane16_swap_b32 v252, v254
    v_permlane16_swap_b32 v253, v255
    v_accvgpr_read_b32 v78, a118
    v_accvgpr_read_b32 v79, a119
    buffer_load_dwordx4 v24, s[12:15], s45 offen offset:2048 nt lds
    v_pk_mul_f32 v[72:73], v[72:73], s[58:59]
    v_pk_mul_f32 v[74:75], v[74:75], s[58:59]
    v_pk_mul_f32 v[76:77], v[76:77], s[58:59]
    v_pk_mul_f32 v[78:79], v[78:79], s[58:59]
    v_accvgpr_read_b32 v64, a104
    v_accvgpr_read_b32 v65, a105
    v_cvt_pk_bf16_f32 v84, v72, v73
    v_cvt_pk_bf16_f32 v86, v76, v77
    v_cvt_pk_bf16_f32 v85, v74, v75
    v_cvt_pk_bf16_f32 v87, v78, v79
    v_accvgpr_read_b32 v66, a106
    v_accvgpr_read_b32 v67, a107
    v_accvgpr_read_b32 v68, a120
    v_accvgpr_read_b32 v69, a121
    v_permlane16_swap_b32 v84, v86
    v_permlane16_swap_b32 v85, v87
    v_accvgpr_read_b32 v70, a122
    v_accvgpr_read_b32 v71, a123
    v_pk_mul_f32 v[64:65], v[64:65], s[58:59]
    v_pk_mul_f32 v[66:67], v[66:67], s[58:59]
    v_pk_mul_f32 v[68:69], v[68:69], s[58:59]
    v_pk_mul_f32 v[70:71], v[70:71], s[58:59]
    v_accvgpr_write_b32 a220, v84
    v_accvgpr_write_b32 a221, v85
    v_accvgpr_write_b32 a222, v86
    v_accvgpr_write_b32 a223, v87
    v_accvgpr_read_b32 v72, a108
    v_accvgpr_read_b32 v73, a109
    v_cvt_pk_bf16_f32 v80, v64, v65
    v_cvt_pk_bf16_f32 v82, v68, v69
    v_cvt_pk_bf16_f32 v81, v66, v67
    v_cvt_pk_bf16_f32 v83, v70, v71
    v_accvgpr_read_b32 v74, a110
    v_accvgpr_read_b32 v75, a111
    v_accvgpr_read_b32 v76, a124
    v_accvgpr_read_b32 v77, a125
    v_permlane16_swap_b32 v80, v82
    v_permlane16_swap_b32 v81, v83
    v_accvgpr_read_b32 v78, a126
    v_accvgpr_read_b32 v79, a127
    buffer_load_dwordx4 v25, s[12:15], s45 offen offset:3072 nt lds
    s_add_u32 s45, s45, 16384
    v_pk_mul_f32 v[72:73], v[72:73], s[58:59]
    v_pk_mul_f32 v[74:75], v[74:75], s[58:59]
    v_pk_mul_f32 v[76:77], v[76:77], s[58:59]
    v_pk_mul_f32 v[78:79], v[78:79], s[58:59]
    v_accvgpr_write_b32 a236, v80
    v_accvgpr_write_b32 a237, v81
    v_accvgpr_write_b32 a238, v82
    v_accvgpr_write_b32 a239, v83
    v_cvt_pk_bf16_f32 v84, v72, v73
    v_cvt_pk_bf16_f32 v86, v76, v77
    v_cvt_pk_bf16_f32 v85, v74, v75
    v_cvt_pk_bf16_f32 v87, v78, v79
    s_nop 1
    v_permlane16_swap_b32 v84, v86
    v_permlane16_swap_b32 v85, v87
    s_nop 1
    v_accvgpr_write_b32 a252, v84
    v_accvgpr_write_b32 a253, v85
    v_accvgpr_write_b32 a254, v86
    v_accvgpr_write_b32 a255, v87
    s_lshl_b32 s3, s43, 14
    v_lshl_add_u32 v26, v0, 4, s3
    v_mov_b32 v4, 0x3f803f80
    v_accvgpr_write_b32 a208, v4
    v_accvgpr_write_b32 a209, v4
    v_accvgpr_write_b32 a210, v4
    v_accvgpr_write_b32 a211, v4
L_att:
    s_mov_b32 s49, 0
    s_mov_b32 s93, 99
L_block:
    v_mov_b32 v224, 0xff800000
    v_mov_b32 v228, 0xff800000
    v_mov_b32 v232, 0xff800000
    v_mov_b32 v236, 0xff800000
    s_cmp_eq_u32 s51, 0
    s_cbranch_scc1 L_nomp
    v_and_b32 v1, 15, v0
    v_lshlrev_b32 v1, 4, v1
    v_xor_b32 v5, v8, v1
    s_lshl_b32 s56, s49, 18
    s_mov_b32 s58, 0
L_mp:
    s_add_u32 s57, s56, 4096
    buffer_load_dwordx4 a[128:131], v5, s[8:11], s56 offen offset:0
    buffer_load_dwordx4 a[132:135], v5, s[8:11], s56 offen offset:64
    buffer_load_dwordx4 a[136:139], v5, s[8:11], s56 offen offset:128
    buffer_load_dwordx4 a[140:143], v5, s[8:11], s56 offen offset:192
    buffer_load_dwordx4 a[144:147], v5, s[8:11], s57 offen offset:0
    buffer_load_dwordx4 a[148:151], v5, s[8:11], s57 offen offset:64
    buffer_load_dwordx4 a[152:155], v5, s[8:11], s57 offen offset:128
    buffer_load_dwordx4 a[156:159], v5, s[8:11], s57 offen offset:192
    s_waitcnt vmcnt(0)
    v_mfma_f32_16x16x32_bf16 v[32:35], a[128:131], v[160:163], 0
    v_mfma_f32_16x16x32_bf16 v[32:35], a[132:135], v[164:167], v[32:35]
    v_mfma_f32_16x16x32_bf16 v[32:35], a[136:139], v[168:171], v[32:35]
    v_mfma_f32_16x16x32_bf16 v[32:35], a[140:143], v[172:175], v[32:35]
    v_mfma_f32_16x16x32_bf16 v[36:39], a[144:147], v[160:163], 0
    v_mfma_f32_16x16x32_bf16 v[36:39], a[148:151], v[164:167], v[36:39]
    v_mfma_f32_16x16x32_bf16 v[36:39], a[152:155], v[168:171], v[36:39]
    v_mfma_f32_16x16x32_bf16 v[36:39], a[156:159], v[172:175], v[36:39]
    v_mfma_f32_16x16x32_bf16 v[40:43], a[128:131], v[176:179], 0
    v_mfma_f32_16x16x32_bf16 v[40:43], a[132:135], v[180:183], v[40:43]
    v_mfma_f32_16x16x32_bf16 v[40:43], a[136:139], v[184:187], v[40:43]
    v_mfma_f32_16x16x32_bf16 v[40:43], a[140:143], v[188:191], v[40:43]
    v_mfma_f32_16x16x32_bf16 v[44:47], a[144:147], v[176:179], 0
    v_mfma_f32_16x16x32_bf16 v[44:47], a[148:151], v[180:183], v[44:47]
    v_mfma_f32_16x16x32_bf16 v[44:47], a[152:155], v[184:187], v[44:47]
    v_mfma_f32_16x16x32_bf16 v[44:47], a[156:159], v[188:191], v[44:47]
    v_mfma_f32_16x16x32_bf16 v[48:51], a[128:131], v[192:195], 0
    v_mfma_f32_16x16x32_bf16 v[48:51], a[132:135], v[196:199], v[48:51]
    v_mfma_f32_16x16x32_bf16 v[48:51], a[136:139], v[200:203], v[48:51]
    v_mfma_f32_16x16x32_bf16 v[48:51], a[140:143], v[204:207], v[48:51]
    v_mfma_f32_16x16x32_bf16 v[52:55], a[144:147], v[192:195], 0
    v_mfma_f32_16x16x32_bf16 v[52:55], a[148:151], v[196:199], v[52:55]
    v_mfma_f32_16x16x32_bf16 v[52:55], a[152:155], v[200:203], v[52:55]
    v_mfma_f32_16x16x32_bf16 v[52:55], a[156:159], v[204:207], v[52:55]
    v_mfma_f32_16x16x32_bf16 v[56:59], a[128:131], v[208:211], 0
    v_mfma_f32_16x16x32_bf16 v[56:59], a[132:135], v[212:215], v[56:59]
    v_mfma_f32_16x16x32_bf16 v[56:59], a[136:139], v[216:219], v[56:59]
    v_mfma_f32_16x16x32_bf16 v[56:59], a[140:143], v[220:223], v[56:59]
    v_mfma_f32_16x16x32_bf16 v[60:63], a[144:147], v[208:211], 0
    v_mfma_f32_16x16x32_bf16 v[60:63], a[148:151], v[212:215], v[60:63]
    v_mfma_f32_16x16x32_bf16 v[60:63], a[152:155], v[216:219], v[60:63]
    v_mfma_f32_16x16x32_bf16 v[60:63], a[156:159], v[220:223], v[60:63]
    s_nop 7
    v_max3_f32 v224, v224, v32, v33
    v_max3_f32 v224, v224, v34, v35
    v_max3_f32 v224, v224, v36, v37
    v_max3_f32 v224, v224, v38, v39
    v_max3_f32 v228, v228, v40, v41
    v_max3_f32 v228, v228, v42, v43
    v_max3_f32 v228, v228, v44, v45
    v_max3_f32 v228, v228, v46, v47
    v_max3_f32 v232, v232, v48, v49
    v_max3_f32 v232, v232, v50, v51
    v_max3_f32 v232, v232, v52, v53
    v_max3_f32 v232, v232, v54, v55
    v_max3_f32 v236, v236, v56, v57
    v_max3_f32 v236, v236, v58, v59
    v_max3_f32 v236, v236, v60, v61
    v_max3_f32 v236, v236, v62, v63
    s_add_u32 s56, s56, 8192
    s_add_u32 s58, s58, 1
    s_cmp_lt_u32 s58, 32
    s_cbranch_scc1 L_mp
L_nomp:
    s_waitcnt vmcnt(24) lgkmcnt(0)
    s_barrier
    ds_read_b128 a[128:131], v8 offset:0
    ds_read_b128 a[132:135], v9 offset:0
    ds_read_b128 a[136:139], v10 offset:0
    ds_read_b128 a[140:143], v11 offset:0
    ds_read_b128 a[144:147], v8 offset:4096
    ds_read_b128 a[148:151], v9 offset:4096
    ds_read_b128 a[152:155], v10 offset:4096
    ds_read_b128 a[156:159], v11 offset:4096
    s_mov_b32 s3, 0x7149f2ca
    s_cmp_eq_u32 s88, 0
    s_cselect_b32 s56, s3, 0xff800000
    s_cmp_eq_u32 s88, 1
    s_cselect_b32 s57, s3, 0xff800000
    s_cmp_eq_u32 s88, 2
    s_cselect_b32 s58, s3, 0xff800000
    s_cmp_eq_u32 s88, 3
    s_cselect_b32 s59, s3, 0xff800000
    s_waitcnt lgkmcnt(0)
    v_mfma_f32_16x16x32_bf16 v[32:35], a[128:131], v[160:163], 0
    v_mfma_f32_16x16x32_bf16 v[32:35], a[132:135], v[164:167], v[32:35]
    v_mfma_f32_16x16x32_bf16 v[32:35], a[136:139], v[168:171], v[32:35]
    v_mfma_f32_16x16x32_bf16 v[32:35], a[140:143], v[172:175], v[32:35]
    v_mfma_f32_16x16x32_bf16 v[36:39], a[144:147], v[160:163], 0
    v_mfma_f32_16x16x32_bf16 v[36:39], a[148:151], v[164:167], v[36:39]
    v_mfma_f32_16x16x32_bf16 v[36:39], a[152:155], v[168:171], v[36:39]
    v_mfma_f32_16x16x32_bf16 v[36:39], a[156:159], v[172:175], v[36:39]
    v_mfma_f32_16x16x32_bf16 v[40:43], a[128:131], v[176:179], 0
    v_mfma_f32_16x16x32_bf16 v[40:43], a[132:135], v[180:183], v[40:43]
    v_mfma_f32_16x16x32_bf16 v[40:43], a[136:139], v[184:187], v[40:43]
    v_mfma_f32_16x16x32_bf16 v[40:43], a[140:143], v[188:191], v[40:43]
    v_mfma_f32_16x16x32_bf16 v[44:47], a[144:147], v[176:179], 0
    v_mfma_f32_16x16x32_bf16 v[44:47], a[148:151], v[180:183], v[44:47]
    v_mfma_f32_16x16x32_bf16 v[44:47], a[152:155], v[184:187], v[44:47]
    v_mfma_f32_16x16x32_bf16 v[44:47], a[156:159], v[188:191], v[44:47]
    v_mfma_f32_16x16x32_bf16 v[48:51], a[128:131], v[192:195], 0
    v_mfma_f32_16x16x32_bf16 v[48:51], a[132:135], v[196:199], v[48:51]
    v_max3_f32 v1, v32, v33, v34
    v_mfma_f32_16x16x32_bf16 v[48:51], a[136:139], v[200:203], v[48:51]
    v_mfma_f32_16x16x32_bf16 v[48:51], a[140:143], v[204:207], v[48:51]
    v_max3_f32 v1, v1, v35, v36
    v_mfma_f32_16x16x32_bf16 v[52:55], a[144:147], v[192:195], 0
    v_mfma_f32_16x16x32_bf16 v[52:55], a[148:151], v[196:199], v[52:55]
    v_max3_f32 v1, v1, v37, v38
    v_mfma_f32_16x16x32_bf16 v[52:55], a[152:155], v[200:203], v[52:55]
    v_mfma_f32_16x16x32_bf16 v[52:55], a[156:159], v[204:207], v[52:55]
    v_max3_f32 v1, v1, v39, v224
    v_mfma_f32_16x16x32_bf16 v[56:59], a[128:131], v[208:211], 0
    v_mfma_f32_16x16x32_bf16 v[56:59], a[132:135], v[212:215], v[56:59]
    v_max3_f32 v2, v40, v41, v42
    v_mfma_f32_16x16x32_bf16 v[56:59], a[136:139], v[216:219], v[56:59]
    v_mfma_f32_16x16x32_bf16 v[56:59], a[140:143], v[220:223], v[56:59]
    v_max3_f32 v2, v2, v43, v44
    v_mfma_f32_16x16x32_bf16 v[60:63], a[144:147], v[208:211], 0
    v_mfma_f32_16x16x32_bf16 v[60:63], a[148:151], v[212:215], v[60:63]
    v_max3_f32 v2, v2, v45, v46
    v_mfma_f32_16x16x32_bf16 v[60:63], a[152:155], v[216:219], v[60:63]
    v_mfma_f32_16x16x32_bf16 v[60:63], a[156:159], v[220:223], v[60:63]
    v_max3_f32 v2, v2, v47, v228
    v_max3_f32 v3, v48, v49, v50
    v_max3_f32 v3, v3, v51, v52
    v_max3_f32 v3, v3, v53, v54
    v_max3_f32 v3, v3, v55, v232
    s_nop 3
    v_max3_f32 v4, v56, v57, v58
    v_max3_f32 v4, v4, v59, v60
    v_max3_f32 v4, v4, v61, v62
    v_max3_f32 v4, v4, v63, v236
    v_mov_b32 v224, v1
    v_mov_b32 v228, v2
    v_mov_b32 v232, v3
    v_mov_b32 v236, v4
    s_nop 0
    v_permlane16_swap_b32 v1, v224
    v_permlane16_swap_b32 v2, v228
    v_permlane16_swap_b32 v3, v232
    v_permlane16_swap_b32 v4, v236
    s_nop 0
    v_max_f32 v1, v1, v224
    v_max_f32 v2, v2, v228
    v_max_f32 v3, v3, v232
    v_max_f32 v4, v4, v236
    v_mov_b32 v224, v1
    v_mov_b32 v228, v2
    v_mov_b32 v232, v3
    v_mov_b32 v236, v4
    s_nop 0
    v_permlane32_swap_b32 v1, v224
    v_permlane32_swap_b32 v2, v228
    v_permlane32_swap_b32 v3, v232
    v_permlane32_swap_b32 v4, v236
    s_nop 0
    v_max3_f32 v1, v1, v224, s56
    v_max3_f32 v2, v2, v228, s57
    v_max3_f32 v3, v3, v232, s58
    v_max3_f32 v4, v4, v236, s59
    v_mul_f32 v224, -1.0, v1
    v_mul_f32 v225, -1.0, v1
    v_mul_f32 v226, -1.0, v1
    v_mul_f32 v227, -1.0, v1
    v_mul_f32 v228, -1.0, v2
    v_mul_f32 v229, -1.0, v2
    v_mul_f32 v230, -1.0, v2
    v_mul_f32 v231, -1.0, v2
    v_mul_f32 v232, -1.0, v3
    v_mul_f32 v233, -1.0, v3
    v_mul_f32 v234, -1.0, v3
    v_mul_f32 v235, -1.0, v3
    v_mul_f32 v236, -1.0, v4
    v_mul_f32 v237, -1.0, v4
    v_mul_f32 v238, -1.0, v4
    v_mul_f32 v239, -1.0, v4
    v_add_f32 v32, v32, v224
    v_add_f32 v33, v33, v224
    v_add_f32 v34, v34, v224
    v_add_f32 v35, v35, v224
    v_add_f32 v36, v36, v224
    v_add_f32 v37, v37, v224
    v_add_f32 v38, v38, v224
    v_add_f32 v39, v39, v224
    v_add_f32 v40, v40, v228
    v_add_f32 v41, v41, v228
    v_add_f32 v42, v42, v228
    v_add_f32 v43, v43, v228
    v_add_f32 v44, v44, v228
    v_add_f32 v45, v45, v228
    v_add_f32 v46, v46, v228
    v_add_f32 v47, v47, v228
    v_add_f32 v48, v48, v232
    v_add_f32 v49, v49, v232
    v_add_f32 v50, v50, v232
    v_add_f32 v51, v51, v232
    v_add_f32 v52, v52, v232
    v_add_f32 v53, v53, v232
    v_add_f32 v54, v54, v232
    v_add_f32 v55, v55, v232
    v_add_f32 v56, v56, v236
    v_add_f32 v57, v57, v236
    v_add_f32 v58, v58, v236
    v_add_f32 v59, v59, v236
    v_add_f32 v60, v60, v236
    v_add_f32 v61, v61, v236
    v_add_f32 v62, v62, v236
    v_add_f32 v63, v63, v236
    ds_read_b128 a[128:131], v8 offset:8192
    v_exp_f32 v32, v32
    ds_read_b128 a[132:135], v9 offset:8192
    v_exp_f32 v33, v33
    s_nop 0
    v_cvt_pk_bf16_f32 v96, v32, v33
    v_exp_f32 v34, v34
    s_mov_b32 m0, s39
    ds_read_b128 a[136:139], v10 offset:8192
    ds_read_b128 a[140:143], v11 offset:8192
    s_nop 0
    buffer_load_dwordx4 v24, s[12:15], s45 offen offset:0 nt lds
    v_exp_f32 v35, v35
    s_nop 0
    v_cvt_pk_bf16_f32 v97, v34, v35
    v_exp_f32 v36, v36
    ds_read_b128 a[144:147], v8 offset:12288
    ds_read_b128 a[148:151], v9 offset:12288
    buffer_load_dwordx4 v25, s[12:15], s45 offen offset:1024 nt lds
    v_exp_f32 v37, v37
    s_nop 0
    v_cvt_pk_bf16_f32 v98, v36, v37
    v_exp_f32 v38, v38
    ds_read_b128 a[152:155], v10 offset:12288
    ds_read_b128 a[156:159], v11 offset:12288
    buffer_load_dwordx4 v24, s[12:15], s45 offen offset:2048 nt lds
    v_exp_f32 v39, v39
    s_nop 0
    v_cvt_pk_bf16_f32 v99, v38, v39
    v_exp_f32 v40, v40
    buffer_load_dwordx4 v25, s[12:15], s45 offen offset:3072 nt lds
    v_exp_f32 v41, v41
    s_nop 0
    v_cvt_pk_bf16_f32 v100, v40, v41
    v_exp_f32 v42, v42
    v_exp_f32 v43, v43
    s_nop 0
    v_cvt_pk_bf16_f32 v101, v42, v43
    v_exp_f32 v44, v44
    v_exp_f32 v45, v45
    s_nop 0
    v_cvt_pk_bf16_f32 v102, v44, v45
    v_exp_f32 v46, v46
    v_exp_f32 v47, v47
    s_nop 0
    v_cvt_pk_bf16_f32 v103, v46, v47
    v_exp_f32 v48, v48
    v_exp_f32 v49, v49
    s_waitcnt lgkmcnt(0)
    v_mfma_f32_16x16x32_bf16 v[64:67], a[128:131], v[160:163], v[224:227]
    v_cvt_pk_bf16_f32 v104, v48, v49
    v_mfma_f32_16x16x32_bf16 v[64:67], a[132:135], v[164:167], v[64:67]
    v_exp_f32 v50, v50
    v_mfma_f32_16x16x32_bf16 v[64:67], a[136:139], v[168:171], v[64:67]
    v_mfma_f32_16x16x32_bf16 v[64:67], a[140:143], v[172:175], v[64:67]
    v_exp_f32 v51, v51
    v_mfma_f32_16x16x32_bf16 v[72:75], a[128:131], v[176:179], v[228:231]
    v_cvt_pk_bf16_f32 v105, v50, v51
    v_mfma_f32_16x16x32_bf16 v[72:75], a[132:135], v[180:183], v[72:75]
    v_exp_f32 v52, v52
    v_mfma_f32_16x16x32_bf16 v[72:75], a[136:139], v[184:187], v[72:75]
    v_mfma_f32_16x16x32_bf16 v[72:75], a[140:143], v[188:191], v[72:75]
    v_exp_f32 v53, v53
    v_mfma_f32_16x16x32_bf16 v[80:83], a[128:131], v[192:195], v[232:235]
    v_cvt_pk_bf16_f32 v106, v52, v53
    v_mfma_f32_16x16x32_bf16 v[80:83], a[132:135], v[196:199], v[80:83]
    v_exp_f32 v54, v54
    v_mfma_f32_16x16x32_bf16 v[80:83], a[136:139], v[200:203], v[80:83]
    v_mfma_f32_16x16x32_bf16 v[80:83], a[140:143], v[204:207], v[80:83]
    v_exp_f32 v55, v55
    v_mfma_f32_16x16x32_bf16 v[88:91], a[128:131], v[208:211], v[236:239]
    v_cvt_pk_bf16_f32 v107, v54, v55
    v_mfma_f32_16x16x32_bf16 v[88:91], a[132:135], v[212:215], v[88:91]
    v_exp_f32 v56, v56
    v_mfma_f32_16x16x32_bf16 v[88:91], a[136:139], v[216:219], v[88:91]
    v_mfma_f32_16x16x32_bf16 v[88:91], a[140:143], v[220:223], v[88:91]
    v_exp_f32 v57, v57
    v_mfma_f32_16x16x32_bf16 v[68:71], a[144:147], v[160:163], v[224:227]
    v_cvt_pk_bf16_f32 v108, v56, v57
    v_mfma_f32_16x16x32_bf16 v[68:71], a[148:151], v[164:167], v[68:71]
    v_exp_f32 v58, v58
    v_mfma_f32_16x16x32_bf16 v[68:71], a[152:155], v[168:171], v[68:71]
    v_mfma_f32_16x16x32_bf16 v[68:71], a[156:159], v[172:175], v[68:71]
    v_exp_f32 v59, v59
    v_mfma_f32_16x16x32_bf16 v[76:79], a[144:147], v[176:179], v[228:231]
    v_cvt_pk_bf16_f32 v109, v58, v59
    v_mfma_f32_16x16x32_bf16 v[76:79], a[148:151], v[180:183], v[76:79]
    v_exp_f32 v60, v60
    v_mfma_f32_16x16x32_bf16 v[76:79], a[152:155], v[184:187], v[76:79]
    v_exp_f32 v61, v61
    v_mfma_f32_16x16x32_bf16 v[76:79], a[156:159], v[188:191], v[76:79]
    v_cvt_pk_bf16_f32 v110, v60, v61
    v_mfma_f32_16x16x32_bf16 v[84:87], a[144:147], v[192:195], v[232:235]
    v_exp_f32 v62, v62
    v_mfma_f32_16x16x32_bf16 v[84:87], a[148:151], v[196:199], v[84:87]
    v_exp_f32 v63, v63
    v_mfma_f32_16x16x32_bf16 v[84:87], a[152:155], v[200:203], v[84:87]
    s_add_u32 s45, s45, 16384
    v_mfma_f32_16x16x32_bf16 v[84:87], a[156:159], v[204:207], v[84:87]
    v_mfma_f32_16x16x32_bf16 v[92:95], a[144:147], v[208:211], v[236:239]
    v_mfma_f32_16x16x32_bf16 v[92:95], a[148:151], v[212:215], v[92:95]
    v_mfma_f32_16x16x32_bf16 v[92:95], a[152:155], v[216:219], v[92:95]
    v_mfma_f32_16x16x32_bf16 v[92:95], a[156:159], v[220:223], v[92:95]
    s_waitcnt vmcnt(20) lgkmcnt(0)
    s_barrier
    ds_read_b128 a[128:131], v8 offset:16384
    v_cvt_pk_bf16_f32 v111, v62, v63
    v_exp_f32 v64, v64
    ds_read_b128 a[132:135], v9 offset:16384
    v_exp_f32 v65, v65
    s_nop 0
    v_cvt_pk_bf16_f32 v112, v64, v65
    v_exp_f32 v66, v66
    s_mov_b32 m0, s32
    ds_read_b128 a[136:139], v10 offset:16384
    ds_read_b128 a[140:143], v11 offset:16384
    s_nop 0
    buffer_load_dwordx4 v20, s[8:11], s44 offen offset:0 nt lds
    v_exp_f32 v67, v67
    s_nop 0
    v_cvt_pk_bf16_f32 v113, v66, v67
    v_exp_f32 v68, v68
    ds_read_b128 a[144:147], v8 offset:20480
    ds_read_b128 a[148:151], v9 offset:20480
    buffer_load_dwordx4 v21, s[8:11], s44 offen offset:1024 nt lds
    v_exp_f32 v69, v69
    s_nop 0
    v_cvt_pk_bf16_f32 v114, v68, v69
    v_exp_f32 v70, v70
    ds_read_b128 a[152:155], v10 offset:20480
    ds_read_b128 a[156:159], v11 offset:20480
    buffer_load_dwordx4 v22, s[8:11], s44 offen offset:2048 nt lds
    v_exp_f32 v71, v71
    s_nop 0
    v_cvt_pk_bf16_f32 v115, v70, v71
    v_exp_f32 v72, v72
    buffer_load_dwordx4 v23, s[8:11], s44 offen offset:3072 nt lds
    v_exp_f32 v73, v73
    s_nop 0
    v_cvt_pk_bf16_f32 v116, v72, v73
    v_exp_f32 v74, v74
    v_exp_f32 v75, v75
    s_nop 0
    v_cvt_pk_bf16_f32 v117, v74, v75
    v_exp_f32 v76, v76
    v_exp_f32 v77, v77
    s_nop 0
    v_cvt_pk_bf16_f32 v118, v76, v77
    v_exp_f32 v78, v78
    v_exp_f32 v79, v79
    s_nop 0
    v_cvt_pk_bf16_f32 v119, v78, v79
    v_exp_f32 v80, v80
    v_exp_f32 v81, v81
    s_waitcnt lgkmcnt(0)
    v_mfma_f32_16x16x32_bf16 v[32:35], a[128:131], v[160:163], v[224:227]
    ds_read_b64_tr_b16 a[160:161], v12 offset:32768
    v_cvt_pk_bf16_f32 v120, v80, v81
    v_mfma_f32_16x16x32_bf16 v[32:35], a[132:135], v[164:167], v[32:35]
    v_exp_f32 v82, v82
    v_mfma_f32_16x16x32_bf16 v[32:35], a[136:139], v[168:171], v[32:35]
    ds_read_b64_tr_b16 a[162:163], v12 offset:36864
    ds_read_b64_tr_b16 a[164:165], v12 offset:40960
    v_mfma_f32_16x16x32_bf16 v[32:35], a[140:143], v[172:175], v[32:35]
    v_exp_f32 v83, v83
    v_mfma_f32_16x16x32_bf16 v[40:43], a[128:131], v[176:179], v[228:231]
    ds_read_b64_tr_b16 a[166:167], v12 offset:45056
    v_cvt_pk_bf16_f32 v121, v82, v83
    v_mfma_f32_16x16x32_bf16 v[40:43], a[132:135], v[180:183], v[40:43]
    v_exp_f32 v84, v84
    v_mfma_f32_16x16x32_bf16 v[40:43], a[136:139], v[184:187], v[40:43]
    ds_read_b64_tr_b16 a[168:169], v13 offset:32768
    ds_read_b64_tr_b16 a[170:171], v13 offset:36864
    v_mfma_f32_16x16x32_bf16 v[40:43], a[140:143], v[188:191], v[40:43]
    v_exp_f32 v85, v85
    v_mfma_f32_16x16x32_bf16 v[48:51], a[128:131], v[192:195], v[232:235]
    ds_read_b64_tr_b16 a[172:173], v13 offset:40960
    v_cvt_pk_bf16_f32 v122, v84, v85
    v_mfma_f32_16x16x32_bf16 v[48:51], a[132:135], v[196:199], v[48:51]
    v_exp_f32 v86, v86
    v_mfma_f32_16x16x32_bf16 v[48:51], a[136:139], v[200:203], v[48:51]
    ds_read_b64_tr_b16 a[174:175], v13 offset:45056
    ds_read_b64_tr_b16 a[176:177], v14 offset:32768
    v_mfma_f32_16x16x32_bf16 v[48:51], a[140:143], v[204:207], v[48:51]
    v_exp_f32 v87, v87
    v_mfma_f32_16x16x32_bf16 v[56:59], a[128:131], v[208:211], v[236:239]
    ds_read_b64_tr_b16 a[178:179], v14 offset:36864
    v_cvt_pk_bf16_f32 v123, v86, v87
    v_mfma_f32_16x16x32_bf16 v[56:59], a[132:135], v[212:215], v[56:59]
    v_exp_f32 v88, v88
    v_mfma_f32_16x16x32_bf16 v[56:59], a[136:139], v[216:219], v[56:59]
    ds_read_b64_tr_b16 a[180:181], v14 offset:40960
    ds_read_b64_tr_b16 a[182:183], v14 offset:45056
    v_mfma_f32_16x16x32_bf16 v[56:59], a[140:143], v[220:223], v[56:59]
    v_exp_f32 v89, v89
    v_mfma_f32_16x16x32_bf16 v[36:39], a[144:147], v[160:163], v[224:227]
    ds_read_b64_tr_b16 a[184:185], v15 offset:32768
    v_cvt_pk_bf16_f32 v124, v88, v89
    v_mfma_f32_16x16x32_bf16 v[36:39], a[148:151], v[164:167], v[36:39]
    v_exp_f32 v90, v90
    v_mfma_f32_16x16x32_bf16 v[36:39], a[152:155], v[168:171], v[36:39]
    ds_read_b64_tr_b16 a[186:187], v15 offset:36864
    ds_read_b64_tr_b16 a[188:189], v15 offset:40960
    v_mfma_f32_16x16x32_bf16 v[36:39], a[156:159], v[172:175], v[36:39]
    v_exp_f32 v91, v91
    v_mfma_f32_16x16x32_bf16 v[44:47], a[144:147], v[176:179], v[228:231]
    ds_read_b64_tr_b16 a[190:191], v15 offset:45056
    v_cvt_pk_bf16_f32 v125, v90, v91
    v_mfma_f32_16x16x32_bf16 v[44:47], a[148:151], v[180:183], v[44:47]
    v_exp_f32 v92, v92
    v_mfma_f32_16x16x32_bf16 v[44:47], a[152:155], v[184:187], v[44:47]
    v_exp_f32 v93, v93
    v_mfma_f32_16x16x32_bf16 v[44:47], a[156:159], v[188:191], v[44:47]
    v_cvt_pk_bf16_f32 v126, v92, v93
    v_mfma_f32_16x16x32_bf16 v[52:55], a[144:147], v[192:195], v[232:235]
    v_exp_f32 v94, v94
    v_mfma_f32_16x16x32_bf16 v[52:55], a[148:151], v[196:199], v[52:55]
    v_exp_f32 v95, v95
    v_mfma_f32_16x16x32_bf16 v[52:55], a[152:155], v[200:203], v[52:55]
    s_add_u32 s44, s44, 16384
    v_mfma_f32_16x16x32_bf16 v[52:55], a[156:159], v[204:207], v[52:55]
    v_mfma_f32_16x16x32_bf16 v[60:63], a[144:147], v[208:211], v[236:239]
    v_mfma_f32_16x16x32_bf16 v[60:63], a[148:151], v[212:215], v[60:63]
    v_mfma_f32_16x16x32_bf16 v[60:63], a[152:155], v[216:219], v[60:63]
    v_mfma_f32_16x16x32_bf16 v[60:63], a[156:159], v[220:223], v[60:63]
    s_waitcnt lgkmcnt(0)
    v_mfma_f32_16x16x32_bf16 a[0:3], a[160:163], v[96:99], 0
    ds_read_b128 a[128:131], v8 offset:24576
    v_cvt_pk_bf16_f32 v127, v94, v95
    v_mfma_f32_16x16x32_bf16 a[0:3], a[164:167], v[112:115], a[0:3]
    v_exp_f32 v32, v32
    v_mfma_f32_16x16x32_bf16 a[4:7], a[160:163], v[100:103], 0
    ds_read_b128 a[132:135], v9 offset:24576
    v_mfma_f32_16x16x32_bf16 a[4:7], a[164:167], v[116:119], a[4:7]
    v_exp_f32 v33, v33
    v_mfma_f32_16x16x32_bf16 a[8:11], a[160:163], v[104:107], 0
    v_cvt_pk_bf16_f32 v128, v32, v33
    v_mfma_f32_16x16x32_bf16 a[8:11], a[164:167], v[120:123], a[8:11]
    v_exp_f32 v34, v34
    v_mfma_f32_16x16x32_bf16 a[12:15], a[160:163], v[108:111], 0
    ds_read_b128 a[136:139], v10 offset:24576
    ds_read_b128 a[140:143], v11 offset:24576
    v_mfma_f32_16x16x32_bf16 a[12:15], a[164:167], v[124:127], a[12:15]
    v_mfma_f32_16x16x32_bf16 a[16:19], a[168:171], v[96:99], 0
    v_exp_f32 v35, v35
    v_mfma_f32_16x16x32_bf16 a[16:19], a[172:175], v[112:115], a[16:19]
    v_cvt_pk_bf16_f32 v129, v34, v35
    v_mfma_f32_16x16x32_bf16 a[20:23], a[168:171], v[100:103], 0
    v_exp_f32 v36, v36
    v_mfma_f32_16x16x32_bf16 a[20:23], a[172:175], v[116:119], a[20:23]
    ds_read_b128 a[144:147], v8 offset:28672
    ds_read_b128 a[148:151], v9 offset:28672
    v_mfma_f32_16x16x32_bf16 a[24:27], a[168:171], v[104:107], 0
    v_mfma_f32_16x16x32_bf16 a[24:27], a[172:175], v[120:123], a[24:27]
    v_exp_f32 v37, v37
    v_mfma_f32_16x16x32_bf16 a[28:31], a[168:171], v[108:111], 0
    v_cvt_pk_bf16_f32 v130, v36, v37
    v_mfma_f32_16x16x32_bf16 a[28:31], a[172:175], v[124:127], a[28:31]
    v_exp_f32 v38, v38
    v_mfma_f32_16x16x32_bf16 a[32:35], a[176:179], v[96:99], 0
    ds_read_b128 a[152:155], v10 offset:28672
    ds_read_b128 a[156:159], v11 offset:28672
    v_mfma_f32_16x16x32_bf16 a[32:35], a[180:183], v[112:115], a[32:35]
    v_mfma_f32_16x16x32_bf16 a[36:39], a[176:179], v[100:103], 0
    v_exp_f32 v39, v39
    v_mfma_f32_16x16x32_bf16 a[36:39], a[180:183], v[116:119], a[36:39]
    v_cvt_pk_bf16_f32 v131, v38, v39
    v_mfma_f32_16x16x32_bf16 a[40:43], a[176:179], v[104:107], 0
    v_exp_f32 v40, v40
    v_mfma_f32_16x16x32_bf16 a[40:43], a[180:183], v[120:123], a[40:43]
    v_mfma_f32_16x16x32_bf16 a[44:47], a[176:179], v[108:111], 0
    v_mfma_f32_16x16x32_bf16 a[44:47], a[180:183], v[124:127], a[44:47]
    v_exp_f32 v41, v41
    v_mfma_f32_16x16x32_bf16 a[48:51], a[184:187], v[96:99], 0
    v_cvt_pk_bf16_f32 v132, v40, v41
    v_mfma_f32_16x16x32_bf16 a[48:51], a[188:191], v[112:115], a[48:51]
    v_exp_f32 v42, v42
    v_mfma_f32_16x16x32_bf16 a[52:55], a[184:187], v[100:103], 0
    v_exp_f32 v43, v43
    v_mfma_f32_16x16x32_bf16 a[52:55], a[188:191], v[116:119], a[52:55]
    v_cvt_pk_bf16_f32 v133, v42, v43
    v_mfma_f32_16x16x32_bf16 a[56:59], a[184:187], v[104:107], 0
    v_exp_f32 v44, v44
    v_mfma_f32_16x16x32_bf16 a[56:59], a[188:191], v[120:123], a[56:59]
    v_exp_f32 v45, v45
    v_mfma_f32_16x16x32_bf16 a[60:63], a[184:187], v[108:111], 0
    v_cvt_pk_bf16_f32 v134, v44, v45
    v_mfma_f32_16x16x32_bf16 a[60:63], a[188:191], v[124:127], a[60:63]
    v_exp_f32 v46, v46
    v_mfma_f32_16x16x32_bf16 a[192:195], a[208:211], v[96:99], 0
    v_exp_f32 v47, v47
    v_mfma_f32_16x16x32_bf16 a[192:195], a[208:211], v[112:115], a[192:195]
    v_cvt_pk_bf16_f32 v135, v46, v47
    v_mfma_f32_16x16x32_bf16 a[196:199], a[208:211], v[100:103], 0
    v_exp_f32 v48, v48
    v_mfma_f32_16x16x32_bf16 a[196:199], a[208:211], v[116:119], a[196:199]
    v_exp_f32 v49, v49
    s_waitcnt lgkmcnt(0)
    v_mfma_f32_16x16x32_bf16 v[64:67], a[128:131], v[160:163], v[224:227]
    ds_read_b64_tr_b16 a[160:161], v16 offset:32768
    v_cvt_pk_bf16_f32 v136, v48, v49
    v_mfma_f32_16x16x32_bf16 v[64:67], a[132:135], v[164:167], v[64:67]
    v_exp_f32 v50, v50
    v_mfma_f32_16x16x32_bf16 v[64:67], a[136:139], v[168:171], v[64:67]
    ds_read_b64_tr_b16 a[162:163], v16 offset:36864
    ds_read_b64_tr_b16 a[164:165], v16 offset:40960
    v_mfma_f32_16x16x32_bf16 v[64:67], a[140:143], v[172:175], v[64:67]
    v_exp_f32 v51, v51
    v_mfma_f32_16x16x32_bf16 v[72:75], a[128:131], v[176:179], v[228:231]
    ds_read_b64_tr_b16 a[166:167], v16 offset:45056
    v_cvt_pk_bf16_f32 v137, v50, v51
    v_mfma_f32_16x16x32_bf16 v[72:75], a[132:135], v[180:183], v[72:75]
    v_exp_f32 v52, v52
    v_mfma_f32_16x16x32_bf16 v[72:75], a[136:139], v[184:187], v[72:75]
    ds_read_b64_tr_b16 a[168:169], v17 offset:32768
    ds_read_b64_tr_b16 a[170:171], v17 offset:36864
    v_mfma_f32_16x16x32_bf16 v[72:75], a[140:143], v[188:191], v[72:75]
    v_exp_f32 v53, v53
    v_mfma_f32_16x16x32_bf16 v[80:83], a[128:131], v[192:195], v[232:235]
    ds_read_b64_tr_b16 a[172:173], v17 offset:40960
    v_cvt_pk_bf16_f32 v138, v52, v53
    v_mfma_f32_16x16x32_bf16 v[80:83], a[132:135], v[196:199], v[80:83]
    v_exp_f32 v54, v54
    v_mfma_f32_16x16x32_bf16 v[80:83], a[136:139], v[200:203], v[80:83]
    ds_read_b64_tr_b16 a[174:175], v17 offset:45056
    ds_read_b64_tr_b16 a[176:177], v18 offset:32768
    v_mfma_f32_16x16x32_bf16 v[80:83], a[140:143], v[204:207], v[80:83]
    v_exp_f32 v55, v55
    v_mfma_f32_16x16x32_bf16 v[88:91], a[128:131], v[208:211], v[236:239]
    ds_read_b64_tr_b16 a[178:179], v18 offset:36864
    v_cvt_pk_bf16_f32 v139, v54, v55
    v_mfma_f32_16x16x32_bf16 v[88:91], a[132:135], v[212:215], v[88:91]
    v_exp_f32 v56, v56
    v_mfma_f32_16x16x32_bf16 v[88:91], a[136:139], v[216:219], v[88:91]
    ds_read_b64_tr_b16 a[180:181], v18 offset:40960
    ds_read_b64_tr_b16 a[182:183], v18 offset:45056
    v_mfma_f32_16x16x32_bf16 v[88:91], a[140:143], v[220:223], v[88:91]
    v_exp_f32 v57, v57
    v_mfma_f32_16x16x32_bf16 v[68:71], a[144:147], v[160:163], v[224:227]
    ds_read_b64_tr_b16 a[184:185], v19 offset:32768
    v_cvt_pk_bf16_f32 v140, v56, v57
    v_mfma_f32_16x16x32_bf16 v[68:71], a[148:151], v[164:167], v[68:71]
    v_exp_f32 v58, v58
    v_mfma_f32_16x16x32_bf16 v[68:71], a[152:155], v[168:171], v[68:71]
    ds_read_b64_tr_b16 a[186:187], v19 offset:36864
    ds_read_b64_tr_b16 a[188:189], v19 offset:40960
    v_mfma_f32_16x16x32_bf16 v[68:71], a[156:159], v[172:175], v[68:71]
    v_exp_f32 v59, v59
    v_mfma_f32_16x16x32_bf16 v[76:79], a[144:147], v[176:179], v[228:231]
    ds_read_b64_tr_b16 a[190:191], v19 offset:45056
    v_cvt_pk_bf16_f32 v141, v58, v59
    v_mfma_f32_16x16x32_bf16 v[76:79], a[148:151], v[180:183], v[76:79]
    v_exp_f32 v60, v60
    v_mfma_f32_16x16x32_bf16 v[76:79], a[152:155], v[184:187], v[76:79]
    v_exp_f32 v61, v61
    v_mfma_f32_16x16x32_bf16 v[76:79], a[156:159], v[188:191], v[76:79]
    v_cvt_pk_bf16_f32 v142, v60, v61
    v_mfma_f32_16x16x32_bf16 v[84:87], a[144:147], v[192:195], v[232:235]
    v_exp_f32 v62, v62
    v_mfma_f32_16x16x32_bf16 v[84:87], a[148:151], v[196:199], v[84:87]
    v_exp_f32 v63, v63
    v_mfma_f32_16x16x32_bf16 v[84:87], a[152:155], v[200:203], v[84:87]
    v_mfma_f32_16x16x32_bf16 v[84:87], a[156:159], v[204:207], v[84:87]
    v_mfma_f32_16x16x32_bf16 v[92:95], a[144:147], v[208:211], v[236:239]
    v_mfma_f32_16x16x32_bf16 v[92:95], a[148:151], v[212:215], v[92:95]
    v_mfma_f32_16x16x32_bf16 v[92:95], a[152:155], v[216:219], v[92:95]
    v_mfma_f32_16x16x32_bf16 v[92:95], a[156:159], v[220:223], v[92:95]
    s_waitcnt vmcnt(16) lgkmcnt(0)
    s_barrier
    v_mfma_f32_16x16x32_bf16 a[64:67], a[160:163], v[96:99], 0
    ds_read_b128 a[128:131], v8 offset:32768
    v_cvt_pk_bf16_f32 v143, v62, v63
    v_mfma_f32_16x16x32_bf16 a[64:67], a[164:167], v[112:115], a[64:67]
    v_exp_f32 v64, v64
    v_mfma_f32_16x16x32_bf16 a[68:71], a[160:163], v[100:103], 0
    ds_read_b128 a[132:135], v9 offset:32768
    v_mfma_f32_16x16x32_bf16 a[68:71], a[164:167], v[116:119], a[68:71]
    v_exp_f32 v65, v65
    v_mfma_f32_16x16x32_bf16 a[72:75], a[160:163], v[104:107], 0
    v_cvt_pk_bf16_f32 v144, v64, v65
    v_mfma_f32_16x16x32_bf16 a[72:75], a[164:167], v[120:123], a[72:75]
    v_exp_f32 v66, v66
    v_mfma_f32_16x16x32_bf16 a[76:79], a[160:163], v[108:111], 0
    s_mov_b32 m0, s33
    ds_read_b128 a[136:139], v10 offset:32768
    ds_read_b128 a[140:143], v11 offset:32768
    v_mfma_f32_16x16x32_bf16 a[76:79], a[164:167], v[124:127], a[76:79]
    buffer_load_dwordx4 v20, s[8:11], s44 offen offset:0 nt lds
    v_mfma_f32_16x16x32_bf16 a[80:83], a[168:171], v[96:99], 0
    v_exp_f32 v67, v67
    v_mfma_f32_16x16x32_bf16 a[80:83], a[172:175], v[112:115], a[80:83]
    v_cvt_pk_bf16_f32 v145, v66, v67
    v_mfma_f32_16x16x32_bf16 a[84:87], a[168:171], v[100:103], 0
    v_exp_f32 v68, v68
    v_mfma_f32_16x16x32_bf16 a[84:87], a[172:175], v[116:119], a[84:87]
    ds_read_b128 a[144:147], v8 offset:36864
    ds_read_b128 a[148:151], v9 offset:36864
    v_mfma_f32_16x16x32_bf16 a[88:91], a[168:171], v[104:107], 0
    buffer_load_dwordx4 v21, s[8:11], s44 offen offset:1024 nt lds
    v_mfma_f32_16x16x32_bf16 a[88:91], a[172:175], v[120:123], a[88:91]
    v_exp_f32 v69, v69
    v_mfma_f32_16x16x32_bf16 a[92:95], a[168:171], v[108:111], 0
    v_cvt_pk_bf16_f32 v146, v68, v69
    v_mfma_f32_16x16x32_bf16 a[92:95], a[172:175], v[124:127], a[92:95]
    v_exp_f32 v70, v70
    v_mfma_f32_16x16x32_bf16 a[96:99], a[176:179], v[96:99], 0
    ds_read_b128 a[152:155], v10 offset:36864
    ds_read_b128 a[156:159], v11 offset:36864
    v_mfma_f32_16x16x32_bf16 a[96:99], a[180:183], v[112:115], a[96:99]
    buffer_load_dwordx4 v22, s[8:11], s44 offen offset:2048 nt lds
    v_mfma_f32_16x16x32_bf16 a[100:103], a[176:179], v[100:103], 0
    v_exp_f32 v71, v71
    v_mfma_f32_16x16x32_bf16 a[100:103], a[180:183], v[116:119], a[100:103]
    v_cvt_pk_bf16_f32 v147, v70, v71
    v_mfma_f32_16x16x32_bf16 a[104:107], a[176:179], v[104:107], 0
    v_exp_f32 v72, v72
    v_mfma_f32_16x16x32_bf16 a[104:107], a[180:183], v[120:123], a[104:107]
    v_mfma_f32_16x16x32_bf16 a[108:111], a[176:179], v[108:111], 0
    buffer_load_dwordx4 v23, s[8:11], s44 offen offset:3072 nt lds
    v_mfma_f32_16x16x32_bf16 a[108:111], a[180:183], v[124:127], a[108:111]
    v_exp_f32 v73, v73
    v_mfma_f32_16x16x32_bf16 a[112:115], a[184:187], v[96:99], 0
    v_cvt_pk_bf16_f32 v148, v72, v73
    v_mfma_f32_16x16x32_bf16 a[112:115], a[188:191], v[112:115], a[112:115]
    v_exp_f32 v74, v74
    v_mfma_f32_16x16x32_bf16 a[116:119], a[184:187], v[100:103], 0
    v_exp_f32 v75, v75
    v_mfma_f32_16x16x32_bf16 a[116:119], a[188:191], v[116:119], a[116:119]
    v_cvt_pk_bf16_f32 v149, v74, v75
    v_mfma_f32_16x16x32_bf16 a[120:123], a[184:187], v[104:107], 0
    v_exp_f32 v76, v76
    v_mfma_f32_16x16x32_bf16 a[120:123], a[188:191], v[120:123], a[120:123]
    v_exp_f32 v77, v77
    v_mfma_f32_16x16x32_bf16 a[124:127], a[184:187], v[108:111], 0
    v_cvt_pk_bf16_f32 v150, v76, v77
    v_mfma_f32_16x16x32_bf16 a[124:127], a[188:191], v[124:127], a[124:127]
    v_exp_f32 v78, v78
    v_mfma_f32_16x16x32_bf16 a[200:203], a[208:211], v[104:107], 0
    v_exp_f32 v79, v79
    v_mfma_f32_16x16x32_bf16 a[200:203], a[208:211], v[120:123], a[200:203]
    v_cvt_pk_bf16_f32 v151, v78, v79
    v_mfma_f32_16x16x32_bf16 a[204:207], a[208:211], v[108:111], 0
    v_exp_f32 v80, v80
    v_mfma_f32_16x16x32_bf16 a[204:207], a[208:211], v[124:127], a[204:207]
    v_exp_f32 v81, v81
    s_waitcnt lgkmcnt(0)
    v_mfma_f32_16x16x32_bf16 v[32:35], a[128:131], v[160:163], v[224:227]
    ds_read_b64_tr_b16 a[160:161], v12 offset:49152
    v_cvt_pk_bf16_f32 v152, v80, v81
    v_mfma_f32_16x16x32_bf16 v[32:35], a[132:135], v[164:167], v[32:35]
    v_exp_f32 v82, v82
    v_mfma_f32_16x16x32_bf16 v[32:35], a[136:139], v[168:171], v[32:35]
    ds_read_b64_tr_b16 a[162:163], v12 offset:53248
    ds_read_b64_tr_b16 a[164:165], v12 offset:57344
    v_mfma_f32_16x16x32_bf16 v[32:35], a[140:143], v[172:175], v[32:35]
    v_exp_f32 v83, v83
    v_mfma_f32_16x16x32_bf16 v[40:43], a[128:131], v[176:179], v[228:231]
    ds_read_b64_tr_b16 a[166:167], v12 offset:61440
    v_cvt_pk_bf16_f32 v153, v82, v83
    v_mfma_f32_16x16x32_bf16 v[40:43], a[132:135], v[180:183], v[40:43]
    v_exp_f32 v84, v84
    v_mfma_f32_16x16x32_bf16 v[40:43], a[136:139], v[184:187], v[40:43]
    ds_read_b64_tr_b16 a[168:169], v13 offset:49152
    ds_read_b64_tr_b16 a[170:171], v13 offset:53248
    v_mfma_f32_16x16x32_bf16 v[40:43], a[140:143], v[188:191], v[40:43]
    v_exp_f32 v85, v85
    v_mfma_f32_16x16x32_bf16 v[48:51], a[128:131], v[192:195], v[232:235]
    ds_read_b64_tr_b16 a[172:173], v13 offset:57344
    v_cvt_pk_bf16_f32 v154, v84, v85
    v_mfma_f32_16x16x32_bf16 v[48:51], a[132:135], v[196:199], v[48:51]
    v_exp_f32 v86, v86
    v_mfma_f32_16x16x32_bf16 v[48:51], a[136:139], v[200:203], v[48:51]
    ds_read_b64_tr_b16 a[174:175], v13 offset:61440
    ds_read_b64_tr_b16 a[176:177], v14 offset:49152
    v_mfma_f32_16x16x32_bf16 v[48:51], a[140:143], v[204:207], v[48:51]
    v_exp_f32 v87, v87
    v_mfma_f32_16x16x32_bf16 v[56:59], a[128:131], v[208:211], v[236:239]
    ds_read_b64_tr_b16 a[178:179], v14 offset:53248
    v_cvt_pk_bf16_f32 v155, v86, v87
    v_mfma_f32_16x16x32_bf16 v[56:59], a[132:135], v[212:215], v[56:59]
    v_exp_f32 v88, v88
    v_mfma_f32_16x16x32_bf16 v[56:59], a[136:139], v[216:219], v[56:59]
    ds_read_b64_tr_b16 a[180:181], v14 offset:57344
    ds_read_b64_tr_b16 a[182:183], v14 offset:61440
    v_mfma_f32_16x16x32_bf16 v[56:59], a[140:143], v[220:223], v[56:59]
    v_exp_f32 v89, v89
    v_mfma_f32_16x16x32_bf16 v[36:39], a[144:147], v[160:163], v[224:227]
    ds_read_b64_tr_b16 a[184:185], v15 offset:49152
    v_cvt_pk_bf16_f32 v156, v88, v89
    v_mfma_f32_16x16x32_bf16 v[36:39], a[148:151], v[164:167], v[36:39]
    v_exp_f32 v90, v90
    v_mfma_f32_16x16x32_bf16 v[36:39], a[152:155], v[168:171], v[36:39]
    ds_read_b64_tr_b16 a[186:187], v15 offset:53248
    ds_read_b64_tr_b16 a[188:189], v15 offset:57344
    v_mfma_f32_16x16x32_bf16 v[36:39], a[156:159], v[172:175], v[36:39]
    v_exp_f32 v91, v91
    v_mfma_f32_16x16x32_bf16 v[44:47], a[144:147], v[176:179], v[228:231]
    ds_read_b64_tr_b16 a[190:191], v15 offset:61440
    v_cvt_pk_bf16_f32 v157, v90, v91
    v_mfma_f32_16x16x32_bf16 v[44:47], a[148:151], v[180:183], v[44:47]
    v_exp_f32 v92, v92
    v_mfma_f32_16x16x32_bf16 v[44:47], a[152:155], v[184:187], v[44:47]
    v_exp_f32 v93, v93
    v_mfma_f32_16x16x32_bf16 v[44:47], a[156:159], v[188:191], v[44:47]
    v_cvt_pk_bf16_f32 v158, v92, v93
    v_mfma_f32_16x16x32_bf16 v[52:55], a[144:147], v[192:195], v[232:235]
    v_exp_f32 v94, v94
    v_mfma_f32_16x16x32_bf16 v[52:55], a[148:151], v[196:199], v[52:55]
    v_exp_f32 v95, v95
    v_mfma_f32_16x16x32_bf16 v[52:55], a[152:155], v[200:203], v[52:55]
    s_add_u32 s44, s44, 16384
    v_mfma_f32_16x16x32_bf16 v[52:55], a[156:159], v[204:207], v[52:55]
    v_mfma_f32_16x16x32_bf16 v[60:63], a[144:147], v[208:211], v[236:239]
    v_mfma_f32_16x16x32_bf16 v[60:63], a[148:151], v[212:215], v[60:63]
    v_mfma_f32_16x16x32_bf16 v[60:63], a[152:155], v[216:219], v[60:63]
    v_mfma_f32_16x16x32_bf16 v[60:63], a[156:159], v[220:223], v[60:63]
    s_waitcnt lgkmcnt(0)
    v_mfma_f32_16x16x32_bf16 a[0:3], a[160:163], v[128:131], a[0:3]
    ds_read_b128 a[128:131], v8 offset:40960
    v_cvt_pk_bf16_f32 v159, v94, v95
    v_mfma_f32_16x16x32_bf16 a[0:3], a[164:167], v[144:147], a[0:3]
    v_exp_f32 v32, v32
    v_mfma_f32_16x16x32_bf16 a[4:7], a[160:163], v[132:135], a[4:7]
    ds_read_b128 a[132:135], v9 offset:40960
    v_mfma_f32_16x16x32_bf16 a[4:7], a[164:167], v[148:151], a[4:7]
    v_exp_f32 v33, v33
    v_mfma_f32_16x16x32_bf16 a[8:11], a[160:163], v[136:139], a[8:11]
    v_cvt_pk_bf16_f32 v96, v32, v33
    v_mfma_f32_16x16x32_bf16 a[8:11], a[164:167], v[152:155], a[8:11]
    v_exp_f32 v34, v34
    v_mfma_f32_16x16x32_bf16 a[12:15], a[160:163], v[140:143], a[12:15]
    s_mov_b32 m0, s36
    ds_read_b128 a[136:139], v10 offset:40960
    ds_read_b128 a[140:143], v11 offset:40960
    v_mfma_f32_16x16x32_bf16 a[12:15], a[164:167], v[156:159], a[12:15]
    buffer_load_dwordx4 v24, s[12:15], s45 offen offset:0 nt lds
    v_mfma_f32_16x16x32_bf16 a[16:19], a[168:171], v[128:131], a[16:19]
    v_exp_f32 v35, v35
    v_mfma_f32_16x16x32_bf16 a[16:19], a[172:175], v[144:147], a[16:19]
    v_cvt_pk_bf16_f32 v97, v34, v35
    v_mfma_f32_16x16x32_bf16 a[20:23], a[168:171], v[132:135], a[20:23]
    v_exp_f32 v36, v36
    v_mfma_f32_16x16x32_bf16 a[20:23], a[172:175], v[148:151], a[20:23]
    ds_read_b128 a[144:147], v8 offset:45056
    ds_read_b128 a[148:151], v9 offset:45056
    v_mfma_f32_16x16x32_bf16 a[24:27], a[168:171], v[136:139], a[24:27]
    buffer_load_dwordx4 v25, s[12:15], s45 offen offset:1024 nt lds
    v_mfma_f32_16x16x32_bf16 a[24:27], a[172:175], v[152:155], a[24:27]
    v_exp_f32 v37, v37
    v_mfma_f32_16x16x32_bf16 a[28:31], a[168:171], v[140:143], a[28:31]
    v_cvt_pk_bf16_f32 v98, v36, v37
    v_mfma_f32_16x16x32_bf16 a[28:31], a[172:175], v[156:159], a[28:31]
    v_exp_f32 v38, v38
    v_mfma_f32_16x16x32_bf16 a[32:35], a[176:179], v[128:131], a[32:35]
    ds_read_b128 a[152:155], v10 offset:45056
    ds_read_b128 a[156:159], v11 offset:45056
    v_mfma_f32_16x16x32_bf16 a[32:35], a[180:183], v[144:147], a[32:35]
    buffer_load_dwordx4 v24, s[12:15], s45 offen offset:2048 nt lds
    v_mfma_f32_16x16x32_bf16 a[36:39], a[176:179], v[132:135], a[36:39]
    v_exp_f32 v39, v39
    v_mfma_f32_16x16x32_bf16 a[36:39], a[180:183], v[148:151], a[36:39]
    v_cvt_pk_bf16_f32 v99, v38, v39
    v_mfma_f32_16x16x32_bf16 a[40:43], a[176:179], v[136:139], a[40:43]
    v_exp_f32 v40, v40
    v_mfma_f32_16x16x32_bf16 a[40:43], a[180:183], v[152:155], a[40:43]
    v_mfma_f32_16x16x32_bf16 a[44:47], a[176:179], v[140:143], a[44:47]
    buffer_load_dwordx4 v25, s[12:15], s45 offen offset:3072 nt lds
    v_mfma_f32_16x16x32_bf16 a[44:47], a[180:183], v[156:159], a[44:47]
    v_exp_f32 v41, v41
    v_mfma_f32_16x16x32_bf16 a[48:51], a[184:187], v[128:131], a[48:51]
    v_cvt_pk_bf16_f32 v100, v40, v41
    v_mfma_f32_16x16x32_bf16 a[48:51], a[188:191], v[144:147], a[48:51]
    v_exp_f32 v42, v42
    v_mfma_f32_16x16x32_bf16 a[52:55], a[184:187], v[132:135], a[52:55]
    v_exp_f32 v43, v43
    v_mfma_f32_16x16x32_bf16 a[52:55], a[188:191], v[148:151], a[52:55]
    v_cvt_pk_bf16_f32 v101, v42, v43
    v_mfma_f32_16x16x32_bf16 a[56:59], a[184:187], v[136:139], a[56:59]
    v_exp_f32 v44, v44
    v_mfma_f32_16x16x32_bf16 a[56:59], a[188:191], v[152:155], a[56:59]
    v_exp_f32 v45, v45
    v_mfma_f32_16x16x32_bf16 a[60:63], a[184:187], v[140:143], a[60:63]
    v_cvt_pk_bf16_f32 v102, v44, v45
    v_mfma_f32_16x16x32_bf16 a[60:63], a[188:191], v[156:159], a[60:63]
    v_exp_f32 v46, v46
    v_mfma_f32_16x16x32_bf16 a[192:195], a[208:211], v[128:131], a[192:195]
    v_exp_f32 v47, v47
    v_mfma_f32_16x16x32_bf16 a[192:195], a[208:211], v[144:147], a[192:195]
    v_cvt_pk_bf16_f32 v103, v46, v47
    v_mfma_f32_16x16x32_bf16 a[196:199], a[208:211], v[132:135], a[196:199]
    v_exp_f32 v48, v48
    v_mfma_f32_16x16x32_bf16 a[196:199], a[208:211], v[148:151], a[196:199]
    v_exp_f32 v49, v49
    s_waitcnt lgkmcnt(0)
    v_mfma_f32_16x16x32_bf16 v[64:67], a[128:131], v[160:163], v[224:227]
    ds_read_b64_tr_b16 a[160:161], v16 offset:49152
    v_cvt_pk_bf16_f32 v104, v48, v49
    v_mfma_f32_16x16x32_bf16 v[64:67], a[132:135], v[164:167], v[64:67]
    v_exp_f32 v50, v50
    v_mfma_f32_16x16x32_bf16 v[64:67], a[136:139], v[168:171], v[64:67]
    ds_read_b64_tr_b16 a[162:163], v16 offset:53248
    ds_read_b64_tr_b16 a[164:165], v16 offset:57344
    v_mfma_f32_16x16x32_bf16 v[64:67], a[140:143], v[172:175], v[64:67]
    v_exp_f32 v51, v51
    v_mfma_f32_16x16x32_bf16 v[72:75], a[128:131], v[176:179], v[228:231]
    ds_read_b64_tr_b16 a[166:167], v16 offset:61440
    v_cvt_pk_bf16_f32 v105, v50, v51
    v_mfma_f32_16x16x32_bf16 v[72:75], a[132:135], v[180:183], v[72:75]
    v_exp_f32 v52, v52
    v_mfma_f32_16x16x32_bf16 v[72:75], a[136:139], v[184:187], v[72:75]
    ds_read_b64_tr_b16 a[168:169], v17 offset:49152
    ds_read_b64_tr_b16 a[170:171], v17 offset:53248
    v_mfma_f32_16x16x32_bf16 v[72:75], a[140:143], v[188:191], v[72:75]
    v_exp_f32 v53, v53
    v_mfma_f32_16x16x32_bf16 v[80:83], a[128:131], v[192:195], v[232:235]
    ds_read_b64_tr_b16 a[172:173], v17 offset:57344
    v_cvt_pk_bf16_f32 v106, v52, v53
    v_mfma_f32_16x16x32_bf16 v[80:83], a[132:135], v[196:199], v[80:83]
    v_exp_f32 v54, v54
    v_mfma_f32_16x16x32_bf16 v[80:83], a[136:139], v[200:203], v[80:83]
    ds_read_b64_tr_b16 a[174:175], v17 offset:61440
    ds_read_b64_tr_b16 a[176:177], v18 offset:49152
    v_mfma_f32_16x16x32_bf16 v[80:83], a[140:143], v[204:207], v[80:83]
    v_exp_f32 v55, v55
    v_mfma_f32_16x16x32_bf16 v[88:91], a[128:131], v[208:211], v[236:239]
    ds_read_b64_tr_b16 a[178:179], v18 offset:53248
    v_cvt_pk_bf16_f32 v107, v54, v55
    v_mfma_f32_16x16x32_bf16 v[88:91], a[132:135], v[212:215], v[88:91]
    v_exp_f32 v56, v56
    v_mfma_f32_16x16x32_bf16 v[88:91], a[136:139], v[216:219], v[88:91]
    ds_read_b64_tr_b16 a[180:181], v18 offset:57344
    ds_read_b64_tr_b16 a[182:183], v18 offset:61440
    v_mfma_f32_16x16x32_bf16 v[88:91], a[140:143], v[220:223], v[88:91]
    v_exp_f32 v57, v57
    v_mfma_f32_16x16x32_bf16 v[68:71], a[144:147], v[160:163], v[224:227]
    ds_read_b64_tr_b16 a[184:185], v19 offset:49152
    v_cvt_pk_bf16_f32 v108, v56, v57
    v_mfma_f32_16x16x32_bf16 v[68:71], a[148:151], v[164:167], v[68:71]
    v_exp_f32 v58, v58
    v_mfma_f32_16x16x32_bf16 v[68:71], a[152:155], v[168:171], v[68:71]
    ds_read_b64_tr_b16 a[186:187], v19 offset:53248
    ds_read_b64_tr_b16 a[188:189], v19 offset:57344
    v_mfma_f32_16x16x32_bf16 v[68:71], a[156:159], v[172:175], v[68:71]
    v_exp_f32 v59, v59
    v_mfma_f32_16x16x32_bf16 v[76:79], a[144:147], v[176:179], v[228:231]
    ds_read_b64_tr_b16 a[190:191], v19 offset:61440
    v_cvt_pk_bf16_f32 v109, v58, v59
    v_mfma_f32_16x16x32_bf16 v[76:79], a[148:151], v[180:183], v[76:79]
    v_exp_f32 v60, v60
    v_mfma_f32_16x16x32_bf16 v[76:79], a[152:155], v[184:187], v[76:79]
    v_exp_f32 v61, v61
    v_mfma_f32_16x16x32_bf16 v[76:79], a[156:159], v[188:191], v[76:79]
    v_cvt_pk_bf16_f32 v110, v60, v61
    v_mfma_f32_16x16x32_bf16 v[84:87], a[144:147], v[192:195], v[232:235]
    v_exp_f32 v62, v62
    v_mfma_f32_16x16x32_bf16 v[84:87], a[148:151], v[196:199], v[84:87]
    v_exp_f32 v63, v63
    v_mfma_f32_16x16x32_bf16 v[84:87], a[152:155], v[200:203], v[84:87]
    s_add_u32 s45, s45, 16384
    v_mfma_f32_16x16x32_bf16 v[84:87], a[156:159], v[204:207], v[84:87]
    v_mfma_f32_16x16x32_bf16 v[92:95], a[144:147], v[208:211], v[236:239]
    v_mfma_f32_16x16x32_bf16 v[92:95], a[148:151], v[212:215], v[92:95]
    v_mfma_f32_16x16x32_bf16 v[92:95], a[152:155], v[216:219], v[92:95]
    v_mfma_f32_16x16x32_bf16 v[92:95], a[156:159], v[220:223], v[92:95]
    s_mov_b32 s50, 0
    s_branch L_it3
.p2align 6
L_loop:
    s_waitcnt vmcnt(16) lgkmcnt(0)
    s_barrier
    v_mfma_f32_16x16x32_bf16 a[64:67], a[160:163], v[96:99], a[64:67]
    ds_read_b128 a[128:131], v8 offset:0
    v_cvt_pk_bf16_f32 v143, v62, v63
    v_mfma_f32_16x16x32_bf16 a[64:67], a[164:167], v[112:115], a[64:67]
    v_exp_f32 v64, v64
    v_mfma_f32_16x16x32_bf16 a[68:71], a[160:163], v[100:103], a[68:71]
    ds_read_b128 a[132:135], v9 offset:0
    v_mfma_f32_16x16x32_bf16 a[68:71], a[164:167], v[116:119], a[68:71]
    v_exp_f32 v65, v65
    v_mfma_f32_16x16x32_bf16 a[72:75], a[160:163], v[104:107], a[72:75]
    v_cvt_pk_bf16_f32 v144, v64, v65
    v_mfma_f32_16x16x32_bf16 a[72:75], a[164:167], v[120:123], a[72:75]
    v_exp_f32 v66, v66
    v_mfma_f32_16x16x32_bf16 a[76:79], a[160:163], v[108:111], a[76:79]
    s_mov_b32 m0, s35
    ds_read_b128 a[136:139], v10 offset:0
    ds_read_b128 a[140:143], v11 offset:0
    v_mfma_f32_16x16x32_bf16 a[76:79], a[164:167], v[124:127], a[76:79]
    buffer_load_dwordx4 v20, s[8:11], s44 offen offset:0 nt lds
    v_mfma_f32_16x16x32_bf16 a[80:83], a[168:171], v[96:99], a[80:83]
    v_exp_f32 v67, v67
    v_mfma_f32_16x16x32_bf16 a[80:83], a[172:175], v[112:115], a[80:83]
    v_cvt_pk_bf16_f32 v145, v66, v67
    v_mfma_f32_16x16x32_bf16 a[84:87], a[168:171], v[100:103], a[84:87]
    v_exp_f32 v68, v68
    v_mfma_f32_16x16x32_bf16 a[84:87], a[172:175], v[116:119], a[84:87]
    ds_read_b128 a[144:147], v8 offset:4096
    ds_read_b128 a[148:151], v9 offset:4096
    v_mfma_f32_16x16x32_bf16 a[88:91], a[168:171], v[104:107], a[88:91]
    buffer_load_dwordx4 v21, s[8:11], s44 offen offset:1024 nt lds
    v_mfma_f32_16x16x32_bf16 a[88:91], a[172:175], v[120:123], a[88:91]
    v_exp_f32 v69, v69
    v_mfma_f32_16x16x32_bf16 a[92:95], a[168:171], v[108:111], a[92:95]
    v_cvt_pk_bf16_f32 v146, v68, v69
    v_mfma_f32_16x16x32_bf16 a[92:95], a[172:175], v[124:127], a[92:95]
    v_exp_f32 v70, v70
    v_mfma_f32_16x16x32_bf16 a[96:99], a[176:179], v[96:99], a[96:99]
    ds_read_b128 a[152:155], v10 offset:4096
    ds_read_b128 a[156:159], v11 offset:4096
    v_mfma_f32_16x16x32_bf16 a[96:99], a[180:183], v[112:115], a[96:99]
    buffer_load_dwordx4 v22, s[8:11], s44 offen offset:2048 nt lds
    v_mfma_f32_16x16x32_bf16 a[100:103], a[176:179], v[100:103], a[100:103]
    v_exp_f32 v71, v71
    v_mfma_f32_16x16x32_bf16 a[100:103], a[180:183], v[116:119], a[100:103]
    v_cvt_pk_bf16_f32 v147, v70, v71
    v_mfma_f32_16x16x32_bf16 a[104:107], a[176:179], v[104:107], a[104:107]
    v_exp_f32 v72, v72
    v_mfma_f32_16x16x32_bf16 a[104:107], a[180:183], v[120:123], a[104:107]
    v_mfma_f32_16x16x32_bf16 a[108:111], a[176:179], v[108:111], a[108:111]
    buffer_load_dwordx4 v23, s[8:11], s44 offen offset:3072 nt lds
    v_mfma_f32_16x16x32_bf16 a[108:111], a[180:183], v[124:127], a[108:111]
    v_exp_f32 v73, v73
    v_mfma_f32_16x16x32_bf16 a[112:115], a[184:187], v[96:99], a[112:115]
    v_cvt_pk_bf16_f32 v148, v72, v73
    v_mfma_f32_16x16x32_bf16 a[112:115], a[188:191], v[112:115], a[112:115]
    v_exp_f32 v74, v74
    v_mfma_f32_16x16x32_bf16 a[116:119], a[184:187], v[100:103], a[116:119]
    v_exp_f32 v75, v75
    v_mfma_f32_16x16x32_bf16 a[116:119], a[188:191], v[116:119], a[116:119]
    v_cvt_pk_bf16_f32 v149, v74, v75
    v_mfma_f32_16x16x32_bf16 a[120:123], a[184:187], v[104:107], a[120:123]
    v_exp_f32 v76, v76
    v_mfma_f32_16x16x32_bf16 a[120:123], a[188:191], v[120:123], a[120:123]
    v_exp_f32 v77, v77
    v_mfma_f32_16x16x32_bf16 a[124:127], a[184:187], v[108:111], a[124:127]
    v_cvt_pk_bf16_f32 v150, v76, v77
    v_mfma_f32_16x16x32_bf16 a[124:127], a[188:191], v[124:127], a[124:127]
    v_exp_f32 v78, v78
    v_mfma_f32_16x16x32_bf16 a[200:203], a[208:211], v[104:107], a[200:203]
    v_exp_f32 v79, v79
    v_mfma_f32_16x16x32_bf16 a[200:203], a[208:211], v[120:123], a[200:203]
    v_cvt_pk_bf16_f32 v151, v78, v79
    v_mfma_f32_16x16x32_bf16 a[204:207], a[208:211], v[108:111], a[204:207]
    v_exp_f32 v80, v80
    v_mfma_f32_16x16x32_bf16 a[204:207], a[208:211], v[124:127], a[204:207]
    v_exp_f32 v81, v81
    s_waitcnt lgkmcnt(0)
    v_mfma_f32_16x16x32_bf16 v[32:35], a[128:131], v[160:163], v[224:227]
    ds_read_b64_tr_b16 a[160:161], v12 offset:16384
    v_cvt_pk_bf16_f32 v152, v80, v81
    v_mfma_f32_16x16x32_bf16 v[32:35], a[132:135], v[164:167], v[32:35]
    v_exp_f32 v82, v82
    v_mfma_f32_16x16x32_bf16 v[32:35], a[136:139], v[168:171], v[32:35]
    ds_read_b64_tr_b16 a[162:163], v12 offset:20480
    ds_read_b64_tr_b16 a[164:165], v12 offset:24576
    v_mfma_f32_16x16x32_bf16 v[32:35], a[140:143], v[172:175], v[32:35]
    v_exp_f32 v83, v83
    v_mfma_f32_16x16x32_bf16 v[40:43], a[128:131], v[176:179], v[228:231]
    ds_read_b64_tr_b16 a[166:167], v12 offset:28672
    v_cvt_pk_bf16_f32 v153, v82, v83
    v_mfma_f32_16x16x32_bf16 v[40:43], a[132:135], v[180:183], v[40:43]
    v_exp_f32 v84, v84
    v_mfma_f32_16x16x32_bf16 v[40:43], a[136:139], v[184:187], v[40:43]
    ds_read_b64_tr_b16 a[168:169], v13 offset:16384
    ds_read_b64_tr_b16 a[170:171], v13 offset:20480
    v_mfma_f32_16x16x32_bf16 v[40:43], a[140:143], v[188:191], v[40:43]
    v_exp_f32 v85, v85
    v_mfma_f32_16x16x32_bf16 v[48:51], a[128:131], v[192:195], v[232:235]
    ds_read_b64_tr_b16 a[172:173], v13 offset:24576
    v_cvt_pk_bf16_f32 v154, v84, v85
    v_mfma_f32_16x16x32_bf16 v[48:51], a[132:135], v[196:199], v[48:51]
    v_exp_f32 v86, v86
    v_mfma_f32_16x16x32_bf16 v[48:51], a[136:139], v[200:203], v[48:51]
    ds_read_b64_tr_b16 a[174:175], v13 offset:28672
    ds_read_b64_tr_b16 a[176:177], v14 offset:16384
    v_mfma_f32_16x16x32_bf16 v[48:51], a[140:143], v[204:207], v[48:51]
    v_exp_f32 v87, v87
    v_mfma_f32_16x16x32_bf16 v[56:59], a[128:131], v[208:211], v[236:239]
    ds_read_b64_tr_b16 a[178:179], v14 offset:20480
    v_cvt_pk_bf16_f32 v155, v86, v87
    v_mfma_f32_16x16x32_bf16 v[56:59], a[132:135], v[212:215], v[56:59]
    v_exp_f32 v88, v88
    v_mfma_f32_16x16x32_bf16 v[56:59], a[136:139], v[216:219], v[56:59]
    ds_read_b64_tr_b16 a[180:181], v14 offset:24576
    ds_read_b64_tr_b16 a[182:183], v14 offset:28672
    v_mfma_f32_16x16x32_bf16 v[56:59], a[140:143], v[220:223], v[56:59]
    v_exp_f32 v89, v89
    v_mfma_f32_16x16x32_bf16 v[36:39], a[144:147], v[160:163], v[224:227]
    ds_read_b64_tr_b16 a[184:185], v15 offset:16384
    v_cvt_pk_bf16_f32 v156, v88, v89
    v_mfma_f32_16x16x32_bf16 v[36:39], a[148:151], v[164:167], v[36:39]
    v_exp_f32 v90, v90
    v_mfma_f32_16x16x32_bf16 v[36:39], a[152:155], v[168:171], v[36:39]
    ds_read_b64_tr_b16 a[186:187], v15 offset:20480
    ds_read_b64_tr_b16 a[188:189], v15 offset:24576
    v_mfma_f32_16x16x32_bf16 v[36:39], a[156:159], v[172:175], v[36:39]
    v_exp_f32 v91, v91
    v_mfma_f32_16x16x32_bf16 v[44:47], a[144:147], v[176:179], v[228:231]
    ds_read_b64_tr_b16 a[190:191], v15 offset:28672
    v_cvt_pk_bf16_f32 v157, v90, v91
    v_mfma_f32_16x16x32_bf16 v[44:47], a[148:151], v[180:183], v[44:47]
    v_exp_f32 v92, v92
    v_mfma_f32_16x16x32_bf16 v[44:47], a[152:155], v[184:187], v[44:47]
    v_exp_f32 v93, v93
    v_mfma_f32_16x16x32_bf16 v[44:47], a[156:159], v[188:191], v[44:47]
    v_cvt_pk_bf16_f32 v158, v92, v93
    v_mfma_f32_16x16x32_bf16 v[52:55], a[144:147], v[192:195], v[232:235]
    v_exp_f32 v94, v94
    v_mfma_f32_16x16x32_bf16 v[52:55], a[148:151], v[196:199], v[52:55]
    v_exp_f32 v95, v95
    v_mfma_f32_16x16x32_bf16 v[52:55], a[152:155], v[200:203], v[52:55]
    s_add_u32 s44, s44, 16384
    v_mfma_f32_16x16x32_bf16 v[52:55], a[156:159], v[204:207], v[52:55]
    v_mfma_f32_16x16x32_bf16 v[60:63], a[144:147], v[208:211], v[236:239]
    v_mfma_f32_16x16x32_bf16 v[60:63], a[148:151], v[212:215], v[60:63]
    v_mfma_f32_16x16x32_bf16 v[60:63], a[152:155], v[216:219], v[60:63]
    v_mfma_f32_16x16x32_bf16 v[60:63], a[156:159], v[220:223], v[60:63]
    s_waitcnt lgkmcnt(0)
    v_mfma_f32_16x16x32_bf16 a[0:3], a[160:163], v[128:131], a[0:3]
    ds_read_b128 a[128:131], v8 offset:8192
    v_cvt_pk_bf16_f32 v159, v94, v95
    v_mfma_f32_16x16x32_bf16 a[0:3], a[164:167], v[144:147], a[0:3]
    v_exp_f32 v32, v32
    v_mfma_f32_16x16x32_bf16 a[4:7], a[160:163], v[132:135], a[4:7]
    ds_read_b128 a[132:135], v9 offset:8192
    v_mfma_f32_16x16x32_bf16 a[4:7], a[164:167], v[148:151], a[4:7]
    v_exp_f32 v33, v33
    v_mfma_f32_16x16x32_bf16 a[8:11], a[160:163], v[136:139], a[8:11]
    v_cvt_pk_bf16_f32 v96, v32, v33
    v_mfma_f32_16x16x32_bf16 a[8:11], a[164:167], v[152:155], a[8:11]
    v_exp_f32 v34, v34
    v_mfma_f32_16x16x32_bf16 a[12:15], a[160:163], v[140:143], a[12:15]
    s_mov_b32 m0, s38
    ds_read_b128 a[136:139], v10 offset:8192
    ds_read_b128 a[140:143], v11 offset:8192
    v_mfma_f32_16x16x32_bf16 a[12:15], a[164:167], v[156:159], a[12:15]
    buffer_load_dwordx4 v24, s[12:15], s45 offen offset:0 nt lds
    v_mfma_f32_16x16x32_bf16 a[16:19], a[168:171], v[128:131], a[16:19]
    v_exp_f32 v35, v35
    v_mfma_f32_16x16x32_bf16 a[16:19], a[172:175], v[144:147], a[16:19]
    v_cvt_pk_bf16_f32 v97, v34, v35
    v_mfma_f32_16x16x32_bf16 a[20:23], a[168:171], v[132:135], a[20:23]
    v_exp_f32 v36, v36
    v_mfma_f32_16x16x32_bf16 a[20:23], a[172:175], v[148:151], a[20:23]
    ds_read_b128 a[144:147], v8 offset:12288
    ds_read_b128 a[148:151], v9 offset:12288
    v_mfma_f32_16x16x32_bf16 a[24:27], a[168:171], v[136:139], a[24:27]
    buffer_load_dwordx4 v25, s[12:15], s45 offen offset:1024 nt lds
    v_mfma_f32_16x16x32_bf16 a[24:27], a[172:175], v[152:155], a[24:27]
    v_exp_f32 v37, v37
    v_mfma_f32_16x16x32_bf16 a[28:31], a[168:171], v[140:143], a[28:31]
    v_cvt_pk_bf16_f32 v98, v36, v37
    v_mfma_f32_16x16x32_bf16 a[28:31], a[172:175], v[156:159], a[28:31]
    v_exp_f32 v38, v38
    v_mfma_f32_16x16x32_bf16 a[32:35], a[176:179], v[128:131], a[32:35]
    ds_read_b128 a[152:155], v10 offset:12288
    ds_read_b128 a[156:159], v11 offset:12288
    v_mfma_f32_16x16x32_bf16 a[32:35], a[180:183], v[144:147], a[32:35]
    buffer_load_dwordx4 v24, s[12:15], s45 offen offset:2048 nt lds
    v_mfma_f32_16x16x32_bf16 a[36:39], a[176:179], v[132:135], a[36:39]
    v_exp_f32 v39, v39
    v_mfma_f32_16x16x32_bf16 a[36:39], a[180:183], v[148:151], a[36:39]
    v_cvt_pk_bf16_f32 v99, v38, v39
    v_mfma_f32_16x16x32_bf16 a[40:43], a[176:179], v[136:139], a[40:43]
    v_exp_f32 v40, v40
    v_mfma_f32_16x16x32_bf16 a[40:43], a[180:183], v[152:155], a[40:43]
    v_mfma_f32_16x16x32_bf16 a[44:47], a[176:179], v[140:143], a[44:47]
    buffer_load_dwordx4 v25, s[12:15], s45 offen offset:3072 nt lds
    v_mfma_f32_16x16x32_bf16 a[44:47], a[180:183], v[156:159], a[44:47]
    v_exp_f32 v41, v41
    v_mfma_f32_16x16x32_bf16 a[48:51], a[184:187], v[128:131], a[48:51]
    v_cvt_pk_bf16_f32 v100, v40, v41
    v_mfma_f32_16x16x32_bf16 a[48:51], a[188:191], v[144:147], a[48:51]
    v_exp_f32 v42, v42
    v_mfma_f32_16x16x32_bf16 a[52:55], a[184:187], v[132:135], a[52:55]
    v_exp_f32 v43, v43
    v_mfma_f32_16x16x32_bf16 a[52:55], a[188:191], v[148:151], a[52:55]
    v_cvt_pk_bf16_f32 v101, v42, v43
    v_mfma_f32_16x16x32_bf16 a[56:59], a[184:187], v[136:139], a[56:59]
    v_exp_f32 v44, v44
    v_mfma_f32_16x16x32_bf16 a[56:59], a[188:191], v[152:155], a[56:59]
    v_exp_f32 v45, v45
    v_mfma_f32_16x16x32_bf16 a[60:63], a[184:187], v[140:143], a[60:63]
    v_cvt_pk_bf16_f32 v102, v44, v45
    v_mfma_f32_16x16x32_bf16 a[60:63], a[188:191], v[156:159], a[60:63]
    v_exp_f32 v46, v46
    v_mfma_f32_16x16x32_bf16 a[192:195], a[208:211], v[128:131], a[192:195]
    v_exp_f32 v47, v47
    v_mfma_f32_16x16x32_bf16 a[192:195], a[208:211], v[144:147], a[192:195]
    v_cvt_pk_bf16_f32 v103, v46, v47
    v_mfma_f32_16x16x32_bf16 a[196:199], a[208:211], v[132:135], a[196:199]
    v_exp_f32 v48, v48
    v_mfma_f32_16x16x32_bf16 a[196:199], a[208:211], v[148:151], a[196:199]
    v_exp_f32 v49, v49
    s_waitcnt lgkmcnt(0)
    v_mfma_f32_16x16x32_bf16 v[64:67], a[128:131], v[160:163], v[224:227]
    ds_read_b64_tr_b16 a[160:161], v16 offset:16384
    v_cvt_pk_bf16_f32 v104, v48, v49
    v_mfma_f32_16x16x32_bf16 v[64:67], a[132:135], v[164:167], v[64:67]
    v_exp_f32 v50, v50
    v_mfma_f32_16x16x32_bf16 v[64:67], a[136:139], v[168:171], v[64:67]
    ds_read_b64_tr_b16 a[162:163], v16 offset:20480
    ds_read_b64_tr_b16 a[164:165], v16 offset:24576
    v_mfma_f32_16x16x32_bf16 v[64:67], a[140:143], v[172:175], v[64:67]
    v_exp_f32 v51, v51
    v_mfma_f32_16x16x32_bf16 v[72:75], a[128:131], v[176:179], v[228:231]
    ds_read_b64_tr_b16 a[166:167], v16 offset:28672
    v_cvt_pk_bf16_f32 v105, v50, v51
    v_mfma_f32_16x16x32_bf16 v[72:75], a[132:135], v[180:183], v[72:75]
    v_exp_f32 v52, v52
    v_mfma_f32_16x16x32_bf16 v[72:75], a[136:139], v[184:187], v[72:75]
    ds_read_b64_tr_b16 a[168:169], v17 offset:16384
    ds_read_b64_tr_b16 a[170:171], v17 offset:20480
    v_mfma_f32_16x16x32_bf16 v[72:75], a[140:143], v[188:191], v[72:75]
    v_exp_f32 v53, v53
    v_mfma_f32_16x16x32_bf16 v[80:83], a[128:131], v[192:195], v[232:235]
    ds_read_b64_tr_b16 a[172:173], v17 offset:24576
    v_cvt_pk_bf16_f32 v106, v52, v53
    v_mfma_f32_16x16x32_bf16 v[80:83], a[132:135], v[196:199], v[80:83]
    v_exp_f32 v54, v54
    v_mfma_f32_16x16x32_bf16 v[80:83], a[136:139], v[200:203], v[80:83]
    ds_read_b64_tr_b16 a[174:175], v17 offset:28672
    ds_read_b64_tr_b16 a[176:177], v18 offset:16384
    v_mfma_f32_16x16x32_bf16 v[80:83], a[140:143], v[204:207], v[80:83]
    v_exp_f32 v55, v55
    v_mfma_f32_16x16x32_bf16 v[88:91], a[128:131], v[208:211], v[236:239]
    ds_read_b64_tr_b16 a[178:179], v18 offset:20480
    v_cvt_pk_bf16_f32 v107, v54, v55
    v_mfma_f32_16x16x32_bf16 v[88:91], a[132:135], v[212:215], v[88:91]
    v_exp_f32 v56, v56
    v_mfma_f32_16x16x32_bf16 v[88:91], a[136:139], v[216:219], v[88:91]
    ds_read_b64_tr_b16 a[180:181], v18 offset:24576
    ds_read_b64_tr_b16 a[182:183], v18 offset:28672
    v_mfma_f32_16x16x32_bf16 v[88:91], a[140:143], v[220:223], v[88:91]
    v_exp_f32 v57, v57
    v_mfma_f32_16x16x32_bf16 v[68:71], a[144:147], v[160:163], v[224:227]
    ds_read_b64_tr_b16 a[184:185], v19 offset:16384
    v_cvt_pk_bf16_f32 v108, v56, v57
    v_mfma_f32_16x16x32_bf16 v[68:71], a[148:151], v[164:167], v[68:71]
    v_exp_f32 v58, v58
    v_mfma_f32_16x16x32_bf16 v[68:71], a[152:155], v[168:171], v[68:71]
    ds_read_b64_tr_b16 a[186:187], v19 offset:20480
    ds_read_b64_tr_b16 a[188:189], v19 offset:24576
    v_mfma_f32_16x16x32_bf16 v[68:71], a[156:159], v[172:175], v[68:71]
    v_exp_f32 v59, v59
    v_mfma_f32_16x16x32_bf16 v[76:79], a[144:147], v[176:179], v[228:231]
    ds_read_b64_tr_b16 a[190:191], v19 offset:28672
    v_cvt_pk_bf16_f32 v109, v58, v59
    v_mfma_f32_16x16x32_bf16 v[76:79], a[148:151], v[180:183], v[76:79]
    v_exp_f32 v60, v60
    v_mfma_f32_16x16x32_bf16 v[76:79], a[152:155], v[184:187], v[76:79]
    v_exp_f32 v61, v61
    v_mfma_f32_16x16x32_bf16 v[76:79], a[156:159], v[188:191], v[76:79]
    v_cvt_pk_bf16_f32 v110, v60, v61
    v_mfma_f32_16x16x32_bf16 v[84:87], a[144:147], v[192:195], v[232:235]
    v_exp_f32 v62, v62
    v_mfma_f32_16x16x32_bf16 v[84:87], a[148:151], v[196:199], v[84:87]
    v_exp_f32 v63, v63
    v_mfma_f32_16x16x32_bf16 v[84:87], a[152:155], v[200:203], v[84:87]
    s_add_u32 s45, s45, 16384
    v_mfma_f32_16x16x32_bf16 v[84:87], a[156:159], v[204:207], v[84:87]
    v_mfma_f32_16x16x32_bf16 v[92:95], a[144:147], v[208:211], v[236:239]
    v_mfma_f32_16x16x32_bf16 v[92:95], a[148:151], v[212:215], v[92:95]
    v_mfma_f32_16x16x32_bf16 v[92:95], a[152:155], v[216:219], v[92:95]
    v_mfma_f32_16x16x32_bf16 v[92:95], a[156:159], v[220:223], v[92:95]
    s_cmp_eq_u32 s50, s93
    s_cbranch_scc1 L_tail
    s_waitcnt vmcnt(16) lgkmcnt(0)
    s_barrier
    v_mfma_f32_16x16x32_bf16 a[64:67], a[160:163], v[128:131], a[64:67]
    ds_read_b128 a[128:131], v8 offset:16384
    v_cvt_pk_bf16_f32 v111, v62, v63
    v_mfma_f32_16x16x32_bf16 a[64:67], a[164:167], v[144:147], a[64:67]
    v_exp_f32 v64, v64
    v_mfma_f32_16x16x32_bf16 a[68:71], a[160:163], v[132:135], a[68:71]
    ds_read_b128 a[132:135], v9 offset:16384
    v_mfma_f32_16x16x32_bf16 a[68:71], a[164:167], v[148:151], a[68:71]
    v_exp_f32 v65, v65
    v_mfma_f32_16x16x32_bf16 a[72:75], a[160:163], v[136:139], a[72:75]
    v_cvt_pk_bf16_f32 v112, v64, v65
    v_mfma_f32_16x16x32_bf16 a[72:75], a[164:167], v[152:155], a[72:75]
    v_exp_f32 v66, v66
    v_mfma_f32_16x16x32_bf16 a[76:79], a[160:163], v[140:143], a[76:79]
    s_mov_b32 m0, s32
    ds_read_b128 a[136:139], v10 offset:16384
    ds_read_b128 a[140:143], v11 offset:16384
    v_mfma_f32_16x16x32_bf16 a[76:79], a[164:167], v[156:159], a[76:79]
    buffer_load_dwordx4 v20, s[8:11], s44 offen offset:0 nt lds
    v_mfma_f32_16x16x32_bf16 a[80:83], a[168:171], v[128:131], a[80:83]
    v_exp_f32 v67, v67
    v_mfma_f32_16x16x32_bf16 a[80:83], a[172:175], v[144:147], a[80:83]
    v_cvt_pk_bf16_f32 v113, v66, v67
    v_mfma_f32_16x16x32_bf16 a[84:87], a[168:171], v[132:135], a[84:87]
    v_exp_f32 v68, v68
    v_mfma_f32_16x16x32_bf16 a[84:87], a[172:175], v[148:151], a[84:87]
    ds_read_b128 a[144:147], v8 offset:20480
    ds_read_b128 a[148:151], v9 offset:20480
    v_mfma_f32_16x16x32_bf16 a[88:91], a[168:171], v[136:139], a[88:91]
    buffer_load_dwordx4 v21, s[8:11], s44 offen offset:1024 nt lds
    v_mfma_f32_16x16x32_bf16 a[88:91], a[172:175], v[152:155], a[88:91]
    v_exp_f32 v69, v69
    v_mfma_f32_16x16x32_bf16 a[92:95], a[168:171], v[140:143], a[92:95]
    v_cvt_pk_bf16_f32 v114, v68, v69
    v_mfma_f32_16x16x32_bf16 a[92:95], a[172:175], v[156:159], a[92:95]
    v_exp_f32 v70, v70
    v_mfma_f32_16x16x32_bf16 a[96:99], a[176:179], v[128:131], a[96:99]
    ds_read_b128 a[152:155], v10 offset:20480
    ds_read_b128 a[156:159], v11 offset:20480
    v_mfma_f32_16x16x32_bf16 a[96:99], a[180:183], v[144:147], a[96:99]
    buffer_load_dwordx4 v22, s[8:11], s44 offen offset:2048 nt lds
    v_mfma_f32_16x16x32_bf16 a[100:103], a[176:179], v[132:135], a[100:103]
    v_exp_f32 v71, v71
    v_mfma_f32_16x16x32_bf16 a[100:103], a[180:183], v[148:151], a[100:103]
    v_cvt_pk_bf16_f32 v115, v70, v71
    v_mfma_f32_16x16x32_bf16 a[104:107], a[176:179], v[136:139], a[104:107]
    v_exp_f32 v72, v72
    v_mfma_f32_16x16x32_bf16 a[104:107], a[180:183], v[152:155], a[104:107]
    v_mfma_f32_16x16x32_bf16 a[108:111], a[176:179], v[140:143], a[108:111]
    buffer_load_dwordx4 v23, s[8:11], s44 offen offset:3072 nt lds
    v_mfma_f32_16x16x32_bf16 a[108:111], a[180:183], v[156:159], a[108:111]
    v_exp_f32 v73, v73
    v_mfma_f32_16x16x32_bf16 a[112:115], a[184:187], v[128:131], a[112:115]
    v_cvt_pk_bf16_f32 v116, v72, v73
    v_mfma_f32_16x16x32_bf16 a[112:115], a[188:191], v[144:147], a[112:115]
    v_exp_f32 v74, v74
    v_mfma_f32_16x16x32_bf16 a[116:119], a[184:187], v[132:135], a[116:119]
    v_exp_f32 v75, v75
    v_mfma_f32_16x16x32_bf16 a[116:119], a[188:191], v[148:151], a[116:119]
    v_cvt_pk_bf16_f32 v117, v74, v75
    v_mfma_f32_16x16x32_bf16 a[120:123], a[184:187], v[136:139], a[120:123]
    v_exp_f32 v76, v76
    v_mfma_f32_16x16x32_bf16 a[120:123], a[188:191], v[152:155], a[120:123]
    v_exp_f32 v77, v77
    v_mfma_f32_16x16x32_bf16 a[124:127], a[184:187], v[140:143], a[124:127]
    v_cvt_pk_bf16_f32 v118, v76, v77
    v_mfma_f32_16x16x32_bf16 a[124:127], a[188:191], v[156:159], a[124:127]
    v_exp_f32 v78, v78
    v_mfma_f32_16x16x32_bf16 a[200:203], a[208:211], v[136:139], a[200:203]
    v_exp_f32 v79, v79
    v_mfma_f32_16x16x32_bf16 a[200:203], a[208:211], v[152:155], a[200:203]
    v_cvt_pk_bf16_f32 v119, v78, v79
    v_mfma_f32_16x16x32_bf16 a[204:207], a[208:211], v[140:143], a[204:207]
    v_exp_f32 v80, v80
    v_mfma_f32_16x16x32_bf16 a[204:207], a[208:211], v[156:159], a[204:207]
    v_exp_f32 v81, v81
    s_waitcnt lgkmcnt(0)
    v_mfma_f32_16x16x32_bf16 v[32:35], a[128:131], v[160:163], v[224:227]
    ds_read_b64_tr_b16 a[160:161], v12 offset:32768
    v_cvt_pk_bf16_f32 v120, v80, v81
    v_mfma_f32_16x16x32_bf16 v[32:35], a[132:135], v[164:167], v[32:35]
    v_exp_f32 v82, v82
    v_mfma_f32_16x16x32_bf16 v[32:35], a[136:139], v[168:171], v[32:35]
    ds_read_b64_tr_b16 a[162:163], v12 offset:36864
    ds_read_b64_tr_b16 a[164:165], v12 offset:40960
    v_mfma_f32_16x16x32_bf16 v[32:35], a[140:143], v[172:175], v[32:35]
    v_exp_f32 v83, v83
    v_mfma_f32_16x16x32_bf16 v[40:43], a[128:131], v[176:179], v[228:231]
    ds_read_b64_tr_b16 a[166:167], v12 offset:45056
    v_cvt_pk_bf16_f32 v121, v82, v83
    v_mfma_f32_16x16x32_bf16 v[40:43], a[132:135], v[180:183], v[40:43]
    v_exp_f32 v84, v84
    v_mfma_f32_16x16x32_bf16 v[40:43], a[136:139], v[184:187], v[40:43]
    ds_read_b64_tr_b16 a[168:169], v13 offset:32768
    ds_read_b64_tr_b16 a[170:171], v13 offset:36864
    v_mfma_f32_16x16x32_bf16 v[40:43], a[140:143], v[188:191], v[40:43]
    v_exp_f32 v85, v85
    v_mfma_f32_16x16x32_bf16 v[48:51], a[128:131], v[192:195], v[232:235]
    ds_read_b64_tr_b16 a[172:173], v13 offset:40960
    v_cvt_pk_bf16_f32 v122, v84, v85
    v_mfma_f32_16x16x32_bf16 v[48:51], a[132:135], v[196:199], v[48:51]
    v_exp_f32 v86, v86
    v_mfma_f32_16x16x32_bf16 v[48:51], a[136:139], v[200:203], v[48:51]
    ds_read_b64_tr_b16 a[174:175], v13 offset:45056
    ds_read_b64_tr_b16 a[176:177], v14 offset:32768
    v_mfma_f32_16x16x32_bf16 v[48:51], a[140:143], v[204:207], v[48:51]
    v_exp_f32 v87, v87
    v_mfma_f32_16x16x32_bf16 v[56:59], a[128:131], v[208:211], v[236:239]
    ds_read_b64_tr_b16 a[178:179], v14 offset:36864
    v_cvt_pk_bf16_f32 v123, v86, v87
    v_mfma_f32_16x16x32_bf16 v[56:59], a[132:135], v[212:215], v[56:59]
    v_exp_f32 v88, v88
    v_mfma_f32_16x16x32_bf16 v[56:59], a[136:139], v[216:219], v[56:59]
    ds_read_b64_tr_b16 a[180:181], v14 offset:40960
    ds_read_b64_tr_b16 a[182:183], v14 offset:45056
    v_mfma_f32_16x16x32_bf16 v[56:59], a[140:143], v[220:223], v[56:59]
    v_exp_f32 v89, v89
    v_mfma_f32_16x16x32_bf16 v[36:39], a[144:147], v[160:163], v[224:227]
    ds_read_b64_tr_b16 a[184:185], v15 offset:32768
    v_cvt_pk_bf16_f32 v124, v88, v89
    v_mfma_f32_16x16x32_bf16 v[36:39], a[148:151], v[164:167], v[36:39]
    v_exp_f32 v90, v90
    v_mfma_f32_16x16x32_bf16 v[36:39], a[152:155], v[168:171], v[36:39]
    ds_read_b64_tr_b16 a[186:187], v15 offset:36864
    ds_read_b64_tr_b16 a[188:189], v15 offset:40960
    v_mfma_f32_16x16x32_bf16 v[36:39], a[156:159], v[172:175], v[36:39]
    v_exp_f32 v91, v91
    v_mfma_f32_16x16x32_bf16 v[44:47], a[144:147], v[176:179], v[228:231]
    ds_read_b64_tr_b16 a[190:191], v15 offset:45056
    v_cvt_pk_bf16_f32 v125, v90, v91
    v_mfma_f32_16x16x32_bf16 v[44:47], a[148:151], v[180:183], v[44:47]
    v_exp_f32 v92, v92
    v_mfma_f32_16x16x32_bf16 v[44:47], a[152:155], v[184:187], v[44:47]
    v_exp_f32 v93, v93
    v_mfma_f32_16x16x32_bf16 v[44:47], a[156:159], v[188:191], v[44:47]
    v_cvt_pk_bf16_f32 v126, v92, v93
    v_mfma_f32_16x16x32_bf16 v[52:55], a[144:147], v[192:195], v[232:235]
    v_exp_f32 v94, v94
    v_mfma_f32_16x16x32_bf16 v[52:55], a[148:151], v[196:199], v[52:55]
    v_exp_f32 v95, v95
    v_mfma_f32_16x16x32_bf16 v[52:55], a[152:155], v[200:203], v[52:55]
    s_add_u32 s44, s44, 16384
    v_mfma_f32_16x16x32_bf16 v[52:55], a[156:159], v[204:207], v[52:55]
    v_mfma_f32_16x16x32_bf16 v[60:63], a[144:147], v[208:211], v[236:239]
    v_mfma_f32_16x16x32_bf16 v[60:63], a[148:151], v[212:215], v[60:63]
    v_mfma_f32_16x16x32_bf16 v[60:63], a[152:155], v[216:219], v[60:63]
    v_mfma_f32_16x16x32_bf16 v[60:63], a[156:159], v[220:223], v[60:63]
    s_waitcnt lgkmcnt(0)
    v_mfma_f32_16x16x32_bf16 a[0:3], a[160:163], v[96:99], a[0:3]
    ds_read_b128 a[128:131], v8 offset:24576
    v_cvt_pk_bf16_f32 v127, v94, v95
    v_mfma_f32_16x16x32_bf16 a[0:3], a[164:167], v[112:115], a[0:3]
    v_exp_f32 v32, v32
    v_mfma_f32_16x16x32_bf16 a[4:7], a[160:163], v[100:103], a[4:7]
    ds_read_b128 a[132:135], v9 offset:24576
    v_mfma_f32_16x16x32_bf16 a[4:7], a[164:167], v[116:119], a[4:7]
    v_exp_f32 v33, v33
    v_mfma_f32_16x16x32_bf16 a[8:11], a[160:163], v[104:107], a[8:11]
    v_cvt_pk_bf16_f32 v128, v32, v33
    v_mfma_f32_16x16x32_bf16 a[8:11], a[164:167], v[120:123], a[8:11]
    v_exp_f32 v34, v34
    v_mfma_f32_16x16x32_bf16 a[12:15], a[160:163], v[108:111], a[12:15]
    s_mov_b32 m0, s39
    ds_read_b128 a[136:139], v10 offset:24576
    ds_read_b128 a[140:143], v11 offset:24576
    v_mfma_f32_16x16x32_bf16 a[12:15], a[164:167], v[124:127], a[12:15]
    buffer_load_dwordx4 v24, s[12:15], s45 offen offset:0 nt lds
    v_mfma_f32_16x16x32_bf16 a[16:19], a[168:171], v[96:99], a[16:19]
    v_exp_f32 v35, v35
    v_mfma_f32_16x16x32_bf16 a[16:19], a[172:175], v[112:115], a[16:19]
    v_cvt_pk_bf16_f32 v129, v34, v35
    v_mfma_f32_16x16x32_bf16 a[20:23], a[168:171], v[100:103], a[20:23]
    v_exp_f32 v36, v36
    v_mfma_f32_16x16x32_bf16 a[20:23], a[172:175], v[116:119], a[20:23]
    ds_read_b128 a[144:147], v8 offset:28672
    ds_read_b128 a[148:151], v9 offset:28672
    v_mfma_f32_16x16x32_bf16 a[24:27], a[168:171], v[104:107], a[24:27]
    buffer_load_dwordx4 v25, s[12:15], s45 offen offset:1024 nt lds
    v_mfma_f32_16x16x32_bf16 a[24:27], a[172:175], v[120:123], a[24:27]
    v_exp_f32 v37, v37
    v_mfma_f32_16x16x32_bf16 a[28:31], a[168:171], v[108:111], a[28:31]
    v_cvt_pk_bf16_f32 v130, v36, v37
    v_mfma_f32_16x16x32_bf16 a[28:31], a[172:175], v[124:127], a[28:31]
    v_exp_f32 v38, v38
    v_mfma_f32_16x16x32_bf16 a[32:35], a[176:179], v[96:99], a[32:35]
    ds_read_b128 a[152:155], v10 offset:28672
    ds_read_b128 a[156:159], v11 offset:28672
    v_mfma_f32_16x16x32_bf16 a[32:35], a[180:183], v[112:115], a[32:35]
    buffer_load_dwordx4 v24, s[12:15], s45 offen offset:2048 nt lds
    v_mfma_f32_16x16x32_bf16 a[36:39], a[176:179], v[100:103], a[36:39]
    v_exp_f32 v39, v39
    v_mfma_f32_16x16x32_bf16 a[36:39], a[180:183], v[116:119], a[36:39]
    v_cvt_pk_bf16_f32 v131, v38, v39
    v_mfma_f32_16x16x32_bf16 a[40:43], a[176:179], v[104:107], a[40:43]
    v_exp_f32 v40, v40
    v_mfma_f32_16x16x32_bf16 a[40:43], a[180:183], v[120:123], a[40:43]
    v_mfma_f32_16x16x32_bf16 a[44:47], a[176:179], v[108:111], a[44:47]
    buffer_load_dwordx4 v25, s[12:15], s45 offen offset:3072 nt lds
    v_mfma_f32_16x16x32_bf16 a[44:47], a[180:183], v[124:127], a[44:47]
    v_exp_f32 v41, v41
    v_mfma_f32_16x16x32_bf16 a[48:51], a[184:187], v[96:99], a[48:51]
    v_cvt_pk_bf16_f32 v132, v40, v41
    v_mfma_f32_16x16x32_bf16 a[48:51], a[188:191], v[112:115], a[48:51]
    v_exp_f32 v42, v42
    v_mfma_f32_16x16x32_bf16 a[52:55], a[184:187], v[100:103], a[52:55]
    v_exp_f32 v43, v43
    v_mfma_f32_16x16x32_bf16 a[52:55], a[188:191], v[116:119], a[52:55]
    v_cvt_pk_bf16_f32 v133, v42, v43
    v_mfma_f32_16x16x32_bf16 a[56:59], a[184:187], v[104:107], a[56:59]
    v_exp_f32 v44, v44
    v_mfma_f32_16x16x32_bf16 a[56:59], a[188:191], v[120:123], a[56:59]
    v_exp_f32 v45, v45
    v_mfma_f32_16x16x32_bf16 a[60:63], a[184:187], v[108:111], a[60:63]
    v_cvt_pk_bf16_f32 v134, v44, v45
    v_mfma_f32_16x16x32_bf16 a[60:63], a[188:191], v[124:127], a[60:63]
    v_exp_f32 v46, v46
    v_mfma_f32_16x16x32_bf16 a[192:195], a[208:211], v[96:99], a[192:195]
    v_exp_f32 v47, v47
    v_mfma_f32_16x16x32_bf16 a[192:195], a[208:211], v[112:115], a[192:195]
    v_cvt_pk_bf16_f32 v135, v46, v47
    v_mfma_f32_16x16x32_bf16 a[196:199], a[208:211], v[100:103], a[196:199]
    v_exp_f32 v48, v48
    v_mfma_f32_16x16x32_bf16 a[196:199], a[208:211], v[116:119], a[196:199]
    v_exp_f32 v49, v49
    s_waitcnt lgkmcnt(0)
    v_mfma_f32_16x16x32_bf16 v[64:67], a[128:131], v[160:163], v[224:227]
    ds_read_b64_tr_b16 a[160:161], v16 offset:32768
    v_cvt_pk_bf16_f32 v136, v48, v49
    v_mfma_f32_16x16x32_bf16 v[64:67], a[132:135], v[164:167], v[64:67]
    v_exp_f32 v50, v50
    v_mfma_f32_16x16x32_bf16 v[64:67], a[136:139], v[168:171], v[64:67]
    ds_read_b64_tr_b16 a[162:163], v16 offset:36864
    ds_read_b64_tr_b16 a[164:165], v16 offset:40960
    v_mfma_f32_16x16x32_bf16 v[64:67], a[140:143], v[172:175], v[64:67]
    v_exp_f32 v51, v51
    v_mfma_f32_16x16x32_bf16 v[72:75], a[128:131], v[176:179], v[228:231]
    ds_read_b64_tr_b16 a[166:167], v16 offset:45056
    v_cvt_pk_bf16_f32 v137, v50, v51
    v_mfma_f32_16x16x32_bf16 v[72:75], a[132:135], v[180:183], v[72:75]
    v_exp_f32 v52, v52
    v_mfma_f32_16x16x32_bf16 v[72:75], a[136:139], v[184:187], v[72:75]
    ds_read_b64_tr_b16 a[168:169], v17 offset:32768
    ds_read_b64_tr_b16 a[170:171], v17 offset:36864
    v_mfma_f32_16x16x32_bf16 v[72:75], a[140:143], v[188:191], v[72:75]
    v_exp_f32 v53, v53
    v_mfma_f32_16x16x32_bf16 v[80:83], a[128:131], v[192:195], v[232:235]
    ds_read_b64_tr_b16 a[172:173], v17 offset:40960
    v_cvt_pk_bf16_f32 v138, v52, v53
    v_mfma_f32_16x16x32_bf16 v[80:83], a[132:135], v[196:199], v[80:83]
    v_exp_f32 v54, v54
    v_mfma_f32_16x16x32_bf16 v[80:83], a[136:139], v[200:203], v[80:83]
    ds_read_b64_tr_b16 a[174:175], v17 offset:45056
    ds_read_b64_tr_b16 a[176:177], v18 offset:32768
    v_mfma_f32_16x16x32_bf16 v[80:83], a[140:143], v[204:207], v[80:83]
    v_exp_f32 v55, v55
    v_mfma_f32_16x16x32_bf16 v[88:91], a[128:131], v[208:211], v[236:239]
    ds_read_b64_tr_b16 a[178:179], v18 offset:36864
    v_cvt_pk_bf16_f32 v139, v54, v55
    v_mfma_f32_16x16x32_bf16 v[88:91], a[132:135], v[212:215], v[88:91]
    v_exp_f32 v56, v56
    v_mfma_f32_16x16x32_bf16 v[88:91], a[136:139], v[216:219], v[88:91]
    ds_read_b64_tr_b16 a[180:181], v18 offset:40960
    ds_read_b64_tr_b16 a[182:183], v18 offset:45056
    v_mfma_f32_16x16x32_bf16 v[88:91], a[140:143], v[220:223], v[88:91]
    v_exp_f32 v57, v57
    v_mfma_f32_16x16x32_bf16 v[68:71], a[144:147], v[160:163], v[224:227]
    ds_read_b64_tr_b16 a[184:185], v19 offset:32768
    v_cvt_pk_bf16_f32 v140, v56, v57
    v_mfma_f32_16x16x32_bf16 v[68:71], a[148:151], v[164:167], v[68:71]
    v_exp_f32 v58, v58
    v_mfma_f32_16x16x32_bf16 v[68:71], a[152:155], v[168:171], v[68:71]
    ds_read_b64_tr_b16 a[186:187], v19 offset:36864
    ds_read_b64_tr_b16 a[188:189], v19 offset:40960
    v_mfma_f32_16x16x32_bf16 v[68:71], a[156:159], v[172:175], v[68:71]
    v_exp_f32 v59, v59
    v_mfma_f32_16x16x32_bf16 v[76:79], a[144:147], v[176:179], v[228:231]
    ds_read_b64_tr_b16 a[190:191], v19 offset:45056
    v_cvt_pk_bf16_f32 v141, v58, v59
    v_mfma_f32_16x16x32_bf16 v[76:79], a[148:151], v[180:183], v[76:79]
    v_exp_f32 v60, v60
    v_mfma_f32_16x16x32_bf16 v[76:79], a[152:155], v[184:187], v[76:79]
    v_exp_f32 v61, v61
    v_mfma_f32_16x16x32_bf16 v[76:79], a[156:159], v[188:191], v[76:79]
    v_cvt_pk_bf16_f32 v142, v60, v61
    v_mfma_f32_16x16x32_bf16 v[84:87], a[144:147], v[192:195], v[232:235]
    v_exp_f32 v62, v62
    v_mfma_f32_16x16x32_bf16 v[84:87], a[148:151], v[196:199], v[84:87]
    v_exp_f32 v63, v63
    v_mfma_f32_16x16x32_bf16 v[84:87], a[152:155], v[200:203], v[84:87]
    s_add_u32 s45, s45, 16384
    v_mfma_f32_16x16x32_bf16 v[84:87], a[156:159], v[204:207], v[84:87]
    v_mfma_f32_16x16x32_bf16 v[92:95], a[144:147], v[208:211], v[236:239]
    v_mfma_f32_16x16x32_bf16 v[92:95], a[148:151], v[212:215], v[92:95]
    v_mfma_f32_16x16x32_bf16 v[92:95], a[152:155], v[216:219], v[92:95]
    v_mfma_f32_16x16x32_bf16 v[92:95], a[156:159], v[220:223], v[92:95]
    s_waitcnt vmcnt(16) lgkmcnt(0)
    s_barrier
    v_mfma_f32_16x16x32_bf16 a[64:67], a[160:163], v[96:99], a[64:67]
    ds_read_b128 a[128:131], v8 offset:32768
    v_cvt_pk_bf16_f32 v143, v62, v63
    v_mfma_f32_16x16x32_bf16 a[64:67], a[164:167], v[112:115], a[64:67]
    v_exp_f32 v64, v64
    v_mfma_f32_16x16x32_bf16 a[68:71], a[160:163], v[100:103], a[68:71]
    ds_read_b128 a[132:135], v9 offset:32768
    v_mfma_f32_16x16x32_bf16 a[68:71], a[164:167], v[116:119], a[68:71]
    v_exp_f32 v65, v65
    v_mfma_f32_16x16x32_bf16 a[72:75], a[160:163], v[104:107], a[72:75]
    v_cvt_pk_bf16_f32 v144, v64, v65
    v_mfma_f32_16x16x32_bf16 a[72:75], a[164:167], v[120:123], a[72:75]
    v_exp_f32 v66, v66
    v_mfma_f32_16x16x32_bf16 a[76:79], a[160:163], v[108:111], a[76:79]
    s_mov_b32 m0, s33
    ds_read_b128 a[136:139], v10 offset:32768
    ds_read_b128 a[140:143], v11 offset:32768
    v_mfma_f32_16x16x32_bf16 a[76:79], a[164:167], v[124:127], a[76:79]
    buffer_load_dwordx4 v20, s[8:11], s44 offen offset:0 nt lds
    v_mfma_f32_16x16x32_bf16 a[80:83], a[168:171], v[96:99], a[80:83]
    v_exp_f32 v67, v67
    v_mfma_f32_16x16x32_bf16 a[80:83], a[172:175], v[112:115], a[80:83]
    v_cvt_pk_bf16_f32 v145, v66, v67
    v_mfma_f32_16x16x32_bf16 a[84:87], a[168:171], v[100:103], a[84:87]
    v_exp_f32 v68, v68
    v_mfma_f32_16x16x32_bf16 a[84:87], a[172:175], v[116:119], a[84:87]
    ds_read_b128 a[144:147], v8 offset:36864
    ds_read_b128 a[148:151], v9 offset:36864
    v_mfma_f32_16x16x32_bf16 a[88:91], a[168:171], v[104:107], a[88:91]
    buffer_load_dwordx4 v21, s[8:11], s44 offen offset:1024 nt lds
    v_mfma_f32_16x16x32_bf16 a[88:91], a[172:175], v[120:123], a[88:91]
    v_exp_f32 v69, v69
    v_mfma_f32_16x16x32_bf16 a[92:95], a[168:171], v[108:111], a[92:95]
    v_cvt_pk_bf16_f32 v146, v68, v69
    v_mfma_f32_16x16x32_bf16 a[92:95], a[172:175], v[124:127], a[92:95]
    v_exp_f32 v70, v70
    v_mfma_f32_16x16x32_bf16 a[96:99], a[176:179], v[96:99], a[96:99]
    ds_read_b128 a[152:155], v10 offset:36864
    ds_read_b128 a[156:159], v11 offset:36864
    v_mfma_f32_16x16x32_bf16 a[96:99], a[180:183], v[112:115], a[96:99]
    buffer_load_dwordx4 v22, s[8:11], s44 offen offset:2048 nt lds
    v_mfma_f32_16x16x32_bf16 a[100:103], a[176:179], v[100:103], a[100:103]
    v_exp_f32 v71, v71
    v_mfma_f32_16x16x32_bf16 a[100:103], a[180:183], v[116:119], a[100:103]
    v_cvt_pk_bf16_f32 v147, v70, v71
    v_mfma_f32_16x16x32_bf16 a[104:107], a[176:179], v[104:107], a[104:107]
    v_exp_f32 v72, v72
    v_mfma_f32_16x16x32_bf16 a[104:107], a[180:183], v[120:123], a[104:107]
    v_mfma_f32_16x16x32_bf16 a[108:111], a[176:179], v[108:111], a[108:111]
    buffer_load_dwordx4 v23, s[8:11], s44 offen offset:3072 nt lds
    v_mfma_f32_16x16x32_bf16 a[108:111], a[180:183], v[124:127], a[108:111]
    v_exp_f32 v73, v73
    v_mfma_f32_16x16x32_bf16 a[112:115], a[184:187], v[96:99], a[112:115]
    v_cvt_pk_bf16_f32 v148, v72, v73
    v_mfma_f32_16x16x32_bf16 a[112:115], a[188:191], v[112:115], a[112:115]
    v_exp_f32 v74, v74
    v_mfma_f32_16x16x32_bf16 a[116:119], a[184:187], v[100:103], a[116:119]
    v_exp_f32 v75, v75
    v_mfma_f32_16x16x32_bf16 a[116:119], a[188:191], v[116:119], a[116:119]
    v_cvt_pk_bf16_f32 v149, v74, v75
    v_mfma_f32_16x16x32_bf16 a[120:123], a[184:187], v[104:107], a[120:123]
    v_exp_f32 v76, v76
    v_mfma_f32_16x16x32_bf16 a[120:123], a[188:191], v[120:123], a[120:123]
    v_exp_f32 v77, v77
    v_mfma_f32_16x16x32_bf16 a[124:127], a[184:187], v[108:111], a[124:127]
    v_cvt_pk_bf16_f32 v150, v76, v77
    v_mfma_f32_16x16x32_bf16 a[124:127], a[188:191], v[124:127], a[124:127]
    v_exp_f32 v78, v78
    v_mfma_f32_16x16x32_bf16 a[200:203], a[208:211], v[104:107], a[200:203]
    v_exp_f32 v79, v79
    v_mfma_f32_16x16x32_bf16 a[200:203], a[208:211], v[120:123], a[200:203]
    v_cvt_pk_bf16_f32 v151, v78, v79
    v_mfma_f32_16x16x32_bf16 a[204:207], a[208:211], v[108:111], a[204:207]
    v_exp_f32 v80, v80
    v_mfma_f32_16x16x32_bf16 a[204:207], a[208:211], v[124:127], a[204:207]
    v_exp_f32 v81, v81
    s_waitcnt lgkmcnt(0)
    v_mfma_f32_16x16x32_bf16 v[32:35], a[128:131], v[160:163], v[224:227]
    ds_read_b64_tr_b16 a[160:161], v12 offset:49152
    v_cvt_pk_bf16_f32 v152, v80, v81
    v_mfma_f32_16x16x32_bf16 v[32:35], a[132:135], v[164:167], v[32:35]
    v_exp_f32 v82, v82
    v_mfma_f32_16x16x32_bf16 v[32:35], a[136:139], v[168:171], v[32:35]
    ds_read_b64_tr_b16 a[162:163], v12 offset:53248
    ds_read_b64_tr_b16 a[164:165], v12 offset:57344
    v_mfma_f32_16x16x32_bf16 v[32:35], a[140:143], v[172:175], v[32:35]
    v_exp_f32 v83, v83
    v_mfma_f32_16x16x32_bf16 v[40:43], a[128:131], v[176:179], v[228:231]
    ds_read_b64_tr_b16 a[166:167], v12 offset:61440
    v_cvt_pk_bf16_f32 v153, v82, v83
    v_mfma_f32_16x16x32_bf16 v[40:43], a[132:135], v[180:183], v[40:43]
    v_exp_f32 v84, v84
    v_mfma_f32_16x16x32_bf16 v[40:43], a[136:139], v[184:187], v[40:43]
    ds_read_b64_tr_b16 a[168:169], v13 offset:49152
    ds_read_b64_tr_b16 a[170:171], v13 offset:53248
    v_mfma_f32_16x16x32_bf16 v[40:43], a[140:143], v[188:191], v[40:43]
    v_exp_f32 v85, v85
    v_mfma_f32_16x16x32_bf16 v[48:51], a[128:131], v[192:195], v[232:235]
    ds_read_b64_tr_b16 a[172:173], v13 offset:57344
    v_cvt_pk_bf16_f32 v154, v84, v85
    v_mfma_f32_16x16x32_bf16 v[48:51], a[132:135], v[196:199], v[48:51]
    v_exp_f32 v86, v86
    v_mfma_f32_16x16x32_bf16 v[48:51], a[136:139], v[200:203], v[48:51]
    ds_read_b64_tr_b16 a[174:175], v13 offset:61440
    ds_read_b64_tr_b16 a[176:177], v14 offset:49152
    v_mfma_f32_16x16x32_bf16 v[48:51], a[140:143], v[204:207], v[48:51]
    v_exp_f32 v87, v87
    v_mfma_f32_16x16x32_bf16 v[56:59], a[128:131], v[208:211], v[236:239]
    ds_read_b64_tr_b16 a[178:179], v14 offset:53248
    v_cvt_pk_bf16_f32 v155, v86, v87
    v_mfma_f32_16x16x32_bf16 v[56:59], a[132:135], v[212:215], v[56:59]
    v_exp_f32 v88, v88
    v_mfma_f32_16x16x32_bf16 v[56:59], a[136:139], v[216:219], v[56:59]
    ds_read_b64_tr_b16 a[180:181], v14 offset:57344
    ds_read_b64_tr_b16 a[182:183], v14 offset:61440
    v_mfma_f32_16x16x32_bf16 v[56:59], a[140:143], v[220:223], v[56:59]
    v_exp_f32 v89, v89
    v_mfma_f32_16x16x32_bf16 v[36:39], a[144:147], v[160:163], v[224:227]
    ds_read_b64_tr_b16 a[184:185], v15 offset:49152
    v_cvt_pk_bf16_f32 v156, v88, v89
    v_mfma_f32_16x16x32_bf16 v[36:39], a[148:151], v[164:167], v[36:39]
    v_exp_f32 v90, v90
    v_mfma_f32_16x16x32_bf16 v[36:39], a[152:155], v[168:171], v[36:39]
    ds_read_b64_tr_b16 a[186:187], v15 offset:53248
    ds_read_b64_tr_b16 a[188:189], v15 offset:57344
    v_mfma_f32_16x16x32_bf16 v[36:39], a[156:159], v[172:175], v[36:39]
    v_exp_f32 v91, v91
    v_mfma_f32_16x16x32_bf16 v[44:47], a[144:147], v[176:179], v[228:231]
    ds_read_b64_tr_b16 a[190:191], v15 offset:61440
    v_cvt_pk_bf16_f32 v157, v90, v91
    v_mfma_f32_16x16x32_bf16 v[44:47], a[148:151], v[180:183], v[44:47]
    v_exp_f32 v92, v92
    v_mfma_f32_16x16x32_bf16 v[44:47], a[152:155], v[184:187], v[44:47]
    v_exp_f32 v93, v93
    v_mfma_f32_16x16x32_bf16 v[44:47], a[156:159], v[188:191], v[44:47]
    v_cvt_pk_bf16_f32 v158, v92, v93
    v_mfma_f32_16x16x32_bf16 v[52:55], a[144:147], v[192:195], v[232:235]
    v_exp_f32 v94, v94
    v_mfma_f32_16x16x32_bf16 v[52:55], a[148:151], v[196:199], v[52:55]
    v_exp_f32 v95, v95
    v_mfma_f32_16x16x32_bf16 v[52:55], a[152:155], v[200:203], v[52:55]
    s_add_u32 s44, s44, 16384
    v_mfma_f32_16x16x32_bf16 v[52:55], a[156:159], v[204:207], v[52:55]
    v_mfma_f32_16x16x32_bf16 v[60:63], a[144:147], v[208:211], v[236:239]
    v_mfma_f32_16x16x32_bf16 v[60:63], a[148:151], v[212:215], v[60:63]
    v_mfma_f32_16x16x32_bf16 v[60:63], a[152:155], v[216:219], v[60:63]
    v_mfma_f32_16x16x32_bf16 v[60:63], a[156:159], v[220:223], v[60:63]
    s_waitcnt lgkmcnt(0)
    v_mfma_f32_16x16x32_bf16 a[0:3], a[160:163], v[128:131], a[0:3]
    ds_read_b128 a[128:131], v8 offset:40960
    v_cvt_pk_bf16_f32 v159, v94, v95
    v_mfma_f32_16x16x32_bf16 a[0:3], a[164:167], v[144:147], a[0:3]
    v_exp_f32 v32, v32
    v_mfma_f32_16x16x32_bf16 a[4:7], a[160:163], v[132:135], a[4:7]
    ds_read_b128 a[132:135], v9 offset:40960
    v_mfma_f32_16x16x32_bf16 a[4:7], a[164:167], v[148:151], a[4:7]
    v_exp_f32 v33, v33
    v_mfma_f32_16x16x32_bf16 a[8:11], a[160:163], v[136:139], a[8:11]
    v_cvt_pk_bf16_f32 v96, v32, v33
    v_mfma_f32_16x16x32_bf16 a[8:11], a[164:167], v[152:155], a[8:11]
    v_exp_f32 v34, v34
    v_mfma_f32_16x16x32_bf16 a[12:15], a[160:163], v[140:143], a[12:15]
    s_mov_b32 m0, s36
    ds_read_b128 a[136:139], v10 offset:40960
    ds_read_b128 a[140:143], v11 offset:40960
    v_mfma_f32_16x16x32_bf16 a[12:15], a[164:167], v[156:159], a[12:15]
    buffer_load_dwordx4 v24, s[12:15], s45 offen offset:0 nt lds
    v_mfma_f32_16x16x32_bf16 a[16:19], a[168:171], v[128:131], a[16:19]
    v_exp_f32 v35, v35
    v_mfma_f32_16x16x32_bf16 a[16:19], a[172:175], v[144:147], a[16:19]
    v_cvt_pk_bf16_f32 v97, v34, v35
    v_mfma_f32_16x16x32_bf16 a[20:23], a[168:171], v[132:135], a[20:23]
    v_exp_f32 v36, v36
    v_mfma_f32_16x16x32_bf16 a[20:23], a[172:175], v[148:151], a[20:23]
    ds_read_b128 a[144:147], v8 offset:45056
    ds_read_b128 a[148:151], v9 offset:45056
    v_mfma_f32_16x16x32_bf16 a[24:27], a[168:171], v[136:139], a[24:27]
    buffer_load_dwordx4 v25, s[12:15], s45 offen offset:1024 nt lds
    v_mfma_f32_16x16x32_bf16 a[24:27], a[172:175], v[152:155], a[24:27]
    v_exp_f32 v37, v37
    v_mfma_f32_16x16x32_bf16 a[28:31], a[168:171], v[140:143], a[28:31]
    v_cvt_pk_bf16_f32 v98, v36, v37
    v_mfma_f32_16x16x32_bf16 a[28:31], a[172:175], v[156:159], a[28:31]
    v_exp_f32 v38, v38
    v_mfma_f32_16x16x32_bf16 a[32:35], a[176:179], v[128:131], a[32:35]
    ds_read_b128 a[152:155], v10 offset:45056
    ds_read_b128 a[156:159], v11 offset:45056
    v_mfma_f32_16x16x32_bf16 a[32:35], a[180:183], v[144:147], a[32:35]
    buffer_load_dwordx4 v24, s[12:15], s45 offen offset:2048 nt lds
    v_mfma_f32_16x16x32_bf16 a[36:39], a[176:179], v[132:135], a[36:39]
    v_exp_f32 v39, v39
    v_mfma_f32_16x16x32_bf16 a[36:39], a[180:183], v[148:151], a[36:39]
    v_cvt_pk_bf16_f32 v99, v38, v39
    v_mfma_f32_16x16x32_bf16 a[40:43], a[176:179], v[136:139], a[40:43]
    v_exp_f32 v40, v40
    v_mfma_f32_16x16x32_bf16 a[40:43], a[180:183], v[152:155], a[40:43]
    v_mfma_f32_16x16x32_bf16 a[44:47], a[176:179], v[140:143], a[44:47]
    buffer_load_dwordx4 v25, s[12:15], s45 offen offset:3072 nt lds
    v_mfma_f32_16x16x32_bf16 a[44:47], a[180:183], v[156:159], a[44:47]
    v_exp_f32 v41, v41
    v_mfma_f32_16x16x32_bf16 a[48:51], a[184:187], v[128:131], a[48:51]
    v_cvt_pk_bf16_f32 v100, v40, v41
    v_mfma_f32_16x16x32_bf16 a[48:51], a[188:191], v[144:147], a[48:51]
    v_exp_f32 v42, v42
    v_mfma_f32_16x16x32_bf16 a[52:55], a[184:187], v[132:135], a[52:55]
    v_exp_f32 v43, v43
    v_mfma_f32_16x16x32_bf16 a[52:55], a[188:191], v[148:151], a[52:55]
    v_cvt_pk_bf16_f32 v101, v42, v43
    v_mfma_f32_16x16x32_bf16 a[56:59], a[184:187], v[136:139], a[56:59]
    v_exp_f32 v44, v44
    v_mfma_f32_16x16x32_bf16 a[56:59], a[188:191], v[152:155], a[56:59]
    v_exp_f32 v45, v45
    v_mfma_f32_16x16x32_bf16 a[60:63], a[184:187], v[140:143], a[60:63]
    v_cvt_pk_bf16_f32 v102, v44, v45
    v_mfma_f32_16x16x32_bf16 a[60:63], a[188:191], v[156:159], a[60:63]
    v_exp_f32 v46, v46
    v_mfma_f32_16x16x32_bf16 a[192:195], a[208:211], v[128:131], a[192:195]
    v_exp_f32 v47, v47
    v_mfma_f32_16x16x32_bf16 a[192:195], a[208:211], v[144:147], a[192:195]
    v_cvt_pk_bf16_f32 v103, v46, v47
    v_mfma_f32_16x16x32_bf16 a[196:199], a[208:211], v[132:135], a[196:199]
    v_exp_f32 v48, v48
    v_mfma_f32_16x16x32_bf16 a[196:199], a[208:211], v[148:151], a[196:199]
    v_exp_f32 v49, v49
    s_waitcnt lgkmcnt(0)
    v_mfma_f32_16x16x32_bf16 v[64:67], a[128:131], v[160:163], v[224:227]
    ds_read_b64_tr_b16 a[160:161], v16 offset:49152
    v_cvt_pk_bf16_f32 v104, v48, v49
    v_mfma_f32_16x16x32_bf16 v[64:67], a[132:135], v[164:167], v[64:67]
    v_exp_f32 v50, v50
    v_mfma_f32_16x16x32_bf16 v[64:67], a[136:139], v[168:171], v[64:67]
    ds_read_b64_tr_b16 a[162:163], v16 offset:53248
    ds_read_b64_tr_b16 a[164:165], v16 offset:57344
    v_mfma_f32_16x16x32_bf16 v[64:67], a[140:143], v[172:175], v[64:67]
    v_exp_f32 v51, v51
    v_mfma_f32_16x16x32_bf16 v[72:75], a[128:131], v[176:179], v[228:231]
    ds_read_b64_tr_b16 a[166:167], v16 offset:61440
    v_cvt_pk_bf16_f32 v105, v50, v51
    v_mfma_f32_16x16x32_bf16 v[72:75], a[132:135], v[180:183], v[72:75]
    v_exp_f32 v52, v52
    v_mfma_f32_16x16x32_bf16 v[72:75], a[136:139], v[184:187], v[72:75]
    ds_read_b64_tr_b16 a[168:169], v17 offset:49152
    ds_read_b64_tr_b16 a[170:171], v17 offset:53248
    v_mfma_f32_16x16x32_bf16 v[72:75], a[140:143], v[188:191], v[72:75]
    v_exp_f32 v53, v53
    v_mfma_f32_16x16x32_bf16 v[80:83], a[128:131], v[192:195], v[232:235]
    ds_read_b64_tr_b16 a[172:173], v17 offset:57344
    v_cvt_pk_bf16_f32 v106, v52, v53
    v_mfma_f32_16x16x32_bf16 v[80:83], a[132:135], v[196:199], v[80:83]
    v_exp_f32 v54, v54
    v_mfma_f32_16x16x32_bf16 v[80:83], a[136:139], v[200:203], v[80:83]
    ds_read_b64_tr_b16 a[174:175], v17 offset:61440
    ds_read_b64_tr_b16 a[176:177], v18 offset:49152
    v_mfma_f32_16x16x32_bf16 v[80:83], a[140:143], v[204:207], v[80:83]
    v_exp_f32 v55, v55
    v_mfma_f32_16x16x32_bf16 v[88:91], a[128:131], v[208:211], v[236:239]
    ds_read_b64_tr_b16 a[178:179], v18 offset:53248
    v_cvt_pk_bf16_f32 v107, v54, v55
    v_mfma_f32_16x16x32_bf16 v[88:91], a[132:135], v[212:215], v[88:91]
    v_exp_f32 v56, v56
    v_mfma_f32_16x16x32_bf16 v[88:91], a[136:139], v[216:219], v[88:91]
    ds_read_b64_tr_b16 a[180:181], v18 offset:57344
    ds_read_b64_tr_b16 a[182:183], v18 offset:61440
    v_mfma_f32_16x16x32_bf16 v[88:91], a[140:143], v[220:223], v[88:91]
    v_exp_f32 v57, v57
    v_mfma_f32_16x16x32_bf16 v[68:71], a[144:147], v[160:163], v[224:227]
    ds_read_b64_tr_b16 a[184:185], v19 offset:49152
    v_cvt_pk_bf16_f32 v108, v56, v57
    v_mfma_f32_16x16x32_bf16 v[68:71], a[148:151], v[164:167], v[68:71]
    v_exp_f32 v58, v58
    v_mfma_f32_16x16x32_bf16 v[68:71], a[152:155], v[168:171], v[68:71]
    ds_read_b64_tr_b16 a[186:187], v19 offset:53248
    ds_read_b64_tr_b16 a[188:189], v19 offset:57344
    v_mfma_f32_16x16x32_bf16 v[68:71], a[156:159], v[172:175], v[68:71]
    v_exp_f32 v59, v59
    v_mfma_f32_16x16x32_bf16 v[76:79], a[144:147], v[176:179], v[228:231]
    ds_read_b64_tr_b16 a[190:191], v19 offset:61440
    v_cvt_pk_bf16_f32 v109, v58, v59
    v_mfma_f32_16x16x32_bf16 v[76:79], a[148:151], v[180:183], v[76:79]
    v_exp_f32 v60, v60
    v_mfma_f32_16x16x32_bf16 v[76:79], a[152:155], v[184:187], v[76:79]
    v_exp_f32 v61, v61
    v_mfma_f32_16x16x32_bf16 v[76:79], a[156:159], v[188:191], v[76:79]
    v_cvt_pk_bf16_f32 v110, v60, v61
    v_mfma_f32_16x16x32_bf16 v[84:87], a[144:147], v[192:195], v[232:235]
    v_exp_f32 v62, v62
    v_mfma_f32_16x16x32_bf16 v[84:87], a[148:151], v[196:199], v[84:87]
    v_exp_f32 v63, v63
    v_mfma_f32_16x16x32_bf16 v[84:87], a[152:155], v[200:203], v[84:87]
    s_add_u32 s45, s45, 16384
    v_mfma_f32_16x16x32_bf16 v[84:87], a[156:159], v[204:207], v[84:87]
    v_mfma_f32_16x16x32_bf16 v[92:95], a[144:147], v[208:211], v[236:239]
    v_mfma_f32_16x16x32_bf16 v[92:95], a[148:151], v[212:215], v[92:95]
    v_mfma_f32_16x16x32_bf16 v[92:95], a[152:155], v[216:219], v[92:95]
    v_mfma_f32_16x16x32_bf16 v[92:95], a[156:159], v[220:223], v[92:95]
L_it3:
    s_waitcnt vmcnt(16) lgkmcnt(0)
    s_barrier
    v_mfma_f32_16x16x32_bf16 a[64:67], a[160:163], v[128:131], a[64:67]
    ds_read_b128 a[128:131], v8 offset:49152
    v_cvt_pk_bf16_f32 v111, v62, v63
    v_mfma_f32_16x16x32_bf16 a[64:67], a[164:167], v[144:147], a[64:67]
    v_exp_f32 v64, v64
    v_mfma_f32_16x16x32_bf16 a[68:71], a[160:163], v[132:135], a[68:71]
    ds_read_b128 a[132:135], v9 offset:49152
    v_mfma_f32_16x16x32_bf16 a[68:71], a[164:167], v[148:151], a[68:71]
    v_exp_f32 v65, v65
    v_mfma_f32_16x16x32_bf16 a[72:75], a[160:163], v[136:139], a[72:75]
    v_cvt_pk_bf16_f32 v112, v64, v65
    v_mfma_f32_16x16x32_bf16 a[72:75], a[164:167], v[152:155], a[72:75]
    v_exp_f32 v66, v66
    v_mfma_f32_16x16x32_bf16 a[76:79], a[160:163], v[140:143], a[76:79]
    s_mov_b32 m0, s34
    ds_read_b128 a[136:139], v10 offset:49152
    ds_read_b128 a[140:143], v11 offset:49152
    v_mfma_f32_16x16x32_bf16 a[76:79], a[164:167], v[156:159], a[76:79]
    buffer_load_dwordx4 v20, s[8:11], s44 offen offset:0 nt lds
    v_mfma_f32_16x16x32_bf16 a[80:83], a[168:171], v[128:131], a[80:83]
    v_exp_f32 v67, v67
    v_mfma_f32_16x16x32_bf16 a[80:83], a[172:175], v[144:147], a[80:83]
    v_cvt_pk_bf16_f32 v113, v66, v67
    v_mfma_f32_16x16x32_bf16 a[84:87], a[168:171], v[132:135], a[84:87]
    v_exp_f32 v68, v68
    v_mfma_f32_16x16x32_bf16 a[84:87], a[172:175], v[148:151], a[84:87]
    ds_read_b128 a[144:147], v8 offset:53248
    ds_read_b128 a[148:151], v9 offset:53248
    v_mfma_f32_16x16x32_bf16 a[88:91], a[168:171], v[136:139], a[88:91]
    buffer_load_dwordx4 v21, s[8:11], s44 offen offset:1024 nt lds
    v_mfma_f32_16x16x32_bf16 a[88:91], a[172:175], v[152:155], a[88:91]
    v_exp_f32 v69, v69
    v_mfma_f32_16x16x32_bf16 a[92:95], a[168:171], v[140:143], a[92:95]
    v_cvt_pk_bf16_f32 v114, v68, v69
    v_mfma_f32_16x16x32_bf16 a[92:95], a[172:175], v[156:159], a[92:95]
    v_exp_f32 v70, v70
    v_mfma_f32_16x16x32_bf16 a[96:99], a[176:179], v[128:131], a[96:99]
    ds_read_b128 a[152:155], v10 offset:53248
    ds_read_b128 a[156:159], v11 offset:53248
    v_mfma_f32_16x16x32_bf16 a[96:99], a[180:183], v[144:147], a[96:99]
    buffer_load_dwordx4 v22, s[8:11], s44 offen offset:2048 nt lds
    v_mfma_f32_16x16x32_bf16 a[100:103], a[176:179], v[132:135], a[100:103]
    v_exp_f32 v71, v71
    v_mfma_f32_16x16x32_bf16 a[100:103], a[180:183], v[148:151], a[100:103]
    v_cvt_pk_bf16_f32 v115, v70, v71
    v_mfma_f32_16x16x32_bf16 a[104:107], a[176:179], v[136:139], a[104:107]
    v_exp_f32 v72, v72
    v_mfma_f32_16x16x32_bf16 a[104:107], a[180:183], v[152:155], a[104:107]
    v_mfma_f32_16x16x32_bf16 a[108:111], a[176:179], v[140:143], a[108:111]
    buffer_load_dwordx4 v23, s[8:11], s44 offen offset:3072 nt lds
    v_mfma_f32_16x16x32_bf16 a[108:111], a[180:183], v[156:159], a[108:111]
    v_exp_f32 v73, v73
    v_mfma_f32_16x16x32_bf16 a[112:115], a[184:187], v[128:131], a[112:115]
    v_cvt_pk_bf16_f32 v116, v72, v73
    v_mfma_f32_16x16x32_bf16 a[112:115], a[188:191], v[144:147], a[112:115]
    v_exp_f32 v74, v74
    v_mfma_f32_16x16x32_bf16 a[116:119], a[184:187], v[132:135], a[116:119]
    v_exp_f32 v75, v75
    v_mfma_f32_16x16x32_bf16 a[116:119], a[188:191], v[148:151], a[116:119]
    v_cvt_pk_bf16_f32 v117, v74, v75
    v_mfma_f32_16x16x32_bf16 a[120:123], a[184:187], v[136:139], a[120:123]
    v_exp_f32 v76, v76
    v_mfma_f32_16x16x32_bf16 a[120:123], a[188:191], v[152:155], a[120:123]
    v_exp_f32 v77, v77
    v_mfma_f32_16x16x32_bf16 a[124:127], a[184:187], v[140:143], a[124:127]
    v_cvt_pk_bf16_f32 v118, v76, v77
    v_mfma_f32_16x16x32_bf16 a[124:127], a[188:191], v[156:159], a[124:127]
    v_exp_f32 v78, v78
    v_mfma_f32_16x16x32_bf16 a[200:203], a[208:211], v[136:139], a[200:203]
    v_exp_f32 v79, v79
    v_mfma_f32_16x16x32_bf16 a[200:203], a[208:211], v[152:155], a[200:203]
    v_cvt_pk_bf16_f32 v119, v78, v79
    v_mfma_f32_16x16x32_bf16 a[204:207], a[208:211], v[140:143], a[204:207]
    v_exp_f32 v80, v80
    v_mfma_f32_16x16x32_bf16 a[204:207], a[208:211], v[156:159], a[204:207]
    v_exp_f32 v81, v81
    s_waitcnt lgkmcnt(0)
    v_mfma_f32_16x16x32_bf16 v[32:35], a[128:131], v[160:163], v[224:227]
    ds_read_b64_tr_b16 a[160:161], v12 offset:0
    v_cvt_pk_bf16_f32 v120, v80, v81
    v_mfma_f32_16x16x32_bf16 v[32:35], a[132:135], v[164:167], v[32:35]
    v_exp_f32 v82, v82
    v_mfma_f32_16x16x32_bf16 v[32:35], a[136:139], v[168:171], v[32:35]
    ds_read_b64_tr_b16 a[162:163], v12 offset:4096
    ds_read_b64_tr_b16 a[164:165], v12 offset:8192
    v_mfma_f32_16x16x32_bf16 v[32:35], a[140:143], v[172:175], v[32:35]
    v_exp_f32 v83, v83
    v_mfma_f32_16x16x32_bf16 v[40:43], a[128:131], v[176:179], v[228:231]
    ds_read_b64_tr_b16 a[166:167], v12 offset:12288
    v_cvt_pk_bf16_f32 v121, v82, v83
    v_mfma_f32_16x16x32_bf16 v[40:43], a[132:135], v[180:183], v[40:43]
    v_exp_f32 v84, v84
    v_mfma_f32_16x16x32_bf16 v[40:43], a[136:139], v[184:187], v[40:43]
    ds_read_b64_tr_b16 a[168:169], v13 offset:0
    ds_read_b64_tr_b16 a[170:171], v13 offset:4096
    v_mfma_f32_16x16x32_bf16 v[40:43], a[140:143], v[188:191], v[40:43]
    v_exp_f32 v85, v85
    v_mfma_f32_16x16x32_bf16 v[48:51], a[128:131], v[192:195], v[232:235]
    ds_read_b64_tr_b16 a[172:173], v13 offset:8192
    v_cvt_pk_bf16_f32 v122, v84, v85
    v_mfma_f32_16x16x32_bf16 v[48:51], a[132:135], v[196:199], v[48:51]
    v_exp_f32 v86, v86
    v_mfma_f32_16x16x32_bf16 v[48:51], a[136:139], v[200:203], v[48:51]
    ds_read_b64_tr_b16 a[174:175], v13 offset:12288
    ds_read_b64_tr_b16 a[176:177], v14 offset:0
    v_mfma_f32_16x16x32_bf16 v[48:51], a[140:143], v[204:207], v[48:51]
    v_exp_f32 v87, v87
    v_mfma_f32_16x16x32_bf16 v[56:59], a[128:131], v[208:211], v[236:239]
    ds_read_b64_tr_b16 a[178:179], v14 offset:4096
    v_cvt_pk_bf16_f32 v123, v86, v87
    v_mfma_f32_16x16x32_bf16 v[56:59], a[132:135], v[212:215], v[56:59]
    v_exp_f32 v88, v88
    v_mfma_f32_16x16x32_bf16 v[56:59], a[136:139], v[216:219], v[56:59]
    ds_read_b64_tr_b16 a[180:181], v14 offset:8192
    ds_read_b64_tr_b16 a[182:183], v14 offset:12288
    v_mfma_f32_16x16x32_bf16 v[56:59], a[140:143], v[220:223], v[56:59]
    v_exp_f32 v89, v89
    v_mfma_f32_16x16x32_bf16 v[36:39], a[144:147], v[160:163], v[224:227]
    ds_read_b64_tr_b16 a[184:185], v15 offset:0
    v_cvt_pk_bf16_f32 v124, v88, v89
    v_mfma_f32_16x16x32_bf16 v[36:39], a[148:151], v[164:167], v[36:39]
    v_exp_f32 v90, v90
    v_mfma_f32_16x16x32_bf16 v[36:39], a[152:155], v[168:171], v[36:39]
    ds_read_b64_tr_b16 a[186:187], v15 offset:4096
    ds_read_b64_tr_b16 a[188:189], v15 offset:8192
    v_mfma_f32_16x16x32_bf16 v[36:39], a[156:159], v[172:175], v[36:39]
    v_exp_f32 v91, v91
    v_mfma_f32_16x16x32_bf16 v[44:47], a[144:147], v[176:179], v[228:231]
    ds_read_b64_tr_b16 a[190:191], v15 offset:12288
    v_cvt_pk_bf16_f32 v125, v90, v91
    v_mfma_f32_16x16x32_bf16 v[44:47], a[148:151], v[180:183], v[44:47]
    v_exp_f32 v92, v92
    v_mfma_f32_16x16x32_bf16 v[44:47], a[152:155], v[184:187], v[44:47]
    v_exp_f32 v93, v93
    v_mfma_f32_16x16x32_bf16 v[44:47], a[156:159], v[188:191], v[44:47]
    v_cvt_pk_bf16_f32 v126, v92, v93
    v_mfma_f32_16x16x32_bf16 v[52:55], a[144:147], v[192:195], v[232:235]
    v_exp_f32 v94, v94
    v_mfma_f32_16x16x32_bf16 v[52:55], a[148:151], v[196:199], v[52:55]
    v_exp_f32 v95, v95
    v_mfma_f32_16x16x32_bf16 v[52:55], a[152:155], v[200:203], v[52:55]
    s_add_u32 s44, s44, 16384
    v_mfma_f32_16x16x32_bf16 v[52:55], a[156:159], v[204:207], v[52:55]
    v_mfma_f32_16x16x32_bf16 v[60:63], a[144:147], v[208:211], v[236:239]
    v_mfma_f32_16x16x32_bf16 v[60:63], a[148:151], v[212:215], v[60:63]
    v_mfma_f32_16x16x32_bf16 v[60:63], a[152:155], v[216:219], v[60:63]
    v_mfma_f32_16x16x32_bf16 v[60:63], a[156:159], v[220:223], v[60:63]
    s_waitcnt lgkmcnt(0)
    v_mfma_f32_16x16x32_bf16 a[0:3], a[160:163], v[96:99], a[0:3]
    ds_read_b128 a[128:131], v8 offset:57344
    v_cvt_pk_bf16_f32 v127, v94, v95
    v_mfma_f32_16x16x32_bf16 a[0:3], a[164:167], v[112:115], a[0:3]
    v_exp_f32 v32, v32
    v_mfma_f32_16x16x32_bf16 a[4:7], a[160:163], v[100:103], a[4:7]
    ds_read_b128 a[132:135], v9 offset:57344
    v_mfma_f32_16x16x32_bf16 a[4:7], a[164:167], v[116:119], a[4:7]
    v_exp_f32 v33, v33
    v_mfma_f32_16x16x32_bf16 a[8:11], a[160:163], v[104:107], a[8:11]
    v_cvt_pk_bf16_f32 v128, v32, v33
    v_mfma_f32_16x16x32_bf16 a[8:11], a[164:167], v[120:123], a[8:11]
    v_exp_f32 v34, v34
    v_mfma_f32_16x16x32_bf16 a[12:15], a[160:163], v[108:111], a[12:15]
    s_mov_b32 m0, s37
    ds_read_b128 a[136:139], v10 offset:57344
    ds_read_b128 a[140:143], v11 offset:57344
    v_mfma_f32_16x16x32_bf16 a[12:15], a[164:167], v[124:127], a[12:15]
    buffer_load_dwordx4 v24, s[12:15], s45 offen offset:0 nt lds
    v_mfma_f32_16x16x32_bf16 a[16:19], a[168:171], v[96:99], a[16:19]
    v_exp_f32 v35, v35
    v_mfma_f32_16x16x32_bf16 a[16:19], a[172:175], v[112:115], a[16:19]
    v_cvt_pk_bf16_f32 v129, v34, v35
    v_mfma_f32_16x16x32_bf16 a[20:23], a[168:171], v[100:103], a[20:23]
    v_exp_f32 v36, v36
    v_mfma_f32_16x16x32_bf16 a[20:23], a[172:175], v[116:119], a[20:23]
    ds_read_b128 a[144:147], v8 offset:61440
    ds_read_b128 a[148:151], v9 offset:61440
    v_mfma_f32_16x16x32_bf16 a[24:27], a[168:171], v[104:107], a[24:27]
    buffer_load_dwordx4 v25, s[12:15], s45 offen offset:1024 nt lds
    v_mfma_f32_16x16x32_bf16 a[24:27], a[172:175], v[120:123], a[24:27]
    v_exp_f32 v37, v37
    v_mfma_f32_16x16x32_bf16 a[28:31], a[168:171], v[108:111], a[28:31]
    v_cvt_pk_bf16_f32 v130, v36, v37
    v_mfma_f32_16x16x32_bf16 a[28:31], a[172:175], v[124:127], a[28:31]
    v_exp_f32 v38, v38
    v_mfma_f32_16x16x32_bf16 a[32:35], a[176:179], v[96:99], a[32:35]
    ds_read_b128 a[152:155], v10 offset:61440
    ds_read_b128 a[156:159], v11 offset:61440
    v_mfma_f32_16x16x32_bf16 a[32:35], a[180:183], v[112:115], a[32:35]
    buffer_load_dwordx4 v24, s[12:15], s45 offen offset:2048 nt lds
    v_mfma_f32_16x16x32_bf16 a[36:39], a[176:179], v[100:103], a[36:39]
    v_exp_f32 v39, v39
    v_mfma_f32_16x16x32_bf16 a[36:39], a[180:183], v[116:119], a[36:39]
    v_cvt_pk_bf16_f32 v131, v38, v39
    v_mfma_f32_16x16x32_bf16 a[40:43], a[176:179], v[104:107], a[40:43]
    v_exp_f32 v40, v40
    v_mfma_f32_16x16x32_bf16 a[40:43], a[180:183], v[120:123], a[40:43]
    v_mfma_f32_16x16x32_bf16 a[44:47], a[176:179], v[108:111], a[44:47]
    buffer_load_dwordx4 v25, s[12:15], s45 offen offset:3072 nt lds
    v_mfma_f32_16x16x32_bf16 a[44:47], a[180:183], v[124:127], a[44:47]
    v_exp_f32 v41, v41
    v_mfma_f32_16x16x32_bf16 a[48:51], a[184:187], v[96:99], a[48:51]
    v_cvt_pk_bf16_f32 v132, v40, v41
    v_mfma_f32_16x16x32_bf16 a[48:51], a[188:191], v[112:115], a[48:51]
    v_exp_f32 v42, v42
    v_mfma_f32_16x16x32_bf16 a[52:55], a[184:187], v[100:103], a[52:55]
    v_exp_f32 v43, v43
    v_mfma_f32_16x16x32_bf16 a[52:55], a[188:191], v[116:119], a[52:55]
    v_cvt_pk_bf16_f32 v133, v42, v43
    v_mfma_f32_16x16x32_bf16 a[56:59], a[184:187], v[104:107], a[56:59]
    v_exp_f32 v44, v44
    v_mfma_f32_16x16x32_bf16 a[56:59], a[188:191], v[120:123], a[56:59]
    v_exp_f32 v45, v45
    v_mfma_f32_16x16x32_bf16 a[60:63], a[184:187], v[108:111], a[60:63]
    v_cvt_pk_bf16_f32 v134, v44, v45
    v_mfma_f32_16x16x32_bf16 a[60:63], a[188:191], v[124:127], a[60:63]
    v_exp_f32 v46, v46
    v_mfma_f32_16x16x32_bf16 a[192:195], a[208:211], v[96:99], a[192:195]
    v_exp_f32 v47, v47
    v_mfma_f32_16x16x32_bf16 a[192:195], a[208:211], v[112:115], a[192:195]
    v_cvt_pk_bf16_f32 v135, v46, v47
    v_mfma_f32_16x16x32_bf16 a[196:199], a[208:211], v[100:103], a[196:199]
    v_exp_f32 v48, v48
    v_mfma_f32_16x16x32_bf16 a[196:199], a[208:211], v[116:119], a[196:199]
    v_exp_f32 v49, v49
    s_waitcnt lgkmcnt(0)
    v_mfma_f32_16x16x32_bf16 v[64:67], a[128:131], v[160:163], v[224:227]
    ds_read_b64_tr_b16 a[160:161], v16 offset:0
    v_cvt_pk_bf16_f32 v136, v48, v49
    v_mfma_f32_16x16x32_bf16 v[64:67], a[132:135], v[164:167], v[64:67]
    v_exp_f32 v50, v50
    v_mfma_f32_16x16x32_bf16 v[64:67], a[136:139], v[168:171], v[64:67]
    ds_read_b64_tr_b16 a[162:163], v16 offset:4096
    ds_read_b64_tr_b16 a[164:165], v16 offset:8192
    v_mfma_f32_16x16x32_bf16 v[64:67], a[140:143], v[172:175], v[64:67]
    v_exp_f32 v51, v51
    v_mfma_f32_16x16x32_bf16 v[72:75], a[128:131], v[176:179], v[228:231]
    ds_read_b64_tr_b16 a[166:167], v16 offset:12288
    v_cvt_pk_bf16_f32 v137, v50, v51
    v_mfma_f32_16x16x32_bf16 v[72:75], a[132:135], v[180:183], v[72:75]
    v_exp_f32 v52, v52
    v_mfma_f32_16x16x32_bf16 v[72:75], a[136:139], v[184:187], v[72:75]
    ds_read_b64_tr_b16 a[168:169], v17 offset:0
    ds_read_b64_tr_b16 a[170:171], v17 offset:4096
    v_mfma_f32_16x16x32_bf16 v[72:75], a[140:143], v[188:191], v[72:75]
    v_exp_f32 v53, v53
    v_mfma_f32_16x16x32_bf16 v[80:83], a[128:131], v[192:195], v[232:235]
    ds_read_b64_tr_b16 a[172:173], v17 offset:8192
    v_cvt_pk_bf16_f32 v138, v52, v53
    v_mfma_f32_16x16x32_bf16 v[80:83], a[132:135], v[196:199], v[80:83]
    v_exp_f32 v54, v54
    v_mfma_f32_16x16x32_bf16 v[80:83], a[136:139], v[200:203], v[80:83]
    ds_read_b64_tr_b16 a[174:175], v17 offset:12288
    ds_read_b64_tr_b16 a[176:177], v18 offset:0
    v_mfma_f32_16x16x32_bf16 v[80:83], a[140:143], v[204:207], v[80:83]
    v_exp_f32 v55, v55
    v_mfma_f32_16x16x32_bf16 v[88:91], a[128:131], v[208:211], v[236:239]
    ds_read_b64_tr_b16 a[178:179], v18 offset:4096
    v_cvt_pk_bf16_f32 v139, v54, v55
    v_mfma_f32_16x16x32_bf16 v[88:91], a[132:135], v[212:215], v[88:91]
    v_exp_f32 v56, v56
    v_mfma_f32_16x16x32_bf16 v[88:91], a[136:139], v[216:219], v[88:91]
    ds_read_b64_tr_b16 a[180:181], v18 offset:8192
    ds_read_b64_tr_b16 a[182:183], v18 offset:12288
    v_mfma_f32_16x16x32_bf16 v[88:91], a[140:143], v[220:223], v[88:91]
    v_exp_f32 v57, v57
    v_mfma_f32_16x16x32_bf16 v[68:71], a[144:147], v[160:163], v[224:227]
    ds_read_b64_tr_b16 a[184:185], v19 offset:0
    v_cvt_pk_bf16_f32 v140, v56, v57
    v_mfma_f32_16x16x32_bf16 v[68:71], a[148:151], v[164:167], v[68:71]
    v_exp_f32 v58, v58
    v_mfma_f32_16x16x32_bf16 v[68:71], a[152:155], v[168:171], v[68:71]
    ds_read_b64_tr_b16 a[186:187], v19 offset:4096
    ds_read_b64_tr_b16 a[188:189], v19 offset:8192
    v_mfma_f32_16x16x32_bf16 v[68:71], a[156:159], v[172:175], v[68:71]
    v_exp_f32 v59, v59
    v_mfma_f32_16x16x32_bf16 v[76:79], a[144:147], v[176:179], v[228:231]
    ds_read_b64_tr_b16 a[190:191], v19 offset:12288
    v_cvt_pk_bf16_f32 v141, v58, v59
    v_mfma_f32_16x16x32_bf16 v[76:79], a[148:151], v[180:183], v[76:79]
    v_exp_f32 v60, v60
    v_mfma_f32_16x16x32_bf16 v[76:79], a[152:155], v[184:187], v[76:79]
    v_exp_f32 v61, v61
    v_mfma_f32_16x16x32_bf16 v[76:79], a[156:159], v[188:191], v[76:79]
    v_cvt_pk_bf16_f32 v142, v60, v61
    v_mfma_f32_16x16x32_bf16 v[84:87], a[144:147], v[192:195], v[232:235]
    v_exp_f32 v62, v62
    v_mfma_f32_16x16x32_bf16 v[84:87], a[148:151], v[196:199], v[84:87]
    v_exp_f32 v63, v63
    v_mfma_f32_16x16x32_bf16 v[84:87], a[152:155], v[200:203], v[84:87]
    s_add_u32 s45, s45, 16384
    v_mfma_f32_16x16x32_bf16 v[84:87], a[156:159], v[204:207], v[84:87]
    v_mfma_f32_16x16x32_bf16 v[92:95], a[144:147], v[208:211], v[236:239]
    v_mfma_f32_16x16x32_bf16 v[92:95], a[148:151], v[212:215], v[92:95]
    v_mfma_f32_16x16x32_bf16 v[92:95], a[152:155], v[216:219], v[92:95]
    v_mfma_f32_16x16x32_bf16 v[92:95], a[156:159], v[220:223], v[92:95]
    s_add_u32 s50, s50, 1
    s_cmp_lt_u32 s50, 4
    s_cbranch_scc1 L_loop
    s_waitcnt vmcnt(16) lgkmcnt(0)
    s_barrier
    v_mfma_f32_16x16x32_bf16 a[64:67], a[160:163], v[96:99], a[64:67]
    v_cvt_pk_bf16_f32 v143, v62, v63
    v_exp_f32 v64, v64
    v_mfma_f32_16x16x32_bf16 a[64:67], a[164:167], v[112:115], a[64:67]
    v_exp_f32 v65, v65
    s_mov_b32 m0, s35
    v_mfma_f32_16x16x32_bf16 a[68:71], a[160:163], v[100:103], a[68:71]
    v_cvt_pk_bf16_f32 v144, v64, v65
    v_exp_f32 v66, v66
    v_mfma_f32_16x16x32_bf16 a[68:71], a[164:167], v[116:119], a[68:71]
    v_exp_f32 v67, v67
    v_mfma_f32_16x16x32_bf16 a[72:75], a[160:163], v[104:107], a[72:75]
    v_cvt_pk_bf16_f32 v145, v66, v67
    v_exp_f32 v68, v68
    v_mfma_f32_16x16x32_bf16 a[72:75], a[164:167], v[120:123], a[72:75]
    v_exp_f32 v69, v69
    v_mfma_f32_16x16x32_bf16 a[76:79], a[160:163], v[108:111], a[76:79]
    v_cvt_pk_bf16_f32 v146, v68, v69
    v_exp_f32 v70, v70
    v_mfma_f32_16x16x32_bf16 a[76:79], a[164:167], v[124:127], a[76:79]
    v_exp_f32 v71, v71
    v_mfma_f32_16x16x32_bf16 a[80:83], a[168:171], v[96:99], a[80:83]
    v_cvt_pk_bf16_f32 v147, v70, v71
    v_exp_f32 v72, v72
    v_mfma_f32_16x16x32_bf16 a[80:83], a[172:175], v[112:115], a[80:83]
    v_exp_f32 v73, v73
    ds_read_b64_tr_b16 a[160:161], v12 offset:16384
    buffer_load_dwordx4 v20, s[8:11], s44 offen offset:0 nt lds
    v_mfma_f32_16x16x32_bf16 a[84:87], a[168:171], v[100:103], a[84:87]
    v_cvt_pk_bf16_f32 v148, v72, v73
    v_exp_f32 v74, v74
    v_mfma_f32_16x16x32_bf16 a[84:87], a[172:175], v[116:119], a[84:87]
    v_exp_f32 v75, v75
    ds_read_b64_tr_b16 a[162:163], v12 offset:20480
    v_mfma_f32_16x16x32_bf16 a[88:91], a[168:171], v[104:107], a[88:91]
    v_cvt_pk_bf16_f32 v149, v74, v75
    v_exp_f32 v76, v76
    v_mfma_f32_16x16x32_bf16 a[88:91], a[172:175], v[120:123], a[88:91]
    v_exp_f32 v77, v77
    ds_read_b64_tr_b16 a[164:165], v12 offset:24576
    v_mfma_f32_16x16x32_bf16 a[92:95], a[168:171], v[108:111], a[92:95]
    v_cvt_pk_bf16_f32 v150, v76, v77
    v_exp_f32 v78, v78
    v_mfma_f32_16x16x32_bf16 a[92:95], a[172:175], v[124:127], a[92:95]
    v_exp_f32 v79, v79
    ds_read_b64_tr_b16 a[166:167], v12 offset:28672
    v_mfma_f32_16x16x32_bf16 a[96:99], a[176:179], v[96:99], a[96:99]
    v_cvt_pk_bf16_f32 v151, v78, v79
    v_exp_f32 v80, v80
    v_mfma_f32_16x16x32_bf16 a[96:99], a[180:183], v[112:115], a[96:99]
    v_exp_f32 v81, v81
    ds_read_b64_tr_b16 a[168:169], v13 offset:16384
    buffer_load_dwordx4 v21, s[8:11], s44 offen offset:1024 nt lds
    v_mfma_f32_16x16x32_bf16 a[100:103], a[176:179], v[100:103], a[100:103]
    v_cvt_pk_bf16_f32 v152, v80, v81
    v_exp_f32 v82, v82
    v_mfma_f32_16x16x32_bf16 a[100:103], a[180:183], v[116:119], a[100:103]
    v_exp_f32 v83, v83
    ds_read_b64_tr_b16 a[170:171], v13 offset:20480
    v_mfma_f32_16x16x32_bf16 a[104:107], a[176:179], v[104:107], a[104:107]
    v_cvt_pk_bf16_f32 v153, v82, v83
    v_exp_f32 v84, v84
    v_mfma_f32_16x16x32_bf16 a[104:107], a[180:183], v[120:123], a[104:107]
    v_exp_f32 v85, v85
    ds_read_b64_tr_b16 a[172:173], v13 offset:24576
    v_mfma_f32_16x16x32_bf16 a[108:111], a[176:179], v[108:111], a[108:111]
    v_cvt_pk_bf16_f32 v154, v84, v85
    v_exp_f32 v86, v86
    v_mfma_f32_16x16x32_bf16 a[108:111], a[180:183], v[124:127], a[108:111]
    v_exp_f32 v87, v87
    ds_read_b64_tr_b16 a[174:175], v13 offset:28672
    v_mfma_f32_16x16x32_bf16 a[112:115], a[184:187], v[96:99], a[112:115]
    v_cvt_pk_bf16_f32 v155, v86, v87
    v_exp_f32 v88, v88
    v_mfma_f32_16x16x32_bf16 a[112:115], a[188:191], v[112:115], a[112:115]
    v_exp_f32 v89, v89
    ds_read_b64_tr_b16 a[176:177], v14 offset:16384
    buffer_load_dwordx4 v22, s[8:11], s44 offen offset:2048 nt lds
    v_mfma_f32_16x16x32_bf16 a[116:119], a[184:187], v[100:103], a[116:119]
    v_cvt_pk_bf16_f32 v156, v88, v89
    v_exp_f32 v90, v90
    v_mfma_f32_16x16x32_bf16 a[116:119], a[188:191], v[116:119], a[116:119]
    v_exp_f32 v91, v91
    ds_read_b64_tr_b16 a[178:179], v14 offset:20480
    v_mfma_f32_16x16x32_bf16 a[120:123], a[184:187], v[104:107], a[120:123]
    v_cvt_pk_bf16_f32 v157, v90, v91
    v_exp_f32 v92, v92
    v_mfma_f32_16x16x32_bf16 a[120:123], a[188:191], v[120:123], a[120:123]
    v_exp_f32 v93, v93
    ds_read_b64_tr_b16 a[180:181], v14 offset:24576
    v_mfma_f32_16x16x32_bf16 a[124:127], a[184:187], v[108:111], a[124:127]
    v_cvt_pk_bf16_f32 v158, v92, v93
    v_exp_f32 v94, v94
    v_mfma_f32_16x16x32_bf16 a[124:127], a[188:191], v[124:127], a[124:127]
    v_exp_f32 v95, v95
    ds_read_b64_tr_b16 a[182:183], v14 offset:28672
    v_mfma_f32_16x16x32_bf16 a[200:203], a[208:211], v[104:107], a[200:203]
    v_cvt_pk_bf16_f32 v159, v94, v95
    ds_read_b64_tr_b16 a[184:185], v15 offset:16384
    v_mfma_f32_16x16x32_bf16 a[200:203], a[208:211], v[120:123], a[200:203]
    ds_read_b64_tr_b16 a[186:187], v15 offset:20480
    buffer_load_dwordx4 v23, s[8:11], s44 offen offset:3072 nt lds
    s_add_u32 s44, s44, 16384
    s_mov_b32 m0, s38
    v_mfma_f32_16x16x32_bf16 a[204:207], a[208:211], v[108:111], a[204:207]
    ds_read_b64_tr_b16 a[188:189], v15 offset:24576
    v_mfma_f32_16x16x32_bf16 a[204:207], a[208:211], v[124:127], a[204:207]
    ds_read_b64_tr_b16 a[190:191], v15 offset:28672
    v_mfma_f32_16x16x32_bf16 a[192:195], a[208:211], v[128:131], a[192:195]
    s_cmp_eq_u32 s43, 0
    s_cselect_b32 s3, 0, 2147483648
    v_mfma_f32_16x16x32_bf16 a[192:195], a[208:211], v[144:147], a[192:195]
    v_mov_b32 v7, s3
    buffer_load_dword v7, v7, s[72:75], 0 offen sc1
    v_mfma_f32_16x16x32_bf16 a[196:199], a[208:211], v[132:135], a[196:199]
    v_mov_b32 v160, v240
    v_mov_b32 v161, v241
    v_mfma_f32_16x16x32_bf16 a[196:199], a[208:211], v[148:151], a[196:199]
    v_mov_b32 v162, v242
    v_mov_b32 v163, v243
    v_mfma_f32_16x16x32_bf16 a[200:203], a[208:211], v[136:139], a[200:203]
    v_mov_b32 v164, v244
    v_mov_b32 v165, v245
    v_mfma_f32_16x16x32_bf16 a[200:203], a[208:211], v[152:155], a[200:203]
    buffer_load_dwordx4 v24, s[12:15], s45 offen offset:0 nt lds
    v_mfma_f32_16x16x32_bf16 a[204:207], a[208:211], v[140:143], a[204:207]
    v_mov_b32 v166, v246
    v_mov_b32 v167, v247
    v_mfma_f32_16x16x32_bf16 a[204:207], a[208:211], v[156:159], a[204:207]
    v_mov_b32 v168, v248
    v_mov_b32 v169, v249
    s_waitcnt lgkmcnt(0)
    v_mfma_f32_16x16x32_bf16 a[0:3], a[160:163], v[128:131], a[0:3]
    v_mov_b32 v170, v250
    v_mov_b32 v171, v251
    v_mfma_f32_16x16x32_bf16 a[0:3], a[164:167], v[144:147], a[0:3]
    v_mov_b32 v172, v252
    v_mov_b32 v173, v253
    v_mfma_f32_16x16x32_bf16 a[4:7], a[160:163], v[132:135], a[4:7]
    v_mov_b32 v174, v254
    v_mov_b32 v175, v255
    v_mfma_f32_16x16x32_bf16 a[4:7], a[164:167], v[148:151], a[4:7]
    v_mov_b32 v176, v28
    v_mov_b32 v177, v29
    v_mfma_f32_16x16x32_bf16 a[8:11], a[160:163], v[136:139], a[8:11]
    s_mov_b32 s60, 0x4e800000
    s_mov_b64 s[54:55], 0
    v_mfma_f32_16x16x32_bf16 a[8:11], a[164:167], v[152:155], a[8:11]
    buffer_load_dwordx4 v25, s[12:15], s45 offen offset:1024 nt lds
    v_mfma_f32_16x16x32_bf16 a[12:15], a[160:163], v[140:143], a[12:15]
    v_accvgpr_read_b32 v224, a192
    v_cmp_ngt_f32 vcc, s60, v224
    v_mfma_f32_16x16x32_bf16 a[12:15], a[164:167], v[156:159], a[12:15]
    s_or_b64 s[54:55], s[54:55], vcc
    v_max_f32 v224, 0x00800000, v224
    v_mfma_f32_16x16x32_bf16 a[16:19], a[168:171], v[128:131], a[16:19]
    ds_read_b64_tr_b16 a[160:161], v16 offset:16384
    v_mfma_f32_16x16x32_bf16 a[16:19], a[172:175], v[144:147], a[16:19]
    v_accvgpr_read_b32 v226, a196
    v_cmp_ngt_f32 vcc, s60, v226
    v_mfma_f32_16x16x32_bf16 a[20:23], a[168:171], v[132:135], a[20:23]
    ds_read_b64_tr_b16 a[162:163], v16 offset:20480
    v_mfma_f32_16x16x32_bf16 a[20:23], a[172:175], v[148:151], a[20:23]
    s_or_b64 s[54:55], s[54:55], vcc
    v_max_f32 v226, 0x00800000, v226
    v_mfma_f32_16x16x32_bf16 a[24:27], a[168:171], v[136:139], a[24:27]
    ds_read_b64_tr_b16 a[164:165], v16 offset:24576
    v_mfma_f32_16x16x32_bf16 a[24:27], a[172:175], v[152:155], a[24:27]
    buffer_load_dwordx4 v24, s[12:15], s45 offen offset:2048 nt lds
    v_mfma_f32_16x16x32_bf16 a[28:31], a[168:171], v[140:143], a[28:31]
    ds_read_b64_tr_b16 a[166:167], v16 offset:28672
    v_mfma_f32_16x16x32_bf16 a[28:31], a[172:175], v[156:159], a[28:31]
    v_accvgpr_read_b32 v228, a200
    v_cmp_ngt_f32 vcc, s60, v228
    v_mfma_f32_16x16x32_bf16 a[32:35], a[176:179], v[128:131], a[32:35]
    ds_read_b64_tr_b16 a[168:169], v17 offset:16384
    v_mfma_f32_16x16x32_bf16 a[32:35], a[180:183], v[144:147], a[32:35]
    s_or_b64 s[54:55], s[54:55], vcc
    v_max_f32 v228, 0x00800000, v228
    v_mfma_f32_16x16x32_bf16 a[36:39], a[176:179], v[132:135], a[36:39]
    ds_read_b64_tr_b16 a[170:171], v17 offset:20480
    v_mfma_f32_16x16x32_bf16 a[36:39], a[180:183], v[148:151], a[36:39]
    v_accvgpr_read_b32 v230, a204
    v_cmp_ngt_f32 vcc, s60, v230
    v_mfma_f32_16x16x32_bf16 a[40:43], a[176:179], v[136:139], a[40:43]
    ds_read_b64_tr_b16 a[172:173], v17 offset:24576
    v_mfma_f32_16x16x32_bf16 a[40:43], a[180:183], v[152:155], a[40:43]
    buffer_load_dwordx4 v25, s[12:15], s45 offen offset:3072 nt lds
    s_add_u32 s45, s45, 16384
    v_mfma_f32_16x16x32_bf16 a[44:47], a[176:179], v[140:143], a[44:47]
    ds_read_b64_tr_b16 a[174:175], v17 offset:28672
    s_or_b64 s[54:55], s[54:55], vcc
    v_max_f32 v230, 0x00800000, v230
    v_mfma_f32_16x16x32_bf16 a[44:47], a[180:183], v[156:159], a[44:47]
    v_rcp_f32 v224, v224
    v_rcp_f32 v226, v226
    v_mfma_f32_16x16x32_bf16 a[48:51], a[184:187], v[128:131], a[48:51]
    ds_read_b64_tr_b16 a[176:177], v18 offset:16384
    v_rcp_f32 v228, v228
    v_mfma_f32_16x16x32_bf16 a[48:51], a[188:191], v[144:147], a[48:51]
    v_rcp_f32 v230, v230
    s_cmp_lg_u64 s[54:55], 0
    s_cselect_b32 s60, 1, 0
    v_mfma_f32_16x16x32_bf16 a[52:55], a[184:187], v[132:135], a[52:55]
    ds_read_b64_tr_b16 a[178:179], v18 offset:20480
    s_lshl_b32 s61, s43, 2
    s_add_u32 s61, s61, 131072
    v_mfma_f32_16x16x32_bf16 a[52:55], a[188:191], v[148:151], a[52:55]
    v_mov_b32 v225, s60
    v_mov_b32 v227, s61
    v_mfma_f32_16x16x32_bf16 a[56:59], a[184:187], v[136:139], a[56:59]
    ds_read_b64_tr_b16 a[180:181], v18 offset:24576
    ds_write_b32 v227, v225 offset:32256
    v_mfma_f32_16x16x32_bf16 a[56:59], a[188:191], v[152:155], a[56:59]
    v_mov_b32 v178, v30
    v_mov_b32 v179, v31
    v_mfma_f32_16x16x32_bf16 a[60:63], a[184:187], v[140:143], a[60:63]
    ds_read_b64_tr_b16 a[182:183], v18 offset:28672
    v_accvgpr_read_b32 v180, a212
    v_mfma_f32_16x16x32_bf16 a[60:63], a[188:191], v[156:159], a[60:63]
    v_accvgpr_read_b32 v181, a213
    v_accvgpr_read_b32 v182, a214
    s_waitcnt lgkmcnt(9)
    v_mfma_f32_16x16x32_bf16 a[64:67], a[160:163], v[128:131], a[64:67]
    ds_read_b64_tr_b16 a[184:185], v19 offset:16384
    ds_read_b64_tr_b16 a[186:187], v19 offset:20480
    v_mfma_f32_16x16x32_bf16 a[64:67], a[164:167], v[144:147], a[64:67]
    ds_read_b64_tr_b16 a[188:189], v19 offset:24576
    ds_read_b64_tr_b16 a[190:191], v19 offset:28672
    v_mfma_f32_16x16x32_bf16 a[68:71], a[160:163], v[132:135], a[68:71]
    v_accvgpr_read_b32 v183, a215
    v_accvgpr_read_b32 v184, a216
    v_mfma_f32_16x16x32_bf16 a[68:71], a[164:167], v[148:151], a[68:71]
    v_accvgpr_read_b32 v185, a217
    v_accvgpr_read_b32 v186, a218
    v_mfma_f32_16x16x32_bf16 a[72:75], a[160:163], v[136:139], a[72:75]
    v_accvgpr_read_b32 v187, a219
    v_accvgpr_read_b32 v188, a220
    v_mfma_f32_16x16x32_bf16 a[72:75], a[164:167], v[152:155], a[72:75]
    v_accvgpr_read_b32 v189, a221
    v_accvgpr_read_b32 v190, a222
    v_mfma_f32_16x16x32_bf16 a[76:79], a[160:163], v[140:143], a[76:79]
    v_accvgpr_read_b32 v191, a223
    v_accvgpr_read_b32 v192, a224
    v_mfma_f32_16x16x32_bf16 a[76:79], a[164:167], v[156:159], a[76:79]
    v_accvgpr_read_b32 v193, a225
    v_accvgpr_read_b32 v194, a226
    s_waitcnt lgkmcnt(9)
    v_mfma_f32_16x16x32_bf16 a[80:83], a[168:171], v[128:131], a[80:83]
    v_accvgpr_read_b32 v195, a227
    v_accvgpr_read_b32 v196, a228
    v_mfma_f32_16x16x32_bf16 a[80:83], a[172:175], v[144:147], a[80:83]
    v_accvgpr_read_b32 v197, a229
    v_accvgpr_read_b32 v198, a230
    v_mfma_f32_16x16x32_bf16 a[84:87], a[168:171], v[132:135], a[84:87]
    v_accvgpr_read_b32 v199, a231
    v_accvgpr_read_b32 v200, a232
    v_mfma_f32_16x16x32_bf16 a[84:87], a[172:175], v[148:151], a[84:87]
    v_accvgpr_read_b32 v201, a233
    v_accvgpr_read_b32 v202, a234
    v_mfma_f32_16x16x32_bf16 a[88:91], a[168:171], v[136:139], a[88:91]
    v_accvgpr_read_b32 v203, a235
    v_accvgpr_read_b32 v204, a236
    v_mfma_f32_16x16x32_bf16 a[88:91], a[172:175], v[152:155], a[88:91]
    v_accvgpr_read_b32 v205, a237
    v_accvgpr_read_b32 v206, a238
    v_mfma_f32_16x16x32_bf16 a[92:95], a[168:171], v[140:143], a[92:95]
    v_accvgpr_read_b32 v207, a239
    v_accvgpr_read_b32 v208, a240
    v_mfma_f32_16x16x32_bf16 a[92:95], a[172:175], v[156:159], a[92:95]
    v_accvgpr_read_b32 v209, a241
    v_accvgpr_read_b32 v210, a242
    s_waitcnt lgkmcnt(4)
    v_mfma_f32_16x16x32_bf16 a[96:99], a[176:179], v[128:131], a[96:99]
    v_accvgpr_read_b32 v211, a243
    v_accvgpr_read_b32 v212, a244
    v_mfma_f32_16x16x32_bf16 a[96:99], a[180:183], v[144:147], a[96:99]
    v_accvgpr_read_b32 v213, a245
    v_accvgpr_read_b32 v214, a246
    v_mfma_f32_16x16x32_bf16 a[100:103], a[176:179], v[132:135], a[100:103]
    v_accvgpr_read_b32 v215, a247
    v_accvgpr_read_b32 v216, a248
    v_mfma_f32_16x16x32_bf16 a[100:103], a[180:183], v[148:151], a[100:103]
    v_accvgpr_read_b32 v217, a249
    v_accvgpr_read_b32 v218, a250
    v_mfma_f32_16x16x32_bf16 a[104:107], a[176:179], v[136:139], a[104:107]
    v_accvgpr_read_b32 v219, a251
    v_accvgpr_read_b32 v220, a252
    v_mfma_f32_16x16x32_bf16 a[104:107], a[180:183], v[152:155], a[104:107]
    v_accvgpr_read_b32 v221, a253
    v_accvgpr_read_b32 v222, a254
    v_mfma_f32_16x16x32_bf16 a[108:111], a[176:179], v[140:143], a[108:111]
    v_accvgpr_read_b32 v223, a255
    v_accvgpr_read_b32 v32, a0
    v_mfma_f32_16x16x32_bf16 a[108:111], a[180:183], v[156:159], a[108:111]
    v_accvgpr_read_b32 v33, a1
    v_accvgpr_read_b32 v34, a2
    s_waitcnt lgkmcnt(0)
    v_mfma_f32_16x16x32_bf16 a[112:115], a[184:187], v[128:131], a[112:115]
    v_accvgpr_read_b32 v35, a3
    v_accvgpr_read_b32 v36, a16
    v_mfma_f32_16x16x32_bf16 a[112:115], a[188:191], v[144:147], a[112:115]
    v_accvgpr_read_b32 v37, a17
    v_accvgpr_read_b32 v38, a18
    v_mfma_f32_16x16x32_bf16 a[116:119], a[184:187], v[132:135], a[116:119]
    v_accvgpr_read_b32 v39, a19
    v_mul_f32 v32, v32, v224
    v_mfma_f32_16x16x32_bf16 a[116:119], a[188:191], v[148:151], a[116:119]
    v_mul_f32 v33, v33, v224
    v_mul_f32 v34, v34, v224
    v_mfma_f32_16x16x32_bf16 a[120:123], a[184:187], v[136:139], a[120:123]
    v_mul_f32 v35, v35, v224
    v_mul_f32 v36, v36, v224
    v_mfma_f32_16x16x32_bf16 a[120:123], a[188:191], v[152:155], a[120:123]
    v_mul_f32 v37, v37, v224
    v_mul_f32 v38, v38, v224
    v_mfma_f32_16x16x32_bf16 a[124:127], a[184:187], v[140:143], a[124:127]
    v_mul_f32 v39, v39, v224
    v_cvt_pk_bf16_f32 v240, v32, v33
    v_mfma_f32_16x16x32_bf16 a[124:127], a[188:191], v[156:159], a[124:127]
    v_cvt_pk_bf16_f32 v241, v34, v35
    v_cvt_pk_bf16_f32 v242, v36, v37
    v_cvt_pk_bf16_f32 v243, v38, v39
    v_accvgpr_read_b32 v40, a4
    v_accvgpr_read_b32 v41, a5
    v_accvgpr_read_b32 v42, a6
    v_accvgpr_read_b32 v43, a7
    v_accvgpr_read_b32 v44, a20
    v_accvgpr_read_b32 v45, a21
    v_accvgpr_read_b32 v46, a22
    v_accvgpr_read_b32 v47, a23
    v_mul_f32 v40, v40, v226
    v_mul_f32 v41, v41, v226
    v_mul_f32 v42, v42, v226
    v_mul_f32 v43, v43, v226
    v_mul_f32 v44, v44, v226
    v_mul_f32 v45, v45, v226
    v_mul_f32 v46, v46, v226
    v_mul_f32 v47, v47, v226
    v_cvt_pk_bf16_f32 v28, v40, v41
    v_cvt_pk_bf16_f32 v29, v42, v43
    v_cvt_pk_bf16_f32 v30, v44, v45
    v_cvt_pk_bf16_f32 v31, v46, v47
    v_accvgpr_read_b32 v32, a8
    v_accvgpr_read_b32 v33, a9
    v_accvgpr_read_b32 v34, a10
    v_accvgpr_read_b32 v35, a11
    v_accvgpr_read_b32 v36, a24
    v_accvgpr_read_b32 v37, a25
    v_accvgpr_read_b32 v38, a26
    v_accvgpr_read_b32 v39, a27
    v_mul_f32 v32, v32, v228
    v_mul_f32 v33, v33, v228
    v_mul_f32 v34, v34, v228
    v_mul_f32 v35, v35, v228
    v_mul_f32 v36, v36, v228
    v_mul_f32 v37, v37, v228
    v_mul_f32 v38, v38, v228
    v_mul_f32 v39, v39, v228
    v_cvt_pk_bf16_f32 v32, v32, v33
    v_cvt_pk_bf16_f32 v33, v34, v35
    v_cvt_pk_bf16_f32 v34, v36, v37
    v_cvt_pk_bf16_f32 v35, v38, v39
    v_accvgpr_write_b32 a224, v32
    v_accvgpr_write_b32 a225, v33
    v_accvgpr_write_b32 a226, v34
    v_accvgpr_write_b32 a227, v35
    v_accvgpr_read_b32 v40, a12
    v_accvgpr_read_b32 v41, a13
    v_accvgpr_read_b32 v42, a14
    v_accvgpr_read_b32 v43, a15
    v_accvgpr_read_b32 v44, a28
    v_accvgpr_read_b32 v45, a29
    v_accvgpr_read_b32 v46, a30
    v_accvgpr_read_b32 v47, a31
    v_mul_f32 v40, v40, v230
    v_mul_f32 v41, v41, v230
    v_mul_f32 v42, v42, v230
    v_mul_f32 v43, v43, v230
    v_mul_f32 v44, v44, v230
    v_mul_f32 v45, v45, v230
    v_mul_f32 v46, v46, v230
    v_mul_f32 v47, v47, v230
    v_cvt_pk_bf16_f32 v40, v40, v41
    v_cvt_pk_bf16_f32 v41, v42, v43
    v_cvt_pk_bf16_f32 v42, v44, v45
    v_cvt_pk_bf16_f32 v43, v46, v47
    v_accvgpr_write_b32 a240, v40
    v_accvgpr_write_b32 a241, v41
    v_accvgpr_write_b32 a242, v42
    v_accvgpr_write_b32 a243, v43
    v_accvgpr_read_b32 v32, a32
    v_accvgpr_read_b32 v33, a33
    v_accvgpr_read_b32 v34, a34
    v_accvgpr_read_b32 v35, a35
    v_accvgpr_read_b32 v36, a48
    v_accvgpr_read_b32 v37, a49
    v_accvgpr_read_b32 v38, a50
    v_accvgpr_read_b32 v39, a51
    v_pk_mul_f32 v[32:33], v[32:33], v[224:225] op_sel_hi:[1,0]
    v_pk_mul_f32 v[34:35], v[34:35], v[224:225] op_sel_hi:[1,0]
    v_pk_mul_f32 v[36:37], v[36:37], v[224:225] op_sel_hi:[1,0]
    v_pk_mul_f32 v[38:39], v[38:39], v[224:225] op_sel_hi:[1,0]
    v_cvt_pk_bf16_f32 v244, v32, v33
    v_cvt_pk_bf16_f32 v245, v34, v35
    v_cvt_pk_bf16_f32 v246, v36, v37
    v_cvt_pk_bf16_f32 v247, v38, v39
    v_accvgpr_read_b32 v40, a36
    v_accvgpr_read_b32 v41, a37
    v_accvgpr_read_b32 v42, a38
    v_accvgpr_read_b32 v43, a39
    v_accvgpr_read_b32 v44, a52
    v_accvgpr_read_b32 v45, a53
    v_accvgpr_read_b32 v46, a54
    v_accvgpr_read_b32 v47, a55
    v_pk_mul_f32 v[40:41], v[40:41], v[226:227] op_sel_hi:[1,0]
    v_pk_mul_f32 v[42:43], v[42:43], v[226:227] op_sel_hi:[1,0]
    v_pk_mul_f32 v[44:45], v[44:45], v[226:227] op_sel_hi:[1,0]
    v_pk_mul_f32 v[46:47], v[46:47], v[226:227] op_sel_hi:[1,0]
    v_cvt_pk_bf16_f32 v40, v40, v41
    v_cvt_pk_bf16_f32 v41, v42, v43
    v_cvt_pk_bf16_f32 v42, v44, v45
    v_cvt_pk_bf16_f32 v43, v46, v47
    v_accvgpr_write_b32 a212, v40
    v_accvgpr_write_b32 a213, v41
    v_accvgpr_write_b32 a214, v42
    v_accvgpr_write_b32 a215, v43
    v_accvgpr_read_b32 v32, a40
    v_accvgpr_read_b32 v33, a41
    v_accvgpr_read_b32 v34, a42
    v_accvgpr_read_b32 v35, a43
    v_accvgpr_read_b32 v36, a56
    v_accvgpr_read_b32 v37, a57
    v_accvgpr_read_b32 v38, a58
    v_accvgpr_read_b32 v39, a59
    v_pk_mul_f32 v[32:33], v[32:33], v[228:229] op_sel_hi:[1,0]
    v_pk_mul_f32 v[34:35], v[34:35], v[228:229] op_sel_hi:[1,0]
    v_pk_mul_f32 v[36:37], v[36:37], v[228:229] op_sel_hi:[1,0]
    v_pk_mul_f32 v[38:39], v[38:39], v[228:229] op_sel_hi:[1,0]
    v_cvt_pk_bf16_f32 v32, v32, v33
    v_cvt_pk_bf16_f32 v33, v34, v35
    v_cvt_pk_bf16_f32 v34, v36, v37
    v_cvt_pk_bf16_f32 v35, v38, v39
    v_accvgpr_write_b32 a228, v32
    v_accvgpr_write_b32 a229, v33
    v_accvgpr_write_b32 a230, v34
    v_accvgpr_write_b32 a231, v35
    v_accvgpr_read_b32 v40, a44
    v_accvgpr_read_b32 v41, a45
    v_accvgpr_read_b32 v42, a46
    v_accvgpr_read_b32 v43, a47
    v_accvgpr_read_b32 v44, a60
    v_accvgpr_read_b32 v45, a61
    v_accvgpr_read_b32 v46, a62
    v_accvgpr_read_b32 v47, a63
    v_pk_mul_f32 v[40:41], v[40:41], v[230:231] op_sel_hi:[1,0]
    v_pk_mul_f32 v[42:43], v[42:43], v[230:231] op_sel_hi:[1,0]
    v_pk_mul_f32 v[44:45], v[44:45], v[230:231] op_sel_hi:[1,0]
    v_pk_mul_f32 v[46:47], v[46:47], v[230:231] op_sel_hi:[1,0]
    v_cvt_pk_bf16_f32 v40, v40, v41
    v_cvt_pk_bf16_f32 v41, v42, v43
    v_cvt_pk_bf16_f32 v42, v44, v45
    v_cvt_pk_bf16_f32 v43, v46, v47
    v_accvgpr_write_b32 a244, v40
    v_accvgpr_write_b32 a245, v41
    v_accvgpr_write_b32 a246, v42
    v_accvgpr_write_b32 a247, v43
    v_accvgpr_read_b32 v32, a64
    v_accvgpr_read_b32 v33, a65
    v_accvgpr_read_b32 v34, a66
    v_accvgpr_read_b32 v35, a67
    v_accvgpr_read_b32 v36, a80
    v_accvgpr_read_b32 v37, a81
    v_accvgpr_read_b32 v38, a82
    v_accvgpr_read_b32 v39, a83
    v_pk_mul_f32 v[32:33], v[32:33], v[224:225] op_sel_hi:[1,0]
    v_pk_mul_f32 v[34:35], v[34:35], v[224:225] op_sel_hi:[1,0]
    v_pk_mul_f32 v[36:37], v[36:37], v[224:225] op_sel_hi:[1,0]
    v_pk_mul_f32 v[38:39], v[38:39], v[224:225] op_sel_hi:[1,0]
    v_cvt_pk_bf16_f32 v248, v32, v33
    v_cvt_pk_bf16_f32 v249, v34, v35
    v_cvt_pk_bf16_f32 v250, v36, v37
    v_cvt_pk_bf16_f32 v251, v38, v39
    v_accvgpr_read_b32 v40, a68
    v_accvgpr_read_b32 v41, a69
    v_accvgpr_read_b32 v42, a70
    v_accvgpr_read_b32 v43, a71
    v_accvgpr_read_b32 v44, a84
    v_accvgpr_read_b32 v45, a85
    v_accvgpr_read_b32 v46, a86
    v_accvgpr_read_b32 v47, a87
    v_pk_mul_f32 v[40:41], v[40:41], v[226:227] op_sel_hi:[1,0]
    v_pk_mul_f32 v[42:43], v[42:43], v[226:227] op_sel_hi:[1,0]
    v_pk_mul_f32 v[44:45], v[44:45], v[226:227] op_sel_hi:[1,0]
    v_pk_mul_f32 v[46:47], v[46:47], v[226:227] op_sel_hi:[1,0]
    v_cvt_pk_bf16_f32 v40, v40, v41
    v_cvt_pk_bf16_f32 v41, v42, v43
    v_cvt_pk_bf16_f32 v42, v44, v45
    v_cvt_pk_bf16_f32 v43, v46, v47
    v_accvgpr_write_b32 a216, v40
    v_accvgpr_write_b32 a217, v41
    v_accvgpr_write_b32 a218, v42
    v_accvgpr_write_b32 a219, v43
    v_accvgpr_read_b32 v32, a72
    v_accvgpr_read_b32 v33, a73
    v_accvgpr_read_b32 v34, a74
    v_accvgpr_read_b32 v35, a75
    v_accvgpr_read_b32 v36, a88
    v_accvgpr_read_b32 v37, a89
    v_accvgpr_read_b32 v38, a90
    v_accvgpr_read_b32 v39, a91
    v_pk_mul_f32 v[32:33], v[32:33], v[228:229] op_sel_hi:[1,0]
    v_pk_mul_f32 v[34:35], v[34:35], v[228:229] op_sel_hi:[1,0]
    v_pk_mul_f32 v[36:37], v[36:37], v[228:229] op_sel_hi:[1,0]
    v_pk_mul_f32 v[38:39], v[38:39], v[228:229] op_sel_hi:[1,0]
    v_cvt_pk_bf16_f32 v32, v32, v33
    v_cvt_pk_bf16_f32 v33, v34, v35
    v_cvt_pk_bf16_f32 v34, v36, v37
    v_cvt_pk_bf16_f32 v35, v38, v39
    v_accvgpr_write_b32 a232, v32
    v_accvgpr_write_b32 a233, v33
    v_accvgpr_write_b32 a234, v34
    v_accvgpr_write_b32 a235, v35
    v_accvgpr_read_b32 v40, a76
    v_accvgpr_read_b32 v41, a77
    v_accvgpr_read_b32 v42, a78
    v_accvgpr_read_b32 v43, a79
    v_accvgpr_read_b32 v44, a92
    v_accvgpr_read_b32 v45, a93
    v_accvgpr_read_b32 v46, a94
    v_accvgpr_read_b32 v47, a95
    v_pk_mul_f32 v[40:41], v[40:41], v[230:231] op_sel_hi:[1,0]
    v_pk_mul_f32 v[42:43], v[42:43], v[230:231] op_sel_hi:[1,0]
    v_pk_mul_f32 v[44:45], v[44:45], v[230:231] op_sel_hi:[1,0]
    v_pk_mul_f32 v[46:47], v[46:47], v[230:231] op_sel_hi:[1,0]
    v_cvt_pk_bf16_f32 v40, v40, v41
    v_cvt_pk_bf16_f32 v41, v42, v43
    v_cvt_pk_bf16_f32 v42, v44, v45
    v_cvt_pk_bf16_f32 v43, v46, v47
    v_accvgpr_write_b32 a248, v40
    v_accvgpr_write_b32 a249, v41
    v_accvgpr_write_b32 a250, v42
    v_accvgpr_write_b32 a251, v43
    v_accvgpr_read_b32 v32, a96
    v_accvgpr_read_b32 v33, a97
    v_accvgpr_read_b32 v34, a98
    v_accvgpr_read_b32 v35, a99
    v_accvgpr_read_b32 v36, a112
    v_accvgpr_read_b32 v37, a113
    v_accvgpr_read_b32 v38, a114
    v_accvgpr_read_b32 v39, a115
    v_pk_mul_f32 v[32:33], v[32:33], v[224:225] op_sel_hi:[1,0]
    v_pk_mul_f32 v[34:35], v[34:35], v[224:225] op_sel_hi:[1,0]
    v_pk_mul_f32 v[36:37], v[36:37], v[224:225] op_sel_hi:[1,0]
    v_pk_mul_f32 v[38:39], v[38:39], v[224:225] op_sel_hi:[1,0]
    v_cvt_pk_bf16_f32 v252, v32, v33
    v_cvt_pk_bf16_f32 v253, v34, v35
    v_cvt_pk_bf16_f32 v254, v36, v37
    v_cvt_pk_bf16_f32 v255, v38, v39
    v_accvgpr_read_b32 v40, a100
    v_accvgpr_read_b32 v41, a101
    v_accvgpr_read_b32 v42, a102
    v_accvgpr_read_b32 v43, a103
    v_accvgpr_read_b32 v44, a116
    v_accvgpr_read_b32 v45, a117
    v_accvgpr_read_b32 v46, a118
    v_accvgpr_read_b32 v47, a119
    v_pk_mul_f32 v[40:41], v[40:41], v[226:227] op_sel_hi:[1,0]
    v_pk_mul_f32 v[42:43], v[42:43], v[226:227] op_sel_hi:[1,0]
    v_pk_mul_f32 v[44:45], v[44:45], v[226:227] op_sel_hi:[1,0]
    v_pk_mul_f32 v[46:47], v[46:47], v[226:227] op_sel_hi:[1,0]
    v_cvt_pk_bf16_f32 v40, v40, v41
    v_cvt_pk_bf16_f32 v41, v42, v43
    v_cvt_pk_bf16_f32 v42, v44, v45
    v_cvt_pk_bf16_f32 v43, v46, v47
    v_accvgpr_write_b32 a220, v40
    v_accvgpr_write_b32 a221, v41
    v_accvgpr_write_b32 a222, v42
    v_accvgpr_write_b32 a223, v43
    v_accvgpr_read_b32 v32, a104
    v_accvgpr_read_b32 v33, a105
    v_accvgpr_read_b32 v34, a106
    v_accvgpr_read_b32 v35, a107
    v_accvgpr_read_b32 v36, a120
    v_accvgpr_read_b32 v37, a121
    v_accvgpr_read_b32 v38, a122
    v_accvgpr_read_b32 v39, a123
    v_pk_mul_f32 v[32:33], v[32:33], v[228:229] op_sel_hi:[1,0]
    v_pk_mul_f32 v[34:35], v[34:35], v[228:229] op_sel_hi:[1,0]
    v_pk_mul_f32 v[36:37], v[36:37], v[228:229] op_sel_hi:[1,0]
    v_pk_mul_f32 v[38:39], v[38:39], v[228:229] op_sel_hi:[1,0]
    v_cvt_pk_bf16_f32 v32, v32, v33
    v_cvt_pk_bf16_f32 v33, v34, v35
    v_cvt_pk_bf16_f32 v34, v36, v37
    v_cvt_pk_bf16_f32 v35, v38, v39
    v_accvgpr_write_b32 a236, v32
    v_accvgpr_write_b32 a237, v33
    v_accvgpr_write_b32 a238, v34
    v_accvgpr_write_b32 a239, v35
    v_accvgpr_read_b32 v40, a108
    v_accvgpr_read_b32 v41, a109
    v_accvgpr_read_b32 v42, a110
    v_accvgpr_read_b32 v43, a111
    v_accvgpr_read_b32 v44, a124
    v_accvgpr_read_b32 v45, a125
    v_accvgpr_read_b32 v46, a126
    v_accvgpr_read_b32 v47, a127
    v_pk_mul_f32 v[40:41], v[40:41], v[230:231] op_sel_hi:[1,0]
    v_pk_mul_f32 v[42:43], v[42:43], v[230:231] op_sel_hi:[1,0]
    v_pk_mul_f32 v[44:45], v[44:45], v[230:231] op_sel_hi:[1,0]
    v_pk_mul_f32 v[46:47], v[46:47], v[230:231] op_sel_hi:[1,0]
    v_cvt_pk_bf16_f32 v40, v40, v41
    v_cvt_pk_bf16_f32 v41, v42, v43
    v_cvt_pk_bf16_f32 v42, v44, v45
    v_cvt_pk_bf16_f32 v43, v46, v47
    v_accvgpr_write_b32 a252, v40
    v_accvgpr_write_b32 a253, v41
    v_accvgpr_write_b32 a254, v42
    v_accvgpr_write_b32 a255, v43
    s_mov_b32 s49, 1
    s_mov_b32 s93, 3
    s_branch L_block
.p2align 6
L_tail:
    v_readfirstlane_b32 s3, v7
    s_cmp_lg_u32 s43, 0
    s_cselect_b32 s3, 256, s3
    s_cmp_ge_u32 s3, 256
    s_cbranch_scc0 L_spinD
L_backD:
    s_waitcnt vmcnt(16) lgkmcnt(0)
    s_barrier
    v_mov_b32 v2, 131072
    ds_read_b128 v[20:23], v2 offset:32256
    s_lshl_b32 s3, s42, 2
    s_add_u32 s3, s3, s53
    s_mul_i32 s3, s3, 36864
    s_add_u32 s3, s3, s92
    v_cmp_gt_u32 vcc, 24, v0
    v_lshl_add_u32 v1, v0, 7, s3
    v_bfrev_b32 v3, 1
    v_cndmask_b32 v1, v3, v1, vcc
    v_mfma_f32_16x16x32_bf16 a[64:67], a[160:163], v[128:131], a[64:67]
    ds_read_b128 a[128:131], v8 offset:16384
    v_cvt_pk_bf16_f32 v111, v62, v63
    v_mfma_f32_16x16x32_bf16 a[64:67], a[164:167], v[144:147], a[64:67]
    v_exp_f32 v64, v64
    v_mfma_f32_16x16x32_bf16 a[68:71], a[160:163], v[132:135], a[68:71]
    ds_read_b128 a[132:135], v9 offset:16384
    s_mov_b32 s63, 0
    buffer_load_dword v5, v1, s[28:31], s63 offen
    v_mfma_f32_16x16x32_bf16 a[68:71], a[164:167], v[148:151], a[68:71]
    v_exp_f32 v65, v65
    v_mfma_f32_16x16x32_bf16 a[72:75], a[160:163], v[136:139], a[72:75]
    v_cvt_pk_bf16_f32 v112, v64, v65
    v_mfma_f32_16x16x32_bf16 a[72:75], a[164:167], v[152:155], a[72:75]
    v_exp_f32 v66, v66
    v_mfma_f32_16x16x32_bf16 a[76:79], a[160:163], v[140:143], a[76:79]
    s_mov_b32 m0, s39
    ds_read_b128 a[136:139], v10 offset:16384
    ds_read_b128 a[140:143], v11 offset:16384
    v_mfma_f32_16x16x32_bf16 a[76:79], a[164:167], v[156:159], a[76:79]
    buffer_load_dwordx4 v24, s[12:15], s45 offen offset:0 nt lds
    v_mfma_f32_16x16x32_bf16 a[80:83], a[168:171], v[128:131], a[80:83]
    v_exp_f32 v67, v67
    v_mfma_f32_16x16x32_bf16 a[80:83], a[172:175], v[144:147], a[80:83]
    v_cvt_pk_bf16_f32 v113, v66, v67
    s_mov_b32 s63, 3072
    buffer_load_dword v5, v1, s[28:31], s63 offen
    v_mfma_f32_16x16x32_bf16 a[84:87], a[168:171], v[132:135], a[84:87]
    v_exp_f32 v68, v68
    v_mfma_f32_16x16x32_bf16 a[84:87], a[172:175], v[148:151], a[84:87]
    ds_read_b128 a[144:147], v8 offset:20480
    ds_read_b128 a[148:151], v9 offset:20480
    v_mfma_f32_16x16x32_bf16 a[88:91], a[168:171], v[136:139], a[88:91]
    buffer_load_dwordx4 v25, s[12:15], s45 offen offset:1024 nt lds
    v_mfma_f32_16x16x32_bf16 a[88:91], a[172:175], v[152:155], a[88:91]
    v_exp_f32 v69, v69
    v_mfma_f32_16x16x32_bf16 a[92:95], a[168:171], v[140:143], a[92:95]
    v_cvt_pk_bf16_f32 v114, v68, v69
    s_mov_b32 s63, 6144
    buffer_load_dword v5, v1, s[28:31], s63 offen
    v_mfma_f32_16x16x32_bf16 a[92:95], a[172:175], v[156:159], a[92:95]
    v_exp_f32 v70, v70
    v_mfma_f32_16x16x32_bf16 a[96:99], a[176:179], v[128:131], a[96:99]
    ds_read_b128 a[152:155], v10 offset:20480
    ds_read_b128 a[156:159], v11 offset:20480
    v_mfma_f32_16x16x32_bf16 a[96:99], a[180:183], v[144:147], a[96:99]
    buffer_load_dwordx4 v24, s[12:15], s45 offen offset:2048 nt lds
    v_mfma_f32_16x16x32_bf16 a[100:103], a[176:179], v[132:135], a[100:103]
    v_exp_f32 v71, v71
    v_mfma_f32_16x16x32_bf16 a[100:103], a[180:183], v[148:151], a[100:103]
    v_cvt_pk_bf16_f32 v115, v70, v71
    v_mfma_f32_16x16x32_bf16 a[104:107], a[176:179], v[136:139], a[104:107]
    v_exp_f32 v72, v72
    v_mfma_f32_16x16x32_bf16 a[104:107], a[180:183], v[152:155], a[104:107]
    v_mfma_f32_16x16x32_bf16 a[108:111], a[176:179], v[140:143], a[108:111]
    buffer_load_dwordx4 v25, s[12:15], s45 offen offset:3072 nt lds
    v_mfma_f32_16x16x32_bf16 a[108:111], a[180:183], v[156:159], a[108:111]
    v_exp_f32 v73, v73
    v_mfma_f32_16x16x32_bf16 a[112:115], a[184:187], v[128:131], a[112:115]
    v_cvt_pk_bf16_f32 v116, v72, v73
    v_mfma_f32_16x16x32_bf16 a[112:115], a[188:191], v[144:147], a[112:115]
    v_exp_f32 v74, v74
    v_mfma_f32_16x16x32_bf16 a[116:119], a[184:187], v[132:135], a[116:119]
    v_exp_f32 v75, v75
    v_mfma_f32_16x16x32_bf16 a[116:119], a[188:191], v[148:151], a[116:119]
    v_cvt_pk_bf16_f32 v117, v74, v75
    v_mfma_f32_16x16x32_bf16 a[120:123], a[184:187], v[136:139], a[120:123]
    v_exp_f32 v76, v76
    v_mfma_f32_16x16x32_bf16 a[120:123], a[188:191], v[152:155], a[120:123]
    v_exp_f32 v77, v77
    v_mfma_f32_16x16x32_bf16 a[124:127], a[184:187], v[140:143], a[124:127]
    v_cvt_pk_bf16_f32 v118, v76, v77
    v_mfma_f32_16x16x32_bf16 a[124:127], a[188:191], v[156:159], a[124:127]
    v_exp_f32 v78, v78
    v_mfma_f32_16x16x32_bf16 a[200:203], a[208:211], v[136:139], a[200:203]
    v_exp_f32 v79, v79
    v_mfma_f32_16x16x32_bf16 a[200:203], a[208:211], v[152:155], a[200:203]
    v_cvt_pk_bf16_f32 v119, v78, v79
    v_mfma_f32_16x16x32_bf16 a[204:207], a[208:211], v[140:143], a[204:207]
    v_exp_f32 v80, v80
    v_mfma_f32_16x16x32_bf16 a[204:207], a[208:211], v[156:159], a[204:207]
    v_exp_f32 v81, v81
    s_waitcnt lgkmcnt(0)
    v_mfma_f32_16x16x32_bf16 v[32:35], a[128:131], v[160:163], v[224:227]
    ds_read_b64_tr_b16 a[160:161], v12 offset:32768
    v_cvt_pk_bf16_f32 v120, v80, v81
    v_mfma_f32_16x16x32_bf16 v[32:35], a[132:135], v[164:167], v[32:35]
    v_exp_f32 v82, v82
    v_mfma_f32_16x16x32_bf16 v[32:35], a[136:139], v[168:171], v[32:35]
    ds_read_b64_tr_b16 a[162:163], v12 offset:36864
    ds_read_b64_tr_b16 a[164:165], v12 offset:40960
    v_mfma_f32_16x16x32_bf16 v[32:35], a[140:143], v[172:175], v[32:35]
    v_exp_f32 v83, v83
    v_mfma_f32_16x16x32_bf16 v[40:43], a[128:131], v[176:179], v[228:231]
    ds_read_b64_tr_b16 a[166:167], v12 offset:45056
    v_cvt_pk_bf16_f32 v121, v82, v83
    v_mfma_f32_16x16x32_bf16 v[40:43], a[132:135], v[180:183], v[40:43]
    v_exp_f32 v84, v84
    v_mfma_f32_16x16x32_bf16 v[40:43], a[136:139], v[184:187], v[40:43]
    ds_read_b64_tr_b16 a[168:169], v13 offset:32768
    ds_read_b64_tr_b16 a[170:171], v13 offset:36864
    v_mfma_f32_16x16x32_bf16 v[40:43], a[140:143], v[188:191], v[40:43]
    v_exp_f32 v85, v85
    v_mfma_f32_16x16x32_bf16 v[48:51], a[128:131], v[192:195], v[232:235]
    ds_read_b64_tr_b16 a[172:173], v13 offset:40960
    v_cvt_pk_bf16_f32 v122, v84, v85
    v_mfma_f32_16x16x32_bf16 v[48:51], a[132:135], v[196:199], v[48:51]
    v_exp_f32 v86, v86
    v_mfma_f32_16x16x32_bf16 v[48:51], a[136:139], v[200:203], v[48:51]
    ds_read_b64_tr_b16 a[174:175], v13 offset:45056
    ds_read_b64_tr_b16 a[176:177], v14 offset:32768
    v_mfma_f32_16x16x32_bf16 v[48:51], a[140:143], v[204:207], v[48:51]
    v_exp_f32 v87, v87
    v_mfma_f32_16x16x32_bf16 v[56:59], a[128:131], v[208:211], v[236:239]
    ds_read_b64_tr_b16 a[178:179], v14 offset:36864
    v_cvt_pk_bf16_f32 v123, v86, v87
    v_mfma_f32_16x16x32_bf16 v[56:59], a[132:135], v[212:215], v[56:59]
    v_exp_f32 v88, v88
    v_mfma_f32_16x16x32_bf16 v[56:59], a[136:139], v[216:219], v[56:59]
    ds_read_b64_tr_b16 a[180:181], v14 offset:40960
    ds_read_b64_tr_b16 a[182:183], v14 offset:45056
    v_mfma_f32_16x16x32_bf16 v[56:59], a[140:143], v[220:223], v[56:59]
    v_exp_f32 v89, v89
    v_mfma_f32_16x16x32_bf16 v[36:39], a[144:147], v[160:163], v[224:227]
    ds_read_b64_tr_b16 a[184:185], v15 offset:32768
    v_cvt_pk_bf16_f32 v124, v88, v89
    v_mfma_f32_16x16x32_bf16 v[36:39], a[148:151], v[164:167], v[36:39]
    v_exp_f32 v90, v90
    v_mfma_f32_16x16x32_bf16 v[36:39], a[152:155], v[168:171], v[36:39]
    ds_read_b64_tr_b16 a[186:187], v15 offset:36864
    ds_read_b64_tr_b16 a[188:189], v15 offset:40960
    v_mfma_f32_16x16x32_bf16 v[36:39], a[156:159], v[172:175], v[36:39]
    v_exp_f32 v91, v91
    v_mfma_f32_16x16x32_bf16 v[44:47], a[144:147], v[176:179], v[228:231]
    ds_read_b64_tr_b16 a[190:191], v15 offset:45056
    v_cvt_pk_bf16_f32 v125, v90, v91
    v_mfma_f32_16x16x32_bf16 v[44:47], a[148:151], v[180:183], v[44:47]
    v_exp_f32 v92, v92
    v_mfma_f32_16x16x32_bf16 v[44:47], a[152:155], v[184:187], v[44:47]
    v_exp_f32 v93, v93
    v_mfma_f32_16x16x32_bf16 v[44:47], a[156:159], v[188:191], v[44:47]
    v_cvt_pk_bf16_f32 v126, v92, v93
    v_mfma_f32_16x16x32_bf16 v[52:55], a[144:147], v[192:195], v[232:235]
    v_exp_f32 v94, v94
    v_mfma_f32_16x16x32_bf16 v[52:55], a[148:151], v[196:199], v[52:55]
    v_exp_f32 v95, v95
    v_mfma_f32_16x16x32_bf16 v[52:55], a[152:155], v[200:203], v[52:55]
    s_add_u32 s45, s45, 16384
    v_mfma_f32_16x16x32_bf16 v[52:55], a[156:159], v[204:207], v[52:55]
    v_mfma_f32_16x16x32_bf16 v[60:63], a[144:147], v[208:211], v[236:239]
    v_mfma_f32_16x16x32_bf16 v[60:63], a[148:151], v[212:215], v[60:63]
    v_mfma_f32_16x16x32_bf16 v[60:63], a[152:155], v[216:219], v[60:63]
    v_mfma_f32_16x16x32_bf16 v[60:63], a[156:159], v[220:223], v[60:63]
    s_waitcnt lgkmcnt(0)
    v_mfma_f32_16x16x32_bf16 a[0:3], a[160:163], v[96:99], a[0:3]
    ds_read_b128 a[128:131], v8 offset:24576
    v_cvt_pk_bf16_f32 v127, v94, v95
    v_mfma_f32_16x16x32_bf16 a[0:3], a[164:167], v[112:115], a[0:3]
    v_exp_f32 v32, v32
    v_mfma_f32_16x16x32_bf16 a[4:7], a[160:163], v[100:103], a[4:7]
    ds_read_b128 a[132:135], v9 offset:24576
    v_or3_b32 v2, v20, v21, v22
    v_mfma_f32_16x16x32_bf16 a[4:7], a[164:167], v[116:119], a[4:7]
    v_exp_f32 v33, v33
    v_mfma_f32_16x16x32_bf16 a[8:11], a[160:163], v[104:107], a[8:11]
    v_cvt_pk_bf16_f32 v128, v32, v33
    v_or_b32 v2, v2, v23
    v_mfma_f32_16x16x32_bf16 a[8:11], a[164:167], v[120:123], a[8:11]
    v_exp_f32 v34, v34
    v_mfma_f32_16x16x32_bf16 a[12:15], a[160:163], v[108:111], a[12:15]
    ds_read_b128 a[136:139], v10 offset:24576
    ds_read_b128 a[140:143], v11 offset:24576
    v_mfma_f32_16x16x32_bf16 a[12:15], a[164:167], v[124:127], a[12:15]
    v_mfma_f32_16x16x32_bf16 a[16:19], a[168:171], v[96:99], a[16:19]
    v_exp_f32 v35, v35
    v_mfma_f32_16x16x32_bf16 a[16:19], a[172:175], v[112:115], a[16:19]
    v_cvt_pk_bf16_f32 v129, v34, v35
    s_nop 0
    v_mfma_f32_16x16x32_bf16 a[20:23], a[168:171], v[100:103], a[20:23]
    v_exp_f32 v36, v36
    v_mfma_f32_16x16x32_bf16 a[20:23], a[172:175], v[116:119], a[20:23]
    ds_read_b128 a[144:147], v8 offset:28672
    ds_read_b128 a[148:151], v9 offset:28672
    v_mfma_f32_16x16x32_bf16 a[24:27], a[168:171], v[104:107], a[24:27]
    v_mfma_f32_16x16x32_bf16 a[24:27], a[172:175], v[120:123], a[24:27]
    v_exp_f32 v37, v37
    v_mfma_f32_16x16x32_bf16 a[28:31], a[168:171], v[108:111], a[28:31]
    v_cvt_pk_bf16_f32 v130, v36, v37
    v_readfirstlane_b32 s94, v2
    v_mfma_f32_16x16x32_bf16 a[28:31], a[172:175], v[124:127], a[28:31]
    v_exp_f32 v38, v38
    v_mfma_f32_16x16x32_bf16 a[32:35], a[176:179], v[96:99], a[32:35]
    ds_read_b128 a[152:155], v10 offset:28672
    ds_read_b128 a[156:159], v11 offset:28672
    v_mfma_f32_16x16x32_bf16 a[32:35], a[180:183], v[112:115], a[32:35]
    v_mfma_f32_16x16x32_bf16 a[36:39], a[176:179], v[100:103], a[36:39]
    v_exp_f32 v39, v39
    v_mfma_f32_16x16x32_bf16 a[36:39], a[180:183], v[116:119], a[36:39]
    v_cvt_pk_bf16_f32 v131, v38, v39
    s_lshr_b32 s6, s2, 3
    v_mfma_f32_16x16x32_bf16 a[40:43], a[176:179], v[104:107], a[40:43]
    v_exp_f32 v40, v40
    v_mfma_f32_16x16x32_bf16 a[40:43], a[180:183], v[120:123], a[40:43]
    v_mfma_f32_16x16x32_bf16 a[44:47], a[176:179], v[108:111], a[44:47]
    v_mfma_f32_16x16x32_bf16 a[44:47], a[180:183], v[124:127], a[44:47]
    v_exp_f32 v41, v41
    v_mfma_f32_16x16x32_bf16 a[48:51], a[184:187], v[96:99], a[48:51]
    v_cvt_pk_bf16_f32 v132, v40, v41
    s_lshl_b32 s6, s6, 2
    v_mfma_f32_16x16x32_bf16 a[48:51], a[188:191], v[112:115], a[48:51]
    v_exp_f32 v42, v42
    v_mfma_f32_16x16x32_bf16 a[52:55], a[184:187], v[100:103], a[52:55]
    v_exp_f32 v43, v43
    v_mfma_f32_16x16x32_bf16 a[52:55], a[188:191], v[116:119], a[52:55]
    v_cvt_pk_bf16_f32 v133, v42, v43
    s_add_u32 s6, s6, s43
    v_mfma_f32_16x16x32_bf16 a[56:59], a[184:187], v[104:107], a[56:59]
    v_exp_f32 v44, v44
    v_mfma_f32_16x16x32_bf16 a[56:59], a[188:191], v[120:123], a[56:59]
    v_exp_f32 v45, v45
    v_mfma_f32_16x16x32_bf16 a[60:63], a[184:187], v[108:111], a[60:63]
    v_cvt_pk_bf16_f32 v134, v44, v45
    s_lshl_b32 s6, s6, 8
    v_mfma_f32_16x16x32_bf16 a[60:63], a[188:191], v[124:127], a[60:63]
    v_exp_f32 v46, v46
    v_mfma_f32_16x16x32_bf16 a[192:195], a[208:211], v[96:99], a[192:195]
    v_exp_f32 v47, v47
    v_mfma_f32_16x16x32_bf16 a[192:195], a[208:211], v[112:115], a[192:195]
    v_cvt_pk_bf16_f32 v135, v46, v47
    s_add_u32 s6, s6, L_op-concat_heads__mha_block_cached__gqa_block_cached__near_ridge_kernel
    v_mfma_f32_16x16x32_bf16 a[196:199], a[208:211], v[100:103], a[196:199]
    v_exp_f32 v48, v48
    v_mfma_f32_16x16x32_bf16 a[196:199], a[208:211], v[116:119], a[196:199]
    v_exp_f32 v49, v49
    s_waitcnt lgkmcnt(0)
    v_mfma_f32_16x16x32_bf16 v[64:67], a[128:131], v[160:163], v[224:227]
    ds_read_b64_tr_b16 a[160:161], v16 offset:32768
    v_cvt_pk_bf16_f32 v136, v48, v49
    v_mfma_f32_16x16x32_bf16 v[64:67], a[132:135], v[164:167], v[64:67]
    v_exp_f32 v50, v50
    v_mfma_f32_16x16x32_bf16 v[64:67], a[136:139], v[168:171], v[64:67]
    ds_read_b64_tr_b16 a[162:163], v16 offset:36864
    ds_read_b64_tr_b16 a[164:165], v16 offset:40960
    v_mfma_f32_16x16x32_bf16 v[64:67], a[140:143], v[172:175], v[64:67]
    v_exp_f32 v51, v51
    v_mfma_f32_16x16x32_bf16 v[72:75], a[128:131], v[176:179], v[228:231]
    ds_read_b64_tr_b16 a[166:167], v16 offset:45056
    v_cvt_pk_bf16_f32 v137, v50, v51
    v_mfma_f32_16x16x32_bf16 v[72:75], a[132:135], v[180:183], v[72:75]
    v_exp_f32 v52, v52
    v_mfma_f32_16x16x32_bf16 v[72:75], a[136:139], v[184:187], v[72:75]
    ds_read_b64_tr_b16 a[168:169], v17 offset:32768
    ds_read_b64_tr_b16 a[170:171], v17 offset:36864
    v_mfma_f32_16x16x32_bf16 v[72:75], a[140:143], v[188:191], v[72:75]
    v_exp_f32 v53, v53
    v_mfma_f32_16x16x32_bf16 v[80:83], a[128:131], v[192:195], v[232:235]
    ds_read_b64_tr_b16 a[172:173], v17 offset:40960
    v_cvt_pk_bf16_f32 v138, v52, v53
    v_mfma_f32_16x16x32_bf16 v[80:83], a[132:135], v[196:199], v[80:83]
    v_exp_f32 v54, v54
    v_mfma_f32_16x16x32_bf16 v[80:83], a[136:139], v[200:203], v[80:83]
    ds_read_b64_tr_b16 a[174:175], v17 offset:45056
    ds_read_b64_tr_b16 a[176:177], v18 offset:32768
    v_mfma_f32_16x16x32_bf16 v[80:83], a[140:143], v[204:207], v[80:83]
    v_exp_f32 v55, v55
    v_mfma_f32_16x16x32_bf16 v[88:91], a[128:131], v[208:211], v[236:239]
    ds_read_b64_tr_b16 a[178:179], v18 offset:36864
    v_cvt_pk_bf16_f32 v139, v54, v55
    v_mfma_f32_16x16x32_bf16 v[88:91], a[132:135], v[212:215], v[88:91]
    v_exp_f32 v56, v56
    v_mfma_f32_16x16x32_bf16 v[88:91], a[136:139], v[216:219], v[88:91]
    ds_read_b64_tr_b16 a[180:181], v18 offset:40960
    ds_read_b64_tr_b16 a[182:183], v18 offset:45056
    v_mfma_f32_16x16x32_bf16 v[88:91], a[140:143], v[220:223], v[88:91]
    v_exp_f32 v57, v57
    v_mfma_f32_16x16x32_bf16 v[68:71], a[144:147], v[160:163], v[224:227]
    ds_read_b64_tr_b16 a[184:185], v19 offset:32768
    v_cvt_pk_bf16_f32 v140, v56, v57
    v_mfma_f32_16x16x32_bf16 v[68:71], a[148:151], v[164:167], v[68:71]
    v_exp_f32 v58, v58
    v_mfma_f32_16x16x32_bf16 v[68:71], a[152:155], v[168:171], v[68:71]
    ds_read_b64_tr_b16 a[186:187], v19 offset:36864
    ds_read_b64_tr_b16 a[188:189], v19 offset:40960
    v_mfma_f32_16x16x32_bf16 v[68:71], a[156:159], v[172:175], v[68:71]
    v_exp_f32 v59, v59
    v_mfma_f32_16x16x32_bf16 v[76:79], a[144:147], v[176:179], v[228:231]
    ds_read_b64_tr_b16 a[190:191], v19 offset:45056
    v_cvt_pk_bf16_f32 v141, v58, v59
    v_mfma_f32_16x16x32_bf16 v[76:79], a[148:151], v[180:183], v[76:79]
    v_exp_f32 v60, v60
    v_mfma_f32_16x16x32_bf16 v[76:79], a[152:155], v[184:187], v[76:79]
    v_exp_f32 v61, v61
    v_mfma_f32_16x16x32_bf16 v[76:79], a[156:159], v[188:191], v[76:79]
    v_cvt_pk_bf16_f32 v142, v60, v61
    v_lshlrev_b32 v6, 7, v0
    v_mfma_f32_16x16x32_bf16 v[84:87], a[144:147], v[192:195], v[232:235]
    v_exp_f32 v62, v62
    v_mfma_f32_16x16x32_bf16 v[84:87], a[148:151], v[196:199], v[84:87]
    v_exp_f32 v63, v63
    v_mfma_f32_16x16x32_bf16 v[84:87], a[152:155], v[200:203], v[84:87]
    s_mov_b64 exec, 3
    buffer_load_dword v5, v6, s[80:83], s6 offen
    s_mov_b64 exec, -1
    v_mfma_f32_16x16x32_bf16 v[84:87], a[156:159], v[204:207], v[84:87]
    s_lshl_b32 s95, s53, 17
    s_cmp_eq_u32 s88, 0
    s_cselect_b64 exec, 0, -1
    buffer_store_dwordx4 v[240:243], v26, s[24:27], s95 offen offset:0 sc1
    s_mov_b64 exec, -1
    v_mfma_f32_16x16x32_bf16 v[92:95], a[144:147], v[208:211], v[236:239]
    v_mfma_f32_16x16x32_bf16 v[92:95], a[148:151], v[212:215], v[92:95]
    v_mfma_f32_16x16x32_bf16 v[92:95], a[152:155], v[216:219], v[92:95]
    v_mfma_f32_16x16x32_bf16 v[92:95], a[156:159], v[220:223], v[92:95]
    s_waitcnt vmcnt(17) lgkmcnt(0)
    s_barrier
    v_mfma_f32_16x16x32_bf16 a[64:67], a[160:163], v[96:99], a[64:67]
    ds_read_b128 a[128:131], v8 offset:32768
    v_cvt_pk_bf16_f32 v143, v62, v63
    v_mfma_f32_16x16x32_bf16 a[64:67], a[164:167], v[112:115], a[64:67]
    v_exp_f32 v64, v64
    v_mfma_f32_16x16x32_bf16 a[68:71], a[160:163], v[100:103], a[68:71]
    ds_read_b128 a[132:135], v9 offset:32768
    v_mul_u32_u24 v2, 3641, v0
    v_mfma_f32_16x16x32_bf16 a[68:71], a[164:167], v[116:119], a[68:71]
    v_exp_f32 v65, v65
    v_mfma_f32_16x16x32_bf16 a[72:75], a[160:163], v[104:107], a[72:75]
    v_cvt_pk_bf16_f32 v144, v64, v65
    v_lshrrev_b32 v2, 16, v2
    v_mfma_f32_16x16x32_bf16 a[72:75], a[164:167], v[120:123], a[72:75]
    v_exp_f32 v66, v66
    v_mfma_f32_16x16x32_bf16 a[76:79], a[160:163], v[108:111], a[76:79]
    ds_read_b128 a[136:139], v10 offset:32768
    ds_read_b128 a[140:143], v11 offset:32768
    v_mfma_f32_16x16x32_bf16 a[76:79], a[164:167], v[124:127], a[76:79]
    v_mul_u32_u24 v3, 18, v2
    v_sub_u32 v3, v0, v3
    v_mfma_f32_16x16x32_bf16 a[80:83], a[168:171], v[96:99], a[80:83]
    v_exp_f32 v67, v67
    v_mfma_f32_16x16x32_bf16 a[80:83], a[172:175], v[112:115], a[80:83]
    v_cvt_pk_bf16_f32 v145, v66, v67
    s_mul_i32 s3, s53, 288
    v_mfma_f32_16x16x32_bf16 a[84:87], a[168:171], v[100:103], a[84:87]
    v_exp_f32 v68, v68
    v_mfma_f32_16x16x32_bf16 a[84:87], a[172:175], v[116:119], a[84:87]
    ds_read_b128 a[144:147], v8 offset:36864
    ds_read_b128 a[148:151], v9 offset:36864
    v_mfma_f32_16x16x32_bf16 a[88:91], a[168:171], v[104:107], a[88:91]
    s_lshl_b32 s4, s92, 2
    s_add_u32 s3, s3, s4
    v_mfma_f32_16x16x32_bf16 a[88:91], a[172:175], v[120:123], a[88:91]
    v_exp_f32 v69, v69
    v_mfma_f32_16x16x32_bf16 a[92:95], a[168:171], v[108:111], a[92:95]
    v_cvt_pk_bf16_f32 v146, v68, v69
    v_mul_u32_u24 v2, 1152, v2
    v_mfma_f32_16x16x32_bf16 a[92:95], a[172:175], v[124:127], a[92:95]
    v_exp_f32 v70, v70
    v_mfma_f32_16x16x32_bf16 a[96:99], a[176:179], v[96:99], a[96:99]
    ds_read_b128 a[152:155], v10 offset:36864
    ds_read_b128 a[156:159], v11 offset:36864
    v_mfma_f32_16x16x32_bf16 a[96:99], a[180:183], v[112:115], a[96:99]
    v_lshl_add_u32 v2, v3, 4, v2
    v_add_u32 v2, s3, v2
    v_mfma_f32_16x16x32_bf16 a[100:103], a[176:179], v[100:103], a[100:103]
    v_exp_f32 v71, v71
    v_mfma_f32_16x16x32_bf16 a[100:103], a[180:183], v[116:119], a[100:103]
    v_cvt_pk_bf16_f32 v147, v70, v71
    s_cmp_eq_u32 s88, 1
    s_cselect_b64 exec, 0, -1
    buffer_store_dwordx4 v[28:31], v26, s[24:27], s95 offen offset:1024 sc1
    s_mov_b64 exec, -1
    v_mfma_f32_16x16x32_bf16 a[104:107], a[176:179], v[104:107], a[104:107]
    v_exp_f32 v72, v72
    v_mfma_f32_16x16x32_bf16 a[104:107], a[180:183], v[120:123], a[104:107]
    v_add_u32 v4, 864, v2
    v_cmp_gt_u32 s[4:5], 18, v3
    v_mfma_f32_16x16x32_bf16 a[108:111], a[176:179], v[108:111], a[108:111]
    v_cmp_gt_u32 s[6:7], 8, v3
    s_nop 0
    v_mfma_f32_16x16x32_bf16 a[108:111], a[180:183], v[124:127], a[108:111]
    v_exp_f32 v73, v73
    v_mfma_f32_16x16x32_bf16 a[112:115], a[184:187], v[96:99], a[112:115]
    v_cvt_pk_bf16_f32 v148, v72, v73
    v_cndmask_b32 v6, v4, v2, s[4:5]
    v_mfma_f32_16x16x32_bf16 a[112:115], a[188:191], v[112:115], a[112:115]
    v_exp_f32 v74, v74
    v_mfma_f32_16x16x32_bf16 a[116:119], a[184:187], v[100:103], a[116:119]
    v_exp_f32 v75, v75
    v_mfma_f32_16x16x32_bf16 a[116:119], a[188:191], v[116:119], a[116:119]
    v_cvt_pk_bf16_f32 v149, v74, v75
    v_add_u32 v6, 0, v6
    v_mfma_f32_16x16x32_bf16 a[120:123], a[184:187], v[104:107], a[120:123]
    v_exp_f32 v76, v76
    v_mfma_f32_16x16x32_bf16 a[120:123], a[188:191], v[120:123], a[120:123]
    v_exp_f32 v77, v77
    v_mfma_f32_16x16x32_bf16 a[124:127], a[184:187], v[108:111], a[124:127]
    v_cvt_pk_bf16_f32 v150, v76, v77
    v_cmp_gt_u32 s[4:5], 16, v3
    v_mfma_f32_16x16x32_bf16 a[124:127], a[188:191], v[124:127], a[124:127]
    v_exp_f32 v78, v78
    v_mfma_f32_16x16x32_bf16 a[200:203], a[208:211], v[104:107], a[200:203]
    v_exp_f32 v79, v79
    v_mfma_f32_16x16x32_bf16 a[200:203], a[208:211], v[120:123], a[200:203]
    v_cvt_pk_bf16_f32 v151, v78, v79
    v_cndmask_b32 v7, v4, v2, s[6:7]
    v_mfma_f32_16x16x32_bf16 a[204:207], a[208:211], v[108:111], a[204:207]
    v_exp_f32 v80, v80
    v_mfma_f32_16x16x32_bf16 a[204:207], a[208:211], v[124:127], a[204:207]
    v_exp_f32 v81, v81
    s_waitcnt lgkmcnt(0)
    v_mfma_f32_16x16x32_bf16 v[32:35], a[128:131], v[160:163], v[224:227]
    ds_read_b64_tr_b16 a[160:161], v12 offset:49152
    v_cvt_pk_bf16_f32 v152, v80, v81
    v_mfma_f32_16x16x32_bf16 v[32:35], a[132:135], v[164:167], v[32:35]
    v_exp_f32 v82, v82
    v_mfma_f32_16x16x32_bf16 v[32:35], a[136:139], v[168:171], v[32:35]
    ds_read_b64_tr_b16 a[162:163], v12 offset:53248
    ds_read_b64_tr_b16 a[164:165], v12 offset:57344
    v_mfma_f32_16x16x32_bf16 v[32:35], a[140:143], v[172:175], v[32:35]
    v_exp_f32 v83, v83
    v_mfma_f32_16x16x32_bf16 v[40:43], a[128:131], v[176:179], v[228:231]
    ds_read_b64_tr_b16 a[166:167], v12 offset:61440
    v_cvt_pk_bf16_f32 v153, v82, v83
    v_mfma_f32_16x16x32_bf16 v[40:43], a[132:135], v[180:183], v[40:43]
    v_exp_f32 v84, v84
    v_mfma_f32_16x16x32_bf16 v[40:43], a[136:139], v[184:187], v[40:43]
    ds_read_b64_tr_b16 a[168:169], v13 offset:49152
    ds_read_b64_tr_b16 a[170:171], v13 offset:53248
    v_mfma_f32_16x16x32_bf16 v[40:43], a[140:143], v[188:191], v[40:43]
    v_exp_f32 v85, v85
    v_mfma_f32_16x16x32_bf16 v[48:51], a[128:131], v[192:195], v[232:235]
    ds_read_b64_tr_b16 a[172:173], v13 offset:57344
    v_cvt_pk_bf16_f32 v154, v84, v85
    v_mfma_f32_16x16x32_bf16 v[48:51], a[132:135], v[196:199], v[48:51]
    v_exp_f32 v86, v86
    v_mfma_f32_16x16x32_bf16 v[48:51], a[136:139], v[200:203], v[48:51]
    ds_read_b64_tr_b16 a[174:175], v13 offset:61440
    ds_read_b64_tr_b16 a[176:177], v14 offset:49152
    v_mfma_f32_16x16x32_bf16 v[48:51], a[140:143], v[204:207], v[48:51]
    v_exp_f32 v87, v87
    v_mfma_f32_16x16x32_bf16 v[56:59], a[128:131], v[208:211], v[236:239]
    ds_read_b64_tr_b16 a[178:179], v14 offset:53248
    v_cvt_pk_bf16_f32 v155, v86, v87
    v_mfma_f32_16x16x32_bf16 v[56:59], a[132:135], v[212:215], v[56:59]
    v_exp_f32 v88, v88
    v_mfma_f32_16x16x32_bf16 v[56:59], a[136:139], v[216:219], v[56:59]
    ds_read_b64_tr_b16 a[180:181], v14 offset:57344
    ds_read_b64_tr_b16 a[182:183], v14 offset:61440
    v_mfma_f32_16x16x32_bf16 v[56:59], a[140:143], v[220:223], v[56:59]
    v_exp_f32 v89, v89
    v_mfma_f32_16x16x32_bf16 v[36:39], a[144:147], v[160:163], v[224:227]
    ds_read_b64_tr_b16 a[184:185], v15 offset:49152
    v_cvt_pk_bf16_f32 v156, v88, v89
    v_mfma_f32_16x16x32_bf16 v[36:39], a[148:151], v[164:167], v[36:39]
    v_exp_f32 v90, v90
    v_mfma_f32_16x16x32_bf16 v[36:39], a[152:155], v[168:171], v[36:39]
    ds_read_b64_tr_b16 a[186:187], v15 offset:53248
    ds_read_b64_tr_b16 a[188:189], v15 offset:57344
    v_mfma_f32_16x16x32_bf16 v[36:39], a[156:159], v[172:175], v[36:39]
    v_exp_f32 v91, v91
    v_mfma_f32_16x16x32_bf16 v[44:47], a[144:147], v[176:179], v[228:231]
    ds_read_b64_tr_b16 a[190:191], v15 offset:61440
    v_cvt_pk_bf16_f32 v157, v90, v91
    v_mfma_f32_16x16x32_bf16 v[44:47], a[148:151], v[180:183], v[44:47]
    v_exp_f32 v92, v92
    v_mfma_f32_16x16x32_bf16 v[44:47], a[152:155], v[184:187], v[44:47]
    v_exp_f32 v93, v93
    v_mfma_f32_16x16x32_bf16 v[44:47], a[156:159], v[188:191], v[44:47]
    v_cvt_pk_bf16_f32 v158, v92, v93
    s_cmp_eq_u32 s88, 2
    s_cselect_b64 exec, 0, -1
    buffer_store_dwordx4 a[224:227], v26, s[24:27], s95 offen offset:2048 sc1
    s_mov_b64 exec, -1
    v_mfma_f32_16x16x32_bf16 v[52:55], a[144:147], v[192:195], v[232:235]
    v_exp_f32 v94, v94
    v_mfma_f32_16x16x32_bf16 v[52:55], a[148:151], v[196:199], v[52:55]
    v_exp_f32 v95, v95
    v_mfma_f32_16x16x32_bf16 v[52:55], a[152:155], v[200:203], v[52:55]
    v_add_u32 v7, 2592, v7
    v_cmp_gt_u32 s[6:7], 6, v3
    v_mfma_f32_16x16x32_bf16 v[52:55], a[156:159], v[204:207], v[52:55]
    v_cndmask_b32 v20, v4, v2, s[4:5]
    v_add_u32 v20, 6048, v20
    v_mfma_f32_16x16x32_bf16 v[60:63], a[144:147], v[208:211], v[236:239]
    v_cmp_gt_u32 s[4:5], 14, v3
    v_cndmask_b32 v21, v4, v2, s[6:7]
    v_mfma_f32_16x16x32_bf16 v[60:63], a[148:151], v[212:215], v[60:63]
    v_add_u32 v21, 8640, v21
    v_cmp_gt_u32 s[6:7], 4, v3
    v_mfma_f32_16x16x32_bf16 v[60:63], a[152:155], v[216:219], v[60:63]
    v_cndmask_b32 v22, v4, v2, s[4:5]
    v_add_u32 v22, 16192, v22
    v_mfma_f32_16x16x32_bf16 v[60:63], a[156:159], v[220:223], v[60:63]
    v_cmp_gt_u32 s[4:5], 12, v3
    v_cndmask_b32 v23, v4, v2, s[6:7]
    s_waitcnt lgkmcnt(0)
    v_mfma_f32_16x16x32_bf16 a[0:3], a[160:163], v[128:131], a[0:3]
    ds_read_b128 a[128:131], v8 offset:40960
    v_cvt_pk_bf16_f32 v159, v94, v95
    v_mfma_f32_16x16x32_bf16 a[0:3], a[164:167], v[144:147], a[0:3]
    v_exp_f32 v32, v32
    v_mfma_f32_16x16x32_bf16 a[4:7], a[160:163], v[132:135], a[4:7]
    ds_read_b128 a[132:135], v9 offset:40960
    v_add_u32 v23, 18784, v23
    v_mfma_f32_16x16x32_bf16 a[4:7], a[164:167], v[148:151], a[4:7]
    v_exp_f32 v33, v33
    v_mfma_f32_16x16x32_bf16 a[8:11], a[160:163], v[136:139], a[8:11]
    v_cvt_pk_bf16_f32 v96, v32, v33
    v_cmp_gt_u32 s[6:7], 2, v3
    v_mfma_f32_16x16x32_bf16 a[8:11], a[164:167], v[152:155], a[8:11]
    v_exp_f32 v34, v34
    v_mfma_f32_16x16x32_bf16 a[12:15], a[160:163], v[140:143], a[12:15]
    ds_read_b128 a[136:139], v10 offset:40960
    ds_read_b128 a[140:143], v11 offset:40960
    v_mfma_f32_16x16x32_bf16 a[12:15], a[164:167], v[156:159], a[12:15]
    v_cndmask_b32 v24, v4, v2, s[4:5]
    v_add_u32 v24, 22240, v24
    v_mfma_f32_16x16x32_bf16 a[16:19], a[168:171], v[128:131], a[16:19]
    v_exp_f32 v35, v35
    v_mfma_f32_16x16x32_bf16 a[16:19], a[172:175], v[144:147], a[16:19]
    v_cvt_pk_bf16_f32 v97, v34, v35
    v_cmp_gt_u32 s[4:5], 10, v3
    v_mfma_f32_16x16x32_bf16 a[20:23], a[168:171], v[132:135], a[20:23]
    v_exp_f32 v36, v36
    v_mfma_f32_16x16x32_bf16 a[20:23], a[172:175], v[148:151], a[20:23]
    ds_read_b128 a[144:147], v8 offset:45056
    ds_read_b128 a[148:151], v9 offset:45056
    v_mfma_f32_16x16x32_bf16 a[24:27], a[168:171], v[136:139], a[24:27]
    v_cndmask_b32 v25, v4, v2, s[6:7]
    v_add_u32 v25, 24832, v25
    v_mfma_f32_16x16x32_bf16 a[24:27], a[172:175], v[152:155], a[24:27]
    v_exp_f32 v37, v37
    v_mfma_f32_16x16x32_bf16 a[28:31], a[168:171], v[140:143], a[28:31]
    v_cvt_pk_bf16_f32 v98, v36, v37
    v_cndmask_b32 v1, v4, v2, s[4:5]
    v_mfma_f32_16x16x32_bf16 a[28:31], a[172:175], v[156:159], a[28:31]
    v_exp_f32 v38, v38
    v_mfma_f32_16x16x32_bf16 a[32:35], a[176:179], v[128:131], a[32:35]
    ds_read_b128 a[152:155], v10 offset:45056
    ds_read_b128 a[156:159], v11 offset:45056
    v_mfma_f32_16x16x32_bf16 a[32:35], a[180:183], v[144:147], a[32:35]
    s_cmp_eq_u32 s88, 3
    s_cselect_b64 exec, 0, -1
    buffer_store_dwordx4 a[240:243], v26, s[24:27], s95 offen offset:3072 sc1
    s_mov_b64 exec, -1
    v_mfma_f32_16x16x32_bf16 a[36:39], a[176:179], v[132:135], a[36:39]
    v_exp_f32 v39, v39
    v_mfma_f32_16x16x32_bf16 a[36:39], a[180:183], v[148:151], a[36:39]
    v_cvt_pk_bf16_f32 v99, v38, v39
    v_add_u32 v1, 32384, v1
    v_mfma_f32_16x16x32_bf16 a[40:43], a[176:179], v[136:139], a[40:43]
    v_exp_f32 v40, v40
    v_mfma_f32_16x16x32_bf16 a[40:43], a[180:183], v[152:155], a[40:43]
    s_mul_i32 s32, s53, 294912
    s_lshl_b32 s36, s53, 17
    v_mfma_f32_16x16x32_bf16 a[44:47], a[176:179], v[140:143], a[44:47]
    s_add_u32 s3, s53, 1
    s_and_b32 s3, s3, 3
    v_mfma_f32_16x16x32_bf16 a[44:47], a[180:183], v[156:159], a[44:47]
    v_exp_f32 v41, v41
    v_mfma_f32_16x16x32_bf16 a[48:51], a[184:187], v[128:131], a[48:51]
    v_cvt_pk_bf16_f32 v100, v40, v41
    s_mul_i32 s33, s3, 294912
    v_mfma_f32_16x16x32_bf16 a[48:51], a[188:191], v[144:147], a[48:51]
    v_exp_f32 v42, v42
    v_mfma_f32_16x16x32_bf16 a[52:55], a[184:187], v[132:135], a[52:55]
    v_exp_f32 v43, v43
    v_mfma_f32_16x16x32_bf16 a[52:55], a[188:191], v[148:151], a[52:55]
    v_cvt_pk_bf16_f32 v101, v42, v43
    s_lshl_b32 s37, s3, 17
    v_mfma_f32_16x16x32_bf16 a[56:59], a[184:187], v[136:139], a[56:59]
    v_exp_f32 v44, v44
    v_mfma_f32_16x16x32_bf16 a[56:59], a[188:191], v[152:155], a[56:59]
    v_exp_f32 v45, v45
    v_mfma_f32_16x16x32_bf16 a[60:63], a[184:187], v[140:143], a[60:63]
    v_cvt_pk_bf16_f32 v102, v44, v45
    s_add_u32 s99, s92, 125952
    v_mfma_f32_16x16x32_bf16 a[60:63], a[188:191], v[156:159], a[60:63]
    v_exp_f32 v46, v46
    v_mfma_f32_16x16x32_bf16 a[192:195], a[208:211], v[128:131], a[192:195]
    v_exp_f32 v47, v47
    v_mfma_f32_16x16x32_bf16 a[192:195], a[208:211], v[144:147], a[192:195]
    v_cvt_pk_bf16_f32 v103, v46, v47
    s_cmp_eq_u32 s43, 0
    s_cselect_b32 s99, 36864, s99
    v_mfma_f32_16x16x32_bf16 a[196:199], a[208:211], v[132:135], a[196:199]
    v_exp_f32 v48, v48
    v_mfma_f32_16x16x32_bf16 a[196:199], a[208:211], v[148:151], a[196:199]
    v_exp_f32 v49, v49
    s_waitcnt lgkmcnt(0)
    v_mfma_f32_16x16x32_bf16 v[64:67], a[128:131], v[160:163], v[224:227]
    ds_read_b64_tr_b16 a[160:161], v16 offset:49152
    v_cvt_pk_bf16_f32 v104, v48, v49
    v_mfma_f32_16x16x32_bf16 v[64:67], a[132:135], v[164:167], v[64:67]
    v_exp_f32 v50, v50
    v_mfma_f32_16x16x32_bf16 v[64:67], a[136:139], v[168:171], v[64:67]
    ds_read_b64_tr_b16 a[162:163], v16 offset:53248
    ds_read_b64_tr_b16 a[164:165], v16 offset:57344
    v_mfma_f32_16x16x32_bf16 v[64:67], a[140:143], v[172:175], v[64:67]
    v_exp_f32 v51, v51
    v_mfma_f32_16x16x32_bf16 v[72:75], a[128:131], v[176:179], v[228:231]
    ds_read_b64_tr_b16 a[166:167], v16 offset:61440
    v_cvt_pk_bf16_f32 v105, v50, v51
    v_mfma_f32_16x16x32_bf16 v[72:75], a[132:135], v[180:183], v[72:75]
    v_exp_f32 v52, v52
    v_mfma_f32_16x16x32_bf16 v[72:75], a[136:139], v[184:187], v[72:75]
    ds_read_b64_tr_b16 a[168:169], v17 offset:49152
    ds_read_b64_tr_b16 a[170:171], v17 offset:53248
    v_mfma_f32_16x16x32_bf16 v[72:75], a[140:143], v[188:191], v[72:75]
    v_exp_f32 v53, v53
    v_mfma_f32_16x16x32_bf16 v[80:83], a[128:131], v[192:195], v[232:235]
    ds_read_b64_tr_b16 a[172:173], v17 offset:57344
    v_cvt_pk_bf16_f32 v106, v52, v53
    v_mfma_f32_16x16x32_bf16 v[80:83], a[132:135], v[196:199], v[80:83]
    v_exp_f32 v54, v54
    v_mfma_f32_16x16x32_bf16 v[80:83], a[136:139], v[200:203], v[80:83]
    ds_read_b64_tr_b16 a[174:175], v17 offset:61440
    ds_read_b64_tr_b16 a[176:177], v18 offset:49152
    v_mfma_f32_16x16x32_bf16 v[80:83], a[140:143], v[204:207], v[80:83]
    v_exp_f32 v55, v55
    v_mfma_f32_16x16x32_bf16 v[88:91], a[128:131], v[208:211], v[236:239]
    ds_read_b64_tr_b16 a[178:179], v18 offset:53248
    v_cvt_pk_bf16_f32 v107, v54, v55
    v_mfma_f32_16x16x32_bf16 v[88:91], a[132:135], v[212:215], v[88:91]
    v_exp_f32 v56, v56
    v_mfma_f32_16x16x32_bf16 v[88:91], a[136:139], v[216:219], v[88:91]
    ds_read_b64_tr_b16 a[180:181], v18 offset:57344
    ds_read_b64_tr_b16 a[182:183], v18 offset:61440
    v_mfma_f32_16x16x32_bf16 v[88:91], a[140:143], v[220:223], v[88:91]
    v_exp_f32 v57, v57
    v_mfma_f32_16x16x32_bf16 v[68:71], a[144:147], v[160:163], v[224:227]
    ds_read_b64_tr_b16 a[184:185], v19 offset:49152
    v_cvt_pk_bf16_f32 v108, v56, v57
    v_mfma_f32_16x16x32_bf16 v[68:71], a[148:151], v[164:167], v[68:71]
    v_exp_f32 v58, v58
    v_mfma_f32_16x16x32_bf16 v[68:71], a[152:155], v[168:171], v[68:71]
    ds_read_b64_tr_b16 a[186:187], v19 offset:53248
    ds_read_b64_tr_b16 a[188:189], v19 offset:57344
    v_mfma_f32_16x16x32_bf16 v[68:71], a[156:159], v[172:175], v[68:71]
    v_exp_f32 v59, v59
    v_mfma_f32_16x16x32_bf16 v[76:79], a[144:147], v[176:179], v[228:231]
    ds_read_b64_tr_b16 a[190:191], v19 offset:61440
    v_cvt_pk_bf16_f32 v109, v58, v59
    v_mfma_f32_16x16x32_bf16 v[76:79], a[148:151], v[180:183], v[76:79]
    v_exp_f32 v60, v60
    v_mfma_f32_16x16x32_bf16 v[76:79], a[152:155], v[184:187], v[76:79]
    v_exp_f32 v61, v61
    v_mfma_f32_16x16x32_bf16 v[76:79], a[156:159], v[188:191], v[76:79]
    v_cvt_pk_bf16_f32 v110, v60, v61
    s_add_u32 s95, s95, 4096
    s_cmp_eq_u32 s88, 0
    s_cselect_b64 exec, 0, -1
    buffer_store_dwordx4 v[244:247], v26, s[24:27], s95 offen offset:0 sc1
    s_mov_b64 exec, -1
    v_mfma_f32_16x16x32_bf16 v[84:87], a[144:147], v[192:195], v[232:235]
    v_exp_f32 v62, v62
    v_mfma_f32_16x16x32_bf16 v[84:87], a[148:151], v[196:199], v[84:87]
    v_exp_f32 v63, v63
    v_mfma_f32_16x16x32_bf16 v[84:87], a[152:155], v[200:203], v[84:87]
    v_mfma_f32_16x16x32_bf16 v[84:87], a[156:159], v[204:207], v[84:87]
    v_mfma_f32_16x16x32_bf16 v[92:95], a[144:147], v[208:211], v[236:239]
    v_mfma_f32_16x16x32_bf16 v[92:95], a[148:151], v[212:215], v[92:95]
    v_mfma_f32_16x16x32_bf16 v[92:95], a[152:155], v[216:219], v[92:95]
    v_mfma_f32_16x16x32_bf16 v[92:95], a[156:159], v[220:223], v[92:95]
    s_andn2_b32 s94, s94, s51
    s_cmp_lg_u32 s94, 0
    s_cbranch_scc1 L_redo
    s_waitcnt vmcnt(13) lgkmcnt(0)
    s_barrier
    s_add_u32 s60, s32, 0
    s_add_u32 m0, s92, 0
    v_mfma_f32_16x16x32_bf16 a[64:67], a[160:163], v[128:131], a[64:67]
    ds_read_b128 a[128:131], v8 offset:49152
    v_cvt_pk_bf16_f32 v111, v62, v63
    v_mfma_f32_16x16x32_bf16 a[64:67], a[164:167], v[144:147], a[64:67]
    v_exp_f32 v64, v64
    v_mfma_f32_16x16x32_bf16 a[68:71], a[160:163], v[132:135], a[68:71]
    ds_read_b128 a[132:135], v9 offset:49152
    buffer_load_dwordx4 v6, s[28:31], s60 offen offset:0 lds
    v_mfma_f32_16x16x32_bf16 a[68:71], a[164:167], v[148:151], a[68:71]
    v_exp_f32 v65, v65
    v_mfma_f32_16x16x32_bf16 a[72:75], a[160:163], v[136:139], a[72:75]
    v_cvt_pk_bf16_f32 v112, v64, v65
    v_mfma_f32_16x16x32_bf16 a[72:75], a[164:167], v[152:155], a[72:75]
    v_exp_f32 v66, v66
    v_mfma_f32_16x16x32_bf16 a[76:79], a[160:163], v[140:143], a[76:79]
    ds_read_b128 a[136:139], v10 offset:49152
    ds_read_b128 a[140:143], v11 offset:49152
    v_mfma_f32_16x16x32_bf16 a[76:79], a[164:167], v[156:159], a[76:79]
    buffer_load_dwordx4 v7, s[28:31], s60 offen offset:1024 lds
    v_mfma_f32_16x16x32_bf16 a[80:83], a[168:171], v[128:131], a[80:83]
    v_exp_f32 v67, v67
    v_mfma_f32_16x16x32_bf16 a[80:83], a[172:175], v[144:147], a[80:83]
    v_cvt_pk_bf16_f32 v113, v66, v67
    v_mfma_f32_16x16x32_bf16 a[84:87], a[168:171], v[132:135], a[84:87]
    v_exp_f32 v68, v68
    v_mfma_f32_16x16x32_bf16 a[84:87], a[172:175], v[148:151], a[84:87]
    ds_read_b128 a[144:147], v8 offset:53248
    ds_read_b128 a[148:151], v9 offset:53248
    v_mfma_f32_16x16x32_bf16 a[88:91], a[168:171], v[136:139], a[88:91]
    buffer_load_dwordx4 v20, s[28:31], s60 offen offset:2048 lds
    v_mfma_f32_16x16x32_bf16 a[88:91], a[172:175], v[152:155], a[88:91]
    v_exp_f32 v69, v69
    v_mfma_f32_16x16x32_bf16 a[92:95], a[168:171], v[140:143], a[92:95]
    v_cvt_pk_bf16_f32 v114, v68, v69
    v_mfma_f32_16x16x32_bf16 a[92:95], a[172:175], v[156:159], a[92:95]
    v_exp_f32 v70, v70
    v_mfma_f32_16x16x32_bf16 a[96:99], a[176:179], v[128:131], a[96:99]
    ds_read_b128 a[152:155], v10 offset:53248
    ds_read_b128 a[156:159], v11 offset:53248
    v_mfma_f32_16x16x32_bf16 a[96:99], a[180:183], v[144:147], a[96:99]
    s_cmp_eq_u32 s88, 1
    s_cselect_b64 exec, 0, -1
    buffer_store_dwordx4 a[212:215], v26, s[24:27], s95 offen offset:1024 sc1
    s_mov_b64 exec, -1
    v_mfma_f32_16x16x32_bf16 a[100:103], a[176:179], v[132:135], a[100:103]
    v_exp_f32 v71, v71
    v_mfma_f32_16x16x32_bf16 a[100:103], a[180:183], v[148:151], a[100:103]
    v_cvt_pk_bf16_f32 v115, v70, v71
    v_mfma_f32_16x16x32_bf16 a[104:107], a[176:179], v[136:139], a[104:107]
    v_exp_f32 v72, v72
    v_mfma_f32_16x16x32_bf16 a[104:107], a[180:183], v[152:155], a[104:107]
    buffer_load_dwordx4 v21, s[28:31], s60 offen offset:3072 lds
    s_add_u32 m0, s92, 4096
    v_mfma_f32_16x16x32_bf16 a[108:111], a[176:179], v[140:143], a[108:111]
    v_mfma_f32_16x16x32_bf16 a[108:111], a[180:183], v[156:159], a[108:111]
    v_exp_f32 v73, v73
    v_mfma_f32_16x16x32_bf16 a[112:115], a[184:187], v[128:131], a[112:115]
    v_cvt_pk_bf16_f32 v116, v72, v73
    buffer_load_dwordx4 v22, s[28:31], s60 offen offset:0 lds
    v_mfma_f32_16x16x32_bf16 a[112:115], a[188:191], v[144:147], a[112:115]
    v_exp_f32 v74, v74
    v_mfma_f32_16x16x32_bf16 a[116:119], a[184:187], v[132:135], a[116:119]
    v_exp_f32 v75, v75
    v_mfma_f32_16x16x32_bf16 a[116:119], a[188:191], v[148:151], a[116:119]
    v_cvt_pk_bf16_f32 v117, v74, v75
    buffer_load_dwordx4 v23, s[28:31], s60 offen offset:1024 lds
    v_mfma_f32_16x16x32_bf16 a[120:123], a[184:187], v[136:139], a[120:123]
    v_exp_f32 v76, v76
    v_mfma_f32_16x16x32_bf16 a[120:123], a[188:191], v[152:155], a[120:123]
    v_exp_f32 v77, v77
    v_mfma_f32_16x16x32_bf16 a[124:127], a[184:187], v[140:143], a[124:127]
    v_cvt_pk_bf16_f32 v118, v76, v77
    buffer_load_dwordx4 v24, s[28:31], s60 offen offset:2048 lds
    v_mfma_f32_16x16x32_bf16 a[124:127], a[188:191], v[156:159], a[124:127]
    v_exp_f32 v78, v78
    v_mfma_f32_16x16x32_bf16 a[200:203], a[208:211], v[136:139], a[200:203]
    v_exp_f32 v79, v79
    v_mfma_f32_16x16x32_bf16 a[200:203], a[208:211], v[152:155], a[200:203]
    v_cvt_pk_bf16_f32 v119, v78, v79
    buffer_load_dwordx4 v25, s[28:31], s60 offen offset:3072 lds
    s_add_u32 m0, s92, 8192
    v_mfma_f32_16x16x32_bf16 a[204:207], a[208:211], v[140:143], a[204:207]
    v_exp_f32 v80, v80
    v_mfma_f32_16x16x32_bf16 a[204:207], a[208:211], v[156:159], a[204:207]
    v_exp_f32 v81, v81
    s_waitcnt lgkmcnt(0)
    v_mfma_f32_16x16x32_bf16 v[32:35], a[128:131], v[160:163], v[224:227]
    ds_read_b64_tr_b16 a[160:161], v12 offset:0
    v_cvt_pk_bf16_f32 v120, v80, v81
    v_mfma_f32_16x16x32_bf16 v[32:35], a[132:135], v[164:167], v[32:35]
    v_exp_f32 v82, v82
    v_mfma_f32_16x16x32_bf16 v[32:35], a[136:139], v[168:171], v[32:35]
    ds_read_b64_tr_b16 a[162:163], v12 offset:4096
    ds_read_b64_tr_b16 a[164:165], v12 offset:8192
    v_mfma_f32_16x16x32_bf16 v[32:35], a[140:143], v[172:175], v[32:35]
    v_exp_f32 v83, v83
    v_mfma_f32_16x16x32_bf16 v[40:43], a[128:131], v[176:179], v[228:231]
    ds_read_b64_tr_b16 a[166:167], v12 offset:12288
    v_cvt_pk_bf16_f32 v121, v82, v83
    v_mfma_f32_16x16x32_bf16 v[40:43], a[132:135], v[180:183], v[40:43]
    v_exp_f32 v84, v84
    v_mfma_f32_16x16x32_bf16 v[40:43], a[136:139], v[184:187], v[40:43]
    ds_read_b64_tr_b16 a[168:169], v13 offset:0
    ds_read_b64_tr_b16 a[170:171], v13 offset:4096
    v_mfma_f32_16x16x32_bf16 v[40:43], a[140:143], v[188:191], v[40:43]
    v_exp_f32 v85, v85
    v_mfma_f32_16x16x32_bf16 v[48:51], a[128:131], v[192:195], v[232:235]
    ds_read_b64_tr_b16 a[172:173], v13 offset:8192
    v_cvt_pk_bf16_f32 v122, v84, v85
    v_mfma_f32_16x16x32_bf16 v[48:51], a[132:135], v[196:199], v[48:51]
    v_exp_f32 v86, v86
    v_mfma_f32_16x16x32_bf16 v[48:51], a[136:139], v[200:203], v[48:51]
    ds_read_b64_tr_b16 a[174:175], v13 offset:12288
    ds_read_b64_tr_b16 a[176:177], v14 offset:0
    v_mfma_f32_16x16x32_bf16 v[48:51], a[140:143], v[204:207], v[48:51]
    v_exp_f32 v87, v87
    v_mfma_f32_16x16x32_bf16 v[56:59], a[128:131], v[208:211], v[236:239]
    ds_read_b64_tr_b16 a[178:179], v14 offset:4096
    v_cvt_pk_bf16_f32 v123, v86, v87
    v_mfma_f32_16x16x32_bf16 v[56:59], a[132:135], v[212:215], v[56:59]
    v_exp_f32 v88, v88
    v_mfma_f32_16x16x32_bf16 v[56:59], a[136:139], v[216:219], v[56:59]
    ds_read_b64_tr_b16 a[180:181], v14 offset:8192
    ds_read_b64_tr_b16 a[182:183], v14 offset:12288
    v_mfma_f32_16x16x32_bf16 v[56:59], a[140:143], v[220:223], v[56:59]
    v_exp_f32 v89, v89
    v_mfma_f32_16x16x32_bf16 v[36:39], a[144:147], v[160:163], v[224:227]
    ds_read_b64_tr_b16 a[184:185], v15 offset:0
    v_cvt_pk_bf16_f32 v124, v88, v89
    v_mfma_f32_16x16x32_bf16 v[36:39], a[148:151], v[164:167], v[36:39]
    v_exp_f32 v90, v90
    v_mfma_f32_16x16x32_bf16 v[36:39], a[152:155], v[168:171], v[36:39]
    ds_read_b64_tr_b16 a[186:187], v15 offset:4096
    ds_read_b64_tr_b16 a[188:189], v15 offset:8192
    v_mfma_f32_16x16x32_bf16 v[36:39], a[156:159], v[172:175], v[36:39]
    v_exp_f32 v91, v91
    v_mfma_f32_16x16x32_bf16 v[44:47], a[144:147], v[176:179], v[228:231]
    ds_read_b64_tr_b16 a[190:191], v15 offset:12288
    v_cvt_pk_bf16_f32 v125, v90, v91
    v_mfma_f32_16x16x32_bf16 v[44:47], a[148:151], v[180:183], v[44:47]
    v_exp_f32 v92, v92
    v_mfma_f32_16x16x32_bf16 v[44:47], a[152:155], v[184:187], v[44:47]
    v_exp_f32 v93, v93
    v_mfma_f32_16x16x32_bf16 v[44:47], a[156:159], v[188:191], v[44:47]
    v_cvt_pk_bf16_f32 v126, v92, v93
    s_cmp_eq_u32 s88, 2
    s_cselect_b64 exec, 0, -1
    buffer_store_dwordx4 a[228:231], v26, s[24:27], s95 offen offset:2048 sc1
    s_mov_b64 exec, -1
    v_mfma_f32_16x16x32_bf16 v[52:55], a[144:147], v[192:195], v[232:235]
    v_exp_f32 v94, v94
    v_mfma_f32_16x16x32_bf16 v[52:55], a[148:151], v[196:199], v[52:55]
    v_exp_f32 v95, v95
    v_mfma_f32_16x16x32_bf16 v[52:55], a[152:155], v[200:203], v[52:55]
    buffer_load_dwordx4 v1, s[28:31], s60 offen offset:0 lds
    s_add_u32 s60, s32, 147456
    s_add_u32 m0, s92, 98304
    v_mfma_f32_16x16x32_bf16 v[52:55], a[156:159], v[204:207], v[52:55]
    v_mfma_f32_16x16x32_bf16 v[60:63], a[144:147], v[208:211], v[236:239]
    v_mfma_f32_16x16x32_bf16 v[60:63], a[148:151], v[212:215], v[60:63]
    buffer_load_dwordx4 v6, s[28:31], s60 offen offset:0 lds
    v_mfma_f32_16x16x32_bf16 v[60:63], a[152:155], v[216:219], v[60:63]
    v_mfma_f32_16x16x32_bf16 v[60:63], a[156:159], v[220:223], v[60:63]
    s_waitcnt lgkmcnt(0)
    v_mfma_f32_16x16x32_bf16 a[0:3], a[160:163], v[96:99], a[0:3]
    ds_read_b128 a[128:131], v8 offset:57344
    v_cvt_pk_bf16_f32 v127, v94, v95
    v_mfma_f32_16x16x32_bf16 a[0:3], a[164:167], v[112:115], a[0:3]
    v_exp_f32 v32, v32
    v_mfma_f32_16x16x32_bf16 a[4:7], a[160:163], v[100:103], a[4:7]
    ds_read_b128 a[132:135], v9 offset:57344
    buffer_load_dwordx4 v7, s[28:31], s60 offen offset:1024 lds
    v_mfma_f32_16x16x32_bf16 a[4:7], a[164:167], v[116:119], a[4:7]
    v_exp_f32 v33, v33
    v_mfma_f32_16x16x32_bf16 a[8:11], a[160:163], v[104:107], a[8:11]
    v_cvt_pk_bf16_f32 v128, v32, v33
    v_mfma_f32_16x16x32_bf16 a[8:11], a[164:167], v[120:123], a[8:11]
    v_exp_f32 v34, v34
    v_mfma_f32_16x16x32_bf16 a[12:15], a[160:163], v[108:111], a[12:15]
    ds_read_b128 a[136:139], v10 offset:57344
    ds_read_b128 a[140:143], v11 offset:57344
    v_mfma_f32_16x16x32_bf16 a[12:15], a[164:167], v[124:127], a[12:15]
    buffer_load_dwordx4 v20, s[28:31], s60 offen offset:2048 lds
    v_mfma_f32_16x16x32_bf16 a[16:19], a[168:171], v[96:99], a[16:19]
    v_exp_f32 v35, v35
    v_mfma_f32_16x16x32_bf16 a[16:19], a[172:175], v[112:115], a[16:19]
    v_cvt_pk_bf16_f32 v129, v34, v35
    v_mfma_f32_16x16x32_bf16 a[20:23], a[168:171], v[100:103], a[20:23]
    v_exp_f32 v36, v36
    v_mfma_f32_16x16x32_bf16 a[20:23], a[172:175], v[116:119], a[20:23]
    ds_read_b128 a[144:147], v8 offset:61440
    ds_read_b128 a[148:151], v9 offset:61440
    v_mfma_f32_16x16x32_bf16 a[24:27], a[168:171], v[104:107], a[24:27]
    buffer_load_dwordx4 v21, s[28:31], s60 offen offset:3072 lds
    s_add_u32 m0, s92, 102400
    v_mfma_f32_16x16x32_bf16 a[24:27], a[172:175], v[120:123], a[24:27]
    v_exp_f32 v37, v37
    v_mfma_f32_16x16x32_bf16 a[28:31], a[168:171], v[108:111], a[28:31]
    v_cvt_pk_bf16_f32 v130, v36, v37
    v_mfma_f32_16x16x32_bf16 a[28:31], a[172:175], v[124:127], a[28:31]
    v_exp_f32 v38, v38
    v_mfma_f32_16x16x32_bf16 a[32:35], a[176:179], v[96:99], a[32:35]
    ds_read_b128 a[152:155], v10 offset:61440
    ds_read_b128 a[156:159], v11 offset:61440
    v_mfma_f32_16x16x32_bf16 a[32:35], a[180:183], v[112:115], a[32:35]
    s_cmp_eq_u32 s88, 3
    s_cselect_b64 exec, 0, -1
    buffer_store_dwordx4 a[244:247], v26, s[24:27], s95 offen offset:3072 sc1
    s_mov_b64 exec, -1
    v_mfma_f32_16x16x32_bf16 a[36:39], a[176:179], v[100:103], a[36:39]
    v_exp_f32 v39, v39
    v_mfma_f32_16x16x32_bf16 a[36:39], a[180:183], v[116:119], a[36:39]
    v_cvt_pk_bf16_f32 v131, v38, v39
    v_mfma_f32_16x16x32_bf16 a[40:43], a[176:179], v[104:107], a[40:43]
    v_exp_f32 v40, v40
    v_mfma_f32_16x16x32_bf16 a[40:43], a[180:183], v[120:123], a[40:43]
    buffer_load_dwordx4 v22, s[28:31], s60 offen offset:0 lds
    v_mfma_f32_16x16x32_bf16 a[44:47], a[176:179], v[108:111], a[44:47]
    v_mfma_f32_16x16x32_bf16 a[44:47], a[180:183], v[124:127], a[44:47]
    v_exp_f32 v41, v41
    v_mfma_f32_16x16x32_bf16 a[48:51], a[184:187], v[96:99], a[48:51]
    v_cvt_pk_bf16_f32 v132, v40, v41
    buffer_load_dwordx4 v23, s[28:31], s60 offen offset:1024 lds
    v_mfma_f32_16x16x32_bf16 a[48:51], a[188:191], v[112:115], a[48:51]
    v_exp_f32 v42, v42
    v_mfma_f32_16x16x32_bf16 a[52:55], a[184:187], v[100:103], a[52:55]
    v_exp_f32 v43, v43
    v_mfma_f32_16x16x32_bf16 a[52:55], a[188:191], v[116:119], a[52:55]
    v_cvt_pk_bf16_f32 v133, v42, v43
    buffer_load_dwordx4 v24, s[28:31], s60 offen offset:2048 lds
    v_mfma_f32_16x16x32_bf16 a[56:59], a[184:187], v[104:107], a[56:59]
    v_exp_f32 v44, v44
    v_mfma_f32_16x16x32_bf16 a[56:59], a[188:191], v[120:123], a[56:59]
    v_exp_f32 v45, v45
    v_mfma_f32_16x16x32_bf16 a[60:63], a[184:187], v[108:111], a[60:63]
    v_cvt_pk_bf16_f32 v134, v44, v45
    buffer_load_dwordx4 v25, s[28:31], s60 offen offset:3072 lds
    s_add_u32 m0, s92, 106496
    v_mfma_f32_16x16x32_bf16 a[60:63], a[188:191], v[124:127], a[60:63]
    v_exp_f32 v46, v46
    v_mfma_f32_16x16x32_bf16 a[192:195], a[208:211], v[96:99], a[192:195]
    v_exp_f32 v47, v47
    v_mfma_f32_16x16x32_bf16 a[192:195], a[208:211], v[112:115], a[192:195]
    v_cvt_pk_bf16_f32 v135, v46, v47
    buffer_load_dwordx4 v1, s[28:31], s60 offen offset:0 lds
    s_add_u32 s60, s33, 0
    s_add_u32 m0, s99, 0
    v_mfma_f32_16x16x32_bf16 a[196:199], a[208:211], v[100:103], a[196:199]
    v_exp_f32 v48, v48
    v_mfma_f32_16x16x32_bf16 a[196:199], a[208:211], v[116:119], a[196:199]
    v_exp_f32 v49, v49
    s_waitcnt lgkmcnt(0)
    v_mfma_f32_16x16x32_bf16 v[64:67], a[128:131], v[160:163], v[224:227]
    ds_read_b64_tr_b16 a[160:161], v16 offset:0
    v_cvt_pk_bf16_f32 v136, v48, v49
    v_mfma_f32_16x16x32_bf16 v[64:67], a[132:135], v[164:167], v[64:67]
    v_exp_f32 v50, v50
    v_mfma_f32_16x16x32_bf16 v[64:67], a[136:139], v[168:171], v[64:67]
    ds_read_b64_tr_b16 a[162:163], v16 offset:4096
    ds_read_b64_tr_b16 a[164:165], v16 offset:8192
    v_mfma_f32_16x16x32_bf16 v[64:67], a[140:143], v[172:175], v[64:67]
    v_exp_f32 v51, v51
    v_mfma_f32_16x16x32_bf16 v[72:75], a[128:131], v[176:179], v[228:231]
    ds_read_b64_tr_b16 a[166:167], v16 offset:12288
    v_cvt_pk_bf16_f32 v137, v50, v51
    v_mfma_f32_16x16x32_bf16 v[72:75], a[132:135], v[180:183], v[72:75]
    v_exp_f32 v52, v52
    v_mfma_f32_16x16x32_bf16 v[72:75], a[136:139], v[184:187], v[72:75]
    ds_read_b64_tr_b16 a[168:169], v17 offset:0
    ds_read_b64_tr_b16 a[170:171], v17 offset:4096
    v_mfma_f32_16x16x32_bf16 v[72:75], a[140:143], v[188:191], v[72:75]
    v_exp_f32 v53, v53
    v_mfma_f32_16x16x32_bf16 v[80:83], a[128:131], v[192:195], v[232:235]
    ds_read_b64_tr_b16 a[172:173], v17 offset:8192
    v_cvt_pk_bf16_f32 v138, v52, v53
    v_mfma_f32_16x16x32_bf16 v[80:83], a[132:135], v[196:199], v[80:83]
    v_exp_f32 v54, v54
    v_mfma_f32_16x16x32_bf16 v[80:83], a[136:139], v[200:203], v[80:83]
    ds_read_b64_tr_b16 a[174:175], v17 offset:12288
    ds_read_b64_tr_b16 a[176:177], v18 offset:0
    v_mfma_f32_16x16x32_bf16 v[80:83], a[140:143], v[204:207], v[80:83]
    v_exp_f32 v55, v55
    v_mfma_f32_16x16x32_bf16 v[88:91], a[128:131], v[208:211], v[236:239]
    ds_read_b64_tr_b16 a[178:179], v18 offset:4096
    v_cvt_pk_bf16_f32 v139, v54, v55
    v_mfma_f32_16x16x32_bf16 v[88:91], a[132:135], v[212:215], v[88:91]
    v_exp_f32 v56, v56
    v_mfma_f32_16x16x32_bf16 v[88:91], a[136:139], v[216:219], v[88:91]
    ds_read_b64_tr_b16 a[180:181], v18 offset:8192
    ds_read_b64_tr_b16 a[182:183], v18 offset:12288
    v_mfma_f32_16x16x32_bf16 v[88:91], a[140:143], v[220:223], v[88:91]
    v_exp_f32 v57, v57
    v_mfma_f32_16x16x32_bf16 v[68:71], a[144:147], v[160:163], v[224:227]
    ds_read_b64_tr_b16 a[184:185], v19 offset:0
    v_cvt_pk_bf16_f32 v140, v56, v57
    v_mfma_f32_16x16x32_bf16 v[68:71], a[148:151], v[164:167], v[68:71]
    v_exp_f32 v58, v58
    v_mfma_f32_16x16x32_bf16 v[68:71], a[152:155], v[168:171], v[68:71]
    ds_read_b64_tr_b16 a[186:187], v19 offset:4096
    ds_read_b64_tr_b16 a[188:189], v19 offset:8192
    v_mfma_f32_16x16x32_bf16 v[68:71], a[156:159], v[172:175], v[68:71]
    v_exp_f32 v59, v59
    v_mfma_f32_16x16x32_bf16 v[76:79], a[144:147], v[176:179], v[228:231]
    ds_read_b64_tr_b16 a[190:191], v19 offset:12288
    v_cvt_pk_bf16_f32 v141, v58, v59
    v_mfma_f32_16x16x32_bf16 v[76:79], a[148:151], v[180:183], v[76:79]
    v_exp_f32 v60, v60
    v_mfma_f32_16x16x32_bf16 v[76:79], a[152:155], v[184:187], v[76:79]
    v_exp_f32 v61, v61
    v_mfma_f32_16x16x32_bf16 v[76:79], a[156:159], v[188:191], v[76:79]
    v_cvt_pk_bf16_f32 v142, v60, v61
    s_add_u32 s95, s95, 4096
    s_cmp_eq_u32 s88, 0
    s_cselect_b64 exec, 0, -1
    buffer_store_dwordx4 v[248:251], v26, s[24:27], s95 offen offset:0 sc1
    s_mov_b64 exec, -1
    v_mfma_f32_16x16x32_bf16 v[84:87], a[144:147], v[192:195], v[232:235]
    v_exp_f32 v62, v62
    v_mfma_f32_16x16x32_bf16 v[84:87], a[148:151], v[196:199], v[84:87]
    v_exp_f32 v63, v63
    v_mfma_f32_16x16x32_bf16 v[84:87], a[152:155], v[200:203], v[84:87]
    buffer_load_dwordx4 v6, s[28:31], s60 offen offset:0 lds
    v_mfma_f32_16x16x32_bf16 v[84:87], a[156:159], v[204:207], v[84:87]
    v_mfma_f32_16x16x32_bf16 v[92:95], a[144:147], v[208:211], v[236:239]
    v_mfma_f32_16x16x32_bf16 v[92:95], a[148:151], v[212:215], v[92:95]
    buffer_load_dwordx4 v7, s[28:31], s60 offen offset:1024 lds
    v_mfma_f32_16x16x32_bf16 v[92:95], a[152:155], v[216:219], v[92:95]
    v_mfma_f32_16x16x32_bf16 v[92:95], a[156:159], v[220:223], v[92:95]
    s_waitcnt vmcnt(30) lgkmcnt(0)
    s_barrier
    v_mfma_f32_16x16x32_bf16 a[64:67], a[160:163], v[96:99], a[64:67]
    v_cvt_pk_bf16_f32 v143, v62, v63
    v_exp_f32 v64, v64
    v_mfma_f32_16x16x32_bf16 a[64:67], a[164:167], v[112:115], a[64:67]
    v_exp_f32 v65, v65
    buffer_load_dwordx4 v20, s[28:31], s60 offen offset:2048 lds
    s_add_u32 s3, s53, 2
    v_mfma_f32_16x16x32_bf16 a[68:71], a[160:163], v[100:103], a[68:71]
    v_cvt_pk_bf16_f32 v144, v64, v65
    v_exp_f32 v66, v66
    v_mfma_f32_16x16x32_bf16 a[68:71], a[164:167], v[116:119], a[68:71]
    v_exp_f32 v67, v67
    s_and_b32 s3, s3, 3
    v_mfma_f32_16x16x32_bf16 a[72:75], a[160:163], v[104:107], a[72:75]
    v_cvt_pk_bf16_f32 v145, v66, v67
    v_exp_f32 v68, v68
    v_mfma_f32_16x16x32_bf16 a[72:75], a[164:167], v[120:123], a[72:75]
    v_exp_f32 v69, v69
    buffer_load_dwordx4 v21, s[28:31], s60 offen offset:3072 lds
    s_add_u32 m0, s99, 4096
    s_mul_i32 s34, s3, 294912
    v_mfma_f32_16x16x32_bf16 a[76:79], a[160:163], v[108:111], a[76:79]
    v_cvt_pk_bf16_f32 v146, v68, v69
    v_exp_f32 v70, v70
    v_mfma_f32_16x16x32_bf16 a[76:79], a[164:167], v[124:127], a[76:79]
    v_exp_f32 v71, v71
    s_lshl_b32 s38, s3, 17
    v_mfma_f32_16x16x32_bf16 a[80:83], a[168:171], v[96:99], a[80:83]
    v_cvt_pk_bf16_f32 v147, v70, v71
    v_exp_f32 v72, v72
    v_mfma_f32_16x16x32_bf16 a[80:83], a[172:175], v[112:115], a[80:83]
    v_exp_f32 v73, v73
    ds_read_b64_tr_b16 a[160:161], v12 offset:16384
    buffer_load_dwordx4 v22, s[28:31], s60 offen offset:0 lds
    s_add_u32 s3, s53, 3
    v_mfma_f32_16x16x32_bf16 a[84:87], a[168:171], v[100:103], a[84:87]
    v_cvt_pk_bf16_f32 v148, v72, v73
    v_exp_f32 v74, v74
    v_mfma_f32_16x16x32_bf16 a[84:87], a[172:175], v[116:119], a[84:87]
    v_exp_f32 v75, v75
    ds_read_b64_tr_b16 a[162:163], v12 offset:20480
    s_and_b32 s3, s3, 3
    v_mfma_f32_16x16x32_bf16 a[88:91], a[168:171], v[104:107], a[88:91]
    v_cvt_pk_bf16_f32 v149, v74, v75
    v_exp_f32 v76, v76
    v_mfma_f32_16x16x32_bf16 a[88:91], a[172:175], v[120:123], a[88:91]
    v_exp_f32 v77, v77
    ds_read_b64_tr_b16 a[164:165], v12 offset:24576
    buffer_load_dwordx4 v23, s[28:31], s60 offen offset:1024 lds
    s_mul_i32 s35, s3, 294912
    v_mfma_f32_16x16x32_bf16 a[92:95], a[168:171], v[108:111], a[92:95]
    v_cvt_pk_bf16_f32 v150, v76, v77
    v_exp_f32 v78, v78
    v_mfma_f32_16x16x32_bf16 a[92:95], a[172:175], v[124:127], a[92:95]
    v_exp_f32 v79, v79
    ds_read_b64_tr_b16 a[166:167], v12 offset:28672
    s_cmp_eq_u32 s88, 1
    s_cselect_b64 exec, 0, -1
    buffer_store_dwordx4 a[216:219], v26, s[24:27], s95 offen offset:1024 sc1
    s_mov_b64 exec, -1
    s_lshl_b32 s39, s3, 17
    v_mfma_f32_16x16x32_bf16 a[96:99], a[176:179], v[96:99], a[96:99]
    v_cvt_pk_bf16_f32 v151, v78, v79
    v_exp_f32 v80, v80
    v_mfma_f32_16x16x32_bf16 a[96:99], a[180:183], v[112:115], a[96:99]
    v_exp_f32 v81, v81
    ds_read_b64_tr_b16 a[168:169], v13 offset:16384
    v_mfma_f32_16x16x32_bf16 a[100:103], a[176:179], v[100:103], a[100:103]
    v_cvt_pk_bf16_f32 v152, v80, v81
    v_exp_f32 v82, v82
    v_mfma_f32_16x16x32_bf16 a[100:103], a[180:183], v[116:119], a[100:103]
    v_exp_f32 v83, v83
    ds_read_b64_tr_b16 a[170:171], v13 offset:20480
    buffer_load_dwordx4 v24, s[28:31], s60 offen offset:2048 lds
    v_mfma_f32_16x16x32_bf16 a[104:107], a[176:179], v[104:107], a[104:107]
    v_cvt_pk_bf16_f32 v153, v82, v83
    v_exp_f32 v84, v84
    v_mfma_f32_16x16x32_bf16 a[104:107], a[180:183], v[120:123], a[104:107]
    v_exp_f32 v85, v85
    ds_read_b64_tr_b16 a[172:173], v13 offset:24576
    v_mfma_f32_16x16x32_bf16 a[108:111], a[176:179], v[108:111], a[108:111]
    v_cvt_pk_bf16_f32 v154, v84, v85
    v_exp_f32 v86, v86
    v_mfma_f32_16x16x32_bf16 a[108:111], a[180:183], v[124:127], a[108:111]
    v_exp_f32 v87, v87
    ds_read_b64_tr_b16 a[174:175], v13 offset:28672
    buffer_load_dwordx4 v25, s[28:31], s60 offen offset:3072 lds
    s_add_u32 m0, s99, 8192
    v_mfma_f32_16x16x32_bf16 a[112:115], a[184:187], v[96:99], a[112:115]
    v_cvt_pk_bf16_f32 v155, v86, v87
    v_exp_f32 v88, v88
    v_mfma_f32_16x16x32_bf16 a[112:115], a[188:191], v[112:115], a[112:115]
    v_exp_f32 v89, v89
    ds_read_b64_tr_b16 a[176:177], v14 offset:16384
    v_mfma_f32_16x16x32_bf16 a[116:119], a[184:187], v[100:103], a[116:119]
    v_cvt_pk_bf16_f32 v156, v88, v89
    v_exp_f32 v90, v90
    v_mfma_f32_16x16x32_bf16 a[116:119], a[188:191], v[116:119], a[116:119]
    v_exp_f32 v91, v91
    ds_read_b64_tr_b16 a[178:179], v14 offset:20480
    buffer_load_dwordx4 v1, s[28:31], s60 offen offset:0 lds
    v_mfma_f32_16x16x32_bf16 a[120:123], a[184:187], v[104:107], a[120:123]
    v_cvt_pk_bf16_f32 v157, v90, v91
    v_exp_f32 v92, v92
    v_mfma_f32_16x16x32_bf16 a[120:123], a[188:191], v[120:123], a[120:123]
    v_exp_f32 v93, v93
    ds_read_b64_tr_b16 a[180:181], v14 offset:24576
    v_mfma_f32_16x16x32_bf16 a[124:127], a[184:187], v[108:111], a[124:127]
    v_cvt_pk_bf16_f32 v158, v92, v93
    v_exp_f32 v94, v94
    v_mfma_f32_16x16x32_bf16 a[124:127], a[188:191], v[124:127], a[124:127]
    v_exp_f32 v95, v95
    ds_read_b64_tr_b16 a[182:183], v14 offset:28672
    v_mfma_f32_16x16x32_bf16 a[200:203], a[208:211], v[104:107], a[200:203]
    v_cvt_pk_bf16_f32 v159, v94, v95
    ds_read_b64_tr_b16 a[184:185], v15 offset:16384
    v_mfma_f32_16x16x32_bf16 a[200:203], a[208:211], v[120:123], a[200:203]
    ds_read_b64_tr_b16 a[186:187], v15 offset:20480
    v_mfma_f32_16x16x32_bf16 a[204:207], a[208:211], v[108:111], a[204:207]
    ds_read_b64_tr_b16 a[188:189], v15 offset:24576
    v_mfma_f32_16x16x32_bf16 a[204:207], a[208:211], v[124:127], a[204:207]
    ds_read_b64_tr_b16 a[190:191], v15 offset:28672
    v_mfma_f32_16x16x32_bf16 a[192:195], a[208:211], v[128:131], a[192:195]
    v_lshrrev_b32 v2, 2, v0
    v_mul_u32_u24 v2, 288, v2
    v_mfma_f32_16x16x32_bf16 a[192:195], a[208:211], v[144:147], a[192:195]
    v_and_b32 v3, 3, v0
    v_lshl_add_u32 v8, v3, 3, v2
    v_mfma_f32_16x16x32_bf16 a[196:199], a[208:211], v[132:135], a[196:199]
    v_add_u32 v9, 98304, v8
    v_add_u32 v10, 46080, v8
    v_mfma_f32_16x16x32_bf16 a[196:199], a[208:211], v[148:151], a[196:199]
    s_cmp_eq_u32 s88, 2
    s_cselect_b64 exec, 0, -1
    buffer_store_dwordx4 a[232:235], v26, s[24:27], s95 offen offset:2048 sc1
    s_mov_b64 exec, -1
    v_mfma_f32_16x16x32_bf16 a[200:203], a[208:211], v[136:139], a[200:203]
    s_lshl_b32 s3, s53, 2
    s_add_u32 s3, s3, s90
    v_mfma_f32_16x16x32_bf16 a[200:203], a[208:211], v[152:155], a[200:203]
    v_bfrev_b32 v11, 1
    v_writelane_b32 v11, s3, 0
    v_mfma_f32_16x16x32_bf16 a[204:207], a[208:211], v[140:143], a[204:207]
    v_mfma_f32_16x16x32_bf16 a[204:207], a[208:211], v[156:159], a[204:207]
    s_waitcnt lgkmcnt(0)
    v_mfma_f32_16x16x32_bf16 a[0:3], a[160:163], v[128:131], a[0:3]
    v_mfma_f32_16x16x32_bf16 a[0:3], a[164:167], v[144:147], a[0:3]
    v_mfma_f32_16x16x32_bf16 a[4:7], a[160:163], v[132:135], a[4:7]
    v_mfma_f32_16x16x32_bf16 a[4:7], a[164:167], v[148:151], a[4:7]
    v_mfma_f32_16x16x32_bf16 a[8:11], a[160:163], v[136:139], a[8:11]
    s_mov_b32 s60, 0x4e800000
    s_mov_b64 s[54:55], 0
    v_mfma_f32_16x16x32_bf16 a[8:11], a[164:167], v[152:155], a[8:11]
    v_accvgpr_read_b32 v224, a192
    v_cmp_ngt_f32 vcc, s60, v224
    v_mfma_f32_16x16x32_bf16 a[12:15], a[160:163], v[140:143], a[12:15]
    s_or_b64 s[54:55], s[54:55], vcc
    v_max_f32 v224, 0x00800000, v224
    v_mfma_f32_16x16x32_bf16 a[12:15], a[164:167], v[156:159], a[12:15]
    v_accvgpr_read_b32 v226, a196
    v_cmp_ngt_f32 vcc, s60, v226
    v_mfma_f32_16x16x32_bf16 a[16:19], a[168:171], v[128:131], a[16:19]
    ds_read_b64_tr_b16 a[160:161], v16 offset:16384
    v_mfma_f32_16x16x32_bf16 a[16:19], a[172:175], v[144:147], a[16:19]
    s_or_b64 s[54:55], s[54:55], vcc
    v_max_f32 v226, 0x00800000, v226
    v_mfma_f32_16x16x32_bf16 a[20:23], a[168:171], v[132:135], a[20:23]
    ds_read_b64_tr_b16 a[162:163], v16 offset:20480
    v_mfma_f32_16x16x32_bf16 a[20:23], a[172:175], v[148:151], a[20:23]
    v_accvgpr_read_b32 v228, a200
    v_cmp_ngt_f32 vcc, s60, v228
    v_mfma_f32_16x16x32_bf16 a[24:27], a[168:171], v[136:139], a[24:27]
    ds_read_b64_tr_b16 a[164:165], v16 offset:24576
    v_mfma_f32_16x16x32_bf16 a[24:27], a[172:175], v[152:155], a[24:27]
    s_or_b64 s[54:55], s[54:55], vcc
    v_max_f32 v228, 0x00800000, v228
    v_mfma_f32_16x16x32_bf16 a[28:31], a[168:171], v[140:143], a[28:31]
    ds_read_b64_tr_b16 a[166:167], v16 offset:28672
    v_mfma_f32_16x16x32_bf16 a[28:31], a[172:175], v[156:159], a[28:31]
    v_accvgpr_read_b32 v230, a204
    v_cmp_ngt_f32 vcc, s60, v230
    v_mfma_f32_16x16x32_bf16 a[32:35], a[176:179], v[128:131], a[32:35]
    ds_read_b64_tr_b16 a[168:169], v17 offset:16384
    v_mfma_f32_16x16x32_bf16 a[32:35], a[180:183], v[144:147], a[32:35]
    s_or_b64 s[54:55], s[54:55], vcc
    v_max_f32 v230, 0x00800000, v230
    v_mfma_f32_16x16x32_bf16 a[36:39], a[176:179], v[132:135], a[36:39]
    ds_read_b64_tr_b16 a[170:171], v17 offset:20480
    v_rcp_f32 v224, v224
    v_mfma_f32_16x16x32_bf16 a[36:39], a[180:183], v[148:151], a[36:39]
    s_cmp_eq_u32 s88, 3
    s_cselect_b64 exec, 0, -1
    buffer_store_dwordx4 a[248:251], v26, s[24:27], s95 offen offset:3072 sc1
    s_mov_b64 exec, -1
    v_mfma_f32_16x16x32_bf16 a[40:43], a[176:179], v[136:139], a[40:43]
    ds_read_b64_tr_b16 a[172:173], v17 offset:24576
    v_rcp_f32 v226, v226
    v_mfma_f32_16x16x32_bf16 a[40:43], a[180:183], v[152:155], a[40:43]
    v_rcp_f32 v228, v228
    v_rcp_f32 v230, v230
    v_mfma_f32_16x16x32_bf16 a[44:47], a[176:179], v[140:143], a[44:47]
    ds_read_b64_tr_b16 a[174:175], v17 offset:28672
    s_cmp_lg_u64 s[54:55], 0
    s_cselect_b32 s60, 1, 0
    v_mfma_f32_16x16x32_bf16 a[44:47], a[180:183], v[156:159], a[44:47]
    s_lshl_b32 s61, s43, 2
    s_add_u32 s61, s61, 131072
    v_mfma_f32_16x16x32_bf16 a[48:51], a[184:187], v[128:131], a[48:51]
    ds_read_b64_tr_b16 a[176:177], v18 offset:16384
    v_mov_b32 v225, s60
    v_mov_b32 v227, s61
    v_mfma_f32_16x16x32_bf16 a[48:51], a[188:191], v[144:147], a[48:51]
    ds_write_b32 v227, v225 offset:32272
    v_accvgpr_read_b32 v32, a0
    v_mfma_f32_16x16x32_bf16 a[52:55], a[184:187], v[132:135], a[52:55]
    ds_read_b64_tr_b16 a[178:179], v18 offset:20480
    v_accvgpr_read_b32 v33, a1
    v_mfma_f32_16x16x32_bf16 a[52:55], a[188:191], v[148:151], a[52:55]
    v_accvgpr_read_b32 v34, a2
    v_accvgpr_read_b32 v35, a3
    v_mfma_f32_16x16x32_bf16 a[56:59], a[184:187], v[136:139], a[56:59]
    ds_read_b64_tr_b16 a[180:181], v18 offset:24576
    v_accvgpr_read_b32 v36, a16
    v_mfma_f32_16x16x32_bf16 a[56:59], a[188:191], v[152:155], a[56:59]
    v_accvgpr_read_b32 v37, a17
    v_accvgpr_read_b32 v38, a18
    v_mfma_f32_16x16x32_bf16 a[60:63], a[184:187], v[140:143], a[60:63]
    ds_read_b64_tr_b16 a[182:183], v18 offset:28672
    v_accvgpr_read_b32 v39, a19
    v_mfma_f32_16x16x32_bf16 a[60:63], a[188:191], v[156:159], a[60:63]
    v_mul_f32 v32, v32, v224
    v_mul_f32 v33, v33, v224
    s_waitcnt vmcnt(18)
    v_mov_b32 v2, 1
    buffer_store_dword v2, v11, s[68:71], 0 offen sc1
    s_waitcnt lgkmcnt(9)
    v_mfma_f32_16x16x32_bf16 a[64:67], a[160:163], v[128:131], a[64:67]
    ds_read_b64_tr_b16 a[184:185], v19 offset:16384
    ds_read_b64_tr_b16 a[186:187], v19 offset:20480
    v_mfma_f32_16x16x32_bf16 a[64:67], a[164:167], v[144:147], a[64:67]
    ds_read_b64_tr_b16 a[188:189], v19 offset:24576
    ds_read_b64_tr_b16 a[190:191], v19 offset:28672
    v_mfma_f32_16x16x32_bf16 a[68:71], a[160:163], v[132:135], a[68:71]
    v_mul_f32 v34, v34, v224
    v_mul_f32 v35, v35, v224
    v_mfma_f32_16x16x32_bf16 a[68:71], a[164:167], v[148:151], a[68:71]
    v_mul_f32 v36, v36, v224
    v_mul_f32 v37, v37, v224
    v_mfma_f32_16x16x32_bf16 a[72:75], a[160:163], v[136:139], a[72:75]
    v_mul_f32 v38, v38, v224
    v_mul_f32 v39, v39, v224
    v_mfma_f32_16x16x32_bf16 a[72:75], a[164:167], v[152:155], a[72:75]
    v_cvt_pk_bf16_f32 v160, v32, v33
    v_cvt_pk_bf16_f32 v161, v34, v35
    v_mfma_f32_16x16x32_bf16 a[76:79], a[160:163], v[140:143], a[76:79]
    v_cvt_pk_bf16_f32 v162, v36, v37
    v_cvt_pk_bf16_f32 v163, v38, v39
    v_mfma_f32_16x16x32_bf16 a[76:79], a[164:167], v[156:159], a[76:79]
    v_accvgpr_read_b32 v40, a4
    v_accvgpr_read_b32 v41, a5
    s_waitcnt lgkmcnt(9)
    v_mfma_f32_16x16x32_bf16 a[80:83], a[168:171], v[128:131], a[80:83]
    v_accvgpr_read_b32 v42, a6
    v_accvgpr_read_b32 v43, a7
    v_mfma_f32_16x16x32_bf16 a[80:83], a[172:175], v[144:147], a[80:83]
    v_accvgpr_read_b32 v44, a20
    v_accvgpr_read_b32 v45, a21
    v_mfma_f32_16x16x32_bf16 a[84:87], a[168:171], v[132:135], a[84:87]
    v_accvgpr_read_b32 v46, a22
    v_accvgpr_read_b32 v47, a23
    v_mfma_f32_16x16x32_bf16 a[84:87], a[172:175], v[148:151], a[84:87]
    s_add_u32 s95, s95, 4096
    s_cmp_eq_u32 s88, 0
    s_cselect_b64 exec, 0, -1
    buffer_store_dwordx4 v[252:255], v26, s[24:27], s95 offen offset:0 sc1
    s_mov_b64 exec, -1
    v_mfma_f32_16x16x32_bf16 a[88:91], a[168:171], v[136:139], a[88:91]
    v_mul_f32 v40, v40, v226
    v_mul_f32 v41, v41, v226
    v_mfma_f32_16x16x32_bf16 a[88:91], a[172:175], v[152:155], a[88:91]
    v_mul_f32 v42, v42, v226
    v_mul_f32 v43, v43, v226
    v_mfma_f32_16x16x32_bf16 a[92:95], a[168:171], v[140:143], a[92:95]
    v_mul_f32 v44, v44, v226
    v_mul_f32 v45, v45, v226
    v_mfma_f32_16x16x32_bf16 a[92:95], a[172:175], v[156:159], a[92:95]
    v_mul_f32 v46, v46, v226
    v_mul_f32 v47, v47, v226
    s_waitcnt lgkmcnt(4)
    v_mfma_f32_16x16x32_bf16 a[96:99], a[176:179], v[128:131], a[96:99]
    v_cvt_pk_bf16_f32 v176, v40, v41
    v_cvt_pk_bf16_f32 v177, v42, v43
    v_mfma_f32_16x16x32_bf16 a[96:99], a[180:183], v[144:147], a[96:99]
    v_cvt_pk_bf16_f32 v178, v44, v45
    v_cvt_pk_bf16_f32 v179, v46, v47
    v_mfma_f32_16x16x32_bf16 a[100:103], a[176:179], v[132:135], a[100:103]
    v_accvgpr_read_b32 v32, a8
    v_accvgpr_read_b32 v33, a9
    v_mfma_f32_16x16x32_bf16 a[100:103], a[180:183], v[148:151], a[100:103]
    v_accvgpr_read_b32 v34, a10
    v_accvgpr_read_b32 v35, a11
    v_mfma_f32_16x16x32_bf16 a[104:107], a[176:179], v[136:139], a[104:107]
    v_accvgpr_read_b32 v36, a24
    v_accvgpr_read_b32 v37, a25
    v_mfma_f32_16x16x32_bf16 a[104:107], a[180:183], v[152:155], a[104:107]
    v_accvgpr_read_b32 v38, a26
    v_accvgpr_read_b32 v39, a27
    v_mfma_f32_16x16x32_bf16 a[108:111], a[176:179], v[140:143], a[108:111]
    v_mul_f32 v32, v32, v228
    v_mul_f32 v33, v33, v228
    v_mfma_f32_16x16x32_bf16 a[108:111], a[180:183], v[156:159], a[108:111]
    v_mul_f32 v34, v34, v228
    v_mul_f32 v35, v35, v228
    s_waitcnt lgkmcnt(0)
    v_mfma_f32_16x16x32_bf16 a[112:115], a[184:187], v[128:131], a[112:115]
    v_mul_f32 v36, v36, v228
    v_mul_f32 v37, v37, v228
    v_mfma_f32_16x16x32_bf16 a[112:115], a[188:191], v[144:147], a[112:115]
    v_mul_f32 v38, v38, v228
    v_mul_f32 v39, v39, v228
    v_mfma_f32_16x16x32_bf16 a[116:119], a[184:187], v[132:135], a[116:119]
    v_cvt_pk_bf16_f32 v192, v32, v33
    v_cvt_pk_bf16_f32 v193, v34, v35
    v_mfma_f32_16x16x32_bf16 a[116:119], a[188:191], v[148:151], a[116:119]
    v_cvt_pk_bf16_f32 v194, v36, v37
    v_cvt_pk_bf16_f32 v195, v38, v39
    v_mfma_f32_16x16x32_bf16 a[120:123], a[184:187], v[136:139], a[120:123]
    v_accvgpr_read_b32 v40, a12
    v_accvgpr_read_b32 v41, a13
    v_mfma_f32_16x16x32_bf16 a[120:123], a[188:191], v[152:155], a[120:123]
    v_accvgpr_read_b32 v42, a14
    v_accvgpr_read_b32 v43, a15
    v_mfma_f32_16x16x32_bf16 a[124:127], a[184:187], v[140:143], a[124:127]
    v_accvgpr_read_b32 v44, a28
    v_accvgpr_read_b32 v45, a29
    v_mfma_f32_16x16x32_bf16 a[124:127], a[188:191], v[156:159], a[124:127]
    v_accvgpr_read_b32 v46, a30
    v_accvgpr_read_b32 v47, a31
    v_mul_f32 v40, v40, v230
    v_mul_f32 v41, v41, v230
    v_mul_f32 v42, v42, v230
    v_mul_f32 v43, v43, v230
    v_mul_f32 v44, v44, v230
    v_mul_f32 v45, v45, v230
    v_mul_f32 v46, v46, v230
    v_mul_f32 v47, v47, v230
    v_cvt_pk_bf16_f32 v208, v40, v41
    v_cvt_pk_bf16_f32 v209, v42, v43
    v_cvt_pk_bf16_f32 v210, v44, v45
    v_cvt_pk_bf16_f32 v211, v46, v47
    v_accvgpr_read_b32 v32, a32
    v_accvgpr_read_b32 v33, a33
    v_accvgpr_read_b32 v34, a34
    v_accvgpr_read_b32 v35, a35
    v_accvgpr_read_b32 v36, a48
    v_accvgpr_read_b32 v37, a49
    v_accvgpr_read_b32 v38, a50
    v_accvgpr_read_b32 v39, a51
    v_mul_f32 v32, v32, v224
    v_mul_f32 v33, v33, v224
    v_mul_f32 v34, v34, v224
    v_mul_f32 v35, v35, v224
    v_mul_f32 v36, v36, v224
    v_mul_f32 v37, v37, v224
    v_mul_f32 v38, v38, v224
    v_mul_f32 v39, v39, v224
    v_cvt_pk_bf16_f32 v164, v32, v33
    v_cvt_pk_bf16_f32 v165, v34, v35
    v_cvt_pk_bf16_f32 v166, v36, v37
    v_cvt_pk_bf16_f32 v167, v38, v39
    s_cmp_eq_u32 s88, 1
    s_cselect_b64 exec, 0, -1
    buffer_store_dwordx4 a[220:223], v26, s[24:27], s95 offen offset:1024 sc1
    s_mov_b64 exec, -1
    s_cmp_eq_u32 s88, 2
    s_cselect_b64 exec, 0, -1
    buffer_store_dwordx4 a[236:239], v26, s[24:27], s95 offen offset:2048 sc1
    s_mov_b64 exec, -1
    s_cmp_eq_u32 s88, 3
    s_cselect_b64 exec, 0, -1
    buffer_store_dwordx4 a[252:255], v26, s[24:27], s95 offen offset:3072 sc1
    s_mov_b64 exec, -1
    s_waitcnt lgkmcnt(0)
    s_barrier
L_op:
    v_mov_b32 v3, 131072
    ds_read_b128 v[236:239], v3 offset:32272
    ds_read_b64_tr_b16 a[144:145], v8 offset:0
    ds_read_b64_tr_b16 a[146:147], v8 offset:4608
    ds_read_b64_tr_b16 a[148:149], v8 offset:9216
    ds_read_b64_tr_b16 a[150:151], v8 offset:13824
    ds_read_b64_tr_b16 a[152:153], v8 offset:32
    ds_read_b64_tr_b16 a[154:155], v8 offset:4640
    ds_read_b64_tr_b16 a[156:157], v8 offset:9248
    ds_read_b64_tr_b16 a[158:159], v8 offset:13856
    s_waitcnt lgkmcnt(4)
    v_mfma_f32_16x16x32_bf16 v[32:35], a[144:147], v[240:243], 0
    ds_read_b64_tr_b16 a[160:161], v8 offset:64
    ds_read_b64_tr_b16 a[162:163], v8 offset:4672
    v_mfma_f32_16x16x32_bf16 v[32:35], a[148:151], v[244:247], v[32:35]
    ds_read_b64_tr_b16 a[164:165], v8 offset:9280
    ds_read_b64_tr_b16 a[166:167], v8 offset:13888
    s_add_u32 s60, s34, 0
    s_add_u32 m0, s92, 46080
    v_mfma_f32_16x16x32_bf16 v[68:71], a[144:147], v[28:31], 0
    buffer_load_dwordx4 v6, s[28:31], s60 offen offset:0 lds
    v_or3_b32 v236, v236, v237, v238
    v_or_b32 v236, v236, v239
    v_mfma_f32_16x16x32_bf16 v[68:71], a[148:151], a[212:215], v[68:71]
    s_nop 0
    v_readfirstlane_b32 s94, v236
    v_mfma_f32_16x16x32_bf16 v[104:107], a[144:147], a[224:227], 0
    v_accvgpr_read_b32 v12, a36
    v_accvgpr_read_b32 v13, a37
    v_mfma_f32_16x16x32_bf16 v[104:107], a[148:151], a[228:231], v[104:107]
    v_accvgpr_read_b32 v14, a38
    v_accvgpr_read_b32 v15, a39
    v_mfma_f32_16x16x32_bf16 v[140:143], a[144:147], a[240:243], 0
    v_accvgpr_read_b32 v16, a52
    v_accvgpr_read_b32 v17, a53
    v_mfma_f32_16x16x32_bf16 v[140:143], a[148:151], a[244:247], v[140:143]
    buffer_load_dwordx4 v7, s[28:31], s60 offen offset:1024 lds
    v_accvgpr_read_b32 v18, a54
    v_accvgpr_read_b32 v19, a55
    s_waitcnt lgkmcnt(4)
    v_mfma_f32_16x16x32_bf16 v[36:39], a[152:155], v[240:243], 0
    ds_read_b64_tr_b16 a[168:169], v8 offset:96
    ds_read_b64_tr_b16 a[170:171], v8 offset:4704
    v_mfma_f32_16x16x32_bf16 v[36:39], a[156:159], v[244:247], v[36:39]
    ds_read_b64_tr_b16 a[172:173], v8 offset:9312
    ds_read_b64_tr_b16 a[174:175], v8 offset:13920
    v_mfma_f32_16x16x32_bf16 v[72:75], a[152:155], v[28:31], 0
    v_mul_f32 v12, v12, v226
    v_mul_f32 v13, v13, v226
    v_mfma_f32_16x16x32_bf16 v[72:75], a[156:159], a[212:215], v[72:75]
    v_mul_f32 v14, v14, v226
    v_mul_f32 v15, v15, v226
    v_mfma_f32_16x16x32_bf16 v[108:111], a[152:155], a[224:227], 0
    buffer_load_dwordx4 v20, s[28:31], s60 offen offset:2048 lds
    v_mul_f32 v16, v16, v226
    v_mul_f32 v17, v17, v226
    v_mfma_f32_16x16x32_bf16 v[108:111], a[156:159], a[228:231], v[108:111]
    v_mul_f32 v18, v18, v226
    v_mul_f32 v19, v19, v226
    v_mfma_f32_16x16x32_bf16 v[144:147], a[152:155], a[240:243], 0
    v_cvt_pk_bf16_f32 v180, v12, v13
    v_cvt_pk_bf16_f32 v181, v14, v15
    v_mfma_f32_16x16x32_bf16 v[144:147], a[156:159], a[244:247], v[144:147]
    v_cvt_pk_bf16_f32 v182, v16, v17
    v_cvt_pk_bf16_f32 v183, v18, v19
    s_waitcnt lgkmcnt(4)
    v_mfma_f32_16x16x32_bf16 v[40:43], a[160:163], v[240:243], 0
    ds_read_b64_tr_b16 a[144:145], v8 offset:128
    ds_read_b64_tr_b16 a[146:147], v8 offset:4736
    v_mfma_f32_16x16x32_bf16 v[40:43], a[164:167], v[244:247], v[40:43]
    ds_read_b64_tr_b16 a[148:149], v8 offset:9344
    ds_read_b64_tr_b16 a[150:151], v8 offset:13952
    v_mfma_f32_16x16x32_bf16 v[76:79], a[160:163], v[28:31], 0
    buffer_load_dwordx4 v21, s[28:31], s60 offen offset:3072 lds
    v_accvgpr_read_b32 v232, a40
    v_accvgpr_read_b32 v233, a41
    v_mfma_f32_16x16x32_bf16 v[76:79], a[164:167], a[212:215], v[76:79]
    v_accvgpr_read_b32 v234, a42
    v_accvgpr_read_b32 v235, a43
    v_mfma_f32_16x16x32_bf16 v[112:115], a[160:163], a[224:227], 0
    v_accvgpr_read_b32 v236, a56
    v_accvgpr_read_b32 v237, a57
    v_mfma_f32_16x16x32_bf16 v[112:115], a[164:167], a[228:231], v[112:115]
    s_add_u32 m0, s92, 50176
    v_accvgpr_read_b32 v238, a58
    v_accvgpr_read_b32 v239, a59
    v_mfma_f32_16x16x32_bf16 v[148:151], a[160:163], a[240:243], 0
    buffer_load_dwordx4 v22, s[28:31], s60 offen offset:0 lds
    v_mul_f32 v232, v232, v228
    v_mul_f32 v233, v233, v228
    v_mfma_f32_16x16x32_bf16 v[148:151], a[164:167], a[244:247], v[148:151]
    v_mul_f32 v234, v234, v228
    v_mul_f32 v235, v235, v228
    s_waitcnt lgkmcnt(4)
    v_mfma_f32_16x16x32_bf16 v[44:47], a[168:171], v[240:243], 0
    ds_read_b64_tr_b16 a[152:153], v8 offset:160
    ds_read_b64_tr_b16 a[154:155], v8 offset:4768
    v_mfma_f32_16x16x32_bf16 v[44:47], a[172:175], v[244:247], v[44:47]
    ds_read_b64_tr_b16 a[156:157], v8 offset:9376
    ds_read_b64_tr_b16 a[158:159], v8 offset:13984
    v_mfma_f32_16x16x32_bf16 v[80:83], a[168:171], v[28:31], 0
    v_mul_f32 v236, v236, v228
    v_mul_f32 v237, v237, v228
    v_mfma_f32_16x16x32_bf16 v[80:83], a[172:175], a[212:215], v[80:83]
    buffer_load_dwordx4 v23, s[28:31], s60 offen offset:1024 lds
    v_mul_f32 v238, v238, v228
    v_mul_f32 v239, v239, v228
    v_mfma_f32_16x16x32_bf16 v[116:119], a[168:171], a[224:227], 0
    v_cvt_pk_bf16_f32 v196, v232, v233
    v_cvt_pk_bf16_f32 v197, v234, v235
    v_mfma_f32_16x16x32_bf16 v[116:119], a[172:175], a[228:231], v[116:119]
    v_cvt_pk_bf16_f32 v198, v236, v237
    v_cvt_pk_bf16_f32 v199, v238, v239
    v_mfma_f32_16x16x32_bf16 v[152:155], a[168:171], a[240:243], 0
    v_accvgpr_read_b32 v12, a44
    v_accvgpr_read_b32 v13, a45
    v_mfma_f32_16x16x32_bf16 v[152:155], a[172:175], a[244:247], v[152:155]
    v_accvgpr_read_b32 v14, a46
    v_accvgpr_read_b32 v15, a47
    s_waitcnt lgkmcnt(4)
    v_mfma_f32_16x16x32_bf16 v[48:51], a[144:147], v[240:243], 0
    ds_read_b64_tr_b16 a[160:161], v8 offset:192
    ds_read_b64_tr_b16 a[162:163], v8 offset:4800
    v_mfma_f32_16x16x32_bf16 v[48:51], a[148:151], v[244:247], v[48:51]
    ds_read_b64_tr_b16 a[164:165], v8 offset:9408
    ds_read_b64_tr_b16 a[166:167], v8 offset:14016
    v_mfma_f32_16x16x32_bf16 v[84:87], a[144:147], v[28:31], 0
    buffer_load_dwordx4 v24, s[28:31], s60 offen offset:2048 lds
    v_accvgpr_read_b32 v16, a60
    v_accvgpr_read_b32 v17, a61
    v_mfma_f32_16x16x32_bf16 v[84:87], a[148:151], a[212:215], v[84:87]
    v_accvgpr_read_b32 v18, a62
    v_accvgpr_read_b32 v19, a63
    v_mfma_f32_16x16x32_bf16 v[120:123], a[144:147], a[224:227], 0
    v_mul_f32 v12, v12, v230
    v_mul_f32 v13, v13, v230
    v_mfma_f32_16x16x32_bf16 v[120:123], a[148:151], a[228:231], v[120:123]
    buffer_load_dwordx4 v25, s[28:31], s60 offen offset:3072 lds
    v_mul_f32 v14, v14, v230
    v_mul_f32 v15, v15, v230
    v_mfma_f32_16x16x32_bf16 v[156:159], a[144:147], a[240:243], 0
    v_mul_f32 v16, v16, v230
    v_mul_f32 v17, v17, v230
    v_mfma_f32_16x16x32_bf16 v[156:159], a[148:151], a[244:247], v[156:159]
    v_mul_f32 v18, v18, v230
    v_mul_f32 v19, v19, v230
    s_waitcnt lgkmcnt(4)
    v_mfma_f32_16x16x32_bf16 v[52:55], a[152:155], v[240:243], 0
    ds_read_b64_tr_b16 a[168:169], v8 offset:224
    ds_read_b64_tr_b16 a[170:171], v8 offset:4832
    v_mfma_f32_16x16x32_bf16 v[52:55], a[156:159], v[244:247], v[52:55]
    ds_read_b64_tr_b16 a[172:173], v8 offset:9440
    ds_read_b64_tr_b16 a[174:175], v8 offset:14048
    s_add_u32 m0, s92, 54272
    v_mfma_f32_16x16x32_bf16 v[88:91], a[152:155], v[28:31], 0
    buffer_load_dwordx4 v1, s[28:31], s60 offen offset:0 lds
    v_cvt_pk_bf16_f32 v212, v12, v13
    v_cvt_pk_bf16_f32 v213, v14, v15
    v_mfma_f32_16x16x32_bf16 v[88:91], a[156:159], a[212:215], v[88:91]
    v_cvt_pk_bf16_f32 v214, v16, v17
    v_cvt_pk_bf16_f32 v215, v18, v19
    v_mfma_f32_16x16x32_bf16 v[124:127], a[152:155], a[224:227], 0
    v_accvgpr_read_b32 v232, a64
    v_accvgpr_read_b32 v233, a65
    v_mfma_f32_16x16x32_bf16 v[124:127], a[156:159], a[228:231], v[124:127]
    v_accvgpr_read_b32 v234, a66
    v_accvgpr_read_b32 v235, a67
    v_mfma_f32_16x16x32_bf16 a[128:131], a[152:155], a[240:243], 0
    v_accvgpr_read_b32 v236, a80
    v_accvgpr_read_b32 v237, a81
    v_mfma_f32_16x16x32_bf16 a[128:131], a[156:159], a[244:247], a[128:131]
    v_accvgpr_read_b32 v238, a82
    v_accvgpr_read_b32 v239, a83
    s_waitcnt lgkmcnt(4)
    v_mfma_f32_16x16x32_bf16 v[56:59], a[160:163], v[240:243], 0
    ds_read_b64_tr_b16 a[144:145], v8 offset:256
    ds_read_b64_tr_b16 a[146:147], v8 offset:4864
    v_mfma_f32_16x16x32_bf16 v[56:59], a[164:167], v[244:247], v[56:59]
    ds_read_b64_tr_b16 a[148:149], v8 offset:9472
    ds_read_b64_tr_b16 a[150:151], v8 offset:14080
    v_mfma_f32_16x16x32_bf16 v[92:95], a[160:163], v[28:31], 0
    s_add_u32 s95, s36, 65536
    s_cmp_eq_u32 s88, 0
    s_cselect_b64 exec, 0, -1
    buffer_store_dwordx4 v[160:163], v26, s[24:27], s95 offen offset:0 sc1
    s_mov_b64 exec, -1
    v_mfma_f32_16x16x32_bf16 v[92:95], a[164:167], a[212:215], v[92:95]
    v_mul_f32 v232, v232, v224
    v_mul_f32 v233, v233, v224
    v_mfma_f32_16x16x32_bf16 v[128:131], a[160:163], a[224:227], 0
    v_mul_f32 v234, v234, v224
    v_mul_f32 v235, v235, v224
    v_mfma_f32_16x16x32_bf16 v[128:131], a[164:167], a[228:231], v[128:131]
    v_mul_f32 v236, v236, v224
    v_mul_f32 v237, v237, v224
    v_mfma_f32_16x16x32_bf16 a[132:135], a[160:163], a[240:243], 0
    v_mul_f32 v238, v238, v224
    v_mul_f32 v239, v239, v224
    v_mfma_f32_16x16x32_bf16 a[132:135], a[164:167], a[244:247], a[132:135]
    v_cvt_pk_bf16_f32 v168, v232, v233
    v_cvt_pk_bf16_f32 v169, v234, v235
    s_waitcnt lgkmcnt(4)
    v_mfma_f32_16x16x32_bf16 v[60:63], a[168:171], v[240:243], 0
    ds_read_b64_tr_b16 a[152:153], v8 offset:18432
    ds_read_b64_tr_b16 a[154:155], v8 offset:23040
    v_mfma_f32_16x16x32_bf16 v[60:63], a[172:175], v[244:247], v[60:63]
    ds_read_b64_tr_b16 a[156:157], v8 offset:27648
    ds_read_b64_tr_b16 a[158:159], v8 offset:32256
    v_mfma_f32_16x16x32_bf16 v[96:99], a[168:171], v[28:31], 0
    v_cvt_pk_bf16_f32 v170, v236, v237
    v_cvt_pk_bf16_f32 v171, v238, v239
    v_mfma_f32_16x16x32_bf16 v[96:99], a[172:175], a[212:215], v[96:99]
    v_accvgpr_read_b32 v12, a68
    v_accvgpr_read_b32 v13, a69
    v_mfma_f32_16x16x32_bf16 v[132:135], a[168:171], a[224:227], 0
    v_accvgpr_read_b32 v14, a70
    v_accvgpr_read_b32 v15, a71
    v_mfma_f32_16x16x32_bf16 v[132:135], a[172:175], a[228:231], v[132:135]
    v_accvgpr_read_b32 v16, a84
    v_accvgpr_read_b32 v17, a85
    v_mfma_f32_16x16x32_bf16 a[136:139], a[168:171], a[240:243], 0
    v_accvgpr_read_b32 v18, a86
    v_accvgpr_read_b32 v19, a87
    v_mfma_f32_16x16x32_bf16 a[136:139], a[172:175], a[244:247], a[136:139]
    v_mul_f32 v12, v12, v226
    v_mul_f32 v13, v13, v226
    s_waitcnt lgkmcnt(4)
    v_mfma_f32_16x16x32_bf16 v[64:67], a[144:147], v[240:243], 0
    ds_read_b64_tr_b16 a[160:161], v8 offset:18464
    ds_read_b64_tr_b16 a[162:163], v8 offset:23072
    v_mfma_f32_16x16x32_bf16 v[64:67], a[148:151], v[244:247], v[64:67]
    ds_read_b64_tr_b16 a[164:165], v8 offset:27680
    ds_read_b64_tr_b16 a[166:167], v8 offset:32288
    v_mfma_f32_16x16x32_bf16 v[100:103], a[144:147], v[28:31], 0
    v_mul_f32 v14, v14, v226
    v_mul_f32 v15, v15, v226
    v_mfma_f32_16x16x32_bf16 v[100:103], a[148:151], a[212:215], v[100:103]
    v_mul_f32 v16, v16, v226
    v_mul_f32 v17, v17, v226
    v_mfma_f32_16x16x32_bf16 v[136:139], a[144:147], a[224:227], 0
    v_mul_f32 v18, v18, v226
    v_mul_f32 v19, v19, v226
    v_mfma_f32_16x16x32_bf16 v[136:139], a[148:151], a[228:231], v[136:139]
    v_cvt_pk_bf16_f32 v184, v12, v13
    v_cvt_pk_bf16_f32 v185, v14, v15
    v_mfma_f32_16x16x32_bf16 a[140:143], a[144:147], a[240:243], 0
    v_cvt_pk_bf16_f32 v186, v16, v17
    v_cvt_pk_bf16_f32 v187, v18, v19
    v_mfma_f32_16x16x32_bf16 a[140:143], a[148:151], a[244:247], a[140:143]
    v_accvgpr_read_b32 v232, a72
    v_accvgpr_read_b32 v233, a73
    s_waitcnt lgkmcnt(4)
    v_mfma_f32_16x16x32_bf16 v[32:35], a[152:155], v[248:251], v[32:35]
    ds_read_b64_tr_b16 a[168:169], v8 offset:18496
    ds_read_b64_tr_b16 a[170:171], v8 offset:23104
    v_mfma_f32_16x16x32_bf16 v[32:35], a[156:159], v[252:255], v[32:35]
    ds_read_b64_tr_b16 a[172:173], v8 offset:27712
    ds_read_b64_tr_b16 a[174:175], v8 offset:32320
    v_mfma_f32_16x16x32_bf16 v[68:71], a[152:155], a[216:219], v[68:71]
    s_cmp_eq_u32 s88, 1
    s_cselect_b64 exec, 0, -1
    buffer_store_dwordx4 v[176:179], v26, s[24:27], s95 offen offset:1024 sc1
    s_mov_b64 exec, -1
    v_mfma_f32_16x16x32_bf16 v[68:71], a[156:159], a[220:223], v[68:71]
    v_accvgpr_read_b32 v234, a74
    v_accvgpr_read_b32 v235, a75
    v_mfma_f32_16x16x32_bf16 v[104:107], a[152:155], a[232:235], v[104:107]
    v_accvgpr_read_b32 v236, a88
    v_accvgpr_read_b32 v237, a89
    v_mfma_f32_16x16x32_bf16 v[104:107], a[156:159], a[236:239], v[104:107]
    v_accvgpr_read_b32 v238, a90
    v_accvgpr_read_b32 v239, a91
    v_mfma_f32_16x16x32_bf16 v[140:143], a[152:155], a[248:251], v[140:143]
    v_mul_f32 v232, v232, v228
    v_mul_f32 v233, v233, v228
    v_mfma_f32_16x16x32_bf16 v[140:143], a[156:159], a[252:255], v[140:143]
    v_mul_f32 v234, v234, v228
    v_mul_f32 v235, v235, v228
    s_waitcnt lgkmcnt(4)
    v_mfma_f32_16x16x32_bf16 v[36:39], a[160:163], v[248:251], v[36:39]
    ds_read_b64_tr_b16 a[144:145], v8 offset:18528
    ds_read_b64_tr_b16 a[146:147], v8 offset:23136
    v_mfma_f32_16x16x32_bf16 v[36:39], a[164:167], v[252:255], v[36:39]
    ds_read_b64_tr_b16 a[148:149], v8 offset:27744
    ds_read_b64_tr_b16 a[150:151], v8 offset:32352
    v_mfma_f32_16x16x32_bf16 v[72:75], a[160:163], a[216:219], v[72:75]
    v_mul_f32 v236, v236, v228
    v_mul_f32 v237, v237, v228
    v_mfma_f32_16x16x32_bf16 v[72:75], a[164:167], a[220:223], v[72:75]
    v_mul_f32 v238, v238, v228
    v_mul_f32 v239, v239, v228
    v_mfma_f32_16x16x32_bf16 v[108:111], a[160:163], a[232:235], v[108:111]
    v_cvt_pk_bf16_f32 v200, v232, v233
    v_cvt_pk_bf16_f32 v201, v234, v235
    v_mfma_f32_16x16x32_bf16 v[108:111], a[164:167], a[236:239], v[108:111]
    v_cvt_pk_bf16_f32 v202, v236, v237
    v_cvt_pk_bf16_f32 v203, v238, v239
    v_mfma_f32_16x16x32_bf16 v[144:147], a[160:163], a[248:251], v[144:147]
    v_accvgpr_read_b32 v12, a76
    v_accvgpr_read_b32 v13, a77
    v_mfma_f32_16x16x32_bf16 v[144:147], a[164:167], a[252:255], v[144:147]
    v_accvgpr_read_b32 v14, a78
    v_accvgpr_read_b32 v15, a79
    s_waitcnt lgkmcnt(4)
    v_mfma_f32_16x16x32_bf16 v[40:43], a[168:171], v[248:251], v[40:43]
    ds_read_b64_tr_b16 a[152:153], v8 offset:18560
    ds_read_b64_tr_b16 a[154:155], v8 offset:23168
    v_mfma_f32_16x16x32_bf16 v[40:43], a[172:175], v[252:255], v[40:43]
    ds_read_b64_tr_b16 a[156:157], v8 offset:27776
    ds_read_b64_tr_b16 a[158:159], v8 offset:32384
    s_waitcnt vmcnt(11)
    v_mov_b32 v2, 2
    buffer_store_dword v2, v11, s[68:71], 0 offen sc1
    v_mfma_f32_16x16x32_bf16 v[76:79], a[168:171], a[216:219], v[76:79]
    v_accvgpr_read_b32 v16, a92
    v_accvgpr_read_b32 v17, a93
    v_mfma_f32_16x16x32_bf16 v[76:79], a[172:175], a[220:223], v[76:79]
    v_accvgpr_read_b32 v18, a94
    v_accvgpr_read_b32 v19, a95
    v_mfma_f32_16x16x32_bf16 v[112:115], a[168:171], a[232:235], v[112:115]
    v_mul_f32 v12, v12, v230
    v_mul_f32 v13, v13, v230
    v_mfma_f32_16x16x32_bf16 v[112:115], a[172:175], a[236:239], v[112:115]
    v_mul_f32 v14, v14, v230
    v_mul_f32 v15, v15, v230
    v_mfma_f32_16x16x32_bf16 v[148:151], a[168:171], a[248:251], v[148:151]
    v_mul_f32 v16, v16, v230
    v_mul_f32 v17, v17, v230
    v_mfma_f32_16x16x32_bf16 v[148:151], a[172:175], a[252:255], v[148:151]
    v_mul_f32 v18, v18, v230
    v_mul_f32 v19, v19, v230
    s_waitcnt lgkmcnt(4)
    v_mfma_f32_16x16x32_bf16 v[44:47], a[144:147], v[248:251], v[44:47]
    ds_read_b64_tr_b16 a[160:161], v8 offset:18592
    ds_read_b64_tr_b16 a[162:163], v8 offset:23200
    v_mfma_f32_16x16x32_bf16 v[44:47], a[148:151], v[252:255], v[44:47]
    ds_read_b64_tr_b16 a[164:165], v8 offset:27808
    ds_read_b64_tr_b16 a[166:167], v8 offset:32416
    v_mfma_f32_16x16x32_bf16 v[80:83], a[144:147], a[216:219], v[80:83]
    s_cmp_eq_u32 s88, 2
    s_cselect_b64 exec, 0, -1
    buffer_store_dwordx4 v[192:195], v26, s[24:27], s95 offen offset:2048 sc1
    s_mov_b64 exec, -1
    v_mfma_f32_16x16x32_bf16 v[80:83], a[148:151], a[220:223], v[80:83]
    v_cvt_pk_bf16_f32 v216, v12, v13
    v_cvt_pk_bf16_f32 v217, v14, v15
    v_mfma_f32_16x16x32_bf16 v[116:119], a[144:147], a[232:235], v[116:119]
    s_buffer_load_dwordx4 s[4:7], s[68:71], s90 glc
    v_cvt_pk_bf16_f32 v218, v16, v17
    v_cvt_pk_bf16_f32 v219, v18, v19
    v_mfma_f32_16x16x32_bf16 v[116:119], a[148:151], a[236:239], v[116:119]
    v_accvgpr_read_b32 v232, a96
    v_accvgpr_read_b32 v233, a97
    v_mfma_f32_16x16x32_bf16 v[152:155], a[144:147], a[248:251], v[152:155]
    v_accvgpr_read_b32 v234, a98
    v_accvgpr_read_b32 v235, a99
    v_mfma_f32_16x16x32_bf16 v[152:155], a[148:151], a[252:255], v[152:155]
    v_accvgpr_read_b32 v236, a112
    v_accvgpr_read_b32 v237, a113
    s_waitcnt lgkmcnt(4)
    v_mfma_f32_16x16x32_bf16 v[48:51], a[152:155], v[248:251], v[48:51]
    ds_read_b64_tr_b16 a[168:169], v8 offset:18624
    ds_read_b64_tr_b16 a[170:171], v8 offset:23232
    v_mfma_f32_16x16x32_bf16 v[48:51], a[156:159], v[252:255], v[48:51]
    ds_read_b64_tr_b16 a[172:173], v8 offset:27840
    ds_read_b64_tr_b16 a[174:175], v8 offset:32448
    v_mfma_f32_16x16x32_bf16 v[84:87], a[152:155], a[216:219], v[84:87]
    v_accvgpr_read_b32 v238, a114
    v_accvgpr_read_b32 v239, a115
    v_mfma_f32_16x16x32_bf16 v[84:87], a[156:159], a[220:223], v[84:87]
    v_mul_f32 v232, v232, v224
    v_mul_f32 v233, v233, v224
    v_mfma_f32_16x16x32_bf16 v[120:123], a[152:155], a[232:235], v[120:123]
    v_mul_f32 v234, v234, v224
    v_mul_f32 v235, v235, v224
    v_mfma_f32_16x16x32_bf16 v[120:123], a[156:159], a[236:239], v[120:123]
    v_mul_f32 v236, v236, v224
    v_mul_f32 v237, v237, v224
    v_mfma_f32_16x16x32_bf16 v[156:159], a[152:155], a[248:251], v[156:159]
    v_mul_f32 v238, v238, v224
    v_mul_f32 v239, v239, v224
    v_mfma_f32_16x16x32_bf16 v[156:159], a[156:159], a[252:255], v[156:159]
    v_cvt_pk_bf16_f32 v172, v232, v233
    v_cvt_pk_bf16_f32 v173, v234, v235
    s_waitcnt lgkmcnt(4)
    v_mfma_f32_16x16x32_bf16 v[52:55], a[160:163], v[248:251], v[52:55]
    ds_read_b64_tr_b16 a[144:145], v8 offset:18656
    ds_read_b64_tr_b16 a[146:147], v8 offset:23264
    v_mfma_f32_16x16x32_bf16 v[52:55], a[164:167], v[252:255], v[52:55]
    ds_read_b64_tr_b16 a[148:149], v8 offset:27872
    ds_read_b64_tr_b16 a[150:151], v8 offset:32480
    v_mfma_f32_16x16x32_bf16 v[88:91], a[160:163], a[216:219], v[88:91]
    v_cvt_pk_bf16_f32 v174, v236, v237
    v_cvt_pk_bf16_f32 v175, v238, v239
    v_mfma_f32_16x16x32_bf16 v[88:91], a[164:167], a[220:223], v[88:91]
    v_accvgpr_read_b32 v12, a100
    v_accvgpr_read_b32 v13, a101
    v_mfma_f32_16x16x32_bf16 v[124:127], a[160:163], a[232:235], v[124:127]
    v_accvgpr_read_b32 v14, a102
    v_accvgpr_read_b32 v15, a103
    v_mfma_f32_16x16x32_bf16 v[124:127], a[164:167], a[236:239], v[124:127]
    v_accvgpr_read_b32 v16, a116
    v_accvgpr_read_b32 v17, a117
    v_mfma_f32_16x16x32_bf16 a[128:131], a[160:163], a[248:251], a[128:131]
    v_accvgpr_read_b32 v18, a118
    v_accvgpr_read_b32 v19, a119
    v_mfma_f32_16x16x32_bf16 a[128:131], a[164:167], a[252:255], a[128:131]
    v_mul_f32 v12, v12, v226
    v_mul_f32 v13, v13, v226
    s_waitcnt lgkmcnt(4)
    v_mfma_f32_16x16x32_bf16 v[56:59], a[168:171], v[248:251], v[56:59]
    ds_read_b64_tr_b16 a[152:153], v8 offset:18688
    ds_read_b64_tr_b16 a[154:155], v8 offset:23296
    v_mfma_f32_16x16x32_bf16 v[56:59], a[172:175], v[252:255], v[56:59]
    ds_read_b64_tr_b16 a[156:157], v8 offset:27904
    ds_read_b64_tr_b16 a[158:159], v8 offset:32512
    s_cmp_eq_u32 s88, 0
    s_cselect_b32 s3, 2147483648, 0
    v_or_b32 v28, s3, v26
    v_mfma_f32_16x16x32_bf16 v[92:95], a[168:171], a[216:219], v[92:95]
    s_cmp_eq_u32 s88, 3
    s_cselect_b64 exec, 0, -1
    buffer_store_dwordx4 v[208:211], v26, s[24:27], s95 offen offset:3072 sc1
    s_mov_b64 exec, -1
    v_mfma_f32_16x16x32_bf16 v[92:95], a[172:175], a[220:223], v[92:95]
    s_cmp_eq_u32 s88, 1
    s_cselect_b32 s3, 2147483648, 0
    v_or_b32 v29, s3, v26
    v_mul_f32 v14, v14, v226
    v_mul_f32 v15, v15, v226
    v_mfma_f32_16x16x32_bf16 v[128:131], a[168:171], a[232:235], v[128:131]
    v_mul_f32 v16, v16, v226
    v_mul_f32 v17, v17, v226
    v_mfma_f32_16x16x32_bf16 v[128:131], a[172:175], a[236:239], v[128:131]
    s_cmp_eq_u32 s88, 2
    s_cselect_b32 s3, 2147483648, 0
    v_or_b32 v30, s3, v26
    v_mul_f32 v18, v18, v226
    v_mul_f32 v19, v19, v226
    v_mfma_f32_16x16x32_bf16 a[132:135], a[168:171], a[248:251], a[132:135]
    v_cvt_pk_bf16_f32 v188, v12, v13
    v_cvt_pk_bf16_f32 v189, v14, v15
    v_mfma_f32_16x16x32_bf16 a[132:135], a[172:175], a[252:255], a[132:135]
    s_cmp_eq_u32 s88, 3
    s_cselect_b32 s3, 2147483648, 0
    v_or_b32 v31, s3, v26
    v_cvt_pk_bf16_f32 v190, v16, v17
    v_cvt_pk_bf16_f32 v191, v18, v19
    s_waitcnt lgkmcnt(0)
    s_andn2_b32 s94, s94, s51
    s_cmp_lg_u32 s94, 0
    s_cbranch_scc1 L_redo
    s_barrier
    s_min_u32 s4, s4, s5
    s_min_u32 s6, s6, s7
    s_min_u32 s4, s4, s6
    s_cmp_ge_u32 s4, 1
    s_cbranch_scc0 L_spinA1
L_backA1:
    v_mfma_f32_16x16x32_bf16 v[60:63], a[144:147], v[248:251], v[60:63]
    ds_read_b64_tr_b16 a[160:161], v9 offset:0
    ds_read_b64_tr_b16 a[162:163], v9 offset:4608
    v_mfma_f32_16x16x32_bf16 v[60:63], a[148:151], v[252:255], v[60:63]
    ds_read_b64_tr_b16 a[164:165], v9 offset:9216
    ds_read_b64_tr_b16 a[166:167], v9 offset:13824
    v_mfma_f32_16x16x32_bf16 v[96:99], a[144:147], a[216:219], v[96:99]
    v_accvgpr_read_b32 v232, a104
    v_accvgpr_read_b32 v233, a105
    v_mfma_f32_16x16x32_bf16 v[96:99], a[148:151], a[220:223], v[96:99]
    v_accvgpr_read_b32 v234, a106
    v_accvgpr_read_b32 v235, a107
    v_mfma_f32_16x16x32_bf16 v[132:135], a[144:147], a[232:235], v[132:135]
    v_accvgpr_read_b32 v236, a120
    v_accvgpr_read_b32 v237, a121
    v_mfma_f32_16x16x32_bf16 v[132:135], a[148:151], a[236:239], v[132:135]
    v_accvgpr_read_b32 v238, a122
    v_accvgpr_read_b32 v239, a123
    v_mfma_f32_16x16x32_bf16 a[136:139], a[144:147], a[248:251], a[136:139]
    v_mul_f32 v232, v232, v228
    v_mul_f32 v233, v233, v228
    v_mfma_f32_16x16x32_bf16 a[136:139], a[148:151], a[252:255], a[136:139]
    v_mul_f32 v234, v234, v228
    v_mul_f32 v235, v235, v228
    v_mfma_f32_16x16x32_bf16 v[64:67], a[152:155], v[248:251], v[64:67]
    ds_read_b64_tr_b16 a[168:169], v9 offset:32
    ds_read_b64_tr_b16 a[170:171], v9 offset:4640
    v_mfma_f32_16x16x32_bf16 v[64:67], a[156:159], v[252:255], v[64:67]
    ds_read_b64_tr_b16 a[172:173], v9 offset:9248
    ds_read_b64_tr_b16 a[174:175], v9 offset:13856
    v_mfma_f32_16x16x32_bf16 v[100:103], a[152:155], a[216:219], v[100:103]
    v_mul_f32 v236, v236, v228
    v_mul_f32 v237, v237, v228
    v_mfma_f32_16x16x32_bf16 v[100:103], a[156:159], a[220:223], v[100:103]
    v_mul_f32 v238, v238, v228
    v_mul_f32 v239, v239, v228
    v_mfma_f32_16x16x32_bf16 v[136:139], a[152:155], a[232:235], v[136:139]
    v_cvt_pk_bf16_f32 v204, v232, v233
    v_cvt_pk_bf16_f32 v205, v234, v235
    v_mfma_f32_16x16x32_bf16 v[136:139], a[156:159], a[236:239], v[136:139]
    v_cvt_pk_bf16_f32 v206, v236, v237
    v_cvt_pk_bf16_f32 v207, v238, v239
    v_mfma_f32_16x16x32_bf16 a[140:143], a[152:155], a[248:251], a[140:143]
    v_accvgpr_read_b32 v12, a108
    v_accvgpr_read_b32 v13, a109
    v_mfma_f32_16x16x32_bf16 a[140:143], a[156:159], a[252:255], a[140:143]
    v_accvgpr_read_b32 v14, a110
    v_accvgpr_read_b32 v15, a111
    s_waitcnt lgkmcnt(4)
    v_mfma_f32_16x16x32_bf16 v[32:35], a[160:163], v[160:163], v[32:35]
    ds_read_b64_tr_b16 a[144:145], v9 offset:64
    ds_read_b64_tr_b16 a[146:147], v9 offset:4672
    v_mfma_f32_16x16x32_bf16 v[32:35], a[164:167], v[164:167], v[32:35]
    ds_read_b64_tr_b16 a[148:149], v9 offset:9280
    ds_read_b64_tr_b16 a[150:151], v9 offset:13888
    s_add_u32 s56, s37, 0
    v_mfma_f32_16x16x32_bf16 v[68:71], a[160:163], v[176:179], v[68:71]
    buffer_load_dwordx4 a[0:3], v28, s[24:27], s56 offen offset:0
    v_mfma_f32_16x16x32_bf16 v[68:71], a[164:167], v[180:183], v[68:71]
    s_add_u32 s95, s36, 69632
    s_cmp_eq_u32 s88, 0
    s_cselect_b64 exec, 0, -1
    buffer_store_dwordx4 v[164:167], v26, s[24:27], s95 offen offset:0 sc1
    s_mov_b64 exec, -1
    v_mfma_f32_16x16x32_bf16 v[104:107], a[160:163], v[192:195], v[104:107]
    v_accvgpr_read_b32 v16, a124
    v_accvgpr_read_b32 v17, a125
    v_mfma_f32_16x16x32_bf16 v[104:107], a[164:167], v[196:199], v[104:107]
    v_accvgpr_read_b32 v18, a126
    v_accvgpr_read_b32 v19, a127
    v_mfma_f32_16x16x32_bf16 v[140:143], a[160:163], v[208:211], v[140:143]
    v_mul_f32 v12, v12, v230
    v_mul_f32 v13, v13, v230
    v_mfma_f32_16x16x32_bf16 v[140:143], a[164:167], v[212:215], v[140:143]
    buffer_load_dwordx4 a[4:7], v29, s[24:27], s56 offen offset:1024
    s_waitcnt lgkmcnt(4)
    v_mfma_f32_16x16x32_bf16 v[36:39], a[168:171], v[160:163], v[36:39]
    ds_read_b64_tr_b16 a[152:153], v9 offset:96
    ds_read_b64_tr_b16 a[154:155], v9 offset:4704
    v_mfma_f32_16x16x32_bf16 v[36:39], a[172:175], v[164:167], v[36:39]
    ds_read_b64_tr_b16 a[156:157], v9 offset:9312
    ds_read_b64_tr_b16 a[158:159], v9 offset:13920
    v_mfma_f32_16x16x32_bf16 v[72:75], a[168:171], v[176:179], v[72:75]
    v_mul_f32 v14, v14, v230
    v_mul_f32 v15, v15, v230
    v_mfma_f32_16x16x32_bf16 v[72:75], a[172:175], v[180:183], v[72:75]
    v_mul_f32 v16, v16, v230
    v_mul_f32 v17, v17, v230
    v_mfma_f32_16x16x32_bf16 v[108:111], a[168:171], v[192:195], v[108:111]
    buffer_load_dwordx4 a[8:11], v30, s[24:27], s56 offen offset:2048
    v_mfma_f32_16x16x32_bf16 v[108:111], a[172:175], v[196:199], v[108:111]
    v_mul_f32 v18, v18, v230
    v_mul_f32 v19, v19, v230
    v_mfma_f32_16x16x32_bf16 v[144:147], a[168:171], v[208:211], v[144:147]
    v_cvt_pk_bf16_f32 v220, v12, v13
    v_cvt_pk_bf16_f32 v221, v14, v15
    v_mfma_f32_16x16x32_bf16 v[144:147], a[172:175], v[212:215], v[144:147]
    v_cvt_pk_bf16_f32 v222, v16, v17
    v_cvt_pk_bf16_f32 v223, v18, v19
    s_waitcnt lgkmcnt(4)
    v_mfma_f32_16x16x32_bf16 v[40:43], a[144:147], v[160:163], v[40:43]
    ds_read_b64_tr_b16 a[160:161], v9 offset:128
    ds_read_b64_tr_b16 a[162:163], v9 offset:4736
    v_mfma_f32_16x16x32_bf16 v[40:43], a[148:151], v[164:167], v[40:43]
    ds_read_b64_tr_b16 a[164:165], v9 offset:9344
    ds_read_b64_tr_b16 a[166:167], v9 offset:13952
    v_mfma_f32_16x16x32_bf16 v[76:79], a[144:147], v[176:179], v[76:79]
    buffer_load_dwordx4 a[12:15], v31, s[24:27], s56 offen offset:3072
    v_mfma_f32_16x16x32_bf16 v[76:79], a[148:151], v[180:183], v[76:79]
    v_mfma_f32_16x16x32_bf16 v[112:115], a[144:147], v[192:195], v[112:115]
    v_mfma_f32_16x16x32_bf16 v[112:115], a[148:151], v[196:199], v[112:115]
    s_add_u32 s57, s37, 4096
    v_mfma_f32_16x16x32_bf16 v[148:151], a[144:147], v[208:211], v[148:151]
    buffer_load_dwordx4 a[16:19], v28, s[24:27], s57 offen offset:0
    v_mfma_f32_16x16x32_bf16 v[148:151], a[148:151], v[212:215], v[148:151]
    s_waitcnt lgkmcnt(4)
    v_mfma_f32_16x16x32_bf16 v[44:47], a[152:155], v[160:163], v[44:47]
    ds_read_b64_tr_b16 a[168:169], v9 offset:160
    ds_read_b64_tr_b16 a[170:171], v9 offset:4768
    v_mfma_f32_16x16x32_bf16 v[44:47], a[156:159], v[164:167], v[44:47]
    ds_read_b64_tr_b16 a[172:173], v9 offset:9376
    ds_read_b64_tr_b16 a[174:175], v9 offset:13984
    v_mfma_f32_16x16x32_bf16 v[80:83], a[152:155], v[176:179], v[80:83]
    s_cmp_eq_u32 s88, 1
    s_cselect_b64 exec, 0, -1
    buffer_store_dwordx4 v[180:183], v26, s[24:27], s95 offen offset:1024 sc1
    s_mov_b64 exec, -1
    v_mfma_f32_16x16x32_bf16 v[80:83], a[156:159], v[180:183], v[80:83]
    buffer_load_dwordx4 a[20:23], v29, s[24:27], s57 offen offset:1024
    v_mfma_f32_16x16x32_bf16 v[116:119], a[152:155], v[192:195], v[116:119]
    v_mfma_f32_16x16x32_bf16 v[116:119], a[156:159], v[196:199], v[116:119]
    v_mfma_f32_16x16x32_bf16 v[152:155], a[152:155], v[208:211], v[152:155]
    v_mfma_f32_16x16x32_bf16 v[152:155], a[156:159], v[212:215], v[152:155]
    s_waitcnt lgkmcnt(4)
    v_mfma_f32_16x16x32_bf16 v[48:51], a[160:163], v[160:163], v[48:51]
    ds_read_b64_tr_b16 a[144:145], v9 offset:192
    ds_read_b64_tr_b16 a[146:147], v9 offset:4800
    v_mfma_f32_16x16x32_bf16 v[48:51], a[164:167], v[164:167], v[48:51]
    ds_read_b64_tr_b16 a[148:149], v9 offset:9408
    ds_read_b64_tr_b16 a[150:151], v9 offset:14016
    v_mfma_f32_16x16x32_bf16 v[84:87], a[160:163], v[176:179], v[84:87]
    buffer_load_dwordx4 a[24:27], v30, s[24:27], s57 offen offset:2048
    v_mfma_f32_16x16x32_bf16 v[84:87], a[164:167], v[180:183], v[84:87]
    v_mfma_f32_16x16x32_bf16 v[120:123], a[160:163], v[192:195], v[120:123]
    v_mfma_f32_16x16x32_bf16 v[120:123], a[164:167], v[196:199], v[120:123]
    buffer_load_dwordx4 a[28:31], v31, s[24:27], s57 offen offset:3072
    v_mfma_f32_16x16x32_bf16 v[156:159], a[160:163], v[208:211], v[156:159]
    v_mfma_f32_16x16x32_bf16 v[156:159], a[164:167], v[212:215], v[156:159]
    s_waitcnt lgkmcnt(4)
    v_mfma_f32_16x16x32_bf16 v[52:55], a[168:171], v[160:163], v[52:55]
    ds_read_b64_tr_b16 a[152:153], v9 offset:224
    ds_read_b64_tr_b16 a[154:155], v9 offset:4832
    v_mfma_f32_16x16x32_bf16 v[52:55], a[172:175], v[164:167], v[52:55]
    ds_read_b64_tr_b16 a[156:157], v9 offset:9440
    ds_read_b64_tr_b16 a[158:159], v9 offset:14048
    v_mfma_f32_16x16x32_bf16 v[88:91], a[168:171], v[176:179], v[88:91]
    v_mfma_f32_16x16x32_bf16 v[88:91], a[172:175], v[180:183], v[88:91]
    v_mfma_f32_16x16x32_bf16 v[124:127], a[168:171], v[192:195], v[124:127]
    v_mfma_f32_16x16x32_bf16 v[124:127], a[172:175], v[196:199], v[124:127]
    v_mfma_f32_16x16x32_bf16 a[128:131], a[168:171], v[208:211], a[128:131]
    v_mfma_f32_16x16x32_bf16 a[128:131], a[172:175], v[212:215], a[128:131]
    s_waitcnt lgkmcnt(4)
    v_mfma_f32_16x16x32_bf16 v[56:59], a[144:147], v[160:163], v[56:59]
    ds_read_b64_tr_b16 a[160:161], v9 offset:256
    ds_read_b64_tr_b16 a[162:163], v9 offset:4864
    v_mfma_f32_16x16x32_bf16 v[56:59], a[148:151], v[164:167], v[56:59]
    ds_read_b64_tr_b16 a[164:165], v9 offset:9472
    ds_read_b64_tr_b16 a[166:167], v9 offset:14080
    v_mfma_f32_16x16x32_bf16 v[92:95], a[144:147], v[176:179], v[92:95]
    s_cmp_eq_u32 s88, 2
    s_cselect_b64 exec, 0, -1
    buffer_store_dwordx4 v[196:199], v26, s[24:27], s95 offen offset:2048 sc1
    s_mov_b64 exec, -1
    v_mfma_f32_16x16x32_bf16 v[92:95], a[148:151], v[180:183], v[92:95]
    v_mfma_f32_16x16x32_bf16 v[128:131], a[144:147], v[192:195], v[128:131]
    v_mfma_f32_16x16x32_bf16 v[128:131], a[148:151], v[196:199], v[128:131]
    v_mfma_f32_16x16x32_bf16 a[132:135], a[144:147], v[208:211], a[132:135]
    v_mfma_f32_16x16x32_bf16 a[132:135], a[148:151], v[212:215], a[132:135]
    s_waitcnt lgkmcnt(4)
    v_mfma_f32_16x16x32_bf16 v[60:63], a[152:155], v[160:163], v[60:63]
    ds_read_b64_tr_b16 a[168:169], v9 offset:18432
    ds_read_b64_tr_b16 a[170:171], v9 offset:23040
    v_mfma_f32_16x16x32_bf16 v[60:63], a[156:159], v[164:167], v[60:63]
    ds_read_b64_tr_b16 a[172:173], v9 offset:27648
    ds_read_b64_tr_b16 a[174:175], v9 offset:32256
    v_mfma_f32_16x16x32_bf16 v[96:99], a[152:155], v[176:179], v[96:99]
    v_mfma_f32_16x16x32_bf16 v[96:99], a[156:159], v[180:183], v[96:99]
    v_mfma_f32_16x16x32_bf16 v[132:135], a[152:155], v[192:195], v[132:135]
    s_buffer_load_dwordx4 s[4:7], s[68:71], s90 glc
    v_mfma_f32_16x16x32_bf16 v[132:135], a[156:159], v[196:199], v[132:135]
    v_mfma_f32_16x16x32_bf16 a[136:139], a[152:155], v[208:211], a[136:139]
    v_mfma_f32_16x16x32_bf16 a[136:139], a[156:159], v[212:215], a[136:139]
    s_waitcnt lgkmcnt(4)
    v_mfma_f32_16x16x32_bf16 v[64:67], a[160:163], v[160:163], v[64:67]
    ds_read_b64_tr_b16 a[144:145], v9 offset:18464
    ds_read_b64_tr_b16 a[146:147], v9 offset:23072
    v_mfma_f32_16x16x32_bf16 v[64:67], a[164:167], v[164:167], v[64:67]
    ds_read_b64_tr_b16 a[148:149], v9 offset:27680
    ds_read_b64_tr_b16 a[150:151], v9 offset:32288
    v_mfma_f32_16x16x32_bf16 v[100:103], a[160:163], v[176:179], v[100:103]
    v_mfma_f32_16x16x32_bf16 v[100:103], a[164:167], v[180:183], v[100:103]
    v_mfma_f32_16x16x32_bf16 v[136:139], a[160:163], v[192:195], v[136:139]
    v_mfma_f32_16x16x32_bf16 v[136:139], a[164:167], v[196:199], v[136:139]
    v_mfma_f32_16x16x32_bf16 a[140:143], a[160:163], v[208:211], a[140:143]
    v_mfma_f32_16x16x32_bf16 a[140:143], a[164:167], v[212:215], a[140:143]
    s_waitcnt lgkmcnt(4)
    v_mfma_f32_16x16x32_bf16 v[32:35], a[168:171], v[168:171], v[32:35]
    ds_read_b64_tr_b16 a[152:153], v9 offset:18496
    ds_read_b64_tr_b16 a[154:155], v9 offset:23104
    v_mfma_f32_16x16x32_bf16 v[32:35], a[172:175], v[172:175], v[32:35]
    ds_read_b64_tr_b16 a[156:157], v9 offset:27712
    ds_read_b64_tr_b16 a[158:159], v9 offset:32320
    v_mfma_f32_16x16x32_bf16 v[68:71], a[168:171], v[184:187], v[68:71]
    s_cmp_eq_u32 s88, 3
    s_cselect_b64 exec, 0, -1
    buffer_store_dwordx4 v[212:215], v26, s[24:27], s95 offen offset:3072 sc1
    s_mov_b64 exec, -1
    v_mfma_f32_16x16x32_bf16 v[68:71], a[172:175], v[188:191], v[68:71]
    v_mfma_f32_16x16x32_bf16 v[104:107], a[168:171], v[200:203], v[104:107]
    v_mfma_f32_16x16x32_bf16 v[104:107], a[172:175], v[204:207], v[104:107]
    v_mfma_f32_16x16x32_bf16 v[140:143], a[168:171], v[216:219], v[140:143]
    v_mfma_f32_16x16x32_bf16 v[140:143], a[172:175], v[220:223], v[140:143]
    s_waitcnt lgkmcnt(4)
    v_mfma_f32_16x16x32_bf16 v[36:39], a[144:147], v[168:171], v[36:39]
    ds_read_b64_tr_b16 a[160:161], v9 offset:18528
    ds_read_b64_tr_b16 a[162:163], v9 offset:23136
    v_mfma_f32_16x16x32_bf16 v[36:39], a[148:151], v[172:175], v[36:39]
    ds_read_b64_tr_b16 a[164:165], v9 offset:27744
    ds_read_b64_tr_b16 a[166:167], v9 offset:32352
    v_mfma_f32_16x16x32_bf16 v[72:75], a[144:147], v[184:187], v[72:75]
    v_mfma_f32_16x16x32_bf16 v[72:75], a[148:151], v[188:191], v[72:75]
    v_mfma_f32_16x16x32_bf16 v[108:111], a[144:147], v[200:203], v[108:111]
    v_mfma_f32_16x16x32_bf16 v[108:111], a[148:151], v[204:207], v[108:111]
    v_mfma_f32_16x16x32_bf16 v[144:147], a[144:147], v[216:219], v[144:147]
    v_mfma_f32_16x16x32_bf16 v[144:147], a[148:151], v[220:223], v[144:147]
    s_waitcnt lgkmcnt(0)
    s_min_u32 s4, s4, s5
    s_min_u32 s6, s6, s7
    s_min_u32 s4, s4, s6
    s_cmp_ge_u32 s4, 2
    s_cbranch_scc0 L_spinA2
L_backA2:
    v_mfma_f32_16x16x32_bf16 v[40:43], a[152:155], v[168:171], v[40:43]
    ds_read_b64_tr_b16 a[168:169], v9 offset:18560
    ds_read_b64_tr_b16 a[170:171], v9 offset:23168
    v_mfma_f32_16x16x32_bf16 v[40:43], a[156:159], v[172:175], v[40:43]
    ds_read_b64_tr_b16 a[172:173], v9 offset:27776
    ds_read_b64_tr_b16 a[174:175], v9 offset:32384
    s_add_u32 s58, s37, 8192
    v_mfma_f32_16x16x32_bf16 v[76:79], a[152:155], v[184:187], v[76:79]
    buffer_load_dwordx4 a[32:35], v28, s[24:27], s58 offen offset:0
    v_mfma_f32_16x16x32_bf16 v[76:79], a[156:159], v[188:191], v[76:79]
    v_mfma_f32_16x16x32_bf16 v[112:115], a[152:155], v[200:203], v[112:115]
    v_mfma_f32_16x16x32_bf16 v[112:115], a[156:159], v[204:207], v[112:115]
    v_mfma_f32_16x16x32_bf16 v[148:151], a[152:155], v[216:219], v[148:151]
    v_mfma_f32_16x16x32_bf16 v[148:151], a[156:159], v[220:223], v[148:151]
    v_mfma_f32_16x16x32_bf16 v[44:47], a[160:163], v[168:171], v[44:47]
    ds_read_b64_tr_b16 a[144:145], v9 offset:18592
    ds_read_b64_tr_b16 a[146:147], v9 offset:23200
    v_mfma_f32_16x16x32_bf16 v[44:47], a[164:167], v[172:175], v[44:47]
    ds_read_b64_tr_b16 a[148:149], v9 offset:27808
    ds_read_b64_tr_b16 a[150:151], v9 offset:32416
    v_mfma_f32_16x16x32_bf16 v[80:83], a[160:163], v[184:187], v[80:83]
    buffer_load_dwordx4 a[36:39], v29, s[24:27], s58 offen offset:1024
    v_mfma_f32_16x16x32_bf16 v[80:83], a[164:167], v[188:191], v[80:83]
    s_add_u32 s95, s36, 73728
    s_cmp_eq_u32 s88, 0
    s_cselect_b64 exec, 0, -1
    buffer_store_dwordx4 v[168:171], v26, s[24:27], s95 offen offset:0 sc1
    s_mov_b64 exec, -1
    v_mfma_f32_16x16x32_bf16 v[116:119], a[160:163], v[200:203], v[116:119]
    v_mfma_f32_16x16x32_bf16 v[116:119], a[164:167], v[204:207], v[116:119]
    v_mfma_f32_16x16x32_bf16 v[152:155], a[160:163], v[216:219], v[152:155]
    buffer_load_dwordx4 a[40:43], v30, s[24:27], s58 offen offset:2048
    v_mfma_f32_16x16x32_bf16 v[152:155], a[164:167], v[220:223], v[152:155]
    s_waitcnt lgkmcnt(4)
    v_mfma_f32_16x16x32_bf16 v[48:51], a[168:171], v[168:171], v[48:51]
    ds_read_b64_tr_b16 a[152:153], v9 offset:18624
    ds_read_b64_tr_b16 a[154:155], v9 offset:23232
    v_mfma_f32_16x16x32_bf16 v[48:51], a[172:175], v[172:175], v[48:51]
    ds_read_b64_tr_b16 a[156:157], v9 offset:27840
    ds_read_b64_tr_b16 a[158:159], v9 offset:32448
    v_mfma_f32_16x16x32_bf16 v[84:87], a[168:171], v[184:187], v[84:87]
    v_mfma_f32_16x16x32_bf16 v[84:87], a[172:175], v[188:191], v[84:87]
    v_mfma_f32_16x16x32_bf16 v[120:123], a[168:171], v[200:203], v[120:123]
    buffer_load_dwordx4 a[44:47], v31, s[24:27], s58 offen offset:3072
    v_mfma_f32_16x16x32_bf16 v[120:123], a[172:175], v[204:207], v[120:123]
    v_mfma_f32_16x16x32_bf16 v[156:159], a[168:171], v[216:219], v[156:159]
    v_mfma_f32_16x16x32_bf16 v[156:159], a[172:175], v[220:223], v[156:159]
    s_waitcnt lgkmcnt(4)
    v_mfma_f32_16x16x32_bf16 v[52:55], a[144:147], v[168:171], v[52:55]
    ds_read_b64_tr_b16 a[160:161], v9 offset:18656
    ds_read_b64_tr_b16 a[162:163], v9 offset:23264
    v_mfma_f32_16x16x32_bf16 v[52:55], a[148:151], v[172:175], v[52:55]
    ds_read_b64_tr_b16 a[164:165], v9 offset:27872
    ds_read_b64_tr_b16 a[166:167], v9 offset:32480
    s_add_u32 s59, s37, 12288
    v_mfma_f32_16x16x32_bf16 v[88:91], a[144:147], v[184:187], v[88:91]
    buffer_load_dwordx4 a[48:51], v28, s[24:27], s59 offen offset:0
    v_mfma_f32_16x16x32_bf16 v[88:91], a[148:151], v[188:191], v[88:91]
    v_mfma_f32_16x16x32_bf16 v[124:127], a[144:147], v[200:203], v[124:127]
    v_mfma_f32_16x16x32_bf16 v[124:127], a[148:151], v[204:207], v[124:127]
    v_mfma_f32_16x16x32_bf16 a[128:131], a[144:147], v[216:219], a[128:131]
    v_mfma_f32_16x16x32_bf16 a[128:131], a[148:151], v[220:223], a[128:131]
    s_waitcnt lgkmcnt(4)
    v_mfma_f32_16x16x32_bf16 v[56:59], a[152:155], v[168:171], v[56:59]
    ds_read_b64_tr_b16 a[168:169], v9 offset:18688
    ds_read_b64_tr_b16 a[170:171], v9 offset:23296
    v_mfma_f32_16x16x32_bf16 v[56:59], a[156:159], v[172:175], v[56:59]
    ds_read_b64_tr_b16 a[172:173], v9 offset:27904
    ds_read_b64_tr_b16 a[174:175], v9 offset:32512
    v_mfma_f32_16x16x32_bf16 v[92:95], a[152:155], v[184:187], v[92:95]
    buffer_load_dwordx4 a[52:55], v29, s[24:27], s59 offen offset:1024
    v_mfma_f32_16x16x32_bf16 v[92:95], a[156:159], v[188:191], v[92:95]
    s_cmp_eq_u32 s88, 1
    s_cselect_b64 exec, 0, -1
    buffer_store_dwordx4 v[184:187], v26, s[24:27], s95 offen offset:1024 sc1
    s_mov_b64 exec, -1
    v_mfma_f32_16x16x32_bf16 v[128:131], a[152:155], v[200:203], v[128:131]
    v_mfma_f32_16x16x32_bf16 v[128:131], a[156:159], v[204:207], v[128:131]
    v_mfma_f32_16x16x32_bf16 a[132:135], a[152:155], v[216:219], a[132:135]
    buffer_load_dwordx4 a[56:59], v30, s[24:27], s59 offen offset:2048
    v_mfma_f32_16x16x32_bf16 a[132:135], a[156:159], v[220:223], a[132:135]
    s_waitcnt lgkmcnt(0)
    s_barrier
    v_mfma_f32_16x16x32_bf16 v[60:63], a[160:163], v[168:171], v[60:63]
    ds_read_b64_tr_b16 a[144:145], v8 offset:36864
    ds_read_b64_tr_b16 a[146:147], v8 offset:41472
    v_mfma_f32_16x16x32_bf16 v[60:63], a[164:167], v[172:175], v[60:63]
    ds_read_b64_tr_b16 a[148:149], v9 offset:36864
    ds_read_b64_tr_b16 a[150:151], v9 offset:41472
    v_mfma_f32_16x16x32_bf16 v[96:99], a[160:163], v[184:187], v[96:99]
    v_mfma_f32_16x16x32_bf16 v[96:99], a[164:167], v[188:191], v[96:99]
    v_mfma_f32_16x16x32_bf16 v[132:135], a[160:163], v[200:203], v[132:135]
    buffer_load_dwordx4 a[60:63], v31, s[24:27], s59 offen offset:3072
    v_mfma_f32_16x16x32_bf16 v[132:135], a[164:167], v[204:207], v[132:135]
    v_mfma_f32_16x16x32_bf16 a[136:139], a[160:163], v[216:219], a[136:139]
    v_mfma_f32_16x16x32_bf16 a[136:139], a[164:167], v[220:223], a[136:139]
    v_mfma_f32_16x16x32_bf16 v[64:67], a[168:171], v[168:171], v[64:67]
    ds_read_b64_tr_b16 a[152:153], v8 offset:36896
    ds_read_b64_tr_b16 a[154:155], v8 offset:41504
    v_mfma_f32_16x16x32_bf16 v[64:67], a[172:175], v[172:175], v[64:67]
    ds_read_b64_tr_b16 a[156:157], v9 offset:36896
    ds_read_b64_tr_b16 a[158:159], v9 offset:41504
    v_mfma_f32_16x16x32_bf16 v[100:103], a[168:171], v[184:187], v[100:103]
    v_mfma_f32_16x16x32_bf16 v[100:103], a[172:175], v[188:191], v[100:103]
    v_mfma_f32_16x16x32_bf16 v[136:139], a[168:171], v[200:203], v[136:139]
    v_mfma_f32_16x16x32_bf16 v[136:139], a[172:175], v[204:207], v[136:139]
    v_mfma_f32_16x16x32_bf16 a[140:143], a[168:171], v[216:219], a[140:143]
    v_mfma_f32_16x16x32_bf16 a[140:143], a[172:175], v[220:223], a[140:143]
    s_waitcnt vmcnt(12) lgkmcnt(4)
    v_mfma_f32_16x16x32_bf16 v[32:35], a[144:147], a[0:3], v[32:35]
    ds_read_b64_tr_b16 a[160:161], v8 offset:36928
    ds_read_b64_tr_b16 a[162:163], v8 offset:41536
    v_mfma_f32_16x16x32_bf16 v[32:35], a[148:151], a[16:19], v[32:35]
    ds_read_b64_tr_b16 a[164:165], v9 offset:36928
    ds_read_b64_tr_b16 a[166:167], v9 offset:41536
    s_add_u32 s56, s38, 0
    v_mfma_f32_16x16x32_bf16 v[68:71], a[144:147], a[4:7], v[68:71]
    buffer_load_dwordx4 a[64:67], v28, s[24:27], s56 offen offset:0
    v_mfma_f32_16x16x32_bf16 v[68:71], a[148:151], a[20:23], v[68:71]
    s_cmp_eq_u32 s88, 2
    s_cselect_b64 exec, 0, -1
    buffer_store_dwordx4 v[200:203], v26, s[24:27], s95 offen offset:2048 sc1
    s_mov_b64 exec, -1
    v_mfma_f32_16x16x32_bf16 v[104:107], a[144:147], a[8:11], v[104:107]
    v_mfma_f32_16x16x32_bf16 v[104:107], a[148:151], a[24:27], v[104:107]
    v_mfma_f32_16x16x32_bf16 v[140:143], a[144:147], a[12:15], v[140:143]
    v_mfma_f32_16x16x32_bf16 v[140:143], a[148:151], a[28:31], v[140:143]
    buffer_load_dwordx4 a[68:71], v29, s[24:27], s56 offen offset:1024
    s_waitcnt lgkmcnt(4)
    v_mfma_f32_16x16x32_bf16 v[36:39], a[152:155], a[0:3], v[36:39]
    ds_read_b64_tr_b16 a[168:169], v8 offset:36960
    ds_read_b64_tr_b16 a[170:171], v8 offset:41568
    v_mfma_f32_16x16x32_bf16 v[36:39], a[156:159], a[16:19], v[36:39]
    ds_read_b64_tr_b16 a[172:173], v9 offset:36960
    ds_read_b64_tr_b16 a[174:175], v9 offset:41568
    v_mfma_f32_16x16x32_bf16 v[72:75], a[152:155], a[4:7], v[72:75]
    v_mfma_f32_16x16x32_bf16 v[72:75], a[156:159], a[20:23], v[72:75]
    v_mfma_f32_16x16x32_bf16 v[108:111], a[152:155], a[8:11], v[108:111]
    v_mfma_f32_16x16x32_bf16 v[108:111], a[156:159], a[24:27], v[108:111]
    buffer_load_dwordx4 a[72:75], v30, s[24:27], s56 offen offset:2048
    v_mfma_f32_16x16x32_bf16 v[144:147], a[152:155], a[12:15], v[144:147]
    v_mfma_f32_16x16x32_bf16 v[144:147], a[156:159], a[28:31], v[144:147]
    s_waitcnt lgkmcnt(4)
    v_mfma_f32_16x16x32_bf16 v[40:43], a[160:163], a[0:3], v[40:43]
    ds_read_b64_tr_b16 a[144:145], v8 offset:36992
    ds_read_b64_tr_b16 a[146:147], v8 offset:41600
    v_mfma_f32_16x16x32_bf16 v[40:43], a[164:167], a[16:19], v[40:43]
    ds_read_b64_tr_b16 a[148:149], v9 offset:36992
    ds_read_b64_tr_b16 a[150:151], v9 offset:41600
    v_mfma_f32_16x16x32_bf16 v[76:79], a[160:163], a[4:7], v[76:79]
    buffer_load_dwordx4 a[76:79], v31, s[24:27], s56 offen offset:3072
    v_mfma_f32_16x16x32_bf16 v[76:79], a[164:167], a[20:23], v[76:79]
    v_mfma_f32_16x16x32_bf16 v[112:115], a[160:163], a[8:11], v[112:115]
    v_mfma_f32_16x16x32_bf16 v[112:115], a[164:167], a[24:27], v[112:115]
    v_mfma_f32_16x16x32_bf16 v[148:151], a[160:163], a[12:15], v[148:151]
    v_mfma_f32_16x16x32_bf16 v[148:151], a[164:167], a[28:31], v[148:151]
    s_waitcnt lgkmcnt(4)
    v_mfma_f32_16x16x32_bf16 v[44:47], a[168:171], a[0:3], v[44:47]
    ds_read_b64_tr_b16 a[152:153], v8 offset:37024
    ds_read_b64_tr_b16 a[154:155], v8 offset:41632
    v_mfma_f32_16x16x32_bf16 v[44:47], a[172:175], a[16:19], v[44:47]
    ds_read_b64_tr_b16 a[156:157], v9 offset:37024
    ds_read_b64_tr_b16 a[158:159], v9 offset:41632
    s_add_u32 s57, s38, 4096
    v_mfma_f32_16x16x32_bf16 v[80:83], a[168:171], a[4:7], v[80:83]
    buffer_load_dwordx4 a[80:83], v28, s[24:27], s57 offen offset:0
    v_mfma_f32_16x16x32_bf16 v[80:83], a[172:175], a[20:23], v[80:83]
    s_cmp_eq_u32 s88, 3
    s_cselect_b64 exec, 0, -1
    buffer_store_dwordx4 v[216:219], v26, s[24:27], s95 offen offset:3072 sc1
    s_mov_b64 exec, -1
    v_mfma_f32_16x16x32_bf16 v[116:119], a[168:171], a[8:11], v[116:119]
    v_mfma_f32_16x16x32_bf16 v[116:119], a[172:175], a[24:27], v[116:119]
    buffer_load_dwordx4 a[84:87], v29, s[24:27], s57 offen offset:1024
    v_mfma_f32_16x16x32_bf16 v[152:155], a[168:171], a[12:15], v[152:155]
    v_mfma_f32_16x16x32_bf16 v[152:155], a[172:175], a[28:31], v[152:155]
    s_waitcnt lgkmcnt(4)
    v_mfma_f32_16x16x32_bf16 v[48:51], a[144:147], a[0:3], v[48:51]
    ds_read_b64_tr_b16 a[160:161], v8 offset:37056
    ds_read_b64_tr_b16 a[162:163], v8 offset:41664
    v_mfma_f32_16x16x32_bf16 v[48:51], a[148:151], a[16:19], v[48:51]
    ds_read_b64_tr_b16 a[164:165], v9 offset:37056
    ds_read_b64_tr_b16 a[166:167], v9 offset:41664
    v_mfma_f32_16x16x32_bf16 v[84:87], a[144:147], a[4:7], v[84:87]
    v_mfma_f32_16x16x32_bf16 v[84:87], a[148:151], a[20:23], v[84:87]
    buffer_load_dwordx4 a[88:91], v30, s[24:27], s57 offen offset:2048
    v_mfma_f32_16x16x32_bf16 v[120:123], a[144:147], a[8:11], v[120:123]
    v_mfma_f32_16x16x32_bf16 v[120:123], a[148:151], a[24:27], v[120:123]
    v_mfma_f32_16x16x32_bf16 v[156:159], a[144:147], a[12:15], v[156:159]
    v_mfma_f32_16x16x32_bf16 v[156:159], a[148:151], a[28:31], v[156:159]
    s_waitcnt lgkmcnt(4)
    v_mfma_f32_16x16x32_bf16 v[52:55], a[152:155], a[0:3], v[52:55]
    ds_read_b64_tr_b16 a[168:169], v8 offset:37088
    ds_read_b64_tr_b16 a[170:171], v8 offset:41696
    v_mfma_f32_16x16x32_bf16 v[52:55], a[156:159], a[16:19], v[52:55]
    ds_read_b64_tr_b16 a[172:173], v9 offset:37088
    ds_read_b64_tr_b16 a[174:175], v9 offset:41696
    s_waitcnt vmcnt(19)
    v_mov_b32 v2, 3
    buffer_store_dword v2, v11, s[68:71], 0 offen sc1
    v_mfma_f32_16x16x32_bf16 v[88:91], a[152:155], a[4:7], v[88:91]
    buffer_load_dwordx4 a[92:95], v31, s[24:27], s57 offen offset:3072
    v_mfma_f32_16x16x32_bf16 v[88:91], a[156:159], a[20:23], v[88:91]
    v_mfma_f32_16x16x32_bf16 v[124:127], a[152:155], a[8:11], v[124:127]
    v_mfma_f32_16x16x32_bf16 v[124:127], a[156:159], a[24:27], v[124:127]
    s_add_u32 s58, s38, 8192
    v_mfma_f32_16x16x32_bf16 a[128:131], a[152:155], a[12:15], a[128:131]
    buffer_load_dwordx4 a[96:99], v28, s[24:27], s58 offen offset:0
    v_mfma_f32_16x16x32_bf16 a[128:131], a[156:159], a[28:31], a[128:131]
    s_waitcnt lgkmcnt(4)
    v_mfma_f32_16x16x32_bf16 v[56:59], a[160:163], a[0:3], v[56:59]
    ds_read_b64_tr_b16 a[144:145], v8 offset:37120
    ds_read_b64_tr_b16 a[146:147], v8 offset:41728
    v_mfma_f32_16x16x32_bf16 v[56:59], a[164:167], a[16:19], v[56:59]
    ds_read_b64_tr_b16 a[148:149], v9 offset:37120
    ds_read_b64_tr_b16 a[150:151], v9 offset:41728
    v_mfma_f32_16x16x32_bf16 v[92:95], a[160:163], a[4:7], v[92:95]
    s_add_u32 s95, s36, 77824
    s_cmp_eq_u32 s88, 0
    s_cselect_b64 exec, 0, -1
    buffer_store_dwordx4 v[172:175], v26, s[24:27], s95 offen offset:0 sc1
    s_mov_b64 exec, -1
    v_mfma_f32_16x16x32_bf16 v[92:95], a[164:167], a[20:23], v[92:95]
    buffer_load_dwordx4 a[100:103], v29, s[24:27], s58 offen offset:1024
    v_mfma_f32_16x16x32_bf16 v[128:131], a[160:163], a[8:11], v[128:131]
    v_mfma_f32_16x16x32_bf16 v[128:131], a[164:167], a[24:27], v[128:131]
    v_mfma_f32_16x16x32_bf16 a[132:135], a[160:163], a[12:15], a[132:135]
    v_mfma_f32_16x16x32_bf16 a[132:135], a[164:167], a[28:31], a[132:135]
    s_waitcnt lgkmcnt(4)
    v_mfma_f32_16x16x32_bf16 v[60:63], a[168:171], a[0:3], v[60:63]
    ds_read_b64_tr_b16 a[152:153], v9 offset:46080
    ds_read_b64_tr_b16 a[154:155], v9 offset:50688
    v_mfma_f32_16x16x32_bf16 v[60:63], a[172:175], a[16:19], v[60:63]
    ds_read_b64_tr_b16 a[156:157], v9 offset:55296
    ds_read_b64_tr_b16 a[158:159], v9 offset:59904
    v_mfma_f32_16x16x32_bf16 v[96:99], a[168:171], a[4:7], v[96:99]
    buffer_load_dwordx4 a[104:107], v30, s[24:27], s58 offen offset:2048
    v_mfma_f32_16x16x32_bf16 v[96:99], a[172:175], a[20:23], v[96:99]
    v_mfma_f32_16x16x32_bf16 v[132:135], a[168:171], a[8:11], v[132:135]
    v_mfma_f32_16x16x32_bf16 v[132:135], a[172:175], a[24:27], v[132:135]
    v_mfma_f32_16x16x32_bf16 a[136:139], a[168:171], a[12:15], a[136:139]
    buffer_load_dwordx4 a[108:111], v31, s[24:27], s58 offen offset:3072
    v_mfma_f32_16x16x32_bf16 a[136:139], a[172:175], a[28:31], a[136:139]
    s_waitcnt lgkmcnt(4)
    v_mfma_f32_16x16x32_bf16 v[64:67], a[144:147], a[0:3], v[64:67]
    ds_read_b64_tr_b16 a[160:161], v9 offset:46112
    ds_read_b64_tr_b16 a[162:163], v9 offset:50720
    v_mfma_f32_16x16x32_bf16 v[64:67], a[148:151], a[16:19], v[64:67]
    ds_read_b64_tr_b16 a[164:165], v9 offset:55328
    ds_read_b64_tr_b16 a[166:167], v9 offset:59936
    v_mfma_f32_16x16x32_bf16 v[100:103], a[144:147], a[4:7], v[100:103]
    v_mfma_f32_16x16x32_bf16 v[100:103], a[148:151], a[20:23], v[100:103]
    s_add_u32 s59, s38, 12288
    v_mfma_f32_16x16x32_bf16 v[136:139], a[144:147], a[8:11], v[136:139]
    buffer_load_dwordx4 a[112:115], v28, s[24:27], s59 offen offset:0
    v_mfma_f32_16x16x32_bf16 v[136:139], a[148:151], a[24:27], v[136:139]
    v_mfma_f32_16x16x32_bf16 a[140:143], a[144:147], a[12:15], a[140:143]
    v_mfma_f32_16x16x32_bf16 a[140:143], a[148:151], a[28:31], a[140:143]
    s_waitcnt vmcnt(17) lgkmcnt(4)
    v_mfma_f32_16x16x32_bf16 v[32:35], a[152:155], a[32:35], v[32:35]
    ds_read_b64_tr_b16 a[168:169], v9 offset:46144
    ds_read_b64_tr_b16 a[170:171], v9 offset:50752
    v_mfma_f32_16x16x32_bf16 v[32:35], a[156:159], a[48:51], v[32:35]
    ds_read_b64_tr_b16 a[172:173], v9 offset:55360
    ds_read_b64_tr_b16 a[174:175], v9 offset:59968
    v_mfma_f32_16x16x32_bf16 v[68:71], a[152:155], a[36:39], v[68:71]
    buffer_load_dwordx4 a[116:119], v29, s[24:27], s59 offen offset:1024
    v_mfma_f32_16x16x32_bf16 v[68:71], a[156:159], a[52:55], v[68:71]
    s_cmp_eq_u32 s88, 1
    s_cselect_b64 exec, 0, -1
    buffer_store_dwordx4 v[188:191], v26, s[24:27], s95 offen offset:1024 sc1
    s_mov_b64 exec, -1
    v_mfma_f32_16x16x32_bf16 v[104:107], a[152:155], a[40:43], v[104:107]
    v_mfma_f32_16x16x32_bf16 v[104:107], a[156:159], a[56:59], v[104:107]
    v_mfma_f32_16x16x32_bf16 v[140:143], a[152:155], a[44:47], v[140:143]
    v_mfma_f32_16x16x32_bf16 v[140:143], a[156:159], a[60:63], v[140:143]
    buffer_load_dwordx4 a[120:123], v30, s[24:27], s59 offen offset:2048
    s_waitcnt lgkmcnt(4)
    v_mfma_f32_16x16x32_bf16 v[36:39], a[160:163], a[32:35], v[36:39]
    ds_read_b64_tr_b16 a[144:145], v9 offset:46176
    ds_read_b64_tr_b16 a[146:147], v9 offset:50784
    v_mfma_f32_16x16x32_bf16 v[36:39], a[164:167], a[48:51], v[36:39]
    ds_read_b64_tr_b16 a[148:149], v9 offset:55392
    ds_read_b64_tr_b16 a[150:151], v9 offset:60000
    v_mfma_f32_16x16x32_bf16 v[72:75], a[160:163], a[36:39], v[72:75]
    v_mfma_f32_16x16x32_bf16 v[72:75], a[164:167], a[52:55], v[72:75]
    v_mfma_f32_16x16x32_bf16 v[108:111], a[160:163], a[40:43], v[108:111]
    buffer_load_dwordx4 a[124:127], v31, s[24:27], s59 offen offset:3072
    v_mfma_f32_16x16x32_bf16 v[108:111], a[164:167], a[56:59], v[108:111]
    v_mfma_f32_16x16x32_bf16 v[144:147], a[160:163], a[44:47], v[144:147]
    v_mfma_f32_16x16x32_bf16 v[144:147], a[164:167], a[60:63], v[144:147]
    s_waitcnt lgkmcnt(4)
    v_mfma_f32_16x16x32_bf16 v[40:43], a[168:171], a[32:35], v[40:43]
    ds_read_b64_tr_b16 a[152:153], v9 offset:46208
    ds_read_b64_tr_b16 a[154:155], v9 offset:50816
    v_mfma_f32_16x16x32_bf16 v[40:43], a[172:175], a[48:51], v[40:43]
    ds_read_b64_tr_b16 a[156:157], v9 offset:55424
    ds_read_b64_tr_b16 a[158:159], v9 offset:60032
    s_add_u32 s60, s35, 0
    s_add_u32 m0, s92, 0
    v_mfma_f32_16x16x32_bf16 v[76:79], a[168:171], a[36:39], v[76:79]
    buffer_load_dwordx4 v6, s[28:31], s60 offen offset:0 lds
    v_mfma_f32_16x16x32_bf16 v[76:79], a[172:175], a[52:55], v[76:79]
    v_mfma_f32_16x16x32_bf16 v[112:115], a[168:171], a[40:43], v[112:115]
    v_mfma_f32_16x16x32_bf16 v[112:115], a[172:175], a[56:59], v[112:115]
    v_mfma_f32_16x16x32_bf16 v[148:151], a[168:171], a[44:47], v[148:151]
    v_mfma_f32_16x16x32_bf16 v[148:151], a[172:175], a[60:63], v[148:151]
    buffer_load_dwordx4 v7, s[28:31], s60 offen offset:1024 lds
    s_waitcnt lgkmcnt(4)
    v_mfma_f32_16x16x32_bf16 v[44:47], a[144:147], a[32:35], v[44:47]
    ds_read_b64_tr_b16 a[160:161], v9 offset:46240
    ds_read_b64_tr_b16 a[162:163], v9 offset:50848
    v_mfma_f32_16x16x32_bf16 v[44:47], a[148:151], a[48:51], v[44:47]
    ds_read_b64_tr_b16 a[164:165], v9 offset:55456
    ds_read_b64_tr_b16 a[166:167], v9 offset:60064
    v_mfma_f32_16x16x32_bf16 v[80:83], a[144:147], a[36:39], v[80:83]
    s_cmp_eq_u32 s88, 2
    s_cselect_b64 exec, 0, -1
    buffer_store_dwordx4 v[204:207], v26, s[24:27], s95 offen offset:2048 sc1
    s_mov_b64 exec, -1
    v_mfma_f32_16x16x32_bf16 v[80:83], a[148:151], a[52:55], v[80:83]
    v_mfma_f32_16x16x32_bf16 v[116:119], a[144:147], a[40:43], v[116:119]
    v_mfma_f32_16x16x32_bf16 v[116:119], a[148:151], a[56:59], v[116:119]
    buffer_load_dwordx4 v20, s[28:31], s60 offen offset:2048 lds
    v_mfma_f32_16x16x32_bf16 v[152:155], a[144:147], a[44:47], v[152:155]
    v_mfma_f32_16x16x32_bf16 v[152:155], a[148:151], a[60:63], v[152:155]
    s_waitcnt lgkmcnt(4)
    v_mfma_f32_16x16x32_bf16 v[48:51], a[152:155], a[32:35], v[48:51]
    ds_read_b64_tr_b16 a[168:169], v9 offset:46272
    ds_read_b64_tr_b16 a[170:171], v9 offset:50880
    v_mfma_f32_16x16x32_bf16 v[48:51], a[156:159], a[48:51], v[48:51]
    ds_read_b64_tr_b16 a[172:173], v9 offset:55488
    ds_read_b64_tr_b16 a[174:175], v9 offset:60096
    v_mfma_f32_16x16x32_bf16 v[84:87], a[152:155], a[36:39], v[84:87]
    buffer_load_dwordx4 v21, s[28:31], s60 offen offset:3072 lds
    v_mfma_f32_16x16x32_bf16 v[84:87], a[156:159], a[52:55], v[84:87]
    v_mfma_f32_16x16x32_bf16 v[120:123], a[152:155], a[40:43], v[120:123]
    v_mfma_f32_16x16x32_bf16 v[120:123], a[156:159], a[56:59], v[120:123]
    v_mfma_f32_16x16x32_bf16 v[156:159], a[152:155], a[44:47], v[156:159]
    v_mfma_f32_16x16x32_bf16 v[156:159], a[156:159], a[60:63], v[156:159]
    s_waitcnt lgkmcnt(4)
    v_mfma_f32_16x16x32_bf16 v[52:55], a[160:163], a[32:35], v[52:55]
    ds_read_b64_tr_b16 a[144:145], v9 offset:46304
    ds_read_b64_tr_b16 a[146:147], v9 offset:50912
    v_mfma_f32_16x16x32_bf16 v[52:55], a[164:167], a[48:51], v[52:55]
    ds_read_b64_tr_b16 a[148:149], v9 offset:55520
    ds_read_b64_tr_b16 a[150:151], v9 offset:60128
    s_add_u32 m0, s92, 4096
    v_mfma_f32_16x16x32_bf16 v[88:91], a[160:163], a[36:39], v[88:91]
    buffer_load_dwordx4 v22, s[28:31], s60 offen offset:0 lds
    v_mfma_f32_16x16x32_bf16 v[88:91], a[164:167], a[52:55], v[88:91]
    v_mfma_f32_16x16x32_bf16 v[124:127], a[160:163], a[40:43], v[124:127]
    v_mfma_f32_16x16x32_bf16 v[124:127], a[164:167], a[56:59], v[124:127]
    buffer_load_dwordx4 v23, s[28:31], s60 offen offset:1024 lds
    v_mfma_f32_16x16x32_bf16 a[128:131], a[160:163], a[44:47], a[128:131]
    v_mfma_f32_16x16x32_bf16 a[128:131], a[164:167], a[60:63], a[128:131]
    s_waitcnt lgkmcnt(4)
    v_mfma_f32_16x16x32_bf16 v[56:59], a[168:171], a[32:35], v[56:59]
    ds_read_b64_tr_b16 a[152:153], v9 offset:46336
    ds_read_b64_tr_b16 a[154:155], v9 offset:50944
    v_mfma_f32_16x16x32_bf16 v[56:59], a[172:175], a[48:51], v[56:59]
    ds_read_b64_tr_b16 a[156:157], v9 offset:55552
    ds_read_b64_tr_b16 a[158:159], v9 offset:60160
    v_mfma_f32_16x16x32_bf16 v[92:95], a[168:171], a[36:39], v[92:95]
    s_cmp_eq_u32 s88, 3
    s_cselect_b64 exec, 0, -1
    buffer_store_dwordx4 v[220:223], v26, s[24:27], s95 offen offset:3072 sc1
    s_mov_b64 exec, -1
    v_mfma_f32_16x16x32_bf16 v[92:95], a[172:175], a[52:55], v[92:95]
    buffer_load_dwordx4 v24, s[28:31], s60 offen offset:2048 lds
    v_mfma_f32_16x16x32_bf16 v[128:131], a[168:171], a[40:43], v[128:131]
    v_mfma_f32_16x16x32_bf16 v[128:131], a[172:175], a[56:59], v[128:131]
    v_mfma_f32_16x16x32_bf16 a[132:135], a[168:171], a[44:47], a[132:135]
    v_mfma_f32_16x16x32_bf16 a[132:135], a[172:175], a[60:63], a[132:135]
    s_waitcnt lgkmcnt(0)
    s_barrier
    v_mfma_f32_16x16x32_bf16 v[60:63], a[144:147], a[32:35], v[60:63]
    ds_read_b64_tr_b16 a[160:161], v10 offset:0
    ds_read_b64_tr_b16 a[162:163], v10 offset:4608
    v_mfma_f32_16x16x32_bf16 v[60:63], a[148:151], a[48:51], v[60:63]
    ds_read_b64_tr_b16 a[164:165], v10 offset:9216
    ds_read_b64_tr_b16 a[166:167], v10 offset:13824
    v_mfma_f32_16x16x32_bf16 v[96:99], a[144:147], a[36:39], v[96:99]
    buffer_load_dwordx4 v25, s[28:31], s60 offen offset:3072 lds
    v_mfma_f32_16x16x32_bf16 v[96:99], a[148:151], a[52:55], v[96:99]
    v_mfma_f32_16x16x32_bf16 v[132:135], a[144:147], a[40:43], v[132:135]
    v_mfma_f32_16x16x32_bf16 v[132:135], a[148:151], a[56:59], v[132:135]
    s_add_u32 m0, s92, 8192
    v_mfma_f32_16x16x32_bf16 a[136:139], a[144:147], a[44:47], a[136:139]
    buffer_load_dwordx4 v1, s[28:31], s60 offen offset:0 lds
    v_mfma_f32_16x16x32_bf16 a[136:139], a[148:151], a[60:63], a[136:139]
    v_mfma_f32_16x16x32_bf16 v[64:67], a[152:155], a[32:35], v[64:67]
    ds_read_b64_tr_b16 a[168:169], v10 offset:32
    ds_read_b64_tr_b16 a[170:171], v10 offset:4640
    v_mfma_f32_16x16x32_bf16 v[64:67], a[156:159], a[48:51], v[64:67]
    ds_read_b64_tr_b16 a[172:173], v10 offset:9248
    ds_read_b64_tr_b16 a[174:175], v10 offset:13856
    v_mfma_f32_16x16x32_bf16 v[100:103], a[152:155], a[36:39], v[100:103]
    v_mfma_f32_16x16x32_bf16 v[100:103], a[156:159], a[52:55], v[100:103]
    v_mfma_f32_16x16x32_bf16 v[136:139], a[152:155], a[40:43], v[136:139]
    v_mfma_f32_16x16x32_bf16 v[136:139], a[156:159], a[56:59], v[136:139]
    v_mfma_f32_16x16x32_bf16 a[140:143], a[152:155], a[44:47], a[140:143]
    v_mfma_f32_16x16x32_bf16 a[140:143], a[156:159], a[60:63], a[140:143]
    s_waitcnt vmcnt(21) lgkmcnt(4)
    v_mfma_f32_16x16x32_bf16 v[32:35], a[160:163], a[64:67], v[32:35]
    ds_read_b64_tr_b16 a[144:145], v10 offset:64
    ds_read_b64_tr_b16 a[146:147], v10 offset:4672
    v_mfma_f32_16x16x32_bf16 v[32:35], a[164:167], a[80:83], v[32:35]
    ds_read_b64_tr_b16 a[148:149], v10 offset:9280
    ds_read_b64_tr_b16 a[150:151], v10 offset:13888
    s_add_u32 s56, s39, 0
    v_mfma_f32_16x16x32_bf16 v[68:71], a[160:163], a[68:71], v[68:71]
    buffer_load_dwordx4 a[0:3], v28, s[24:27], s56 offen offset:0
    v_mfma_f32_16x16x32_bf16 v[68:71], a[164:167], a[84:87], v[68:71]
    v_mfma_f32_16x16x32_bf16 v[104:107], a[160:163], a[72:75], v[104:107]
    v_mfma_f32_16x16x32_bf16 v[104:107], a[164:167], a[88:91], v[104:107]
    v_mfma_f32_16x16x32_bf16 v[140:143], a[160:163], a[76:79], v[140:143]
    v_mfma_f32_16x16x32_bf16 v[140:143], a[164:167], a[92:95], v[140:143]
    buffer_load_dwordx4 a[4:7], v29, s[24:27], s56 offen offset:1024
    s_waitcnt lgkmcnt(4)
    v_mfma_f32_16x16x32_bf16 v[36:39], a[168:171], a[64:67], v[36:39]
    ds_read_b64_tr_b16 a[152:153], v10 offset:96
    ds_read_b64_tr_b16 a[154:155], v10 offset:4704
    v_mfma_f32_16x16x32_bf16 v[36:39], a[172:175], a[80:83], v[36:39]
    ds_read_b64_tr_b16 a[156:157], v10 offset:9312
    ds_read_b64_tr_b16 a[158:159], v10 offset:13920
    v_mfma_f32_16x16x32_bf16 v[72:75], a[168:171], a[68:71], v[72:75]
    v_mfma_f32_16x16x32_bf16 v[72:75], a[172:175], a[84:87], v[72:75]
    v_mfma_f32_16x16x32_bf16 v[108:111], a[168:171], a[72:75], v[108:111]
    v_mfma_f32_16x16x32_bf16 v[108:111], a[172:175], a[88:91], v[108:111]
    buffer_load_dwordx4 a[8:11], v30, s[24:27], s56 offen offset:2048
    v_mfma_f32_16x16x32_bf16 v[144:147], a[168:171], a[76:79], v[144:147]
    v_mfma_f32_16x16x32_bf16 v[144:147], a[172:175], a[92:95], v[144:147]
    s_waitcnt lgkmcnt(4)
    v_mfma_f32_16x16x32_bf16 v[40:43], a[144:147], a[64:67], v[40:43]
    ds_read_b64_tr_b16 a[160:161], v10 offset:128
    ds_read_b64_tr_b16 a[162:163], v10 offset:4736
    v_mfma_f32_16x16x32_bf16 v[40:43], a[148:151], a[80:83], v[40:43]
    ds_read_b64_tr_b16 a[164:165], v10 offset:9344
    ds_read_b64_tr_b16 a[166:167], v10 offset:13952
    v_mfma_f32_16x16x32_bf16 v[76:79], a[144:147], a[68:71], v[76:79]
    buffer_load_dwordx4 a[12:15], v31, s[24:27], s56 offen offset:3072
    v_mfma_f32_16x16x32_bf16 v[76:79], a[148:151], a[84:87], v[76:79]
    v_mfma_f32_16x16x32_bf16 v[112:115], a[144:147], a[72:75], v[112:115]
    v_mfma_f32_16x16x32_bf16 v[112:115], a[148:151], a[88:91], v[112:115]
    v_mfma_f32_16x16x32_bf16 v[148:151], a[144:147], a[76:79], v[148:151]
    v_mfma_f32_16x16x32_bf16 v[148:151], a[148:151], a[92:95], v[148:151]
    s_waitcnt lgkmcnt(4)
    v_mfma_f32_16x16x32_bf16 v[44:47], a[152:155], a[64:67], v[44:47]
    ds_read_b64_tr_b16 a[168:169], v10 offset:160
    ds_read_b64_tr_b16 a[170:171], v10 offset:4768
    v_mfma_f32_16x16x32_bf16 v[44:47], a[156:159], a[80:83], v[44:47]
    ds_read_b64_tr_b16 a[172:173], v10 offset:9376
    ds_read_b64_tr_b16 a[174:175], v10 offset:13984
    s_add_u32 s57, s39, 4096
    v_mfma_f32_16x16x32_bf16 v[80:83], a[152:155], a[68:71], v[80:83]
    buffer_load_dwordx4 a[16:19], v28, s[24:27], s57 offen offset:0
    v_mfma_f32_16x16x32_bf16 v[80:83], a[156:159], a[84:87], v[80:83]
    v_mfma_f32_16x16x32_bf16 v[116:119], a[152:155], a[72:75], v[116:119]
    v_mfma_f32_16x16x32_bf16 v[116:119], a[156:159], a[88:91], v[116:119]
    buffer_load_dwordx4 a[20:23], v29, s[24:27], s57 offen offset:1024
    v_mfma_f32_16x16x32_bf16 v[152:155], a[152:155], a[76:79], v[152:155]
    v_mfma_f32_16x16x32_bf16 v[152:155], a[156:159], a[92:95], v[152:155]
    s_waitcnt lgkmcnt(4)
    v_mfma_f32_16x16x32_bf16 v[48:51], a[160:163], a[64:67], v[48:51]
    ds_read_b64_tr_b16 a[144:145], v10 offset:192
    ds_read_b64_tr_b16 a[146:147], v10 offset:4800
    v_mfma_f32_16x16x32_bf16 v[48:51], a[164:167], a[80:83], v[48:51]
    ds_read_b64_tr_b16 a[148:149], v10 offset:9408
    ds_read_b64_tr_b16 a[150:151], v10 offset:14016
    v_mfma_f32_16x16x32_bf16 v[84:87], a[160:163], a[68:71], v[84:87]
    v_mfma_f32_16x16x32_bf16 v[84:87], a[164:167], a[84:87], v[84:87]
    buffer_load_dwordx4 a[24:27], v30, s[24:27], s57 offen offset:2048
    v_mfma_f32_16x16x32_bf16 v[120:123], a[160:163], a[72:75], v[120:123]
    v_mfma_f32_16x16x32_bf16 v[120:123], a[164:167], a[88:91], v[120:123]
    v_mfma_f32_16x16x32_bf16 v[156:159], a[160:163], a[76:79], v[156:159]
    v_mfma_f32_16x16x32_bf16 v[156:159], a[164:167], a[92:95], v[156:159]
    s_waitcnt lgkmcnt(4)
    v_mfma_f32_16x16x32_bf16 v[52:55], a[168:171], a[64:67], v[52:55]
    ds_read_b64_tr_b16 a[152:153], v10 offset:224
    ds_read_b64_tr_b16 a[154:155], v10 offset:4832
    v_mfma_f32_16x16x32_bf16 v[52:55], a[172:175], a[80:83], v[52:55]
    ds_read_b64_tr_b16 a[156:157], v10 offset:9440
    ds_read_b64_tr_b16 a[158:159], v10 offset:14048
    v_mfma_f32_16x16x32_bf16 v[88:91], a[168:171], a[68:71], v[88:91]
    buffer_load_dwordx4 a[28:31], v31, s[24:27], s57 offen offset:3072
    v_mfma_f32_16x16x32_bf16 v[88:91], a[172:175], a[84:87], v[88:91]
    v_mfma_f32_16x16x32_bf16 v[124:127], a[168:171], a[72:75], v[124:127]
    v_mfma_f32_16x16x32_bf16 v[124:127], a[172:175], a[88:91], v[124:127]
    s_add_u32 s58, s39, 8192
    v_mfma_f32_16x16x32_bf16 a[128:131], a[168:171], a[76:79], a[128:131]
    buffer_load_dwordx4 a[32:35], v28, s[24:27], s58 offen offset:0
    v_mfma_f32_16x16x32_bf16 a[128:131], a[172:175], a[92:95], a[128:131]
    s_waitcnt lgkmcnt(4)
    v_mfma_f32_16x16x32_bf16 v[56:59], a[144:147], a[64:67], v[56:59]
    ds_read_b64_tr_b16 a[160:161], v10 offset:256
    ds_read_b64_tr_b16 a[162:163], v10 offset:4864
    v_mfma_f32_16x16x32_bf16 v[56:59], a[148:151], a[80:83], v[56:59]
    ds_read_b64_tr_b16 a[164:165], v10 offset:9472
    ds_read_b64_tr_b16 a[166:167], v10 offset:14080
    v_mfma_f32_16x16x32_bf16 v[92:95], a[144:147], a[68:71], v[92:95]
    v_mfma_f32_16x16x32_bf16 v[92:95], a[148:151], a[84:87], v[92:95]
    buffer_load_dwordx4 a[36:39], v29, s[24:27], s58 offen offset:1024
    v_mfma_f32_16x16x32_bf16 v[128:131], a[144:147], a[72:75], v[128:131]
    v_mfma_f32_16x16x32_bf16 v[128:131], a[148:151], a[88:91], v[128:131]
    v_mfma_f32_16x16x32_bf16 a[132:135], a[144:147], a[76:79], a[132:135]
    v_mfma_f32_16x16x32_bf16 a[132:135], a[148:151], a[92:95], a[132:135]
    s_waitcnt lgkmcnt(4)
    v_mfma_f32_16x16x32_bf16 v[60:63], a[152:155], a[64:67], v[60:63]
    ds_read_b64_tr_b16 a[168:169], v10 offset:18432
    ds_read_b64_tr_b16 a[170:171], v10 offset:23040
    v_mfma_f32_16x16x32_bf16 v[60:63], a[156:159], a[80:83], v[60:63]
    ds_read_b64_tr_b16 a[172:173], v10 offset:27648
    ds_read_b64_tr_b16 a[174:175], v10 offset:32256
    v_mfma_f32_16x16x32_bf16 v[96:99], a[152:155], a[68:71], v[96:99]
    buffer_load_dwordx4 a[40:43], v30, s[24:27], s58 offen offset:2048
    v_mfma_f32_16x16x32_bf16 v[96:99], a[156:159], a[84:87], v[96:99]
    v_mfma_f32_16x16x32_bf16 v[132:135], a[152:155], a[72:75], v[132:135]
    v_mfma_f32_16x16x32_bf16 v[132:135], a[156:159], a[88:91], v[132:135]
    v_mfma_f32_16x16x32_bf16 a[136:139], a[152:155], a[76:79], a[136:139]
    buffer_load_dwordx4 a[44:47], v31, s[24:27], s58 offen offset:3072
    v_mfma_f32_16x16x32_bf16 a[136:139], a[156:159], a[92:95], a[136:139]
    s_waitcnt lgkmcnt(4)
    v_mfma_f32_16x16x32_bf16 v[64:67], a[160:163], a[64:67], v[64:67]
    ds_read_b64_tr_b16 a[144:145], v10 offset:18464
    ds_read_b64_tr_b16 a[146:147], v10 offset:23072
    v_mfma_f32_16x16x32_bf16 v[64:67], a[164:167], a[80:83], v[64:67]
    ds_read_b64_tr_b16 a[148:149], v10 offset:27680
    ds_read_b64_tr_b16 a[150:151], v10 offset:32288
    v_mfma_f32_16x16x32_bf16 v[100:103], a[160:163], a[68:71], v[100:103]
    v_mfma_f32_16x16x32_bf16 v[100:103], a[164:167], a[84:87], v[100:103]
    s_add_u32 s59, s39, 12288
    v_mfma_f32_16x16x32_bf16 v[136:139], a[160:163], a[72:75], v[136:139]
    buffer_load_dwordx4 a[48:51], v28, s[24:27], s59 offen offset:0
    v_mfma_f32_16x16x32_bf16 v[136:139], a[164:167], a[88:91], v[136:139]
    v_mfma_f32_16x16x32_bf16 a[140:143], a[160:163], a[76:79], a[140:143]
    v_mfma_f32_16x16x32_bf16 a[140:143], a[164:167], a[92:95], a[140:143]
    s_waitcnt vmcnt(24) lgkmcnt(4)
    v_mfma_f32_16x16x32_bf16 v[32:35], a[168:171], a[96:99], v[32:35]
    ds_read_b64_tr_b16 a[152:153], v10 offset:18496
    ds_read_b64_tr_b16 a[154:155], v10 offset:23104
    v_mfma_f32_16x16x32_bf16 v[32:35], a[172:175], a[112:115], v[32:35]
    ds_read_b64_tr_b16 a[156:157], v10 offset:27712
    ds_read_b64_tr_b16 a[158:159], v10 offset:32320
    v_mfma_f32_16x16x32_bf16 v[68:71], a[168:171], a[100:103], v[68:71]
    buffer_load_dwordx4 a[52:55], v29, s[24:27], s59 offen offset:1024
    v_mfma_f32_16x16x32_bf16 v[68:71], a[172:175], a[116:119], v[68:71]
    v_mfma_f32_16x16x32_bf16 v[104:107], a[168:171], a[104:107], v[104:107]
    v_mfma_f32_16x16x32_bf16 v[104:107], a[172:175], a[120:123], v[104:107]
    v_mfma_f32_16x16x32_bf16 v[140:143], a[168:171], a[108:111], v[140:143]
    v_mfma_f32_16x16x32_bf16 v[140:143], a[172:175], a[124:127], v[140:143]
    buffer_load_dwordx4 a[56:59], v30, s[24:27], s59 offen offset:2048
    s_waitcnt lgkmcnt(4)
    v_mfma_f32_16x16x32_bf16 v[36:39], a[144:147], a[96:99], v[36:39]
    ds_read_b64_tr_b16 a[160:161], v10 offset:18528
    ds_read_b64_tr_b16 a[162:163], v10 offset:23136
    v_mfma_f32_16x16x32_bf16 v[36:39], a[148:151], a[112:115], v[36:39]
    ds_read_b64_tr_b16 a[164:165], v10 offset:27744
    ds_read_b64_tr_b16 a[166:167], v10 offset:32352
    v_mfma_f32_16x16x32_bf16 v[72:75], a[144:147], a[100:103], v[72:75]
    v_mfma_f32_16x16x32_bf16 v[72:75], a[148:151], a[116:119], v[72:75]
    v_mfma_f32_16x16x32_bf16 v[108:111], a[144:147], a[104:107], v[108:111]
    buffer_load_dwordx4 a[60:63], v31, s[24:27], s59 offen offset:3072
    v_mfma_f32_16x16x32_bf16 v[108:111], a[148:151], a[120:123], v[108:111]
    v_mfma_f32_16x16x32_bf16 v[144:147], a[144:147], a[108:111], v[144:147]
    v_mfma_f32_16x16x32_bf16 v[144:147], a[148:151], a[124:127], v[144:147]
    s_waitcnt lgkmcnt(4)
    v_mfma_f32_16x16x32_bf16 v[40:43], a[152:155], a[96:99], v[40:43]
    ds_read_b64_tr_b16 a[168:169], v10 offset:18560
    ds_read_b64_tr_b16 a[170:171], v10 offset:23168
    v_mfma_f32_16x16x32_bf16 v[40:43], a[156:159], a[112:115], v[40:43]
    ds_read_b64_tr_b16 a[172:173], v10 offset:27776
    ds_read_b64_tr_b16 a[174:175], v10 offset:32384
    s_add_u32 s60, s33, 147456
    s_add_u32 m0, s92, 98304
    v_mfma_f32_16x16x32_bf16 v[76:79], a[152:155], a[100:103], v[76:79]
    buffer_load_dwordx4 v6, s[28:31], s60 offen offset:0 lds
    v_mfma_f32_16x16x32_bf16 v[76:79], a[156:159], a[116:119], v[76:79]
    v_mfma_f32_16x16x32_bf16 v[112:115], a[152:155], a[104:107], v[112:115]
    v_mfma_f32_16x16x32_bf16 v[112:115], a[156:159], a[120:123], v[112:115]
    s_waitcnt vmcnt(20)
    v_mov_b32 v2, 4
    buffer_store_dword v2, v11, s[68:71], 0 offen sc1
    v_mfma_f32_16x16x32_bf16 v[148:151], a[152:155], a[108:111], v[148:151]
    v_mfma_f32_16x16x32_bf16 v[148:151], a[156:159], a[124:127], v[148:151]
    buffer_load_dwordx4 v7, s[28:31], s60 offen offset:1024 lds
    s_waitcnt lgkmcnt(4)
    v_mfma_f32_16x16x32_bf16 v[44:47], a[160:163], a[96:99], v[44:47]
    ds_read_b64_tr_b16 a[144:145], v10 offset:18592
    ds_read_b64_tr_b16 a[146:147], v10 offset:23200
    v_mfma_f32_16x16x32_bf16 v[44:47], a[164:167], a[112:115], v[44:47]
    ds_read_b64_tr_b16 a[148:149], v10 offset:27808
    ds_read_b64_tr_b16 a[150:151], v10 offset:32416
    v_mfma_f32_16x16x32_bf16 v[80:83], a[160:163], a[100:103], v[80:83]
    v_mfma_f32_16x16x32_bf16 v[80:83], a[164:167], a[116:119], v[80:83]
    v_mfma_f32_16x16x32_bf16 v[116:119], a[160:163], a[104:107], v[116:119]
    s_buffer_load_dwordx4 s[4:7], s[68:71], s90 glc
    v_mfma_f32_16x16x32_bf16 v[116:119], a[164:167], a[120:123], v[116:119]
    buffer_load_dwordx4 v20, s[28:31], s60 offen offset:2048 lds
    v_mfma_f32_16x16x32_bf16 v[152:155], a[160:163], a[108:111], v[152:155]
    v_mfma_f32_16x16x32_bf16 v[152:155], a[164:167], a[124:127], v[152:155]
    s_waitcnt lgkmcnt(4)
    v_mfma_f32_16x16x32_bf16 v[48:51], a[168:171], a[96:99], v[48:51]
    ds_read_b64_tr_b16 a[152:153], v10 offset:18624
    ds_read_b64_tr_b16 a[154:155], v10 offset:23232
    v_mfma_f32_16x16x32_bf16 v[48:51], a[172:175], a[112:115], v[48:51]
    ds_read_b64_tr_b16 a[156:157], v10 offset:27840
    ds_read_b64_tr_b16 a[158:159], v10 offset:32448
    v_mfma_f32_16x16x32_bf16 v[84:87], a[168:171], a[100:103], v[84:87]
    buffer_load_dwordx4 v21, s[28:31], s60 offen offset:3072 lds
    v_mfma_f32_16x16x32_bf16 v[84:87], a[172:175], a[116:119], v[84:87]
    v_mfma_f32_16x16x32_bf16 v[120:123], a[168:171], a[104:107], v[120:123]
    v_mfma_f32_16x16x32_bf16 v[120:123], a[172:175], a[120:123], v[120:123]
    v_mfma_f32_16x16x32_bf16 v[156:159], a[168:171], a[108:111], v[156:159]
    v_mfma_f32_16x16x32_bf16 v[156:159], a[172:175], a[124:127], v[156:159]
    s_waitcnt lgkmcnt(4)
    v_mfma_f32_16x16x32_bf16 v[52:55], a[144:147], a[96:99], v[52:55]
    ds_read_b64_tr_b16 a[160:161], v10 offset:18656
    ds_read_b64_tr_b16 a[162:163], v10 offset:23264
    v_mfma_f32_16x16x32_bf16 v[52:55], a[148:151], a[112:115], v[52:55]
    ds_read_b64_tr_b16 a[164:165], v10 offset:27872
    ds_read_b64_tr_b16 a[166:167], v10 offset:32480
    s_add_u32 m0, s92, 102400
    v_mfma_f32_16x16x32_bf16 v[88:91], a[144:147], a[100:103], v[88:91]
    buffer_load_dwordx4 v22, s[28:31], s60 offen offset:0 lds
    v_mfma_f32_16x16x32_bf16 v[88:91], a[148:151], a[116:119], v[88:91]
    v_mfma_f32_16x16x32_bf16 v[124:127], a[144:147], a[104:107], v[124:127]
    v_mfma_f32_16x16x32_bf16 v[124:127], a[148:151], a[120:123], v[124:127]
    buffer_load_dwordx4 v23, s[28:31], s60 offen offset:1024 lds
    v_mfma_f32_16x16x32_bf16 a[128:131], a[144:147], a[108:111], a[128:131]
    v_mfma_f32_16x16x32_bf16 a[128:131], a[148:151], a[124:127], a[128:131]
    s_waitcnt lgkmcnt(4)
    v_mfma_f32_16x16x32_bf16 v[56:59], a[152:155], a[96:99], v[56:59]
    ds_read_b64_tr_b16 a[168:169], v10 offset:18688
    ds_read_b64_tr_b16 a[170:171], v10 offset:23296
    v_mfma_f32_16x16x32_bf16 v[56:59], a[156:159], a[112:115], v[56:59]
    ds_read_b64_tr_b16 a[172:173], v10 offset:27904
    ds_read_b64_tr_b16 a[174:175], v10 offset:32512
    v_mfma_f32_16x16x32_bf16 v[92:95], a[152:155], a[100:103], v[92:95]
    v_mfma_f32_16x16x32_bf16 v[92:95], a[156:159], a[116:119], v[92:95]
    buffer_load_dwordx4 v24, s[28:31], s60 offen offset:2048 lds
    v_mfma_f32_16x16x32_bf16 v[128:131], a[152:155], a[104:107], v[128:131]
    v_mfma_f32_16x16x32_bf16 v[128:131], a[156:159], a[120:123], v[128:131]
    v_mfma_f32_16x16x32_bf16 a[132:135], a[152:155], a[108:111], a[132:135]
    v_mfma_f32_16x16x32_bf16 a[132:135], a[156:159], a[124:127], a[132:135]
    s_waitcnt vmcnt(24) lgkmcnt(0)
    s_barrier
    s_min_u32 s4, s4, s5
    s_min_u32 s6, s6, s7
    s_min_u32 s4, s4, s6
    s_cmp_ge_u32 s4, 3
    s_cbranch_scc0 L_spinB1
L_backB1:
    v_mfma_f32_16x16x32_bf16 v[60:63], a[160:163], a[96:99], v[60:63]
    ds_read_b64_tr_b16 a[144:145], v8 offset:0
    ds_read_b64_tr_b16 a[146:147], v8 offset:4608
    v_mfma_f32_16x16x32_bf16 v[60:63], a[164:167], a[112:115], v[60:63]
    ds_read_b64_tr_b16 a[148:149], v8 offset:9216
    ds_read_b64_tr_b16 a[150:151], v8 offset:13824
    v_mfma_f32_16x16x32_bf16 v[96:99], a[160:163], a[100:103], v[96:99]
    buffer_load_dwordx4 v25, s[28:31], s60 offen offset:3072 lds
    v_mfma_f32_16x16x32_bf16 v[96:99], a[164:167], a[116:119], v[96:99]
    v_mfma_f32_16x16x32_bf16 v[132:135], a[160:163], a[104:107], v[132:135]
    v_mfma_f32_16x16x32_bf16 v[132:135], a[164:167], a[120:123], v[132:135]
    s_add_u32 m0, s92, 106496
    v_mfma_f32_16x16x32_bf16 a[136:139], a[160:163], a[108:111], a[136:139]
    buffer_load_dwordx4 v1, s[28:31], s60 offen offset:0 lds
    v_mfma_f32_16x16x32_bf16 a[136:139], a[164:167], a[124:127], a[136:139]
    v_mfma_f32_16x16x32_bf16 v[64:67], a[168:171], a[96:99], v[64:67]
    ds_read_b64_tr_b16 a[152:153], v8 offset:32
    ds_read_b64_tr_b16 a[154:155], v8 offset:4640
    v_mfma_f32_16x16x32_bf16 v[64:67], a[172:175], a[112:115], v[64:67]
    ds_read_b64_tr_b16 a[156:157], v8 offset:9248
    ds_read_b64_tr_b16 a[158:159], v8 offset:13856
    v_mfma_f32_16x16x32_bf16 v[100:103], a[168:171], a[100:103], v[100:103]
    v_mfma_f32_16x16x32_bf16 v[100:103], a[172:175], a[116:119], v[100:103]
    v_mfma_f32_16x16x32_bf16 v[136:139], a[168:171], a[104:107], v[136:139]
    v_mfma_f32_16x16x32_bf16 v[136:139], a[172:175], a[120:123], v[136:139]
    v_mfma_f32_16x16x32_bf16 a[140:143], a[168:171], a[108:111], a[140:143]
    v_mfma_f32_16x16x32_bf16 a[140:143], a[172:175], a[124:127], a[140:143]
    s_waitcnt vmcnt(18) lgkmcnt(4)
    v_mfma_f32_16x16x32_bf16 v[32:35], a[144:147], a[0:3], v[32:35]
    ds_read_b64_tr_b16 a[160:161], v8 offset:64
    ds_read_b64_tr_b16 a[162:163], v8 offset:4672
    v_mfma_f32_16x16x32_bf16 v[32:35], a[148:151], a[16:19], v[32:35]
    ds_read_b64_tr_b16 a[164:165], v8 offset:9280
    ds_read_b64_tr_b16 a[166:167], v8 offset:13888
    s_add_u32 s56, s37, 65536
    v_mfma_f32_16x16x32_bf16 v[68:71], a[144:147], a[4:7], v[68:71]
    buffer_load_dwordx4 v[240:243], v28, s[24:27], s56 offen offset:0
    v_mfma_f32_16x16x32_bf16 v[68:71], a[148:151], a[20:23], v[68:71]
    v_mfma_f32_16x16x32_bf16 v[104:107], a[144:147], a[8:11], v[104:107]
    v_mfma_f32_16x16x32_bf16 v[104:107], a[148:151], a[24:27], v[104:107]
    v_mfma_f32_16x16x32_bf16 v[140:143], a[144:147], a[12:15], v[140:143]
    v_mfma_f32_16x16x32_bf16 v[140:143], a[148:151], a[28:31], v[140:143]
    buffer_load_dwordx4 a[68:71], v29, s[24:27], s56 offen offset:1024
    s_waitcnt lgkmcnt(4)
    v_mfma_f32_16x16x32_bf16 v[36:39], a[152:155], a[0:3], v[36:39]
    ds_read_b64_tr_b16 a[168:169], v8 offset:96
    ds_read_b64_tr_b16 a[170:171], v8 offset:4704
    v_mfma_f32_16x16x32_bf16 v[36:39], a[156:159], a[16:19], v[36:39]
    ds_read_b64_tr_b16 a[172:173], v8 offset:9312
    ds_read_b64_tr_b16 a[174:175], v8 offset:13920
    v_mfma_f32_16x16x32_bf16 v[72:75], a[152:155], a[4:7], v[72:75]
    v_mfma_f32_16x16x32_bf16 v[72:75], a[156:159], a[20:23], v[72:75]
    v_mfma_f32_16x16x32_bf16 v[108:111], a[152:155], a[8:11], v[108:111]
    buffer_load_dwordx4 a[72:75], v30, s[24:27], s56 offen offset:2048
    v_mfma_f32_16x16x32_bf16 v[108:111], a[156:159], a[24:27], v[108:111]
    v_mfma_f32_16x16x32_bf16 v[144:147], a[152:155], a[12:15], v[144:147]
    v_mfma_f32_16x16x32_bf16 v[144:147], a[156:159], a[28:31], v[144:147]
    s_waitcnt lgkmcnt(4)
    v_mfma_f32_16x16x32_bf16 v[40:43], a[160:163], a[0:3], v[40:43]
    ds_read_b64_tr_b16 a[144:145], v8 offset:128
    ds_read_b64_tr_b16 a[146:147], v8 offset:4736
    v_mfma_f32_16x16x32_bf16 v[40:43], a[164:167], a[16:19], v[40:43]
    ds_read_b64_tr_b16 a[148:149], v8 offset:9344
    ds_read_b64_tr_b16 a[150:151], v8 offset:13952
    v_mfma_f32_16x16x32_bf16 v[76:79], a[160:163], a[4:7], v[76:79]
    buffer_load_dwordx4 a[76:79], v31, s[24:27], s56 offen offset:3072
    v_mfma_f32_16x16x32_bf16 v[76:79], a[164:167], a[20:23], v[76:79]
    v_mfma_f32_16x16x32_bf16 v[112:115], a[160:163], a[8:11], v[112:115]
    v_mfma_f32_16x16x32_bf16 v[112:115], a[164:167], a[24:27], v[112:115]
    s_add_u32 s57, s37, 69632
    v_mfma_f32_16x16x32_bf16 v[148:151], a[160:163], a[12:15], v[148:151]
    buffer_load_dwordx4 v[244:247], v28, s[24:27], s57 offen offset:0
    v_mfma_f32_16x16x32_bf16 v[148:151], a[164:167], a[28:31], v[148:151]
    s_waitcnt lgkmcnt(4)
    v_mfma_f32_16x16x32_bf16 v[44:47], a[168:171], a[0:3], v[44:47]
    ds_read_b64_tr_b16 a[152:153], v8 offset:160
    ds_read_b64_tr_b16 a[154:155], v8 offset:4768
    v_mfma_f32_16x16x32_bf16 v[44:47], a[172:175], a[16:19], v[44:47]
    ds_read_b64_tr_b16 a[156:157], v8 offset:9376
    ds_read_b64_tr_b16 a[158:159], v8 offset:13984
    v_mfma_f32_16x16x32_bf16 v[80:83], a[168:171], a[4:7], v[80:83]
    v_mfma_f32_16x16x32_bf16 v[80:83], a[172:175], a[20:23], v[80:83]
    buffer_load_dwordx4 a[84:87], v29, s[24:27], s57 offen offset:1024
    v_mfma_f32_16x16x32_bf16 v[116:119], a[168:171], a[8:11], v[116:119]
    v_mfma_f32_16x16x32_bf16 v[116:119], a[172:175], a[24:27], v[116:119]
    v_mfma_f32_16x16x32_bf16 v[152:155], a[168:171], a[12:15], v[152:155]
    v_mfma_f32_16x16x32_bf16 v[152:155], a[172:175], a[28:31], v[152:155]
    s_waitcnt lgkmcnt(4)
    v_mfma_f32_16x16x32_bf16 v[48:51], a[144:147], a[0:3], v[48:51]
    ds_read_b64_tr_b16 a[160:161], v8 offset:192
    ds_read_b64_tr_b16 a[162:163], v8 offset:4800
    v_mfma_f32_16x16x32_bf16 v[48:51], a[148:151], a[16:19], v[48:51]
    ds_read_b64_tr_b16 a[164:165], v8 offset:9408
    ds_read_b64_tr_b16 a[166:167], v8 offset:14016
    v_mfma_f32_16x16x32_bf16 v[84:87], a[144:147], a[4:7], v[84:87]
    buffer_load_dwordx4 a[88:91], v30, s[24:27], s57 offen offset:2048
    v_mfma_f32_16x16x32_bf16 v[84:87], a[148:151], a[20:23], v[84:87]
    v_mfma_f32_16x16x32_bf16 v[120:123], a[144:147], a[8:11], v[120:123]
    v_mfma_f32_16x16x32_bf16 v[120:123], a[148:151], a[24:27], v[120:123]
    buffer_load_dwordx4 a[92:95], v31, s[24:27], s57 offen offset:3072
    v_mfma_f32_16x16x32_bf16 v[156:159], a[144:147], a[12:15], v[156:159]
    v_mfma_f32_16x16x32_bf16 v[156:159], a[148:151], a[28:31], v[156:159]
    s_waitcnt lgkmcnt(4)
    v_mfma_f32_16x16x32_bf16 v[52:55], a[152:155], a[0:3], v[52:55]
    ds_read_b64_tr_b16 a[168:169], v8 offset:224
    ds_read_b64_tr_b16 a[170:171], v8 offset:4832
    v_mfma_f32_16x16x32_bf16 v[52:55], a[156:159], a[16:19], v[52:55]
    ds_read_b64_tr_b16 a[172:173], v8 offset:9440
    ds_read_b64_tr_b16 a[174:175], v8 offset:14048
    s_add_u32 s60, s34, 147456
    s_add_u32 m0, s99, 0
    v_mfma_f32_16x16x32_bf16 v[88:91], a[152:155], a[4:7], v[88:91]
    buffer_load_dwordx4 v6, s[28:31], s60 offen offset:0 lds
    v_mfma_f32_16x16x32_bf16 v[88:91], a[156:159], a[20:23], v[88:91]
    v_mfma_f32_16x16x32_bf16 v[124:127], a[152:155], a[8:11], v[124:127]
    v_mfma_f32_16x16x32_bf16 v[124:127], a[156:159], a[24:27], v[124:127]
    v_mfma_f32_16x16x32_bf16 a[128:131], a[152:155], a[12:15], a[128:131]
    v_mfma_f32_16x16x32_bf16 a[128:131], a[156:159], a[28:31], a[128:131]
    buffer_load_dwordx4 v7, s[28:31], s60 offen offset:1024 lds
    s_waitcnt lgkmcnt(4)
    v_mfma_f32_16x16x32_bf16 v[56:59], a[160:163], a[0:3], v[56:59]
    ds_read_b64_tr_b16 a[144:145], v8 offset:256
    ds_read_b64_tr_b16 a[146:147], v8 offset:4864
    v_mfma_f32_16x16x32_bf16 v[56:59], a[164:167], a[16:19], v[56:59]
    ds_read_b64_tr_b16 a[148:149], v8 offset:9472
    ds_read_b64_tr_b16 a[150:151], v8 offset:14080
    v_mfma_f32_16x16x32_bf16 v[92:95], a[160:163], a[4:7], v[92:95]
    v_mfma_f32_16x16x32_bf16 v[92:95], a[164:167], a[20:23], v[92:95]
    v_mfma_f32_16x16x32_bf16 v[128:131], a[160:163], a[8:11], v[128:131]
    buffer_load_dwordx4 v20, s[28:31], s60 offen offset:2048 lds
    v_mfma_f32_16x16x32_bf16 v[128:131], a[164:167], a[24:27], v[128:131]
    v_mfma_f32_16x16x32_bf16 a[132:135], a[160:163], a[12:15], a[132:135]
    v_mfma_f32_16x16x32_bf16 a[132:135], a[164:167], a[28:31], a[132:135]
    s_waitcnt lgkmcnt(4)
    v_mfma_f32_16x16x32_bf16 v[60:63], a[168:171], a[0:3], v[60:63]
    ds_read_b64_tr_b16 a[152:153], v8 offset:18432
    ds_read_b64_tr_b16 a[154:155], v8 offset:23040
    v_mfma_f32_16x16x32_bf16 v[60:63], a[172:175], a[16:19], v[60:63]
    ds_read_b64_tr_b16 a[156:157], v8 offset:27648
    ds_read_b64_tr_b16 a[158:159], v8 offset:32256
    v_mfma_f32_16x16x32_bf16 v[96:99], a[168:171], a[4:7], v[96:99]
    buffer_load_dwordx4 v21, s[28:31], s60 offen offset:3072 lds
    v_mfma_f32_16x16x32_bf16 v[96:99], a[172:175], a[20:23], v[96:99]
    v_mfma_f32_16x16x32_bf16 v[132:135], a[168:171], a[8:11], v[132:135]
    s_buffer_load_dwordx4 s[4:7], s[68:71], s90 glc
    v_mfma_f32_16x16x32_bf16 v[132:135], a[172:175], a[24:27], v[132:135]
    s_add_u32 m0, s99, 4096
    v_mfma_f32_16x16x32_bf16 a[136:139], a[168:171], a[12:15], a[136:139]
    buffer_load_dwordx4 v22, s[28:31], s60 offen offset:0 lds
    v_mfma_f32_16x16x32_bf16 a[136:139], a[172:175], a[28:31], a[136:139]
    s_waitcnt lgkmcnt(4)
    v_mfma_f32_16x16x32_bf16 v[64:67], a[144:147], a[0:3], v[64:67]
    ds_read_b64_tr_b16 a[160:161], v8 offset:18464
    ds_read_b64_tr_b16 a[162:163], v8 offset:23072
    v_mfma_f32_16x16x32_bf16 v[64:67], a[148:151], a[16:19], v[64:67]
    ds_read_b64_tr_b16 a[164:165], v8 offset:27680
    ds_read_b64_tr_b16 a[166:167], v8 offset:32288
    v_mfma_f32_16x16x32_bf16 v[100:103], a[144:147], a[4:7], v[100:103]
    v_mfma_f32_16x16x32_bf16 v[100:103], a[148:151], a[20:23], v[100:103]
    buffer_load_dwordx4 v23, s[28:31], s60 offen offset:1024 lds
    v_mfma_f32_16x16x32_bf16 v[136:139], a[144:147], a[8:11], v[136:139]
    v_mfma_f32_16x16x32_bf16 v[136:139], a[148:151], a[24:27], v[136:139]
    v_mfma_f32_16x16x32_bf16 a[140:143], a[144:147], a[12:15], a[140:143]
    v_mfma_f32_16x16x32_bf16 a[140:143], a[148:151], a[28:31], a[140:143]
    s_waitcnt vmcnt(24) lgkmcnt(4)
    v_mfma_f32_16x16x32_bf16 v[32:35], a[152:155], a[32:35], v[32:35]
    ds_read_b64_tr_b16 a[168:169], v8 offset:18496
    ds_read_b64_tr_b16 a[170:171], v8 offset:23104
    v_mfma_f32_16x16x32_bf16 v[32:35], a[156:159], a[48:51], v[32:35]
    ds_read_b64_tr_b16 a[172:173], v8 offset:27712
    ds_read_b64_tr_b16 a[174:175], v8 offset:32320
    v_mfma_f32_16x16x32_bf16 v[68:71], a[152:155], a[36:39], v[68:71]
    buffer_load_dwordx4 v24, s[28:31], s60 offen offset:2048 lds
    v_mfma_f32_16x16x32_bf16 v[68:71], a[156:159], a[52:55], v[68:71]
    v_mfma_f32_16x16x32_bf16 v[104:107], a[152:155], a[40:43], v[104:107]
    v_mfma_f32_16x16x32_bf16 v[104:107], a[156:159], a[56:59], v[104:107]
    buffer_load_dwordx4 v25, s[28:31], s60 offen offset:3072 lds
    v_mfma_f32_16x16x32_bf16 v[140:143], a[152:155], a[44:47], v[140:143]
    v_mfma_f32_16x16x32_bf16 v[140:143], a[156:159], a[60:63], v[140:143]
    s_waitcnt lgkmcnt(4)
    v_mfma_f32_16x16x32_bf16 v[36:39], a[160:163], a[32:35], v[36:39]
    ds_read_b64_tr_b16 a[144:145], v8 offset:18528
    ds_read_b64_tr_b16 a[146:147], v8 offset:23136
    v_mfma_f32_16x16x32_bf16 v[36:39], a[164:167], a[48:51], v[36:39]
    ds_read_b64_tr_b16 a[148:149], v8 offset:27744
    ds_read_b64_tr_b16 a[150:151], v8 offset:32352
    s_add_u32 m0, s99, 8192
    v_mfma_f32_16x16x32_bf16 v[72:75], a[160:163], a[36:39], v[72:75]
    buffer_load_dwordx4 v1, s[28:31], s60 offen offset:0 lds
    v_mfma_f32_16x16x32_bf16 v[72:75], a[164:167], a[52:55], v[72:75]
    v_mfma_f32_16x16x32_bf16 v[108:111], a[160:163], a[40:43], v[108:111]
    v_mfma_f32_16x16x32_bf16 v[108:111], a[164:167], a[56:59], v[108:111]
    v_mfma_f32_16x16x32_bf16 v[144:147], a[160:163], a[44:47], v[144:147]
    v_mfma_f32_16x16x32_bf16 v[144:147], a[164:167], a[60:63], v[144:147]
    s_waitcnt lgkmcnt(0)
    s_min_u32 s4, s4, s5
    s_min_u32 s6, s6, s7
    s_min_u32 s4, s4, s6
    s_cmp_ge_u32 s4, 4
    s_cbranch_scc0 L_spinB2
L_backB2:
    v_mfma_f32_16x16x32_bf16 v[40:43], a[168:171], a[32:35], v[40:43]
    ds_read_b64_tr_b16 a[152:153], v8 offset:18560
    ds_read_b64_tr_b16 a[154:155], v8 offset:23168
    v_mfma_f32_16x16x32_bf16 v[40:43], a[172:175], a[48:51], v[40:43]
    ds_read_b64_tr_b16 a[156:157], v8 offset:27776
    ds_read_b64_tr_b16 a[158:159], v8 offset:32384
    s_add_u32 s58, s37, 73728
    v_mfma_f32_16x16x32_bf16 v[76:79], a[168:171], a[36:39], v[76:79]
    buffer_load_dwordx4 v[248:251], v28, s[24:27], s58 offen offset:0
    v_mfma_f32_16x16x32_bf16 v[76:79], a[172:175], a[52:55], v[76:79]
    v_mfma_f32_16x16x32_bf16 v[112:115], a[168:171], a[40:43], v[112:115]
    v_mfma_f32_16x16x32_bf16 v[112:115], a[172:175], a[56:59], v[112:115]
    v_mfma_f32_16x16x32_bf16 v[148:151], a[168:171], a[44:47], v[148:151]
    v_mfma_f32_16x16x32_bf16 v[148:151], a[172:175], a[60:63], v[148:151]
    v_mfma_f32_16x16x32_bf16 v[44:47], a[144:147], a[32:35], v[44:47]
    ds_read_b64_tr_b16 a[160:161], v8 offset:18592
    ds_read_b64_tr_b16 a[162:163], v8 offset:23200
    v_mfma_f32_16x16x32_bf16 v[44:47], a[148:151], a[48:51], v[44:47]
    ds_read_b64_tr_b16 a[164:165], v8 offset:27808
    ds_read_b64_tr_b16 a[166:167], v8 offset:32416
    v_mfma_f32_16x16x32_bf16 v[80:83], a[144:147], a[36:39], v[80:83]
    buffer_load_dwordx4 a[100:103], v29, s[24:27], s58 offen offset:1024
    v_mfma_f32_16x16x32_bf16 v[80:83], a[148:151], a[52:55], v[80:83]
    v_mfma_f32_16x16x32_bf16 v[116:119], a[144:147], a[40:43], v[116:119]
    v_mfma_f32_16x16x32_bf16 v[116:119], a[148:151], a[56:59], v[116:119]
    v_mfma_f32_16x16x32_bf16 v[152:155], a[144:147], a[44:47], v[152:155]
    buffer_load_dwordx4 a[104:107], v30, s[24:27], s58 offen offset:2048
    v_mfma_f32_16x16x32_bf16 v[152:155], a[148:151], a[60:63], v[152:155]
    s_waitcnt lgkmcnt(4)
    v_mfma_f32_16x16x32_bf16 v[48:51], a[152:155], a[32:35], v[48:51]
    ds_read_b64_tr_b16 a[168:169], v8 offset:18624
    ds_read_b64_tr_b16 a[170:171], v8 offset:23232
    v_mfma_f32_16x16x32_bf16 v[48:51], a[156:159], a[48:51], v[48:51]
    ds_read_b64_tr_b16 a[172:173], v8 offset:27840
    ds_read_b64_tr_b16 a[174:175], v8 offset:32448
    v_mfma_f32_16x16x32_bf16 v[84:87], a[152:155], a[36:39], v[84:87]
    v_mfma_f32_16x16x32_bf16 v[84:87], a[156:159], a[52:55], v[84:87]
    v_mfma_f32_16x16x32_bf16 v[120:123], a[152:155], a[40:43], v[120:123]
    buffer_load_dwordx4 a[108:111], v31, s[24:27], s58 offen offset:3072
    v_mfma_f32_16x16x32_bf16 v[120:123], a[156:159], a[56:59], v[120:123]
    v_mfma_f32_16x16x32_bf16 v[156:159], a[152:155], a[44:47], v[156:159]
    v_mfma_f32_16x16x32_bf16 v[156:159], a[156:159], a[60:63], v[156:159]
    s_waitcnt lgkmcnt(4)
    v_mfma_f32_16x16x32_bf16 v[52:55], a[160:163], a[32:35], v[52:55]
    ds_read_b64_tr_b16 a[144:145], v8 offset:18656
    ds_read_b64_tr_b16 a[146:147], v8 offset:23264
    v_mfma_f32_16x16x32_bf16 v[52:55], a[164:167], a[48:51], v[52:55]
    ds_read_b64_tr_b16 a[148:149], v8 offset:27872
    ds_read_b64_tr_b16 a[150:151], v8 offset:32480
    s_add_u32 s59, s37, 77824
    v_mfma_f32_16x16x32_bf16 v[88:91], a[160:163], a[36:39], v[88:91]
    buffer_load_dwordx4 v[252:255], v28, s[24:27], s59 offen offset:0
    v_mfma_f32_16x16x32_bf16 v[88:91], a[164:167], a[52:55], v[88:91]
    v_mfma_f32_16x16x32_bf16 v[124:127], a[160:163], a[40:43], v[124:127]
    v_mfma_f32_16x16x32_bf16 v[124:127], a[164:167], a[56:59], v[124:127]
    v_mfma_f32_16x16x32_bf16 a[128:131], a[160:163], a[44:47], a[128:131]
    v_mfma_f32_16x16x32_bf16 a[128:131], a[164:167], a[60:63], a[128:131]
    s_waitcnt lgkmcnt(4)
    v_mfma_f32_16x16x32_bf16 v[56:59], a[168:171], a[32:35], v[56:59]
    ds_read_b64_tr_b16 a[152:153], v8 offset:18688
    ds_read_b64_tr_b16 a[154:155], v8 offset:23296
    v_mfma_f32_16x16x32_bf16 v[56:59], a[172:175], a[48:51], v[56:59]
    ds_read_b64_tr_b16 a[156:157], v8 offset:27904
    ds_read_b64_tr_b16 a[158:159], v8 offset:32512
    v_mfma_f32_16x16x32_bf16 v[92:95], a[168:171], a[36:39], v[92:95]
    buffer_load_dwordx4 a[116:119], v29, s[24:27], s59 offen offset:1024
    v_mfma_f32_16x16x32_bf16 v[92:95], a[172:175], a[52:55], v[92:95]
    v_mfma_f32_16x16x32_bf16 v[128:131], a[168:171], a[40:43], v[128:131]
    v_mfma_f32_16x16x32_bf16 v[128:131], a[172:175], a[56:59], v[128:131]
    v_mfma_f32_16x16x32_bf16 a[132:135], a[168:171], a[44:47], a[132:135]
    buffer_load_dwordx4 a[120:123], v30, s[24:27], s59 offen offset:2048
    v_mfma_f32_16x16x32_bf16 a[132:135], a[172:175], a[60:63], a[132:135]
    s_waitcnt vmcnt(24) lgkmcnt(0)
    s_barrier
    v_mfma_f32_16x16x32_bf16 v[60:63], a[144:147], a[32:35], v[60:63]
    ds_read_b64_tr_b16 a[160:161], v9 offset:0
    ds_read_b64_tr_b16 a[162:163], v9 offset:4608
    v_mfma_f32_16x16x32_bf16 v[60:63], a[148:151], a[48:51], v[60:63]
    ds_read_b64_tr_b16 a[164:165], v9 offset:9216
    ds_read_b64_tr_b16 a[166:167], v9 offset:13824
    v_mfma_f32_16x16x32_bf16 v[96:99], a[144:147], a[36:39], v[96:99]
    v_mfma_f32_16x16x32_bf16 v[96:99], a[148:151], a[52:55], v[96:99]
    v_mfma_f32_16x16x32_bf16 v[132:135], a[144:147], a[40:43], v[132:135]
    buffer_load_dwordx4 a[124:127], v31, s[24:27], s59 offen offset:3072
    v_mfma_f32_16x16x32_bf16 v[132:135], a[148:151], a[56:59], v[132:135]
    v_mfma_f32_16x16x32_bf16 a[136:139], a[144:147], a[44:47], a[136:139]
    v_mfma_f32_16x16x32_bf16 a[136:139], a[148:151], a[60:63], a[136:139]
    v_mfma_f32_16x16x32_bf16 v[64:67], a[152:155], a[32:35], v[64:67]
    ds_read_b64_tr_b16 a[168:169], v9 offset:32
    ds_read_b64_tr_b16 a[170:171], v9 offset:4640
    v_mfma_f32_16x16x32_bf16 v[64:67], a[156:159], a[48:51], v[64:67]
    ds_read_b64_tr_b16 a[172:173], v9 offset:9248
    ds_read_b64_tr_b16 a[174:175], v9 offset:13856
    v_mfma_f32_16x16x32_bf16 v[100:103], a[152:155], a[36:39], v[100:103]
    v_mfma_f32_16x16x32_bf16 v[100:103], a[156:159], a[52:55], v[100:103]
    v_mfma_f32_16x16x32_bf16 v[136:139], a[152:155], a[40:43], v[136:139]
    v_mfma_f32_16x16x32_bf16 v[136:139], a[156:159], a[56:59], v[136:139]
    v_mfma_f32_16x16x32_bf16 a[140:143], a[152:155], a[44:47], a[140:143]
    v_mfma_f32_16x16x32_bf16 a[140:143], a[156:159], a[60:63], a[140:143]
    s_waitcnt vmcnt(17) lgkmcnt(4)
    v_mfma_f32_16x16x32_bf16 v[68:71], a[160:163], a[68:71], v[68:71]
    ds_read_b64_tr_b16 a[144:145], v9 offset:64
    ds_read_b64_tr_b16 a[146:147], v9 offset:4672
    v_mfma_f32_16x16x32_bf16 v[68:71], a[164:167], a[84:87], v[68:71]
    ds_read_b64_tr_b16 a[148:149], v9 offset:9280
    ds_read_b64_tr_b16 a[150:151], v9 offset:13888
    s_add_u32 s56, s38, 65536
    v_mfma_f32_16x16x32_bf16 v[104:107], a[160:163], a[72:75], v[104:107]
    buffer_load_dwordx4 a[0:3], v28, s[24:27], s56 offen offset:0
    v_mfma_f32_16x16x32_bf16 v[104:107], a[164:167], a[88:91], v[104:107]
    s_mul_i32 s3, s43, 5120
    v_lshl_add_u32 v12, v0, 4, s3
    v_mfma_f32_16x16x32_bf16 v[140:143], a[160:163], a[76:79], v[140:143]
    s_add_u32 s3, s3, 4096
    v_lshl_add_u32 v13, v0, 3, s3
    v_mfma_f32_16x16x32_bf16 v[140:143], a[164:167], a[92:95], v[140:143]
    s_add_u32 s3, s52, 1
    s_and_b32 s3, s3, 3
    s_waitcnt lgkmcnt(4)
    v_mfma_f32_16x16x32_bf16 v[72:75], a[168:171], a[68:71], v[72:75]
    ds_read_b64_tr_b16 a[152:153], v9 offset:96
    ds_read_b64_tr_b16 a[154:155], v9 offset:4704
    v_mfma_f32_16x16x32_bf16 v[72:75], a[172:175], a[84:87], v[72:75]
    ds_read_b64_tr_b16 a[156:157], v9 offset:9312
    ds_read_b64_tr_b16 a[158:159], v9 offset:13920
    v_mfma_f32_16x16x32_bf16 v[108:111], a[168:171], a[72:75], v[108:111]
    buffer_load_dwordx4 a[4:7], v29, s[24:27], s56 offen offset:1024
    v_mfma_f32_16x16x32_bf16 v[108:111], a[172:175], a[88:91], v[108:111]
    s_mul_i32 s3, s3, 61440
    s_add_u32 s44, s3, 0
    v_mfma_f32_16x16x32_bf16 v[144:147], a[168:171], a[76:79], v[144:147]
    buffer_load_dwordx4 a[8:11], v30, s[24:27], s56 offen offset:2048
    v_mfma_f32_16x16x32_bf16 v[144:147], a[172:175], a[92:95], v[144:147]
    s_add_u32 s3, s52, 2
    s_and_b32 s3, s3, 3
    s_waitcnt lgkmcnt(4)
    v_mfma_f32_16x16x32_bf16 v[76:79], a[144:147], a[68:71], v[76:79]
    ds_read_b64_tr_b16 a[160:161], v9 offset:128
    ds_read_b64_tr_b16 a[162:163], v9 offset:4736
    v_mfma_f32_16x16x32_bf16 v[76:79], a[148:151], a[84:87], v[76:79]
    ds_read_b64_tr_b16 a[164:165], v9 offset:9344
    ds_read_b64_tr_b16 a[166:167], v9 offset:13952
    v_mfma_f32_16x16x32_bf16 v[112:115], a[144:147], a[72:75], v[112:115]
    buffer_load_dwordx4 a[12:15], v31, s[24:27], s56 offen offset:3072
    v_mfma_f32_16x16x32_bf16 v[112:115], a[148:151], a[88:91], v[112:115]
    s_mul_i32 s3, s3, 61440
    s_add_u32 s45, s3, 20480
    v_mfma_f32_16x16x32_bf16 v[148:151], a[144:147], a[76:79], v[148:151]
    s_add_u32 s3, s52, 3
    s_and_b32 s3, s3, 3
    v_mfma_f32_16x16x32_bf16 v[148:151], a[148:151], a[92:95], v[148:151]
    s_mul_i32 s3, s3, 61440
    s_add_u32 s46, s3, 40960
    s_waitcnt lgkmcnt(4)
    v_mfma_f32_16x16x32_bf16 v[80:83], a[152:155], a[68:71], v[80:83]
    ds_read_b64_tr_b16 a[168:169], v9 offset:160
    ds_read_b64_tr_b16 a[170:171], v9 offset:4768
    v_mfma_f32_16x16x32_bf16 v[80:83], a[156:159], a[84:87], v[80:83]
    ds_read_b64_tr_b16 a[172:173], v9 offset:9376
    ds_read_b64_tr_b16 a[174:175], v9 offset:13984
    s_add_u32 s57, s38, 69632
    v_mfma_f32_16x16x32_bf16 v[116:119], a[152:155], a[72:75], v[116:119]
    buffer_load_dwordx4 a[16:19], v28, s[24:27], s57 offen offset:0
    v_mfma_f32_16x16x32_bf16 v[116:119], a[156:159], a[88:91], v[116:119]
    s_mul_i32 s61, s52, 61440
    s_add_u32 s62, s61, 20480
    v_mfma_f32_16x16x32_bf16 v[152:155], a[152:155], a[76:79], v[152:155]
    buffer_load_dwordx4 a[20:23], v29, s[24:27], s57 offen offset:1024
    v_mfma_f32_16x16x32_bf16 v[152:155], a[156:159], a[92:95], v[152:155]
    s_add_u32 s63, s61, 40960
    s_mul_i32 s3, s42, 240
    s_waitcnt lgkmcnt(4)
    v_mfma_f32_16x16x32_bf16 v[84:87], a[160:163], a[68:71], v[84:87]
    ds_read_b64_tr_b16 a[144:145], v9 offset:192
    ds_read_b64_tr_b16 a[146:147], v9 offset:4800
    v_mfma_f32_16x16x32_bf16 v[84:87], a[164:167], a[84:87], v[84:87]
    ds_read_b64_tr_b16 a[148:149], v9 offset:9408
    ds_read_b64_tr_b16 a[150:151], v9 offset:14016
    v_mfma_f32_16x16x32_bf16 v[120:123], a[160:163], a[72:75], v[120:123]
    buffer_load_dwordx4 a[24:27], v30, s[24:27], s57 offen offset:2048
    v_mfma_f32_16x16x32_bf16 v[120:123], a[164:167], a[88:91], v[120:123]
    s_lshl_b32 s4, s43, 6
    s_add_u32 s3, s3, s4
    v_mfma_f32_16x16x32_bf16 v[156:159], a[160:163], a[76:79], v[156:159]
    s_lshl_b32 s4, s52, 4
    s_add_u32 s3, s3, s4
    v_mfma_f32_16x16x32_bf16 v[156:159], a[164:167], a[92:95], v[156:159]
    s_mul_i32 s3, s3, 2304
    s_mul_i32 s4, s40, 1152
    s_waitcnt lgkmcnt(4)
    v_mfma_f32_16x16x32_bf16 v[88:91], a[168:171], a[68:71], v[88:91]
    ds_read_b64_tr_b16 a[152:153], v9 offset:224
    ds_read_b64_tr_b16 a[154:155], v9 offset:4832
    v_mfma_f32_16x16x32_bf16 v[88:91], a[172:175], a[84:87], v[88:91]
    ds_read_b64_tr_b16 a[156:157], v9 offset:9440
    ds_read_b64_tr_b16 a[158:159], v9 offset:14048
    v_mfma_f32_16x16x32_bf16 v[124:127], a[168:171], a[72:75], v[124:127]
    buffer_load_dwordx4 a[28:31], v31, s[24:27], s57 offen offset:3072
    v_mfma_f32_16x16x32_bf16 v[124:127], a[172:175], a[88:91], v[124:127]
    s_add_u32 s58, s38, 73728
    s_add_u32 s3, s3, s4
    s_mul_i32 s4, s53, 288
    v_mfma_f32_16x16x32_bf16 a[128:131], a[168:171], a[76:79], a[128:131]
    buffer_load_dwordx4 a[32:35], v28, s[24:27], s58 offen offset:0
    v_mfma_f32_16x16x32_bf16 a[128:131], a[172:175], a[92:95], a[128:131]
    s_add_u32 s3, s3, s4
    s_cmp_eq_u32 s88, 0
    s_waitcnt lgkmcnt(4)
    v_mfma_f32_16x16x32_bf16 v[92:95], a[144:147], a[68:71], v[92:95]
    ds_read_b64_tr_b16 a[160:161], v9 offset:256
    ds_read_b64_tr_b16 a[162:163], v9 offset:4864
    v_mfma_f32_16x16x32_bf16 v[92:95], a[148:151], a[84:87], v[92:95]
    ds_read_b64_tr_b16 a[164:165], v9 offset:9472
    ds_read_b64_tr_b16 a[166:167], v9 offset:14080
    v_mfma_f32_16x16x32_bf16 v[128:131], a[144:147], a[72:75], v[128:131]
    s_cselect_b32 s3, 2147483648, s3
    v_and_b32 v17, 15, v0
    v_mfma_f32_16x16x32_bf16 v[128:131], a[148:151], a[88:91], v[128:131]
    buffer_load_dwordx4 a[36:39], v29, s[24:27], s58 offen offset:1024
    v_mfma_f32_16x16x32_bf16 a[132:135], a[144:147], a[76:79], a[132:135]
    v_mul_u32_u24 v17, 2304, v17
    v_add_u32 v17, s3, v17
    v_mfma_f32_16x16x32_bf16 a[132:135], a[148:151], a[92:95], a[132:135]
    v_lshrrev_b32 v18, 4, v0
    v_lshl_add_u32 v16, v18, 3, v17
    s_waitcnt lgkmcnt(4)
    v_mfma_f32_16x16x32_bf16 v[96:99], a[152:155], a[68:71], v[96:99]
    ds_read_b64_tr_b16 a[168:169], v9 offset:18432
    ds_read_b64_tr_b16 a[170:171], v9 offset:23040
    v_mfma_f32_16x16x32_bf16 v[96:99], a[156:159], a[84:87], v[96:99]
    ds_read_b64_tr_b16 a[172:173], v9 offset:27648
    ds_read_b64_tr_b16 a[174:175], v9 offset:32256
    v_mfma_f32_16x16x32_bf16 v[132:135], a[152:155], a[72:75], v[132:135]
    buffer_load_dwordx4 a[40:43], v30, s[24:27], s58 offen offset:2048
    v_mfma_f32_16x16x32_bf16 v[132:135], a[156:159], a[88:91], v[132:135]
    v_and_b32 v19, 1, v18
    v_lshl_add_u32 v17, v19, 5, v17
    v_mfma_f32_16x16x32_bf16 a[136:139], a[152:155], a[76:79], a[136:139]
    v_lshrrev_b32 v18, 1, v18
    v_lshl_add_u32 v15, v18, 4, v17
    v_mfma_f32_16x16x32_bf16 a[136:139], a[156:159], a[92:95], a[136:139]
    buffer_load_dwordx4 a[44:47], v31, s[24:27], s58 offen offset:3072
    s_waitcnt lgkmcnt(4)
    v_mfma_f32_16x16x32_bf16 v[100:103], a[160:163], a[68:71], v[100:103]
    ds_read_b64_tr_b16 a[144:145], v9 offset:18464
    ds_read_b64_tr_b16 a[146:147], v9 offset:23072
    v_mfma_f32_16x16x32_bf16 v[100:103], a[164:167], a[84:87], v[100:103]
    ds_read_b64_tr_b16 a[148:149], v9 offset:27680
    ds_read_b64_tr_b16 a[150:151], v9 offset:32288
    v_mfma_f32_16x16x32_bf16 v[136:139], a[160:163], a[72:75], v[136:139]
    s_add_u32 s59, s38, 77824
    s_lshl_b32 s3, s52, 2
    s_add_u32 s3, s3, s91
    v_mfma_f32_16x16x32_bf16 v[136:139], a[164:167], a[88:91], v[136:139]
    buffer_load_dwordx4 a[48:51], v28, s[24:27], s59 offen offset:0
    v_mfma_f32_16x16x32_bf16 a[140:143], a[160:163], a[76:79], a[140:143]
    v_writelane_b32 v11, s3, 0
    v_mfma_f32_16x16x32_bf16 a[140:143], a[164:167], a[92:95], a[140:143]
    s_waitcnt vmcnt(13) lgkmcnt(4)
    v_mfma_f32_16x16x32_bf16 v[68:71], a[168:171], a[100:103], v[68:71]
    ds_read_b64_tr_b16 a[152:153], v9 offset:18496
    ds_read_b64_tr_b16 a[154:155], v9 offset:23104
    v_mfma_f32_16x16x32_bf16 v[68:71], a[172:175], a[116:119], v[68:71]
    ds_read_b64_tr_b16 a[156:157], v9 offset:27712
    ds_read_b64_tr_b16 a[158:159], v9 offset:32320
    v_mfma_f32_16x16x32_bf16 v[104:107], a[168:171], a[104:107], v[104:107]
    buffer_load_dwordx4 a[52:55], v29, s[24:27], s59 offen offset:1024
    v_mfma_f32_16x16x32_bf16 v[104:107], a[172:175], a[120:123], v[104:107]
    v_mfma_f32_16x16x32_bf16 v[140:143], a[168:171], a[108:111], v[140:143]
    v_mfma_f32_16x16x32_bf16 v[140:143], a[172:175], a[124:127], v[140:143]
    buffer_load_dwordx4 a[56:59], v30, s[24:27], s59 offen offset:2048
    s_waitcnt lgkmcnt(4)
    v_mfma_f32_16x16x32_bf16 v[72:75], a[144:147], a[100:103], v[72:75]
    ds_read_b64_tr_b16 a[160:161], v9 offset:18528
    ds_read_b64_tr_b16 a[162:163], v9 offset:23136
    v_mfma_f32_16x16x32_bf16 v[72:75], a[148:151], a[116:119], v[72:75]
    ds_read_b64_tr_b16 a[164:165], v9 offset:27744
    ds_read_b64_tr_b16 a[166:167], v9 offset:32352
    v_mfma_f32_16x16x32_bf16 v[108:111], a[144:147], a[104:107], v[108:111]
    v_mfma_f32_16x16x32_bf16 v[108:111], a[148:151], a[120:123], v[108:111]
    buffer_load_dwordx4 a[60:63], v31, s[24:27], s59 offen offset:3072
    v_mfma_f32_16x16x32_bf16 v[144:147], a[144:147], a[108:111], v[144:147]
    v_mfma_f32_16x16x32_bf16 v[144:147], a[148:151], a[124:127], v[144:147]
    s_waitcnt lgkmcnt(4)
    v_mfma_f32_16x16x32_bf16 v[76:79], a[152:155], a[100:103], v[76:79]
    ds_read_b64_tr_b16 a[168:169], v9 offset:18560
    ds_read_b64_tr_b16 a[170:171], v9 offset:23168
    v_mfma_f32_16x16x32_bf16 v[76:79], a[156:159], a[116:119], v[76:79]
    ds_read_b64_tr_b16 a[172:173], v9 offset:27776
    ds_read_b64_tr_b16 a[174:175], v9 offset:32384
    s_add_u32 s60, s35, 147456
    s_add_u32 m0, s92, 46080
    v_mfma_f32_16x16x32_bf16 v[112:115], a[152:155], a[104:107], v[112:115]
    buffer_load_dwordx4 v6, s[28:31], s60 offen offset:0 lds
    v_mfma_f32_16x16x32_bf16 v[112:115], a[156:159], a[120:123], v[112:115]
    v_mfma_f32_16x16x32_bf16 v[148:151], a[152:155], a[108:111], v[148:151]
    v_mfma_f32_16x16x32_bf16 v[148:151], a[156:159], a[124:127], v[148:151]
    s_waitcnt lgkmcnt(4)
    v_mfma_f32_16x16x32_bf16 v[80:83], a[160:163], a[100:103], v[80:83]
    ds_read_b64_tr_b16 a[144:145], v9 offset:18592
    ds_read_b64_tr_b16 a[146:147], v9 offset:23200
    v_mfma_f32_16x16x32_bf16 v[80:83], a[164:167], a[116:119], v[80:83]
    ds_read_b64_tr_b16 a[148:149], v9 offset:27808
    ds_read_b64_tr_b16 a[150:151], v9 offset:32416
    v_mfma_f32_16x16x32_bf16 v[116:119], a[160:163], a[104:107], v[116:119]
    buffer_load_dwordx4 v7, s[28:31], s60 offen offset:1024 lds
    v_mfma_f32_16x16x32_bf16 v[116:119], a[164:167], a[120:123], v[116:119]
    v_mfma_f32_16x16x32_bf16 v[152:155], a[160:163], a[108:111], v[152:155]
    buffer_load_dwordx4 v20, s[28:31], s60 offen offset:2048 lds
    v_mfma_f32_16x16x32_bf16 v[152:155], a[164:167], a[124:127], v[152:155]
    s_waitcnt lgkmcnt(4)
    v_mfma_f32_16x16x32_bf16 v[84:87], a[168:171], a[100:103], v[84:87]
    ds_read_b64_tr_b16 a[152:153], v9 offset:18624
    ds_read_b64_tr_b16 a[154:155], v9 offset:23232
    v_mfma_f32_16x16x32_bf16 v[84:87], a[172:175], a[116:119], v[84:87]
    ds_read_b64_tr_b16 a[156:157], v9 offset:27840
    ds_read_b64_tr_b16 a[158:159], v9 offset:32448
    v_mfma_f32_16x16x32_bf16 v[120:123], a[168:171], a[104:107], v[120:123]
    buffer_load_dwordx4 v21, s[28:31], s60 offen offset:3072 lds
    v_mfma_f32_16x16x32_bf16 v[120:123], a[172:175], a[120:123], v[120:123]
    v_mfma_f32_16x16x32_bf16 v[156:159], a[168:171], a[108:111], v[156:159]
    v_mfma_f32_16x16x32_bf16 v[156:159], a[172:175], a[124:127], v[156:159]
    s_waitcnt lgkmcnt(4)
    v_mfma_f32_16x16x32_bf16 v[88:91], a[144:147], a[100:103], v[88:91]
    ds_read_b64_tr_b16 a[160:161], v9 offset:18656
    ds_read_b64_tr_b16 a[162:163], v9 offset:23264
    v_mfma_f32_16x16x32_bf16 v[88:91], a[148:151], a[116:119], v[88:91]
    ds_read_b64_tr_b16 a[164:165], v9 offset:27872
    ds_read_b64_tr_b16 a[166:167], v9 offset:32480
    s_add_u32 m0, s92, 50176
    v_mfma_f32_16x16x32_bf16 v[124:127], a[144:147], a[104:107], v[124:127]
    buffer_load_dwordx4 v22, s[28:31], s60 offen offset:0 lds
    v_mfma_f32_16x16x32_bf16 v[124:127], a[148:151], a[120:123], v[124:127]
    v_mfma_f32_16x16x32_bf16 a[128:131], a[144:147], a[108:111], a[128:131]
    buffer_load_dwordx4 v23, s[28:31], s60 offen offset:1024 lds
    v_mfma_f32_16x16x32_bf16 a[128:131], a[148:151], a[124:127], a[128:131]
    s_waitcnt lgkmcnt(4)
    v_mfma_f32_16x16x32_bf16 v[92:95], a[152:155], a[100:103], v[92:95]
    ds_read_b64_tr_b16 a[168:169], v9 offset:18688
    ds_read_b64_tr_b16 a[170:171], v9 offset:23296
    v_mfma_f32_16x16x32_bf16 v[92:95], a[156:159], a[116:119], v[92:95]
    ds_read_b64_tr_b16 a[172:173], v9 offset:27904
    ds_read_b64_tr_b16 a[174:175], v9 offset:32512
    v_mfma_f32_16x16x32_bf16 v[128:131], a[152:155], a[104:107], v[128:131]
    buffer_load_dwordx4 v24, s[28:31], s60 offen offset:2048 lds
    v_mfma_f32_16x16x32_bf16 v[128:131], a[156:159], a[120:123], v[128:131]
    v_mfma_f32_16x16x32_bf16 a[132:135], a[152:155], a[108:111], a[132:135]
    v_mfma_f32_16x16x32_bf16 a[132:135], a[156:159], a[124:127], a[132:135]
    s_waitcnt lgkmcnt(0)
    s_barrier
    v_mfma_f32_16x16x32_bf16 v[96:99], a[160:163], a[100:103], v[96:99]
    ds_read_b64_tr_b16 a[144:145], v8 offset:36864
    ds_read_b64_tr_b16 a[146:147], v8 offset:41472
    v_mfma_f32_16x16x32_bf16 v[96:99], a[164:167], a[116:119], v[96:99]
    ds_read_b64_tr_b16 a[148:149], v9 offset:36864
    ds_read_b64_tr_b16 a[150:151], v9 offset:41472
    v_mfma_f32_16x16x32_bf16 v[132:135], a[160:163], a[104:107], v[132:135]
    buffer_load_dwordx4 v25, s[28:31], s60 offen offset:3072 lds
    v_mfma_f32_16x16x32_bf16 v[132:135], a[164:167], a[120:123], v[132:135]
    s_add_u32 m0, s92, 54272
    v_mfma_f32_16x16x32_bf16 a[136:139], a[160:163], a[108:111], a[136:139]
    buffer_load_dwordx4 v1, s[28:31], s60 offen offset:0 lds
    v_mfma_f32_16x16x32_bf16 a[136:139], a[164:167], a[124:127], a[136:139]
    v_mfma_f32_16x16x32_bf16 v[100:103], a[168:171], a[100:103], v[100:103]
    ds_read_b64_tr_b16 a[152:153], v8 offset:36896
    ds_read_b64_tr_b16 a[154:155], v8 offset:41504
    v_mfma_f32_16x16x32_bf16 v[100:103], a[172:175], a[116:119], v[100:103]
    ds_read_b64_tr_b16 a[156:157], v9 offset:36896
    ds_read_b64_tr_b16 a[158:159], v9 offset:41504
    v_mfma_f32_16x16x32_bf16 v[136:139], a[168:171], a[104:107], v[136:139]
    v_mfma_f32_16x16x32_bf16 v[136:139], a[172:175], a[120:123], v[136:139]
    v_mfma_f32_16x16x32_bf16 a[140:143], a[168:171], a[108:111], a[140:143]
    v_mfma_f32_16x16x32_bf16 a[140:143], a[172:175], a[124:127], a[140:143]
    s_waitcnt vmcnt(17) lgkmcnt(4)
    v_mfma_f32_16x16x32_bf16 v[68:71], a[144:147], a[4:7], v[68:71]
    ds_read_b64_tr_b16 a[160:161], v8 offset:36928
    ds_read_b64_tr_b16 a[162:163], v8 offset:41536
    v_mfma_f32_16x16x32_bf16 v[68:71], a[148:151], a[20:23], v[68:71]
    ds_read_b64_tr_b16 a[164:165], v9 offset:36928
    ds_read_b64_tr_b16 a[166:167], v9 offset:41536
    s_add_u32 s56, s39, 65536
    v_mfma_f32_16x16x32_bf16 v[104:107], a[144:147], a[8:11], v[104:107]
    buffer_load_dwordx4 a[64:67], v28, s[24:27], s56 offen offset:0
    v_mfma_f32_16x16x32_bf16 v[104:107], a[148:151], a[24:27], v[104:107]
    v_mfma_f32_16x16x32_bf16 v[140:143], a[144:147], a[12:15], v[140:143]
    v_mfma_f32_16x16x32_bf16 v[140:143], a[148:151], a[28:31], v[140:143]
    s_waitcnt lgkmcnt(4)
    v_mfma_f32_16x16x32_bf16 v[72:75], a[152:155], a[4:7], v[72:75]
    ds_read_b64_tr_b16 a[168:169], v8 offset:36960
    ds_read_b64_tr_b16 a[170:171], v8 offset:41568
    v_mfma_f32_16x16x32_bf16 v[72:75], a[156:159], a[20:23], v[72:75]
    ds_read_b64_tr_b16 a[172:173], v9 offset:36960
    ds_read_b64_tr_b16 a[174:175], v9 offset:41568
    v_mfma_f32_16x16x32_bf16 v[108:111], a[152:155], a[8:11], v[108:111]
    buffer_load_dwordx4 a[68:71], v29, s[24:27], s56 offen offset:1024
    v_mfma_f32_16x16x32_bf16 v[108:111], a[156:159], a[24:27], v[108:111]
    v_mfma_f32_16x16x32_bf16 v[144:147], a[152:155], a[12:15], v[144:147]
    v_mfma_f32_16x16x32_bf16 v[144:147], a[156:159], a[28:31], v[144:147]
    buffer_load_dwordx4 a[72:75], v30, s[24:27], s56 offen offset:2048
    s_waitcnt lgkmcnt(4)
    v_mfma_f32_16x16x32_bf16 v[76:79], a[160:163], a[4:7], v[76:79]
    ds_read_b64_tr_b16 a[144:145], v8 offset:36992
    ds_read_b64_tr_b16 a[146:147], v8 offset:41600
    v_mfma_f32_16x16x32_bf16 v[76:79], a[164:167], a[20:23], v[76:79]
    ds_read_b64_tr_b16 a[148:149], v9 offset:36992
    ds_read_b64_tr_b16 a[150:151], v9 offset:41600
    v_mfma_f32_16x16x32_bf16 v[112:115], a[160:163], a[8:11], v[112:115]
    v_mfma_f32_16x16x32_bf16 v[112:115], a[164:167], a[24:27], v[112:115]
    v_mfma_f32_16x16x32_bf16 v[148:151], a[160:163], a[12:15], v[148:151]
    buffer_load_dwordx4 a[76:79], v31, s[24:27], s56 offen offset:3072
    v_mfma_f32_16x16x32_bf16 v[148:151], a[164:167], a[28:31], v[148:151]
    s_waitcnt lgkmcnt(4)
    v_mfma_f32_16x16x32_bf16 v[80:83], a[168:171], a[4:7], v[80:83]
    ds_read_b64_tr_b16 a[152:153], v8 offset:37024
    ds_read_b64_tr_b16 a[154:155], v8 offset:41632
    v_mfma_f32_16x16x32_bf16 v[80:83], a[172:175], a[20:23], v[80:83]
    ds_read_b64_tr_b16 a[156:157], v9 offset:37024
    ds_read_b64_tr_b16 a[158:159], v9 offset:41632
    s_add_u32 s57, s39, 69632
    v_mfma_f32_16x16x32_bf16 v[116:119], a[168:171], a[8:11], v[116:119]
    buffer_load_dwordx4 a[80:83], v28, s[24:27], s57 offen offset:0
    v_mfma_f32_16x16x32_bf16 v[116:119], a[172:175], a[24:27], v[116:119]
    v_mfma_f32_16x16x32_bf16 v[152:155], a[168:171], a[12:15], v[152:155]
    v_mfma_f32_16x16x32_bf16 v[152:155], a[172:175], a[28:31], v[152:155]
    s_waitcnt lgkmcnt(4)
    v_mfma_f32_16x16x32_bf16 v[84:87], a[144:147], a[4:7], v[84:87]
    ds_read_b64_tr_b16 a[160:161], v8 offset:37056
    ds_read_b64_tr_b16 a[162:163], v8 offset:41664
    v_mfma_f32_16x16x32_bf16 v[84:87], a[148:151], a[20:23], v[84:87]
    ds_read_b64_tr_b16 a[164:165], v9 offset:37056
    ds_read_b64_tr_b16 a[166:167], v9 offset:41664
    v_mfma_f32_16x16x32_bf16 v[120:123], a[144:147], a[8:11], v[120:123]
    buffer_load_dwordx4 a[84:87], v29, s[24:27], s57 offen offset:1024
    v_mfma_f32_16x16x32_bf16 v[120:123], a[148:151], a[24:27], v[120:123]
    v_mfma_f32_16x16x32_bf16 v[156:159], a[144:147], a[12:15], v[156:159]
    v_mfma_f32_16x16x32_bf16 v[156:159], a[148:151], a[28:31], v[156:159]
    s_waitcnt lgkmcnt(4)
    v_mfma_f32_16x16x32_bf16 v[88:91], a[152:155], a[4:7], v[88:91]
    ds_read_b64_tr_b16 a[168:169], v8 offset:37088
    ds_read_b64_tr_b16 a[170:171], v8 offset:41696
    v_mfma_f32_16x16x32_bf16 v[88:91], a[156:159], a[20:23], v[88:91]
    ds_read_b64_tr_b16 a[172:173], v9 offset:37088
    ds_read_b64_tr_b16 a[174:175], v9 offset:41696
    v_mfma_f32_16x16x32_bf16 v[124:127], a[152:155], a[8:11], v[124:127]
    buffer_load_dwordx4 a[88:91], v30, s[24:27], s57 offen offset:2048
    v_mfma_f32_16x16x32_bf16 v[124:127], a[156:159], a[24:27], v[124:127]
    v_mfma_f32_16x16x32_bf16 a[128:131], a[152:155], a[12:15], a[128:131]
    buffer_load_dwordx4 a[92:95], v31, s[24:27], s57 offen offset:3072
    v_mfma_f32_16x16x32_bf16 a[128:131], a[156:159], a[28:31], a[128:131]
    s_waitcnt lgkmcnt(4)
    v_mfma_f32_16x16x32_bf16 v[92:95], a[160:163], a[4:7], v[92:95]
    ds_read_b64_tr_b16 a[144:145], v8 offset:37120
    ds_read_b64_tr_b16 a[146:147], v8 offset:41728
    v_mfma_f32_16x16x32_bf16 v[92:95], a[164:167], a[20:23], v[92:95]
    ds_read_b64_tr_b16 a[148:149], v9 offset:37120
    ds_read_b64_tr_b16 a[150:151], v9 offset:41728
    v_mfma_f32_16x16x32_bf16 v[128:131], a[160:163], a[8:11], v[128:131]
    s_add_u32 s58, s39, 73728
    v_mfma_f32_16x16x32_bf16 v[128:131], a[164:167], a[24:27], v[128:131]
    buffer_load_dwordx4 a[96:99], v28, s[24:27], s58 offen offset:0
    v_mfma_f32_16x16x32_bf16 a[132:135], a[160:163], a[12:15], a[132:135]
    v_mfma_f32_16x16x32_bf16 a[132:135], a[164:167], a[28:31], a[132:135]
    s_waitcnt lgkmcnt(4)
    v_mfma_f32_16x16x32_bf16 v[96:99], a[168:171], a[4:7], v[96:99]
    ds_read_b64_tr_b16 a[152:153], v9 offset:46080
    ds_read_b64_tr_b16 a[154:155], v9 offset:50688
    v_mfma_f32_16x16x32_bf16 v[96:99], a[172:175], a[20:23], v[96:99]
    ds_read_b64_tr_b16 a[156:157], v9 offset:55296
    ds_read_b64_tr_b16 a[158:159], v9 offset:59904
    v_mfma_f32_16x16x32_bf16 v[132:135], a[168:171], a[8:11], v[132:135]
    buffer_load_dwordx4 a[100:103], v29, s[24:27], s58 offen offset:1024
    v_mfma_f32_16x16x32_bf16 v[132:135], a[172:175], a[24:27], v[132:135]
    v_mfma_f32_16x16x32_bf16 a[136:139], a[168:171], a[12:15], a[136:139]
    v_mfma_f32_16x16x32_bf16 a[136:139], a[172:175], a[28:31], a[136:139]
    s_waitcnt lgkmcnt(4)
    v_mfma_f32_16x16x32_bf16 v[100:103], a[144:147], a[4:7], v[100:103]
    ds_read_b64_tr_b16 a[160:161], v9 offset:46112
    ds_read_b64_tr_b16 a[162:163], v9 offset:50720
    v_mfma_f32_16x16x32_bf16 v[100:103], a[148:151], a[20:23], v[100:103]
    ds_read_b64_tr_b16 a[164:165], v9 offset:55328
    ds_read_b64_tr_b16 a[166:167], v9 offset:59936
    v_mfma_f32_16x16x32_bf16 v[136:139], a[144:147], a[8:11], v[136:139]
    buffer_load_dwordx4 a[104:107], v30, s[24:27], s58 offen offset:2048
    v_mfma_f32_16x16x32_bf16 v[136:139], a[148:151], a[24:27], v[136:139]
    v_mfma_f32_16x16x32_bf16 a[140:143], a[144:147], a[12:15], a[140:143]
    v_mfma_f32_16x16x32_bf16 a[140:143], a[148:151], a[28:31], a[140:143]
    buffer_load_dwordx4 a[108:111], v31, s[24:27], s58 offen offset:3072
    s_waitcnt vmcnt(21) lgkmcnt(4)
    v_mfma_f32_16x16x32_bf16 v[68:71], a[152:155], a[36:39], v[68:71]
    ds_read_b64_tr_b16 a[168:169], v9 offset:46144
    ds_read_b64_tr_b16 a[170:171], v9 offset:50752
    v_mfma_f32_16x16x32_bf16 v[68:71], a[156:159], a[52:55], v[68:71]
    ds_read_b64_tr_b16 a[172:173], v9 offset:55360
    ds_read_b64_tr_b16 a[174:175], v9 offset:59968
    v_mfma_f32_16x16x32_bf16 v[104:107], a[152:155], a[40:43], v[104:107]
    v_mfma_f32_16x16x32_bf16 v[104:107], a[156:159], a[56:59], v[104:107]
    s_add_u32 s59, s39, 77824
    v_mfma_f32_16x16x32_bf16 v[140:143], a[152:155], a[44:47], v[140:143]
    buffer_load_dwordx4 a[112:115], v28, s[24:27], s59 offen offset:0
    v_mfma_f32_16x16x32_bf16 v[140:143], a[156:159], a[60:63], v[140:143]
    s_waitcnt lgkmcnt(4)
    v_mfma_f32_16x16x32_bf16 v[72:75], a[160:163], a[36:39], v[72:75]
    ds_read_b64_tr_b16 a[144:145], v9 offset:46176
    ds_read_b64_tr_b16 a[146:147], v9 offset:50784
    v_mfma_f32_16x16x32_bf16 v[72:75], a[164:167], a[52:55], v[72:75]
    ds_read_b64_tr_b16 a[148:149], v9 offset:55392
    ds_read_b64_tr_b16 a[150:151], v9 offset:60000
    v_mfma_f32_16x16x32_bf16 v[108:111], a[160:163], a[40:43], v[108:111]
    buffer_load_dwordx4 a[116:119], v29, s[24:27], s59 offen offset:1024
    v_mfma_f32_16x16x32_bf16 v[108:111], a[164:167], a[56:59], v[108:111]
    v_mfma_f32_16x16x32_bf16 v[144:147], a[160:163], a[44:47], v[144:147]
    v_mfma_f32_16x16x32_bf16 v[144:147], a[164:167], a[60:63], v[144:147]
    s_waitcnt lgkmcnt(4)
    v_mfma_f32_16x16x32_bf16 v[76:79], a[168:171], a[36:39], v[76:79]
    ds_read_b64_tr_b16 a[152:153], v9 offset:46208
    ds_read_b64_tr_b16 a[154:155], v9 offset:50816
    v_mfma_f32_16x16x32_bf16 v[76:79], a[172:175], a[52:55], v[76:79]
    ds_read_b64_tr_b16 a[156:157], v9 offset:55424
    ds_read_b64_tr_b16 a[158:159], v9 offset:60032
    v_mfma_f32_16x16x32_bf16 v[112:115], a[168:171], a[40:43], v[112:115]
    buffer_load_dwordx4 a[120:123], v30, s[24:27], s59 offen offset:2048
    v_mfma_f32_16x16x32_bf16 v[112:115], a[172:175], a[56:59], v[112:115]
    v_mfma_f32_16x16x32_bf16 v[148:151], a[168:171], a[44:47], v[148:151]
    v_mfma_f32_16x16x32_bf16 v[148:151], a[172:175], a[60:63], v[148:151]
    s_waitcnt lgkmcnt(4)
    v_mfma_f32_16x16x32_bf16 v[80:83], a[144:147], a[36:39], v[80:83]
    ds_read_b64_tr_b16 a[160:161], v9 offset:46240
    ds_read_b64_tr_b16 a[162:163], v9 offset:50848
    v_mfma_f32_16x16x32_bf16 v[80:83], a[148:151], a[52:55], v[80:83]
    ds_read_b64_tr_b16 a[164:165], v9 offset:55456
    ds_read_b64_tr_b16 a[166:167], v9 offset:60064
    v_mfma_f32_16x16x32_bf16 v[116:119], a[144:147], a[40:43], v[116:119]
    buffer_load_dwordx4 a[124:127], v31, s[24:27], s59 offen offset:3072
    v_mfma_f32_16x16x32_bf16 v[116:119], a[148:151], a[56:59], v[116:119]
    v_mfma_f32_16x16x32_bf16 v[152:155], a[144:147], a[44:47], v[152:155]
    v_mfma_f32_16x16x32_bf16 v[152:155], a[148:151], a[60:63], v[152:155]
    s_waitcnt lgkmcnt(4)
    v_mfma_f32_16x16x32_bf16 v[84:87], a[152:155], a[36:39], v[84:87]
    ds_read_b64_tr_b16 a[168:169], v9 offset:46272
    ds_read_b64_tr_b16 a[170:171], v9 offset:50880
    v_mfma_f32_16x16x32_bf16 v[84:87], a[156:159], a[52:55], v[84:87]
    ds_read_b64_tr_b16 a[172:173], v9 offset:55488
    ds_read_b64_tr_b16 a[174:175], v9 offset:60096
    v_mfma_f32_16x16x32_bf16 v[120:123], a[152:155], a[40:43], v[120:123]
    v_mfma_f32_16x16x32_bf16 v[120:123], a[156:159], a[56:59], v[120:123]
    v_mfma_f32_16x16x32_bf16 v[156:159], a[152:155], a[44:47], v[156:159]
    v_mfma_f32_16x16x32_bf16 v[156:159], a[156:159], a[60:63], v[156:159]
    s_waitcnt lgkmcnt(4)
    v_mfma_f32_16x16x32_bf16 v[88:91], a[160:163], a[36:39], v[88:91]
    ds_read_b64_tr_b16 a[144:145], v9 offset:46304
    ds_read_b64_tr_b16 a[146:147], v9 offset:50912
    v_mfma_f32_16x16x32_bf16 v[88:91], a[164:167], a[52:55], v[88:91]
    ds_read_b64_tr_b16 a[148:149], v9 offset:55520
    ds_read_b64_tr_b16 a[150:151], v9 offset:60128
    v_mfma_f32_16x16x32_bf16 v[124:127], a[160:163], a[40:43], v[124:127]
    v_mfma_f32_16x16x32_bf16 v[124:127], a[164:167], a[56:59], v[124:127]
    v_mfma_f32_16x16x32_bf16 a[128:131], a[160:163], a[44:47], a[128:131]
    v_mfma_f32_16x16x32_bf16 a[128:131], a[164:167], a[60:63], a[128:131]
    s_waitcnt lgkmcnt(4)
    v_mfma_f32_16x16x32_bf16 v[92:95], a[168:171], a[36:39], v[92:95]
    ds_read_b64_tr_b16 a[152:153], v9 offset:46336
    ds_read_b64_tr_b16 a[154:155], v9 offset:50944
    v_mfma_f32_16x16x32_bf16 v[92:95], a[172:175], a[52:55], v[92:95]
    ds_read_b64_tr_b16 a[156:157], v9 offset:55552
    ds_read_b64_tr_b16 a[158:159], v9 offset:60160
    v_mfma_f32_16x16x32_bf16 v[128:131], a[168:171], a[40:43], v[128:131]
    v_mfma_f32_16x16x32_bf16 v[128:131], a[172:175], a[56:59], v[128:131]
    v_mfma_f32_16x16x32_bf16 a[132:135], a[168:171], a[44:47], a[132:135]
    v_mfma_f32_16x16x32_bf16 a[132:135], a[172:175], a[60:63], a[132:135]
    s_waitcnt vmcnt(16) lgkmcnt(0)
    s_barrier
    v_mfma_f32_16x16x32_bf16 v[96:99], a[144:147], a[36:39], v[96:99]
    ds_read_b64_tr_b16 a[160:161], v10 offset:192
    ds_read_b64_tr_b16 a[162:163], v10 offset:4800
    v_mfma_f32_16x16x32_bf16 v[96:99], a[148:151], a[52:55], v[96:99]
    ds_read_b64_tr_b16 a[164:165], v10 offset:9408
    ds_read_b64_tr_b16 a[166:167], v10 offset:14016
    v_mfma_f32_16x16x32_bf16 v[132:135], a[144:147], a[40:43], v[132:135]
    v_mfma_f32_16x16x32_bf16 v[132:135], a[148:151], a[56:59], v[132:135]
    v_mfma_f32_16x16x32_bf16 a[136:139], a[144:147], a[44:47], a[136:139]
    v_mfma_f32_16x16x32_bf16 a[136:139], a[148:151], a[60:63], a[136:139]
    v_mfma_f32_16x16x32_bf16 v[100:103], a[152:155], a[36:39], v[100:103]
    ds_read_b64_tr_b16 a[168:169], v10 offset:18624
    ds_read_b64_tr_b16 a[170:171], v10 offset:23232
    v_mfma_f32_16x16x32_bf16 v[100:103], a[156:159], a[52:55], v[100:103]
    ds_read_b64_tr_b16 a[172:173], v10 offset:27840
    ds_read_b64_tr_b16 a[174:175], v10 offset:32448
    v_mfma_f32_16x16x32_bf16 v[136:139], a[152:155], a[40:43], v[136:139]
    v_mfma_f32_16x16x32_bf16 v[136:139], a[156:159], a[56:59], v[136:139]
    v_mfma_f32_16x16x32_bf16 a[140:143], a[152:155], a[44:47], a[140:143]
    v_mfma_f32_16x16x32_bf16 a[140:143], a[156:159], a[60:63], a[140:143]
    s_waitcnt vmcnt(0) lgkmcnt(4)
    v_mfma_f32_16x16x32_bf16 v[92:95], a[160:163], a[68:71], v[92:95]
    ds_read_b64_tr_b16 a[144:145], v10 offset:224
    ds_read_b64_tr_b16 a[146:147], v10 offset:4832
    v_mfma_f32_16x16x32_bf16 v[92:95], a[164:167], a[84:87], v[92:95]
    ds_read_b64_tr_b16 a[148:149], v10 offset:9440
    ds_read_b64_tr_b16 a[150:151], v10 offset:14048
    v_mfma_f32_16x16x32_bf16 v[128:131], a[160:163], a[72:75], v[128:131]
    v_mfma_f32_16x16x32_bf16 v[128:131], a[164:167], a[88:91], v[128:131]
    v_mfma_f32_16x16x32_bf16 a[132:135], a[160:163], a[76:79], a[132:135]
    v_mfma_f32_16x16x32_bf16 a[132:135], a[164:167], a[92:95], a[132:135]
    s_waitcnt lgkmcnt(4)
    v_mfma_f32_16x16x32_bf16 v[92:95], a[168:171], a[100:103], v[92:95]
    ds_read_b64_tr_b16 a[152:153], v10 offset:18656
    ds_read_b64_tr_b16 a[154:155], v10 offset:23264
    v_mfma_f32_16x16x32_bf16 v[92:95], a[172:175], a[116:119], v[92:95]
    ds_read_b64_tr_b16 a[156:157], v10 offset:27872
    ds_read_b64_tr_b16 a[158:159], v10 offset:32480
    v_mfma_f32_16x16x32_bf16 v[128:131], a[168:171], a[104:107], v[128:131]
    v_mfma_f32_16x16x32_bf16 v[128:131], a[172:175], a[120:123], v[128:131]
    v_mfma_f32_16x16x32_bf16 a[132:135], a[168:171], a[108:111], a[132:135]
    v_mfma_f32_16x16x32_bf16 a[132:135], a[172:175], a[124:127], a[132:135]
    s_waitcnt lgkmcnt(4)
    v_mfma_f32_16x16x32_bf16 v[96:99], a[144:147], a[68:71], v[96:99]
    ds_read_b64_tr_b16 a[160:161], v10 offset:128
    ds_read_b64_tr_b16 a[162:163], v10 offset:4736
    v_mfma_f32_16x16x32_bf16 v[96:99], a[148:151], a[84:87], v[96:99]
    ds_read_b64_tr_b16 a[164:165], v10 offset:9344
    ds_read_b64_tr_b16 a[166:167], v10 offset:13952
    v_mfma_f32_16x16x32_bf16 v[132:135], a[144:147], a[72:75], v[132:135]
    v_mfma_f32_16x16x32_bf16 v[132:135], a[148:151], a[88:91], v[132:135]
    v_mfma_f32_16x16x32_bf16 a[136:139], a[144:147], a[76:79], a[136:139]
    v_mfma_f32_16x16x32_bf16 a[136:139], a[148:151], a[92:95], a[136:139]
    s_waitcnt lgkmcnt(4)
    v_mfma_f32_16x16x32_bf16 v[96:99], a[152:155], a[100:103], v[96:99]
    ds_read_b64_tr_b16 a[168:169], v10 offset:18560
    ds_read_b64_tr_b16 a[170:171], v10 offset:23168
    v_mfma_f32_16x16x32_bf16 v[96:99], a[156:159], a[116:119], v[96:99]
    ds_read_b64_tr_b16 a[172:173], v10 offset:27776
    ds_read_b64_tr_b16 a[174:175], v10 offset:32384
    v_mfma_f32_16x16x32_bf16 v[132:135], a[152:155], a[104:107], v[132:135]
    v_mfma_f32_16x16x32_bf16 v[132:135], a[156:159], a[120:123], v[132:135]
    v_mfma_f32_16x16x32_bf16 a[136:139], a[152:155], a[108:111], a[136:139]
    v_mfma_f32_16x16x32_bf16 a[136:139], a[156:159], a[124:127], a[136:139]
    s_waitcnt lgkmcnt(4)
    v_mfma_f32_16x16x32_bf16 v[84:87], a[160:163], a[68:71], v[84:87]
    ds_read_b64_tr_b16 a[144:145], v10 offset:160
    ds_read_b64_tr_b16 a[146:147], v10 offset:4768
    v_mfma_f32_16x16x32_bf16 v[84:87], a[164:167], a[84:87], v[84:87]
    ds_read_b64_tr_b16 a[148:149], v10 offset:9376
    ds_read_b64_tr_b16 a[150:151], v10 offset:13984
    v_mfma_f32_16x16x32_bf16 v[120:123], a[160:163], a[72:75], v[120:123]
    v_cvt_pk_bf16_f32 v92, v92, v93
    v_cvt_pk_bf16_f32 v93, v94, v95
    v_mfma_f32_16x16x32_bf16 v[120:123], a[164:167], a[88:91], v[120:123]
    v_cvt_pk_bf16_f32 v94, v96, v97
    v_cvt_pk_bf16_f32 v95, v98, v99
    v_mfma_f32_16x16x32_bf16 v[156:159], a[160:163], a[76:79], v[156:159]
    s_cmp_eq_u32 s88, 1
    s_cselect_b64 exec, 0, -1
    buffer_store_dwordx4 v[92:95], v12, s[64:67], s44 offen offset:3072 sc1
    s_mov_b64 exec, -1
    v_mfma_f32_16x16x32_bf16 v[156:159], a[164:167], a[92:95], v[156:159]
    v_cvt_pk_bf16_f32 v128, v128, v129
    v_cvt_pk_bf16_f32 v129, v130, v131
    s_waitcnt lgkmcnt(4)
    v_mfma_f32_16x16x32_bf16 v[84:87], a[168:171], a[100:103], v[84:87]
    ds_read_b64_tr_b16 a[152:153], v10 offset:18592
    ds_read_b64_tr_b16 a[154:155], v10 offset:23200
    v_mfma_f32_16x16x32_bf16 v[84:87], a[172:175], a[116:119], v[84:87]
    ds_read_b64_tr_b16 a[156:157], v10 offset:27808
    ds_read_b64_tr_b16 a[158:159], v10 offset:32416
    v_mfma_f32_16x16x32_bf16 v[120:123], a[168:171], a[104:107], v[120:123]
    v_cvt_pk_bf16_f32 v130, v132, v133
    v_cvt_pk_bf16_f32 v131, v134, v135
    v_mfma_f32_16x16x32_bf16 v[120:123], a[172:175], a[120:123], v[120:123]
    s_cmp_eq_u32 s88, 2
    s_cselect_b64 exec, 0, -1
    buffer_store_dwordx4 v[128:131], v12, s[64:67], s45 offen offset:3072 sc1
    s_mov_b64 exec, -1
    v_mfma_f32_16x16x32_bf16 v[156:159], a[168:171], a[108:111], v[156:159]
    v_accvgpr_read_b32 v228, a132
    v_accvgpr_read_b32 v229, a133
    v_mfma_f32_16x16x32_bf16 v[156:159], a[172:175], a[124:127], v[156:159]
    v_accvgpr_read_b32 v230, a134
    v_accvgpr_read_b32 v231, a135
    s_waitcnt lgkmcnt(4)
    v_mfma_f32_16x16x32_bf16 v[88:91], a[144:147], a[68:71], v[88:91]
    ds_read_b64_tr_b16 a[160:161], v10 offset:64
    ds_read_b64_tr_b16 a[162:163], v10 offset:4672
    v_mfma_f32_16x16x32_bf16 v[88:91], a[148:151], a[84:87], v[88:91]
    ds_read_b64_tr_b16 a[164:165], v10 offset:9280
    ds_read_b64_tr_b16 a[166:167], v10 offset:13888
    v_mfma_f32_16x16x32_bf16 v[124:127], a[144:147], a[72:75], v[124:127]
    v_accvgpr_read_b32 v232, a136
    v_accvgpr_read_b32 v233, a137
    v_mfma_f32_16x16x32_bf16 v[124:127], a[148:151], a[88:91], v[124:127]
    v_accvgpr_read_b32 v234, a138
    v_accvgpr_read_b32 v235, a139
    v_mfma_f32_16x16x32_bf16 a[128:131], a[144:147], a[76:79], a[128:131]
    v_cvt_pk_bf16_f32 v228, v228, v229
    v_cvt_pk_bf16_f32 v229, v230, v231
    v_mfma_f32_16x16x32_bf16 a[128:131], a[148:151], a[92:95], a[128:131]
    v_cvt_pk_bf16_f32 v230, v232, v233
    v_cvt_pk_bf16_f32 v231, v234, v235
    s_waitcnt lgkmcnt(4)
    v_mfma_f32_16x16x32_bf16 v[88:91], a[152:155], a[100:103], v[88:91]
    ds_read_b64_tr_b16 a[168:169], v10 offset:18496
    ds_read_b64_tr_b16 a[170:171], v10 offset:23104
    v_mfma_f32_16x16x32_bf16 v[88:91], a[156:159], a[116:119], v[88:91]
    ds_read_b64_tr_b16 a[172:173], v10 offset:27712
    ds_read_b64_tr_b16 a[174:175], v10 offset:32320
    v_mfma_f32_16x16x32_bf16 v[124:127], a[152:155], a[104:107], v[124:127]
    s_cmp_eq_u32 s88, 3
    s_cselect_b64 exec, 0, -1
    buffer_store_dwordx4 v[228:231], v12, s[64:67], s46 offen offset:3072 sc1
    s_mov_b64 exec, -1
    v_mfma_f32_16x16x32_bf16 v[124:127], a[156:159], a[120:123], v[124:127]
    v_mfma_f32_16x16x32_bf16 a[128:131], a[152:155], a[108:111], a[128:131]
    v_mfma_f32_16x16x32_bf16 a[128:131], a[156:159], a[124:127], a[128:131]
    s_waitcnt lgkmcnt(4)
    v_mfma_f32_16x16x32_bf16 v[76:79], a[160:163], a[68:71], v[76:79]
    ds_read_b64_tr_b16 a[144:145], v10 offset:96
    ds_read_b64_tr_b16 a[146:147], v10 offset:4704
    v_mfma_f32_16x16x32_bf16 v[76:79], a[164:167], a[84:87], v[76:79]
    ds_read_b64_tr_b16 a[148:149], v10 offset:9312
    ds_read_b64_tr_b16 a[150:151], v10 offset:13920
    v_mfma_f32_16x16x32_bf16 v[112:115], a[160:163], a[72:75], v[112:115]
    v_cvt_pk_bf16_f32 v84, v84, v85
    v_cvt_pk_bf16_f32 v85, v86, v87
    v_mfma_f32_16x16x32_bf16 v[112:115], a[164:167], a[88:91], v[112:115]
    v_cvt_pk_bf16_f32 v86, v88, v89
    v_cvt_pk_bf16_f32 v87, v90, v91
    v_mfma_f32_16x16x32_bf16 v[148:151], a[160:163], a[76:79], v[148:151]
    s_cmp_eq_u32 s88, 1
    s_cselect_b64 exec, 0, -1
    buffer_store_dwordx4 v[84:87], v12, s[64:67], s44 offen offset:2048 sc1
    s_mov_b64 exec, -1
    v_mfma_f32_16x16x32_bf16 v[148:151], a[164:167], a[92:95], v[148:151]
    v_cvt_pk_bf16_f32 v120, v120, v121
    v_cvt_pk_bf16_f32 v121, v122, v123
    s_waitcnt lgkmcnt(4)
    v_mfma_f32_16x16x32_bf16 v[76:79], a[168:171], a[100:103], v[76:79]
    ds_read_b64_tr_b16 a[152:153], v10 offset:18528
    ds_read_b64_tr_b16 a[154:155], v10 offset:23136
    v_mfma_f32_16x16x32_bf16 v[76:79], a[172:175], a[116:119], v[76:79]
    ds_read_b64_tr_b16 a[156:157], v10 offset:27744
    ds_read_b64_tr_b16 a[158:159], v10 offset:32352
    v_mfma_f32_16x16x32_bf16 v[112:115], a[168:171], a[104:107], v[112:115]
    v_cvt_pk_bf16_f32 v122, v124, v125
    v_cvt_pk_bf16_f32 v123, v126, v127
    v_mfma_f32_16x16x32_bf16 v[112:115], a[172:175], a[120:123], v[112:115]
    s_cmp_eq_u32 s88, 2
    s_cselect_b64 exec, 0, -1
    buffer_store_dwordx4 v[120:123], v12, s[64:67], s45 offen offset:2048 sc1
    s_mov_b64 exec, -1
    v_mfma_f32_16x16x32_bf16 v[148:151], a[168:171], a[108:111], v[148:151]
    v_accvgpr_read_b32 v224, a128
    v_accvgpr_read_b32 v225, a129
    v_mfma_f32_16x16x32_bf16 v[148:151], a[172:175], a[124:127], v[148:151]
    v_accvgpr_read_b32 v226, a130
    v_accvgpr_read_b32 v227, a131
    s_waitcnt lgkmcnt(4)
    v_mfma_f32_16x16x32_bf16 v[80:83], a[144:147], a[68:71], v[80:83]
    ds_read_b64_tr_b16 a[160:161], v10 offset:256
    ds_read_b64_tr_b16 a[162:163], v10 offset:4864
    v_mfma_f32_16x16x32_bf16 v[80:83], a[148:151], a[84:87], v[80:83]
    ds_read_b64_tr_b16 a[164:165], v10 offset:9472
    ds_read_b64_tr_b16 a[166:167], v10 offset:14080
    v_mfma_f32_16x16x32_bf16 v[116:119], a[144:147], a[72:75], v[116:119]
    v_cvt_pk_bf16_f32 v156, v156, v157
    v_cvt_pk_bf16_f32 v157, v158, v159
    v_mfma_f32_16x16x32_bf16 v[116:119], a[148:151], a[88:91], v[116:119]
    v_cvt_pk_bf16_f32 v158, v224, v225
    v_cvt_pk_bf16_f32 v159, v226, v227
    v_mfma_f32_16x16x32_bf16 v[152:155], a[144:147], a[76:79], v[152:155]
    s_cmp_eq_u32 s88, 3
    s_cselect_b64 exec, 0, -1
    buffer_store_dwordx4 v[156:159], v12, s[64:67], s46 offen offset:2048 sc1
    s_mov_b64 exec, -1
    v_mfma_f32_16x16x32_bf16 v[152:155], a[148:151], a[92:95], v[152:155]
    s_waitcnt lgkmcnt(4)
    v_mfma_f32_16x16x32_bf16 v[80:83], a[152:155], a[100:103], v[80:83]
    ds_read_b64_tr_b16 a[168:169], v10 offset:18688
    ds_read_b64_tr_b16 a[170:171], v10 offset:23296
    v_mfma_f32_16x16x32_bf16 v[80:83], a[156:159], a[116:119], v[80:83]
    ds_read_b64_tr_b16 a[172:173], v10 offset:27904
    ds_read_b64_tr_b16 a[174:175], v10 offset:32512
    v_mfma_f32_16x16x32_bf16 v[116:119], a[152:155], a[104:107], v[116:119]
    v_mfma_f32_16x16x32_bf16 v[116:119], a[156:159], a[120:123], v[116:119]
    v_mfma_f32_16x16x32_bf16 v[152:155], a[152:155], a[108:111], v[152:155]
    buffer_load_dwordx4 v[2:5], off, s[68:71], s91 sc1
    v_mfma_f32_16x16x32_bf16 v[152:155], a[156:159], a[124:127], v[152:155]
    s_waitcnt lgkmcnt(4)
    v_mfma_f32_16x16x32_bf16 v[100:103], a[160:163], a[68:71], v[100:103]
    ds_read_b64_tr_b16 a[144:145], v10 offset:0
    ds_read_b64_tr_b16 a[146:147], v10 offset:4608
    v_mfma_f32_16x16x32_bf16 v[100:103], a[164:167], a[84:87], v[100:103]
    ds_read_b64_tr_b16 a[148:149], v10 offset:9216
    ds_read_b64_tr_b16 a[150:151], v10 offset:13824
    v_mfma_f32_16x16x32_bf16 v[136:139], a[160:163], a[72:75], v[136:139]
    v_cvt_pk_bf16_f32 v76, v76, v77
    v_cvt_pk_bf16_f32 v77, v78, v79
    v_mfma_f32_16x16x32_bf16 v[136:139], a[164:167], a[88:91], v[136:139]
    v_cvt_pk_bf16_f32 v78, v80, v81
    v_cvt_pk_bf16_f32 v79, v82, v83
    v_mfma_f32_16x16x32_bf16 a[140:143], a[160:163], a[76:79], a[140:143]
    s_cmp_eq_u32 s88, 1
    s_cselect_b64 exec, 0, -1
    buffer_store_dwordx4 v[76:79], v12, s[64:67], s44 offen offset:1024 sc1
    s_mov_b64 exec, -1
    v_mfma_f32_16x16x32_bf16 a[140:143], a[164:167], a[92:95], a[140:143]
    v_cvt_pk_bf16_f32 v112, v112, v113
    v_cvt_pk_bf16_f32 v113, v114, v115
    s_waitcnt lgkmcnt(4)
    v_mfma_f32_16x16x32_bf16 v[100:103], a[168:171], a[100:103], v[100:103]
    ds_read_b64_tr_b16 a[152:153], v10 offset:18432
    ds_read_b64_tr_b16 a[154:155], v10 offset:23040
    v_mfma_f32_16x16x32_bf16 v[100:103], a[172:175], a[116:119], v[100:103]
    ds_read_b64_tr_b16 a[156:157], v10 offset:27648
    ds_read_b64_tr_b16 a[158:159], v10 offset:32256
    v_mfma_f32_16x16x32_bf16 v[136:139], a[168:171], a[104:107], v[136:139]
    v_cvt_pk_bf16_f32 v114, v116, v117
    v_cvt_pk_bf16_f32 v115, v118, v119
    v_mfma_f32_16x16x32_bf16 v[136:139], a[172:175], a[120:123], v[136:139]
    s_cmp_eq_u32 s88, 2
    s_cselect_b64 exec, 0, -1
    buffer_store_dwordx4 v[112:115], v12, s[64:67], s45 offen offset:1024 sc1
    s_mov_b64 exec, -1
    v_mfma_f32_16x16x32_bf16 a[140:143], a[168:171], a[108:111], a[140:143]
    v_cvt_pk_bf16_f32 v148, v148, v149
    v_cvt_pk_bf16_f32 v149, v150, v151
    v_mfma_f32_16x16x32_bf16 a[140:143], a[172:175], a[124:127], a[140:143]
    v_cvt_pk_bf16_f32 v150, v152, v153
    v_cvt_pk_bf16_f32 v151, v154, v155
    s_waitcnt lgkmcnt(4)
    v_mfma_f32_16x16x32_bf16 v[68:71], a[144:147], a[68:71], v[68:71]
    ds_read_b64_tr_b16 a[160:161], v10 offset:32
    ds_read_b64_tr_b16 a[162:163], v10 offset:4640
    v_mfma_f32_16x16x32_bf16 v[68:71], a[148:151], a[84:87], v[68:71]
    ds_read_b64_tr_b16 a[164:165], v10 offset:9248
    ds_read_b64_tr_b16 a[166:167], v10 offset:13856
    v_mfma_f32_16x16x32_bf16 v[104:107], a[144:147], a[72:75], v[104:107]
    s_cmp_eq_u32 s88, 3
    s_cselect_b64 exec, 0, -1
    buffer_store_dwordx4 v[148:151], v12, s[64:67], s46 offen offset:1024 sc1
    s_mov_b64 exec, -1
    v_mfma_f32_16x16x32_bf16 v[104:107], a[148:151], a[88:91], v[104:107]
    v_cvt_pk_bf16_f32 v100, v100, v101
    v_cvt_pk_bf16_f32 v101, v102, v103
    v_mfma_f32_16x16x32_bf16 v[140:143], a[144:147], a[76:79], v[140:143]
    s_cmp_eq_u32 s88, 1
    s_cselect_b64 exec, 0, -1
    buffer_store_dwordx2 v[100:101], v13, s[64:67], s44 offen sc1
    s_mov_b64 exec, -1
    v_mfma_f32_16x16x32_bf16 v[140:143], a[148:151], a[92:95], v[140:143]
    v_cvt_pk_bf16_f32 v136, v136, v137
    v_cvt_pk_bf16_f32 v137, v138, v139
    s_waitcnt lgkmcnt(4)
    v_mfma_f32_16x16x32_bf16 v[68:71], a[152:155], a[100:103], v[68:71]
    ds_read_b64_tr_b16 a[168:169], v10 offset:18464
    ds_read_b64_tr_b16 a[170:171], v10 offset:23072
    v_mfma_f32_16x16x32_bf16 v[68:71], a[156:159], a[116:119], v[68:71]
    ds_read_b64_tr_b16 a[172:173], v10 offset:27680
    ds_read_b64_tr_b16 a[174:175], v10 offset:32288
    v_mfma_f32_16x16x32_bf16 v[104:107], a[152:155], a[104:107], v[104:107]
    s_cmp_eq_u32 s88, 2
    s_cselect_b64 exec, 0, -1
    buffer_store_dwordx2 v[136:137], v13, s[64:67], s45 offen sc1
    s_mov_b64 exec, -1
    v_mfma_f32_16x16x32_bf16 v[104:107], a[156:159], a[120:123], v[104:107]
    v_accvgpr_read_b32 v236, a140
    v_accvgpr_read_b32 v237, a141
    v_mfma_f32_16x16x32_bf16 v[140:143], a[152:155], a[108:111], v[140:143]
    v_accvgpr_read_b32 v238, a142
    v_accvgpr_read_b32 v239, a143
    v_mfma_f32_16x16x32_bf16 v[140:143], a[156:159], a[124:127], v[140:143]
    v_cvt_pk_bf16_f32 v236, v236, v237
    v_cvt_pk_bf16_f32 v237, v238, v239
    s_waitcnt lgkmcnt(4)
    v_mfma_f32_16x16x32_bf16 v[72:75], a[160:163], a[68:71], v[72:75]
    ds_read_b64_tr_b16 v[160:161], v9 offset:0
    ds_read_b64_tr_b16 v[162:163], v9 offset:4608
    v_mfma_f32_16x16x32_bf16 v[72:75], a[164:167], a[84:87], v[72:75]
    ds_read_b64_tr_b16 v[164:165], v9 offset:9216
    ds_read_b64_tr_b16 v[166:167], v9 offset:13824
    v_mfma_f32_16x16x32_bf16 v[108:111], a[160:163], a[72:75], v[108:111]
    ds_read_b64_tr_b16 v[168:169], v9 offset:18432
    ds_read_b64_tr_b16 v[170:171], v9 offset:23040
    v_mfma_f32_16x16x32_bf16 v[108:111], a[164:167], a[88:91], v[108:111]
    ds_read_b64_tr_b16 v[172:173], v9 offset:27648
    ds_read_b64_tr_b16 v[174:175], v9 offset:32256
    v_mfma_f32_16x16x32_bf16 v[144:147], a[160:163], a[76:79], v[144:147]
    s_cmp_eq_u32 s88, 3
    s_cselect_b64 exec, 0, -1
    buffer_store_dwordx2 v[236:237], v13, s[64:67], s46 offen sc1
    s_mov_b64 exec, -1
    v_mfma_f32_16x16x32_bf16 v[144:147], a[164:167], a[92:95], v[144:147]
    s_waitcnt lgkmcnt(8)
    v_mfma_f32_16x16x32_bf16 v[72:75], a[168:171], a[100:103], v[72:75]
    ds_read_b64_tr_b16 v[176:177], v8 offset:36864
    ds_read_b64_tr_b16 v[178:179], v8 offset:41472
    v_mfma_f32_16x16x32_bf16 v[72:75], a[172:175], a[116:119], v[72:75]
    ds_read_b64_tr_b16 v[180:181], v9 offset:36864
    ds_read_b64_tr_b16 v[182:183], v9 offset:41472
    v_mfma_f32_16x16x32_bf16 v[108:111], a[168:171], a[104:107], v[108:111]
    ds_read_b64_tr_b16 v[184:185], v9 offset:46080
    ds_read_b64_tr_b16 v[186:187], v9 offset:50688
    v_mfma_f32_16x16x32_bf16 v[108:111], a[172:175], a[120:123], v[108:111]
    ds_read_b64_tr_b16 v[188:189], v9 offset:55296
    ds_read_b64_tr_b16 v[190:191], v9 offset:59904
    v_mfma_f32_16x16x32_bf16 v[144:147], a[168:171], a[108:111], v[144:147]
    v_mfma_f32_16x16x32_bf16 v[144:147], a[172:175], a[124:127], v[144:147]
    s_waitcnt lgkmcnt(12)
    v_mfma_f32_16x16x32_bf16 v[32:35], v[160:163], v[240:243], v[32:35]
    ds_read_b64_tr_b16 v[192:193], v10 offset:0
    ds_read_b64_tr_b16 v[194:195], v10 offset:4608
    v_mfma_f32_16x16x32_bf16 v[32:35], v[164:167], v[244:247], v[32:35]
    ds_read_b64_tr_b16 v[196:197], v10 offset:9216
    ds_read_b64_tr_b16 v[198:199], v10 offset:13824
    s_waitcnt lgkmcnt(12)
    v_mfma_f32_16x16x32_bf16 v[32:35], v[168:171], v[248:251], v[32:35]
    ds_read_b64_tr_b16 v[200:201], v10 offset:18432
    ds_read_b64_tr_b16 v[202:203], v10 offset:23040
    v_cvt_pk_bf16_f32 v68, v68, v69
    v_cvt_pk_bf16_f32 v69, v70, v71
    v_cvt_pk_bf16_f32 v70, v72, v73
    v_cvt_pk_bf16_f32 v71, v74, v75
    s_cmp_eq_u32 s88, 1
    s_cselect_b64 exec, 0, -1
    buffer_store_dwordx4 v[68:71], v12, s[64:67], s44 offen offset:0 sc1
    s_mov_b64 exec, -1
    v_cvt_pk_bf16_f32 v104, v104, v105
    v_cvt_pk_bf16_f32 v105, v106, v107
    v_cvt_pk_bf16_f32 v106, v108, v109
    v_cvt_pk_bf16_f32 v107, v110, v111
    s_cmp_eq_u32 s88, 2
    s_cselect_b64 exec, 0, -1
    buffer_store_dwordx4 v[104:107], v12, s[64:67], s45 offen offset:0 sc1
    s_mov_b64 exec, -1
    v_mfma_f32_16x16x32_bf16 v[32:35], v[172:175], v[252:255], v[32:35]
    ds_read_b64_tr_b16 v[204:205], v10 offset:27648
    ds_read_b64_tr_b16 v[206:207], v10 offset:32256
    v_cvt_pk_bf16_f32 v140, v140, v141
    v_cvt_pk_bf16_f32 v141, v142, v143
    v_cvt_pk_bf16_f32 v142, v144, v145
    v_cvt_pk_bf16_f32 v143, v146, v147
    s_cmp_eq_u32 s88, 3
    s_cselect_b64 exec, 0, -1
    buffer_store_dwordx4 v[140:143], v12, s[64:67], s46 offen offset:0 sc1
    s_mov_b64 exec, -1
    s_cmp_eq_u32 s52, 0
    s_cselect_b32 s56, 1, 0
    s_cmp_eq_u32 s52, 1
    s_cselect_b32 s57, 1, 0
    s_cmp_eq_u32 s52, 2
    s_waitcnt lgkmcnt(12)
    v_mfma_f32_16x16x32_bf16 v[32:35], v[176:179], a[0:3], v[32:35]
    ds_read_b64_tr_b16 v[208:209], v9 offset:32
    ds_read_b64_tr_b16 v[210:211], v9 offset:4640
    s_cselect_b32 s58, 1, 0
    s_cmp_eq_u32 s52, 3
    s_cselect_b32 s59, 1, 0
    v_mfma_f32_16x16x32_bf16 v[32:35], v[180:183], a[16:19], v[32:35]
    ds_read_b64_tr_b16 v[212:213], v9 offset:9248
    ds_read_b64_tr_b16 v[214:215], v9 offset:13856
    s_waitcnt lgkmcnt(12)
    v_mfma_f32_16x16x32_bf16 v[32:35], v[184:187], a[32:35], v[32:35]
    ds_read_b64_tr_b16 v[216:217], v9 offset:18464
    ds_read_b64_tr_b16 v[218:219], v9 offset:23072
    v_mfma_f32_16x16x32_bf16 v[32:35], v[188:191], a[48:51], v[32:35]
    ds_read_b64_tr_b16 v[220:221], v9 offset:27680
    ds_read_b64_tr_b16 v[222:223], v9 offset:32288
    s_waitcnt lgkmcnt(12)
    v_mfma_f32_16x16x32_bf16 v[32:35], v[192:195], a[64:67], v[32:35]
    ds_read_b64_tr_b16 v[160:161], v8 offset:36896
    ds_read_b64_tr_b16 v[162:163], v8 offset:41504
    v_mfma_f32_16x16x32_bf16 v[32:35], v[196:199], a[80:83], v[32:35]
    ds_read_b64_tr_b16 v[164:165], v9 offset:36896
    ds_read_b64_tr_b16 v[166:167], v9 offset:41504
    s_waitcnt lgkmcnt(12)
    v_mfma_f32_16x16x32_bf16 v[32:35], v[200:203], a[96:99], v[32:35]
    ds_read_b64_tr_b16 v[168:169], v9 offset:46112
    ds_read_b64_tr_b16 v[170:171], v9 offset:50720
    v_mfma_f32_16x16x32_bf16 v[32:35], v[204:207], a[112:115], v[32:35]
    ds_read_b64_tr_b16 v[172:173], v9 offset:55328
    ds_read_b64_tr_b16 v[174:175], v9 offset:59936
    s_waitcnt lgkmcnt(12)
    v_mfma_f32_16x16x32_bf16 v[36:39], v[208:211], v[240:243], v[36:39]
    ds_read_b64_tr_b16 v[176:177], v10 offset:32
    ds_read_b64_tr_b16 v[178:179], v10 offset:4640
    v_mfma_f32_16x16x32_bf16 v[36:39], v[212:215], v[244:247], v[36:39]
    ds_read_b64_tr_b16 v[180:181], v10 offset:9248
    ds_read_b64_tr_b16 v[182:183], v10 offset:13856
    s_waitcnt lgkmcnt(12)
    v_mfma_f32_16x16x32_bf16 v[36:39], v[216:219], v[248:251], v[36:39]
    ds_read_b64_tr_b16 v[184:185], v10 offset:18464
    ds_read_b64_tr_b16 v[186:187], v10 offset:23072
    v_mfma_f32_16x16x32_bf16 v[36:39], v[220:223], v[252:255], v[36:39]
    ds_read_b64_tr_b16 v[188:189], v10 offset:27680
    ds_read_b64_tr_b16 v[190:191], v10 offset:32288
    s_waitcnt lgkmcnt(12)
    v_mfma_f32_16x16x32_bf16 v[36:39], v[160:163], a[0:3], v[36:39]
    ds_read_b64_tr_b16 v[192:193], v9 offset:64
    ds_read_b64_tr_b16 v[194:195], v9 offset:4672
    v_mfma_f32_16x16x32_bf16 v[36:39], v[164:167], a[16:19], v[36:39]
    ds_read_b64_tr_b16 v[196:197], v9 offset:9280
    ds_read_b64_tr_b16 v[198:199], v9 offset:13888
    s_waitcnt lgkmcnt(12)
    v_mfma_f32_16x16x32_bf16 v[36:39], v[168:171], a[32:35], v[36:39]
    ds_read_b64_tr_b16 v[200:201], v9 offset:18496
    ds_read_b64_tr_b16 v[202:203], v9 offset:23104
    v_mfma_f32_16x16x32_bf16 v[36:39], v[172:175], a[48:51], v[36:39]
    ds_read_b64_tr_b16 v[204:205], v9 offset:27712
    ds_read_b64_tr_b16 v[206:207], v9 offset:32320
    s_waitcnt lgkmcnt(12)
    v_mfma_f32_16x16x32_bf16 v[36:39], v[176:179], a[64:67], v[36:39]
    ds_read_b64_tr_b16 v[208:209], v8 offset:36928
    ds_read_b64_tr_b16 v[210:211], v8 offset:41536
    v_mfma_f32_16x16x32_bf16 v[36:39], v[180:183], a[80:83], v[36:39]
    ds_read_b64_tr_b16 v[212:213], v9 offset:36928
    ds_read_b64_tr_b16 v[214:215], v9 offset:41536
    s_waitcnt lgkmcnt(12)
    v_mfma_f32_16x16x32_bf16 v[36:39], v[184:187], a[96:99], v[36:39]
    ds_read_b64_tr_b16 v[216:217], v9 offset:46144
    ds_read_b64_tr_b16 v[218:219], v9 offset:50752
    v_mfma_f32_16x16x32_bf16 v[36:39], v[188:191], a[112:115], v[36:39]
    ds_read_b64_tr_b16 v[220:221], v9 offset:55360
    ds_read_b64_tr_b16 v[222:223], v9 offset:59968
    s_waitcnt lgkmcnt(12)
    v_mfma_f32_16x16x32_bf16 v[40:43], v[192:195], v[240:243], v[40:43]
    ds_read_b64_tr_b16 v[160:161], v10 offset:64
    ds_read_b64_tr_b16 v[162:163], v10 offset:4672
    v_mfma_f32_16x16x32_bf16 v[40:43], v[196:199], v[244:247], v[40:43]
    ds_read_b64_tr_b16 v[164:165], v10 offset:9280
    ds_read_b64_tr_b16 v[166:167], v10 offset:13888
    s_waitcnt lgkmcnt(12)
    v_mfma_f32_16x16x32_bf16 v[40:43], v[200:203], v[248:251], v[40:43]
    ds_read_b64_tr_b16 v[168:169], v10 offset:18496
    ds_read_b64_tr_b16 v[170:171], v10 offset:23104
    v_mfma_f32_16x16x32_bf16 v[40:43], v[204:207], v[252:255], v[40:43]
    ds_read_b64_tr_b16 v[172:173], v10 offset:27712
    ds_read_b64_tr_b16 v[174:175], v10 offset:32320
    s_waitcnt lgkmcnt(12)
    v_mfma_f32_16x16x32_bf16 v[40:43], v[208:211], a[0:3], v[40:43]
    ds_read_b64_tr_b16 v[176:177], v9 offset:96
    ds_read_b64_tr_b16 v[178:179], v9 offset:4704
    v_mfma_f32_16x16x32_bf16 v[40:43], v[212:215], a[16:19], v[40:43]
    ds_read_b64_tr_b16 v[180:181], v9 offset:9312
    ds_read_b64_tr_b16 v[182:183], v9 offset:13920
    s_waitcnt lgkmcnt(12)
    v_mfma_f32_16x16x32_bf16 v[40:43], v[216:219], a[32:35], v[40:43]
    ds_read_b64_tr_b16 v[184:185], v9 offset:18528
    ds_read_b64_tr_b16 v[186:187], v9 offset:23136
    v_mfma_f32_16x16x32_bf16 v[40:43], v[220:223], a[48:51], v[40:43]
    ds_read_b64_tr_b16 v[188:189], v9 offset:27744
    ds_read_b64_tr_b16 v[190:191], v9 offset:32352
    s_waitcnt lgkmcnt(12)
    v_mfma_f32_16x16x32_bf16 v[40:43], v[160:163], a[64:67], v[40:43]
    ds_read_b64_tr_b16 v[192:193], v8 offset:36960
    ds_read_b64_tr_b16 v[194:195], v8 offset:41568
    v_mfma_f32_16x16x32_bf16 v[40:43], v[164:167], a[80:83], v[40:43]
    ds_read_b64_tr_b16 v[196:197], v9 offset:36960
    ds_read_b64_tr_b16 v[198:199], v9 offset:41568
    s_waitcnt lgkmcnt(12)
    v_mfma_f32_16x16x32_bf16 v[40:43], v[168:171], a[96:99], v[40:43]
    ds_read_b64_tr_b16 v[200:201], v9 offset:46176
    ds_read_b64_tr_b16 v[202:203], v9 offset:50784
    v_mfma_f32_16x16x32_bf16 v[40:43], v[172:175], a[112:115], v[40:43]
    ds_read_b64_tr_b16 v[204:205], v9 offset:55392
    ds_read_b64_tr_b16 v[206:207], v9 offset:60000
    s_waitcnt lgkmcnt(12)
    v_mfma_f32_16x16x32_bf16 v[44:47], v[176:179], v[240:243], v[44:47]
    ds_read_b64_tr_b16 v[208:209], v10 offset:96
    ds_read_b64_tr_b16 v[210:211], v10 offset:4704
    v_mfma_f32_16x16x32_bf16 v[44:47], v[180:183], v[244:247], v[44:47]
    ds_read_b64_tr_b16 v[212:213], v10 offset:9312
    ds_read_b64_tr_b16 v[214:215], v10 offset:13920
    s_waitcnt lgkmcnt(12)
    v_mfma_f32_16x16x32_bf16 v[44:47], v[184:187], v[248:251], v[44:47]
    ds_read_b64_tr_b16 v[216:217], v10 offset:18528
    ds_read_b64_tr_b16 v[218:219], v10 offset:23136
    v_mfma_f32_16x16x32_bf16 v[44:47], v[188:191], v[252:255], v[44:47]
    ds_read_b64_tr_b16 v[220:221], v10 offset:27744
    ds_read_b64_tr_b16 v[222:223], v10 offset:32352
    s_waitcnt lgkmcnt(12)
    v_mfma_f32_16x16x32_bf16 v[44:47], v[192:195], a[0:3], v[44:47]
    ds_read_b64_tr_b16 v[160:161], v9 offset:128
    ds_read_b64_tr_b16 v[162:163], v9 offset:4736
    v_mfma_f32_16x16x32_bf16 v[44:47], v[196:199], a[16:19], v[44:47]
    ds_read_b64_tr_b16 v[164:165], v9 offset:9344
    ds_read_b64_tr_b16 v[166:167], v9 offset:13952
    s_waitcnt lgkmcnt(12)
    v_mfma_f32_16x16x32_bf16 v[44:47], v[200:203], a[32:35], v[44:47]
    ds_read_b64_tr_b16 v[168:169], v9 offset:18560
    ds_read_b64_tr_b16 v[170:171], v9 offset:23168
    v_mfma_f32_16x16x32_bf16 v[44:47], v[204:207], a[48:51], v[44:47]
    ds_read_b64_tr_b16 v[172:173], v9 offset:27776
    ds_read_b64_tr_b16 v[174:175], v9 offset:32384
    s_waitcnt lgkmcnt(12)
    v_mov_b32 v6, 1
    s_cmp_eq_u32 s88, 0
    s_cselect_b32 s3, 2147483648, 0
    v_or_b32 v12, s3, v12
    v_or_b32 v13, s3, v13
    s_waitcnt vmcnt(0)
    buffer_store_dword v6, v11, s[68:71], 0 offen sc1
    v_max_u32 v2, s56, v2
    v_max_u32 v3, s57, v3
    v_max_u32 v4, s58, v4
    v_max_u32 v5, s59, v5
    v_min3_u32 v2, v2, v3, v4
    v_min_u32 v2, v2, v5
    s_nop 0
    v_readfirstlane_b32 s60, v2
    s_cmp_ge_u32 s60, 1
    s_cbranch_scc0 L_later
    buffer_load_dwordx4 v[68:71], v12, s[64:67], s61 offen offset:0 sc1
    buffer_load_dwordx4 v[72:75], v12, s[64:67], s62 offen offset:0 sc1
    buffer_load_dwordx4 v[76:79], v12, s[64:67], s63 offen offset:0 sc1
    buffer_load_dwordx4 v[80:83], v12, s[64:67], s61 offen offset:1024 sc1
    buffer_load_dwordx4 v[84:87], v12, s[64:67], s62 offen offset:1024 sc1
    buffer_load_dwordx4 v[88:91], v12, s[64:67], s63 offen offset:1024 sc1
    buffer_load_dwordx4 v[92:95], v12, s[64:67], s61 offen offset:2048 sc1
    buffer_load_dwordx4 v[96:99], v12, s[64:67], s62 offen offset:2048 sc1
    buffer_load_dwordx4 v[100:103], v12, s[64:67], s63 offen offset:2048 sc1
    buffer_load_dwordx4 v[104:107], v12, s[64:67], s61 offen offset:3072 sc1
    buffer_load_dwordx4 v[108:111], v12, s[64:67], s62 offen offset:3072 sc1
    buffer_load_dwordx4 v[112:115], v12, s[64:67], s63 offen offset:3072 sc1
    buffer_load_dwordx2 v[116:117], v13, s[64:67], s61 offen sc1
    buffer_load_dwordx2 v[120:121], v13, s[64:67], s62 offen sc1
    buffer_load_dwordx2 v[124:125], v13, s[64:67], s63 offen sc1
L_later:
    v_mfma_f32_16x16x32_bf16 v[44:47], v[208:211], a[64:67], v[44:47]
    ds_read_b64_tr_b16 v[176:177], v8 offset:36992
    ds_read_b64_tr_b16 v[178:179], v8 offset:41600
    v_mfma_f32_16x16x32_bf16 v[44:47], v[212:215], a[80:83], v[44:47]
    ds_read_b64_tr_b16 v[180:181], v9 offset:36992
    ds_read_b64_tr_b16 v[182:183], v9 offset:41600
    s_waitcnt lgkmcnt(12)
    v_mfma_f32_16x16x32_bf16 v[44:47], v[216:219], a[96:99], v[44:47]
    ds_read_b64_tr_b16 v[184:185], v9 offset:46208
    ds_read_b64_tr_b16 v[186:187], v9 offset:50816
    v_mfma_f32_16x16x32_bf16 v[44:47], v[220:223], a[112:115], v[44:47]
    ds_read_b64_tr_b16 v[188:189], v9 offset:55424
    ds_read_b64_tr_b16 v[190:191], v9 offset:60032
    s_waitcnt lgkmcnt(12)
    v_mfma_f32_16x16x32_bf16 v[48:51], v[160:163], v[240:243], v[48:51]
    ds_read_b64_tr_b16 v[192:193], v10 offset:128
    ds_read_b64_tr_b16 v[194:195], v10 offset:4736
    v_mfma_f32_16x16x32_bf16 v[48:51], v[164:167], v[244:247], v[48:51]
    ds_read_b64_tr_b16 v[196:197], v10 offset:9344
    ds_read_b64_tr_b16 v[198:199], v10 offset:13952
    s_waitcnt lgkmcnt(12)
    v_mfma_f32_16x16x32_bf16 v[48:51], v[168:171], v[248:251], v[48:51]
    ds_read_b64_tr_b16 v[200:201], v10 offset:18560
    ds_read_b64_tr_b16 v[202:203], v10 offset:23168
    v_mfma_f32_16x16x32_bf16 v[48:51], v[172:175], v[252:255], v[48:51]
    ds_read_b64_tr_b16 v[204:205], v10 offset:27776
    ds_read_b64_tr_b16 v[206:207], v10 offset:32384
    s_waitcnt lgkmcnt(12)
    v_mfma_f32_16x16x32_bf16 v[48:51], v[176:179], a[0:3], v[48:51]
    ds_read_b64_tr_b16 v[208:209], v9 offset:160
    ds_read_b64_tr_b16 v[210:211], v9 offset:4768
    v_mfma_f32_16x16x32_bf16 v[48:51], v[180:183], a[16:19], v[48:51]
    ds_read_b64_tr_b16 v[212:213], v9 offset:9376
    ds_read_b64_tr_b16 v[214:215], v9 offset:13984
    s_waitcnt lgkmcnt(12)
    v_mfma_f32_16x16x32_bf16 v[48:51], v[184:187], a[32:35], v[48:51]
    ds_read_b64_tr_b16 v[216:217], v9 offset:18592
    ds_read_b64_tr_b16 v[218:219], v9 offset:23200
    v_mfma_f32_16x16x32_bf16 v[48:51], v[188:191], a[48:51], v[48:51]
    ds_read_b64_tr_b16 v[220:221], v9 offset:27808
    ds_read_b64_tr_b16 v[222:223], v9 offset:32416
    s_waitcnt lgkmcnt(12)
    v_mfma_f32_16x16x32_bf16 v[48:51], v[192:195], a[64:67], v[48:51]
    ds_read_b64_tr_b16 v[160:161], v8 offset:37024
    ds_read_b64_tr_b16 v[162:163], v8 offset:41632
    v_mfma_f32_16x16x32_bf16 v[48:51], v[196:199], a[80:83], v[48:51]
    ds_read_b64_tr_b16 v[164:165], v9 offset:37024
    ds_read_b64_tr_b16 v[166:167], v9 offset:41632
    s_waitcnt lgkmcnt(12)
    v_mfma_f32_16x16x32_bf16 v[48:51], v[200:203], a[96:99], v[48:51]
    ds_read_b64_tr_b16 v[168:169], v9 offset:46240
    ds_read_b64_tr_b16 v[170:171], v9 offset:50848
    v_mfma_f32_16x16x32_bf16 v[48:51], v[204:207], a[112:115], v[48:51]
    ds_read_b64_tr_b16 v[172:173], v9 offset:55456
    ds_read_b64_tr_b16 v[174:175], v9 offset:60064
    s_waitcnt lgkmcnt(12)
    v_mfma_f32_16x16x32_bf16 v[52:55], v[208:211], v[240:243], v[52:55]
    ds_read_b64_tr_b16 v[176:177], v10 offset:160
    ds_read_b64_tr_b16 v[178:179], v10 offset:4768
    v_mfma_f32_16x16x32_bf16 v[52:55], v[212:215], v[244:247], v[52:55]
    ds_read_b64_tr_b16 v[180:181], v10 offset:9376
    ds_read_b64_tr_b16 v[182:183], v10 offset:13984
    s_waitcnt lgkmcnt(12)
    v_mfma_f32_16x16x32_bf16 v[52:55], v[216:219], v[248:251], v[52:55]
    ds_read_b64_tr_b16 v[184:185], v10 offset:18592
    ds_read_b64_tr_b16 v[186:187], v10 offset:23200
    v_mfma_f32_16x16x32_bf16 v[52:55], v[220:223], v[252:255], v[52:55]
    ds_read_b64_tr_b16 v[188:189], v10 offset:27808
    ds_read_b64_tr_b16 v[190:191], v10 offset:32416
    s_waitcnt lgkmcnt(12)
    v_mfma_f32_16x16x32_bf16 v[52:55], v[160:163], a[0:3], v[52:55]
    ds_read_b64_tr_b16 v[192:193], v9 offset:192
    ds_read_b64_tr_b16 v[194:195], v9 offset:4800
    v_mfma_f32_16x16x32_bf16 v[52:55], v[164:167], a[16:19], v[52:55]
    ds_read_b64_tr_b16 v[196:197], v9 offset:9408
    ds_read_b64_tr_b16 v[198:199], v9 offset:14016
    s_waitcnt lgkmcnt(12)
    v_mfma_f32_16x16x32_bf16 v[52:55], v[168:171], a[32:35], v[52:55]
    ds_read_b64_tr_b16 v[200:201], v9 offset:18624
    ds_read_b64_tr_b16 v[202:203], v9 offset:23232
    v_mfma_f32_16x16x32_bf16 v[52:55], v[172:175], a[48:51], v[52:55]
    ds_read_b64_tr_b16 v[204:205], v9 offset:27840
    ds_read_b64_tr_b16 v[206:207], v9 offset:32448
    s_waitcnt lgkmcnt(12)
    v_mfma_f32_16x16x32_bf16 v[52:55], v[176:179], a[64:67], v[52:55]
    ds_read_b64_tr_b16 v[208:209], v8 offset:37056
    ds_read_b64_tr_b16 v[210:211], v8 offset:41664
    v_mfma_f32_16x16x32_bf16 v[52:55], v[180:183], a[80:83], v[52:55]
    ds_read_b64_tr_b16 v[212:213], v9 offset:37056
    ds_read_b64_tr_b16 v[214:215], v9 offset:41664
    s_waitcnt lgkmcnt(12)
    v_mfma_f32_16x16x32_bf16 v[52:55], v[184:187], a[96:99], v[52:55]
    ds_read_b64_tr_b16 v[216:217], v9 offset:46272
    ds_read_b64_tr_b16 v[218:219], v9 offset:50880
    v_mfma_f32_16x16x32_bf16 v[52:55], v[188:191], a[112:115], v[52:55]
    ds_read_b64_tr_b16 v[220:221], v9 offset:55488
    ds_read_b64_tr_b16 v[222:223], v9 offset:60096
    s_waitcnt lgkmcnt(12)
    v_mfma_f32_16x16x32_bf16 v[56:59], v[192:195], v[240:243], v[56:59]
    ds_read_b64_tr_b16 v[160:161], v10 offset:192
    ds_read_b64_tr_b16 v[162:163], v10 offset:4800
    v_mfma_f32_16x16x32_bf16 v[56:59], v[196:199], v[244:247], v[56:59]
    ds_read_b64_tr_b16 v[164:165], v10 offset:9408
    ds_read_b64_tr_b16 v[166:167], v10 offset:14016
    s_waitcnt lgkmcnt(12)
    v_mfma_f32_16x16x32_bf16 v[56:59], v[200:203], v[248:251], v[56:59]
    ds_read_b64_tr_b16 v[168:169], v10 offset:18624
    ds_read_b64_tr_b16 v[170:171], v10 offset:23232
    v_mfma_f32_16x16x32_bf16 v[56:59], v[204:207], v[252:255], v[56:59]
    ds_read_b64_tr_b16 v[172:173], v10 offset:27840
    ds_read_b64_tr_b16 v[174:175], v10 offset:32448
    s_waitcnt lgkmcnt(12)
    v_mfma_f32_16x16x32_bf16 v[56:59], v[208:211], a[0:3], v[56:59]
    ds_read_b64_tr_b16 v[176:177], v9 offset:224
    ds_read_b64_tr_b16 v[178:179], v9 offset:4832
    v_mfma_f32_16x16x32_bf16 v[56:59], v[212:215], a[16:19], v[56:59]
    ds_read_b64_tr_b16 v[180:181], v9 offset:9440
    ds_read_b64_tr_b16 v[182:183], v9 offset:14048
    s_waitcnt lgkmcnt(12)
    v_mfma_f32_16x16x32_bf16 v[56:59], v[216:219], a[32:35], v[56:59]
    ds_read_b64_tr_b16 v[184:185], v9 offset:18656
    ds_read_b64_tr_b16 v[186:187], v9 offset:23264
    v_mfma_f32_16x16x32_bf16 v[56:59], v[220:223], a[48:51], v[56:59]
    ds_read_b64_tr_b16 v[188:189], v9 offset:27872
    ds_read_b64_tr_b16 v[190:191], v9 offset:32480
    s_waitcnt lgkmcnt(12)
    v_mfma_f32_16x16x32_bf16 v[56:59], v[160:163], a[64:67], v[56:59]
    ds_read_b64_tr_b16 v[192:193], v8 offset:37088
    ds_read_b64_tr_b16 v[194:195], v8 offset:41696
    v_mfma_f32_16x16x32_bf16 v[56:59], v[164:167], a[80:83], v[56:59]
    ds_read_b64_tr_b16 v[196:197], v9 offset:37088
    ds_read_b64_tr_b16 v[198:199], v9 offset:41696
    s_waitcnt lgkmcnt(12)
    v_mfma_f32_16x16x32_bf16 v[56:59], v[168:171], a[96:99], v[56:59]
    ds_read_b64_tr_b16 v[200:201], v9 offset:46304
    ds_read_b64_tr_b16 v[202:203], v9 offset:50912
    v_mfma_f32_16x16x32_bf16 v[56:59], v[172:175], a[112:115], v[56:59]
    ds_read_b64_tr_b16 v[204:205], v9 offset:55520
    ds_read_b64_tr_b16 v[206:207], v9 offset:60128
    s_waitcnt lgkmcnt(12)
    v_mfma_f32_16x16x32_bf16 v[60:63], v[176:179], v[240:243], v[60:63]
    ds_read_b64_tr_b16 v[208:209], v10 offset:224
    ds_read_b64_tr_b16 v[210:211], v10 offset:4832
    v_mfma_f32_16x16x32_bf16 v[60:63], v[180:183], v[244:247], v[60:63]
    ds_read_b64_tr_b16 v[212:213], v10 offset:9440
    ds_read_b64_tr_b16 v[214:215], v10 offset:14048
    s_waitcnt lgkmcnt(12)
    v_mfma_f32_16x16x32_bf16 v[60:63], v[184:187], v[248:251], v[60:63]
    ds_read_b64_tr_b16 v[216:217], v10 offset:18656
    ds_read_b64_tr_b16 v[218:219], v10 offset:23264
    v_mfma_f32_16x16x32_bf16 v[60:63], v[188:191], v[252:255], v[60:63]
    ds_read_b64_tr_b16 v[220:221], v10 offset:27872
    ds_read_b64_tr_b16 v[222:223], v10 offset:32480
    s_waitcnt lgkmcnt(12)
    v_mfma_f32_16x16x32_bf16 v[60:63], v[192:195], a[0:3], v[60:63]
    ds_read_b64_tr_b16 v[160:161], v9 offset:256
    ds_read_b64_tr_b16 v[162:163], v9 offset:4864
    v_mfma_f32_16x16x32_bf16 v[60:63], v[196:199], a[16:19], v[60:63]
    ds_read_b64_tr_b16 v[164:165], v9 offset:9472
    ds_read_b64_tr_b16 v[166:167], v9 offset:14080
    s_waitcnt lgkmcnt(12)
    v_mfma_f32_16x16x32_bf16 v[60:63], v[200:203], a[32:35], v[60:63]
    ds_read_b64_tr_b16 v[168:169], v9 offset:18688
    ds_read_b64_tr_b16 v[170:171], v9 offset:23296
    v_mfma_f32_16x16x32_bf16 v[60:63], v[204:207], a[48:51], v[60:63]
    ds_read_b64_tr_b16 v[172:173], v9 offset:27904
    ds_read_b64_tr_b16 v[174:175], v9 offset:32512
    s_waitcnt lgkmcnt(12)
    v_mfma_f32_16x16x32_bf16 v[60:63], v[208:211], a[64:67], v[60:63]
    ds_read_b64_tr_b16 v[176:177], v8 offset:37120
    ds_read_b64_tr_b16 v[178:179], v8 offset:41728
    v_mfma_f32_16x16x32_bf16 v[60:63], v[212:215], a[80:83], v[60:63]
    ds_read_b64_tr_b16 v[180:181], v9 offset:37120
    ds_read_b64_tr_b16 v[182:183], v9 offset:41728
    s_waitcnt lgkmcnt(12)
    v_mfma_f32_16x16x32_bf16 v[60:63], v[216:219], a[96:99], v[60:63]
    ds_read_b64_tr_b16 v[184:185], v9 offset:46336
    ds_read_b64_tr_b16 v[186:187], v9 offset:50944
    v_mfma_f32_16x16x32_bf16 v[60:63], v[220:223], a[112:115], v[60:63]
    ds_read_b64_tr_b16 v[188:189], v9 offset:55552
    ds_read_b64_tr_b16 v[190:191], v9 offset:60160
    s_waitcnt lgkmcnt(12)
    v_mfma_f32_16x16x32_bf16 v[64:67], v[160:163], v[240:243], v[64:67]
    ds_read_b64_tr_b16 v[192:193], v10 offset:256
    ds_read_b64_tr_b16 v[194:195], v10 offset:4864
    v_mfma_f32_16x16x32_bf16 v[64:67], v[164:167], v[244:247], v[64:67]
    ds_read_b64_tr_b16 v[196:197], v10 offset:9472
    ds_read_b64_tr_b16 v[198:199], v10 offset:14080
    s_waitcnt lgkmcnt(12)
    v_mfma_f32_16x16x32_bf16 v[64:67], v[168:171], v[248:251], v[64:67]
    ds_read_b64_tr_b16 v[200:201], v10 offset:18688
    ds_read_b64_tr_b16 v[202:203], v10 offset:23296
    v_mfma_f32_16x16x32_bf16 v[64:67], v[172:175], v[252:255], v[64:67]
    ds_read_b64_tr_b16 v[204:205], v10 offset:27904
    ds_read_b64_tr_b16 v[206:207], v10 offset:32512
    s_waitcnt lgkmcnt(12)
    v_mfma_f32_16x16x32_bf16 v[64:67], v[176:179], a[0:3], v[64:67]
    v_mfma_f32_16x16x32_bf16 v[64:67], v[180:183], a[16:19], v[64:67]
    s_waitcnt lgkmcnt(8)
    v_mfma_f32_16x16x32_bf16 v[64:67], v[184:187], a[32:35], v[64:67]
    v_mfma_f32_16x16x32_bf16 v[64:67], v[188:191], a[48:51], v[64:67]
    s_waitcnt lgkmcnt(4)
    v_mfma_f32_16x16x32_bf16 v[64:67], v[192:195], a[64:67], v[64:67]
    v_mfma_f32_16x16x32_bf16 v[64:67], v[196:199], a[80:83], v[64:67]
    s_waitcnt lgkmcnt(0)
    v_mfma_f32_16x16x32_bf16 v[64:67], v[200:203], a[96:99], v[64:67]
    v_mfma_f32_16x16x32_bf16 v[64:67], v[204:207], a[112:115], v[64:67]
    s_cmp_ge_u32 s60, 1
    s_cbranch_scc1 L_have
    buffer_load_dwordx4 v[2:5], off, s[68:71], s91 sc1
    s_waitcnt vmcnt(0)
    v_min3_u32 v2, v2, v3, v4
    v_min_u32 v2, v2, v5
    s_nop 0
    v_readfirstlane_b32 s3, v2
    s_cmp_ge_u32 s3, 1
    s_cbranch_scc0 L_spinC
L_backC:
    buffer_load_dwordx4 v[68:71], v12, s[64:67], s61 offen offset:0 sc1
    buffer_load_dwordx4 v[72:75], v12, s[64:67], s62 offen offset:0 sc1
    buffer_load_dwordx4 v[76:79], v12, s[64:67], s63 offen offset:0 sc1
    buffer_load_dwordx4 v[80:83], v12, s[64:67], s61 offen offset:1024 sc1
    buffer_load_dwordx4 v[84:87], v12, s[64:67], s62 offen offset:1024 sc1
    buffer_load_dwordx4 v[88:91], v12, s[64:67], s63 offen offset:1024 sc1
    buffer_load_dwordx4 v[92:95], v12, s[64:67], s61 offen offset:2048 sc1
    buffer_load_dwordx4 v[96:99], v12, s[64:67], s62 offen offset:2048 sc1
    buffer_load_dwordx4 v[100:103], v12, s[64:67], s63 offen offset:2048 sc1
    buffer_load_dwordx4 v[104:107], v12, s[64:67], s61 offen offset:3072 sc1
    buffer_load_dwordx4 v[108:111], v12, s[64:67], s62 offen offset:3072 sc1
    buffer_load_dwordx4 v[112:115], v12, s[64:67], s63 offen offset:3072 sc1
    buffer_load_dwordx2 v[116:117], v13, s[64:67], s61 offen sc1
    buffer_load_dwordx2 v[120:121], v13, s[64:67], s62 offen sc1
    buffer_load_dwordx2 v[124:125], v13, s[64:67], s63 offen sc1
L_have:
    s_mov_b32 s4, 0x3f80
    s_mov_b32 s5, 0x3f800000
    s_waitcnt vmcnt(12)
    v_dot2c_f32_bf16 v32, s4, v68
    v_dot2c_f32_bf16 v33, s5, v68
    v_dot2c_f32_bf16 v34, s4, v69
    v_dot2c_f32_bf16 v35, s5, v69
    v_dot2c_f32_bf16 v36, s4, v70
    v_dot2c_f32_bf16 v37, s5, v70
    v_dot2c_f32_bf16 v38, s4, v71
    v_dot2c_f32_bf16 v39, s5, v71
    v_dot2c_f32_bf16 v32, s4, v72
    v_dot2c_f32_bf16 v33, s5, v72
    v_dot2c_f32_bf16 v34, s4, v73
    v_dot2c_f32_bf16 v35, s5, v73
    v_dot2c_f32_bf16 v36, s4, v74
    v_dot2c_f32_bf16 v37, s5, v74
    v_dot2c_f32_bf16 v38, s4, v75
    v_dot2c_f32_bf16 v39, s5, v75
    v_dot2c_f32_bf16 v32, s4, v76
    v_dot2c_f32_bf16 v33, s5, v76
    v_dot2c_f32_bf16 v34, s4, v77
    v_dot2c_f32_bf16 v35, s5, v77
    v_dot2c_f32_bf16 v36, s4, v78
    v_dot2c_f32_bf16 v37, s5, v78
    v_dot2c_f32_bf16 v38, s4, v79
    v_dot2c_f32_bf16 v39, s5, v79
    s_nop 1
    v_cvt_pk_bf16_f32 v180, v32, v33
    v_cvt_pk_bf16_f32 v181, v34, v35
    v_cvt_pk_bf16_f32 v182, v36, v37
    v_cvt_pk_bf16_f32 v183, v38, v39
    s_nop 1
    v_permlane16_swap_b32 v180, v182
    v_permlane16_swap_b32 v181, v183
    buffer_store_dwordx4 v[180:183], v15, s[76:79], 0 offen offset:0
    s_waitcnt vmcnt(10)
    v_dot2c_f32_bf16 v40, s4, v80
    v_dot2c_f32_bf16 v41, s5, v80
    v_dot2c_f32_bf16 v42, s4, v81
    v_dot2c_f32_bf16 v43, s5, v81
    v_dot2c_f32_bf16 v44, s4, v82
    v_dot2c_f32_bf16 v45, s5, v82
    v_dot2c_f32_bf16 v46, s4, v83
    v_dot2c_f32_bf16 v47, s5, v83
    v_dot2c_f32_bf16 v40, s4, v84
    v_dot2c_f32_bf16 v41, s5, v84
    v_dot2c_f32_bf16 v42, s4, v85
    v_dot2c_f32_bf16 v43, s5, v85
    v_dot2c_f32_bf16 v44, s4, v86
    v_dot2c_f32_bf16 v45, s5, v86
    v_dot2c_f32_bf16 v46, s4, v87
    v_dot2c_f32_bf16 v47, s5, v87
    v_dot2c_f32_bf16 v40, s4, v88
    v_dot2c_f32_bf16 v41, s5, v88
    v_dot2c_f32_bf16 v42, s4, v89
    v_dot2c_f32_bf16 v43, s5, v89
    v_dot2c_f32_bf16 v44, s4, v90
    v_dot2c_f32_bf16 v45, s5, v90
    v_dot2c_f32_bf16 v46, s4, v91
    v_dot2c_f32_bf16 v47, s5, v91
    s_nop 1
    v_cvt_pk_bf16_f32 v184, v40, v41
    v_cvt_pk_bf16_f32 v185, v42, v43
    v_cvt_pk_bf16_f32 v186, v44, v45
    v_cvt_pk_bf16_f32 v187, v46, v47
    s_nop 1
    v_permlane16_swap_b32 v184, v186
    v_permlane16_swap_b32 v185, v187
    buffer_store_dwordx4 v[184:187], v15, s[76:79], 0 offen offset:64
    s_waitcnt vmcnt(8)
    v_dot2c_f32_bf16 v48, s4, v92
    v_dot2c_f32_bf16 v49, s5, v92
    v_dot2c_f32_bf16 v50, s4, v93
    v_dot2c_f32_bf16 v51, s5, v93
    v_dot2c_f32_bf16 v52, s4, v94
    v_dot2c_f32_bf16 v53, s5, v94
    v_dot2c_f32_bf16 v54, s4, v95
    v_dot2c_f32_bf16 v55, s5, v95
    v_dot2c_f32_bf16 v48, s4, v96
    v_dot2c_f32_bf16 v49, s5, v96
    v_dot2c_f32_bf16 v50, s4, v97
    v_dot2c_f32_bf16 v51, s5, v97
    v_dot2c_f32_bf16 v52, s4, v98
    v_dot2c_f32_bf16 v53, s5, v98
    v_dot2c_f32_bf16 v54, s4, v99
    v_dot2c_f32_bf16 v55, s5, v99
    v_dot2c_f32_bf16 v48, s4, v100
    v_dot2c_f32_bf16 v49, s5, v100
    v_dot2c_f32_bf16 v50, s4, v101
    v_dot2c_f32_bf16 v51, s5, v101
    v_dot2c_f32_bf16 v52, s4, v102
    v_dot2c_f32_bf16 v53, s5, v102
    v_dot2c_f32_bf16 v54, s4, v103
    v_dot2c_f32_bf16 v55, s5, v103
    s_nop 1
    v_cvt_pk_bf16_f32 v188, v48, v49
    v_cvt_pk_bf16_f32 v189, v50, v51
    v_cvt_pk_bf16_f32 v190, v52, v53
    v_cvt_pk_bf16_f32 v191, v54, v55
    s_nop 1
    v_permlane16_swap_b32 v188, v190
    v_permlane16_swap_b32 v189, v191
    buffer_store_dwordx4 v[188:191], v15, s[76:79], 0 offen offset:128
    s_waitcnt vmcnt(6)
    v_dot2c_f32_bf16 v56, s4, v104
    v_dot2c_f32_bf16 v57, s5, v104
    v_dot2c_f32_bf16 v58, s4, v105
    v_dot2c_f32_bf16 v59, s5, v105
    v_dot2c_f32_bf16 v60, s4, v106
    v_dot2c_f32_bf16 v61, s5, v106
    v_dot2c_f32_bf16 v62, s4, v107
    v_dot2c_f32_bf16 v63, s5, v107
    v_dot2c_f32_bf16 v56, s4, v108
    v_dot2c_f32_bf16 v57, s5, v108
    v_dot2c_f32_bf16 v58, s4, v109
    v_dot2c_f32_bf16 v59, s5, v109
    v_dot2c_f32_bf16 v60, s4, v110
    v_dot2c_f32_bf16 v61, s5, v110
    v_dot2c_f32_bf16 v62, s4, v111
    v_dot2c_f32_bf16 v63, s5, v111
    v_dot2c_f32_bf16 v56, s4, v112
    v_dot2c_f32_bf16 v57, s5, v112
    v_dot2c_f32_bf16 v58, s4, v113
    v_dot2c_f32_bf16 v59, s5, v113
    v_dot2c_f32_bf16 v60, s4, v114
    v_dot2c_f32_bf16 v61, s5, v114
    v_dot2c_f32_bf16 v62, s4, v115
    v_dot2c_f32_bf16 v63, s5, v115
    s_nop 1
    v_cvt_pk_bf16_f32 v192, v56, v57
    v_cvt_pk_bf16_f32 v193, v58, v59
    v_cvt_pk_bf16_f32 v194, v60, v61
    v_cvt_pk_bf16_f32 v195, v62, v63
    s_nop 1
    v_permlane16_swap_b32 v192, v194
    v_permlane16_swap_b32 v193, v195
    buffer_store_dwordx4 v[192:195], v15, s[76:79], 0 offen offset:192
    s_waitcnt vmcnt(4)
    v_dot2c_f32_bf16 v64, s4, v116
    v_dot2c_f32_bf16 v65, s5, v116
    v_dot2c_f32_bf16 v66, s4, v117
    v_dot2c_f32_bf16 v67, s5, v117
    v_dot2c_f32_bf16 v64, s4, v120
    v_dot2c_f32_bf16 v65, s5, v120
    v_dot2c_f32_bf16 v66, s4, v121
    v_dot2c_f32_bf16 v67, s5, v121
    v_dot2c_f32_bf16 v64, s4, v124
    v_dot2c_f32_bf16 v65, s5, v124
    v_dot2c_f32_bf16 v66, s4, v125
    v_dot2c_f32_bf16 v67, s5, v125
    s_nop 1
    v_cvt_pk_bf16_f32 v196, v64, v65
    v_cvt_pk_bf16_f32 v197, v66, v67
    buffer_store_dwordx2 v[196:197], v16, s[76:79], 0 offen offset:256
    s_endpgm
L_redo:
    s_mov_b32 s51, 1
    s_mov_b32 s89, 0
    s_waitcnt vmcnt(0) lgkmcnt(0)
    s_barrier
    v_and_b32 v1, 15, v0
    v_lshrrev_b32 v2, 4, v0
    s_mul_i32 s3, s43, 73728
    v_lshrrev_b32 v3, 3, v0
    v_mul_u32_u24 v3, 1152, v3
    v_add_u32 v3, s3, v3
    v_and_b32 v4, 7, v0
    v_xor_b32 v4, v4, v2
    v_lshl_add_u32 v32, v4, 4, v3
    v_xor_b32 v4, 4, v4
    v_lshl_add_u32 v33, v4, 4, v3
    s_add_u32 s3, s52, 3
    s_and_b32 s3, s3, 3
    s_mul_i32 s3, s3, 18432
    s_add_u32 s4, s3, 8192
    v_add_u32 v39, s4, v33
    s_add_u32 s4, s3, 0
    v_add_u32 v38, s4, v32
    s_add_u32 s3, s52, 2
    s_and_b32 s3, s3, 3
    s_mul_i32 s3, s3, 18432
    s_add_u32 s4, s3, 8192
    v_add_u32 v37, s4, v33
    s_add_u32 s4, s3, 0
    v_add_u32 v36, s4, v32
    s_add_u32 s3, s52, 1
    s_and_b32 s3, s3, 3
    s_mul_i32 s3, s3, 18432
    s_add_u32 s4, s3, 8192
    v_add_u32 v35, s4, v33
    s_add_u32 s4, s3, 0
    v_add_u32 v34, s4, v32
    s_add_u32 s3, s52, 0
    s_and_b32 s3, s3, 3
    s_mul_i32 s3, s3, 18432
    s_add_u32 s4, s3, 8192
    v_add_u32 v33, s4, v33
    s_add_u32 s4, s3, 0
    v_add_u32 v32, s4, v32
    s_lshl_b32 s3, s43, 17
    v_lshrrev_b32 v3, 5, v0
    v_lshl_add_u32 v5, v3, 13, s3
    v_and_b32 v4, 31, v0
    v_or_b32 v6, 0, v3
    v_lshlrev_b32 v6, 1, v6
    v_xor_b32 v6, v6, v4
    v_lshl_add_u32 v6, v6, 4, v5
    v_add_u32 v40, 0, v6
    v_or_b32 v6, 2, v3
    v_lshlrev_b32 v6, 1, v6
    v_xor_b32 v6, v6, v4
    v_lshl_add_u32 v6, v6, 4, v5
    v_add_u32 v41, 15360, v6
    v_or_b32 v6, 0, v3
    v_lshlrev_b32 v6, 1, v6
    v_xor_b32 v6, v6, v4
    v_lshl_add_u32 v6, v6, 4, v5
    v_add_u32 v42, 30720, v6
    v_or_b32 v6, 2, v3
    v_lshlrev_b32 v6, 1, v6
    v_xor_b32 v6, v6, v4
    v_lshl_add_u32 v6, v6, 4, v5
    v_add_u32 v43, 46080, v6
    v_or_b32 v6, 4, v3
    v_lshlrev_b32 v6, 1, v6
    v_xor_b32 v6, v6, v4
    v_lshl_add_u32 v6, v6, 4, v5
    v_add_u32 v44, 65536, v6
    v_or_b32 v6, 6, v3
    v_lshlrev_b32 v6, 1, v6
    v_xor_b32 v6, v6, v4
    v_lshl_add_u32 v6, v6, 4, v5
    v_add_u32 v45, 80896, v6
    v_or_b32 v6, 4, v3
    v_lshlrev_b32 v6, 1, v6
    v_xor_b32 v6, v6, v4
    v_lshl_add_u32 v6, v6, 4, v5
    v_add_u32 v46, 96256, v6
    v_or_b32 v6, 6, v3
    v_lshlrev_b32 v6, 1, v6
    v_xor_b32 v6, v6, v4
    v_lshl_add_u32 v6, v6, 4, v5
    v_add_u32 v47, 111616, v6
    s_mul_i32 s3, s53, 60
    s_mul_i32 s4, s43, 15
    s_add_u32 s3, s3, s4
    s_mul_i32 s3, s3, 1152
    v_mul_u32_u24 v4, 1152, v0
    v_cmp_gt_u32 vcc, 15, v0
    v_add_u32 v4, s3, v4
    v_add_u32 v5, 4294950144, v4
    v_cndmask_b32 v4, v5, v4, vcc
    v_cmp_gt_u32 vcc, 30, v0
    v_bfrev_b32 v6, 1
    s_lshl_b32 s3, s42, 2
    v_cndmask_b32 v28, v6, v4, vcc
    s_add_u32 s3, s3, s43
    s_lshl_b32 s3, s3, 14
    v_and_b32 v5, 3, v0
    v_lshl_add_u32 v5, v5, 7, s3
    v_bfe_u32 v3, v0, 2, 1
    v_lshl_add_u32 v5, v3, 13, v5
    v_cmp_gt_u32 vcc, 16, v0
    v_lshrrev_b32 v3, 3, v0
    v_lshl_add_u32 v5, v3, 19, v5
    v_cndmask_b32 v26, v6, v5, vcc
    s_mov_b32 s46, 0
    s_mov_b32 s47, 0
    s_mov_b32 s3, 0
    s_mov_b32 s4, 0
    buffer_load_dword v29, v28, s[16:19], s3 offen nt
    buffer_load_dword v29, v26, s[20:23], s4 offen nt
    s_add_u32 m0, s48, 32768
    s_nop 0
    buffer_load_dwordx4 v32, s[16:19], s46 offen offset:0 lds
    buffer_load_dwordx4 v33, s[16:19], s46 offen offset:1024 lds
    s_add_u32 m0, s48, 34816
    s_nop 0
    buffer_load_dwordx4 v34, s[16:19], s46 offen offset:0 lds
    buffer_load_dwordx4 v35, s[16:19], s46 offen offset:1024 lds
    s_add_u32 m0, s48, 36864
    s_nop 0
    buffer_load_dwordx4 v36, s[16:19], s46 offen offset:0 lds
    buffer_load_dwordx4 v37, s[16:19], s46 offen offset:1024 lds
    s_add_u32 m0, s48, 38912
    s_nop 0
    buffer_load_dwordx4 v38, s[16:19], s46 offen offset:0 lds
    buffer_load_dwordx4 v39, s[16:19], s46 offen offset:1024 lds
    s_add_u32 s46, s46, 128
    s_add_u32 m0, s48, 98304
    s_nop 0
    buffer_load_dwordx4 v40, s[20:23], s47 offen offset:0 lds
    buffer_load_dwordx4 v41, s[20:23], s47 offen offset:1024 lds
    buffer_load_dwordx4 v42, s[20:23], s47 offen offset:2048 lds
    buffer_load_dwordx4 v43, s[20:23], s47 offen offset:3072 lds
    s_add_u32 m0, s48, 102400
    s_nop 0
    buffer_load_dwordx4 v44, s[20:23], s47 offen offset:0 lds
    buffer_load_dwordx4 v45, s[20:23], s47 offen offset:1024 lds
    buffer_load_dwordx4 v46, s[20:23], s47 offen offset:2048 lds
    buffer_load_dwordx4 v47, s[20:23], s47 offen offset:3072 lds
    s_add_u32 s47, s47, 524288
    s_branch L_go
L_spinD:
    s_mov_b32 s4, 0
L_spD:
    buffer_load_dword v7, off, s[72:75], 0 sc1
    s_waitcnt vmcnt(0)
    v_readfirstlane_b32 s3, v7
    s_cmp_ge_u32 s3, 256
    s_cbranch_scc1 L_backD
    s_add_u32 s4, s4, 1
    s_cmp_lt_u32 s4, 32768
    s_cbranch_scc1 L_spD
    s_branch L_backD
L_spinA1:
    s_mov_b32 s4, 0
L_spA1:
    buffer_load_dwordx4 v[2:5], off, s[68:71], s90 sc1
    s_waitcnt vmcnt(0)
    v_min3_u32 v2, v2, v3, v4
    v_min_u32 v2, v2, v5
    s_nop 0
    v_readfirstlane_b32 s3, v2
    s_cmp_ge_u32 s3, 1
    s_cbranch_scc1 L_backA1
    s_add_u32 s4, s4, 1
    s_cmp_lt_u32 s4, 32768
    s_cbranch_scc1 L_spA1
    s_branch L_backA1
L_spinA2:
    s_mov_b32 s4, 0
L_spA2:
    buffer_load_dwordx4 v[2:5], off, s[68:71], s90 sc1
    s_waitcnt vmcnt(0)
    v_min3_u32 v2, v2, v3, v4
    v_min_u32 v2, v2, v5
    s_nop 0
    v_readfirstlane_b32 s3, v2
    s_cmp_ge_u32 s3, 2
    s_cbranch_scc1 L_backA2
    s_add_u32 s4, s4, 1
    s_cmp_lt_u32 s4, 32768
    s_cbranch_scc1 L_spA2
    s_branch L_backA2
L_spinB1:
    s_mov_b32 s4, 0
L_spB1:
    buffer_load_dwordx4 v[2:5], off, s[68:71], s90 sc1
    s_waitcnt vmcnt(0)
    v_min3_u32 v2, v2, v3, v4
    v_min_u32 v2, v2, v5
    s_nop 0
    v_readfirstlane_b32 s3, v2
    s_cmp_ge_u32 s3, 3
    s_cbranch_scc1 L_backB1
    s_add_u32 s4, s4, 1
    s_cmp_lt_u32 s4, 32768
    s_cbranch_scc1 L_spB1
    s_branch L_backB1
L_spinB2:
    s_mov_b32 s4, 0
L_spB2:
    buffer_load_dwordx4 v[2:5], off, s[68:71], s90 sc1
    s_waitcnt vmcnt(0)
    v_min3_u32 v2, v2, v3, v4
    v_min_u32 v2, v2, v5
    s_nop 0
    v_readfirstlane_b32 s3, v2
    s_cmp_ge_u32 s3, 4
    s_cbranch_scc1 L_backB2
    s_add_u32 s4, s4, 1
    s_cmp_lt_u32 s4, 32768
    s_cbranch_scc1 L_spB2
    s_branch L_backB2
L_spinC:
    s_mov_b32 s4, 0
L_spC:
    buffer_load_dwordx4 v[2:5], off, s[68:71], s91 sc1
    s_waitcnt vmcnt(0)
    v_min3_u32 v2, v2, v3, v4
    v_min_u32 v2, v2, v5
    s_nop 0
    v_readfirstlane_b32 s3, v2
    s_cmp_ge_u32 s3, 1
    s_cbranch_scc1 L_backC
    s_add_u32 s4, s4, 1
    s_cmp_lt_u32 s4, 32768
    s_cbranch_scc1 L_spC
    s_branch L_backC
L_end:
    s_endpgm
.section .rodata,"a"
.p2align 6
.amdhsa_kernel concat_heads__mha_block_cached__gqa_block_cached__near_ridge_kernel
  .amdhsa_next_free_vgpr 512
  .amdhsa_next_free_sgpr 102
  .amdhsa_accum_offset 256
  .amdhsa_group_segment_fixed_size 0
  .amdhsa_kernarg_size 104
  .amdhsa_user_sgpr_count 2
  .amdhsa_user_sgpr_kernarg_segment_ptr 1
  .amdhsa_system_sgpr_workgroup_id_x 1
.end_amdhsa_kernel
```
